```python
import torch

def _softmax(x, axis=-1):
    return torch.softmax(x, dim=axis)

def _gelu(x):
    return torch.nn.functional.gelu(x, approximate='tanh')

def _silu(x):
    return torch.nn.functional.silu(x)

def _sigmoid(x):
    return torch.sigmoid(x)

def _layernorm(x, axis=-1, eps=1e-05):
    m = x.mean(dim=axis, keepdim=True)
    v = x.var(dim=axis, keepdim=True, unbiased=False)
    return (x - m) / torch.sqrt(v + eps)

def _scatter_add(tgt, idx, src, axis=0):
    return tgt.clone().index_add_(axis, idx, src)

def _segment_sum(src, seg, n):
    out = torch.zeros((n,) + src.shape[1:], dtype=src.dtype)
    return out.index_add_(0, seg, src)

def _pad(x, pw):
    flat = tuple((v for pair in reversed(pw) for v in pair))
    return torch.nn.functional.pad(x, flat)
kernel_name = 'recurrent_scan__mha_block_cached__mixer_gmlp__prompt'

def setup_inputs():

    _w = lambda a: (lambda t: t.to(torch.bfloat16) if t.is_floating_point() else t)(torch.as_tensor(a))

    def _A_setup():
        B, Sq, D = (1, 2048, 1024)
        H, Sk, Dh = (32, 2048, 128)
        return {'x': _w((lambda *s: torch.randn(*s, dtype=torch.bfloat16) * 0.05)(B, Sq, D)), 'k_cache': _w((lambda *s: torch.randn(*s, dtype=torch.bfloat16) * 0.8)(B, H, Sk, Dh)), 'v_cache': _w((lambda *s: torch.randn(*s, dtype=torch.bfloat16) * 0.2)(B, H, Sk, Dh)), 'wq': _w((lambda *s: torch.randn(*s, dtype=torch.bfloat16) * 0.8)(D, H * Dh) * D ** (-0.5)), 'wo': _w((lambda *s: torch.randn(*s, dtype=torch.bfloat16) * 0.2)(H * Dh, D) * (H * Dh) ** (-0.5))}
    _A_in = _A_setup()

    def _B_setup():
        B, S, D, F = (1, 2048, 1024, 3584)
        Fh = F // 2
        return {'x': _w((lambda *s: torch.randn(*s, dtype=torch.bfloat16) * 0.05)(B, S, D)), 'w_in': _w((lambda *s: torch.randn(*s, dtype=torch.bfloat16) * 0.4)(D, 2 * Fh)), 'w_sp': _w(0.01 * (lambda *s: torch.randn(*s, dtype=torch.bfloat16) * 0.4)(S, S)), 'b_sp': _w(1.0 + 0.01 * (lambda *s: torch.randn(*s, dtype=torch.bfloat16) * 0.1)(S)), 'w_out': _w((lambda *s: torch.randn(*s, dtype=torch.bfloat16) * 0.1)(Fh, D))}
    _B_in = _B_setup()
    return {'A_x': _A_in['x'], 'A_k_cache': _A_in['k_cache'], 'A_v_cache': _A_in['v_cache'], 'A_wq': _A_in['wq'], 'A_wo': _A_in['wo'], 'B_x': _B_in['x'], 'B_w_in': _B_in['w_in'], 'B_w_sp': _B_in['w_sp'], 'B_b_sp': _B_in['b_sp'], 'B_w_out': _B_in['w_out']}

def reference(A_x, A_k_cache, A_v_cache, A_wq, A_wo, B_x, B_w_in, B_w_sp, B_b_sp, B_w_out):

    def _A_ref(x, k_cache, v_cache, wq, wo):
        B, Sq, D = x.shape
        H, Dh = (32, 128)
        q = (lambda x, *d: x.permute(*d))((x @ wq).reshape(B, Sq, H, Dh), 0, 2, 1, 3)
        scores = torch.einsum('bhqd,bhkd->bhqk', q, k_cache) * Dh ** (-0.5)
        p = _softmax(scores, axis=-1)
        o = torch.einsum('bhqk,bhkd->bhqd', p, v_cache)
        return (lambda x, *d: x.permute(*d))(o, 0, 2, 1, 3).reshape(B, Sq, H * Dh) @ wo

    def _B_ref(x, w_in, w_sp, b_sp, w_out):
        B, S, D = x.shape
        F = w_in.shape[-1]
        Fh = F // 2
        z = _gelu(torch.einsum('bsd,df->bsf', x, w_in))
        z1 = z[..., :Fh].clone()
        z2 = _layernorm(z[..., Fh:], axis=-1)
        g = torch.einsum('ts,bsf->btf', w_sp, z2) + b_sp[None, :, None]
        return torch.einsum('bsf,fd->bsd', z1 * g, w_out)
    x = A_x
    xn = _layernorm(x, axis=-1)
    s = _A_ref(xn, A_k_cache, A_v_cache, A_wq, A_wo)
    g = _silu(_B_ref(xn, B_w_in, B_w_sp, B_b_sp, B_w_out))
    return x + s * g
```

```asm
; @launch grid=(256,1,1) block=(256,1,1) lds=163840
.amdgcn_target "amdgcn-amd-amdhsa--gfx950"
.text
.globl recurrent_scan__mha_block_cached__mixer_gmlp__prompt_kernel
.p2align 8
.type recurrent_scan__mha_block_cached__mixer_gmlp__prompt_kernel,@function
recurrent_scan__mha_block_cached__mixer_gmlp__prompt_kernel:
f_code0:
    s_cmp_ge_u32 s2, 256
    s_cbranch_scc1 f_end
    s_load_dwordx2 s[62:63], s[0:1], 0
    s_load_dwordx2 s[6:7], s[0:1], 24
    s_load_dwordx2 s[8:9], s[0:1], 48
    s_load_dwordx2 s[10:11], s[0:1], 96
    s_load_dwordx4 s[44:47], s[0:1], 8
    s_load_dwordx2 s[48:49], s[0:1], 56
    s_load_dwordx2 s[50:51], s[0:1], 88
    s_load_dwordx2 s[56:57], s[0:1], 32
    s_load_dwordx2 s[58:59], s[0:1], 72
    v_and_b32 v1, 63, v0
    v_lshrrev_b32 v2, 6, v0
    s_nop 0
    v_readfirstlane_b32 s3, v2
    s_and_b32 s4, s2, 7
    s_lshl_b32 s4, s4, 2
    s_bfe_u32 s5, s2, 0x20003
    s_add_u32 s4, s4, s5
    s_lshr_b32 s5, s2, 5
    s_mov_b32 s33, 0
    v_mov_b32 v10, 0
    v_mov_b32 v11, 131328
    ds_write_b32 v11, v10
    s_waitcnt lgkmcnt(0)
    v_and_b32 v9, 7, v0
    v_bfe_u32 v10, v0, 3, 1
    v_bfe_u32 v11, v0, 4, 2
    v_lshrrev_b32 v12, 6, v0
    v_lshlrev_b32 v13, 11, v9
    v_lshl_add_u32 v13, v12, 9, v13
    v_lshl_add_u32 v13, v10, 6, v13
    v_lshl_add_u32 v13, v11, 4, v13
    s_lshl_b32 s28, s5, 5
    s_add_u32 s28, s28, s4
    s_lshl_b32 s28, s28, 14
    s_mov_b32 s36, s62
    s_mov_b32 s37, s63
    s_mov_b32 s38, 4194304
    s_mov_b32 s39, 0x20000
    buffer_load_dwordx4 v[16:19], v13, s[36:39], s28 offen offset:0
    buffer_load_dwordx4 v[20:23], v13, s[36:39], s28 offen offset:128
    buffer_load_dwordx4 v[24:27], v13, s[36:39], s28 offen offset:256
    buffer_load_dwordx4 v[28:31], v13, s[36:39], s28 offen offset:384
    s_or_b32 s28, s2, s3
    s_cmp_lg_u32 s28, 0
    s_cbranch_scc1 f_nonce
    s_memrealtime s[28:29]
    s_mov_b32 s40, s50
    s_mov_b32 s41, s51
    s_mov_b32 s42, 256
    s_mov_b32 s43, 0x20000
    s_waitcnt lgkmcnt(0)
    s_or_b32 s28, s28, 1
    v_mov_b32 v4, s28
    v_mov_b32 v5, s29
    buffer_store_dwordx2 v[4:5], off, s[40:43], 0 offset:16 sc1
f_nonce:
    s_mov_b32 s12, s6
    s_mov_b32 s13, s7
    s_mov_b32 s14, 8388608
    s_mov_b32 s15, 0x20000
    s_mov_b32 s16, s8
    s_mov_b32 s17, s9
    s_mov_b32 s18, 7340032
    s_mov_b32 s19, 0x20000
    s_lshl_b32 s28, s5, 19
    s_add_u32 s28, s28, 0
    s_add_u32 s20, s10, s28
    s_addc_u32 s21, s11, 0
    s_mov_b32 s22, 524288
    s_mov_b32 s23, 0x20000
    s_add_u32 s24, s10, 4194304
    s_addc_u32 s25, s11, 0
    s_mov_b32 s26, 25165824
    s_mov_b32 s27, 0x20000
    s_mov_b32 s96, s50
    s_mov_b32 s97, s51
    s_mov_b32 s98, 256
    s_mov_b32 s99, 0x20000
    s_lshl_b32 s61, s5, 5
    v_lshrrev_b32 v3, 2, v1
    v_and_b32 v4, 7, v3
    v_lshlrev_b32 v4, 1, v4
    v_bfe_u32 v5, v1, 1, 1
    v_xor_b32 v4, v4, v5
    v_bfe_u32 v3, v1, 2, 2
    v_lshlrev_b32 v3, 8, v3
    v_bfe_u32 v5, v1, 4, 1
    v_lshl_add_u32 v3, v5, 10, v3
    v_lshrrev_b32 v5, 5, v1
    v_lshl_add_u32 v3, v5, 12, v3
    v_and_b32 v5, 1, v1
    v_lshl_add_u32 v3, v5, 3, v3
    v_xor_b32 v5, 0, v4
    v_lshl_add_u32 v152, v5, 4, v3
    v_add_u32 v168, 0x10000, v152
    v_xor_b32 v5, 2, v4
    v_lshl_add_u32 v153, v5, 4, v3
    v_add_u32 v169, 0x10000, v153
    v_xor_b32 v5, 4, v4
    v_lshl_add_u32 v154, v5, 4, v3
    v_add_u32 v170, 0x10000, v154
    v_xor_b32 v5, 6, v4
    v_lshl_add_u32 v155, v5, 4, v3
    v_add_u32 v171, 0x10000, v155
    v_xor_b32 v5, 8, v4
    v_lshl_add_u32 v156, v5, 4, v3
    v_add_u32 v172, 0x10000, v156
    v_xor_b32 v5, 10, v4
    v_lshl_add_u32 v157, v5, 4, v3
    v_add_u32 v173, 0x10000, v157
    v_xor_b32 v5, 12, v4
    v_lshl_add_u32 v158, v5, 4, v3
    v_add_u32 v174, 0x10000, v158
    v_xor_b32 v5, 14, v4
    v_lshl_add_u32 v159, v5, 4, v3
    v_add_u32 v175, 0x10000, v159
    v_lshrrev_b32 v3, 4, v1
    v_and_b32 v4, 15, v1
    s_mul_i32 s28, s3, 65536
    s_mul_i32 s29, s4, 256
    s_add_u32 s28, s28, s29
    v_add_u32 v5, 0, v3
    v_mul_u32_u24 v6, 8192, v5
    v_lshlrev_b32 v5, 1, v5
    v_xor_b32 v5, v5, v4
    v_lshl_add_u32 v5, v5, 4, v6
    v_add_u32 v160, s28, v5
    v_add_u32 v5, 4, v3
    v_mul_u32_u24 v6, 8192, v5
    v_lshlrev_b32 v5, 1, v5
    v_xor_b32 v5, v5, v4
    v_lshl_add_u32 v5, v5, 4, v6
    v_add_u32 v161, s28, v5
    s_mul_i32 s28, s3, 57344
    s_mul_i32 s29, s4, 224
    s_add_u32 s28, s28, s29
    v_add_u32 v5, 0, v3
    v_mul_u32_u24 v6, 7168, v5
    v_lshlrev_b32 v5, 1, v5
    v_xor_b32 v5, v5, v4
    v_lshl_add_u32 v5, v5, 4, v6
    v_add_u32 v162, s28, v5
    v_add_u32 v5, 4, v3
    v_mul_u32_u24 v6, 7168, v5
    v_lshlrev_b32 v5, 1, v5
    v_xor_b32 v5, v5, v4
    v_lshl_add_u32 v5, v5, 4, v6
    v_add_u32 v163, s28, v5
    v_lshlrev_b32 v164, 4, v1
    s_lshl_b32 s52, s3, 12
    s_mov_b32 s30, 4294705152
    s_mov_b32 s31, 4294737920
    s_add_u32 s30, s30, 262144
    s_add_u32 m0, s52, 0
    s_nop 0
    buffer_load_dwordx4 v160, s[12:15], s30 offen lds
    s_add_u32 m0, s52, 1024
    s_nop 0
    buffer_load_dwordx4 v161, s[12:15], s30 offen lds
    s_add_u32 s31, s31, 229376
    s_add_u32 m0, s52, 2048
    s_nop 0
    buffer_load_dwordx4 v162, s[16:19], s31 offen lds
    s_add_u32 m0, s52, 3072
    s_nop 0
    buffer_load_dwordx4 v163, s[16:19], s31 offen lds
    s_add_u32 s30, s30, 262144
    s_add_u32 m0, s52, 16384
    s_nop 0
    buffer_load_dwordx4 v160, s[12:15], s30 offen lds
    s_add_u32 m0, s52, 17408
    s_nop 0
    buffer_load_dwordx4 v161, s[12:15], s30 offen lds
    s_add_u32 s31, s31, 229376
    s_add_u32 m0, s52, 18432
    s_nop 0
    buffer_load_dwordx4 v162, s[16:19], s31 offen lds
    s_add_u32 m0, s52, 19456
    s_nop 0
    buffer_load_dwordx4 v163, s[16:19], s31 offen lds
    s_lshr_b32 s28, s4, 3
    s_lshl_b32 s28, s28, 17
    s_bfe_u32 s29, s4, 0x20001
    s_lshl_b32 s29, s29, 10
    s_add_u32 s28, s28, s29
    s_and_b32 s29, s4, 1
    s_lshl_b32 s29, s29, 7
    s_add_u32 s28, s28, s29
    v_lshlrev_b32 v14, 4, v9
    v_lshl_add_u32 v14, v11, 8, v14
    v_lshl_add_u32 v14, v10, 12, v14
    v_lshl_add_u32 v14, v12, 15, v14
    v_lshlrev_b32 v15, 5, v9
    v_add_u32 v15, 131072, v15
    v_lshl_add_u32 v2, v12, 3, v15
    s_waitcnt vmcnt(11)
    v_lshlrev_b32 v32, 16, v16
    v_and_b32 v33, 0xffff0000, v16
    v_lshlrev_b32 v34, 16, v17
    v_and_b32 v35, 0xffff0000, v17
    v_lshlrev_b32 v36, 16, v18
    v_and_b32 v37, 0xffff0000, v18
    v_lshlrev_b32 v38, 16, v19
    v_and_b32 v39, 0xffff0000, v19
    s_waitcnt vmcnt(10)
    v_lshlrev_b32 v40, 16, v20
    v_and_b32 v41, 0xffff0000, v20
    v_lshlrev_b32 v42, 16, v21
    v_and_b32 v43, 0xffff0000, v21
    v_lshlrev_b32 v44, 16, v22
    v_and_b32 v45, 0xffff0000, v22
    v_lshlrev_b32 v46, 16, v23
    v_and_b32 v47, 0xffff0000, v23
    s_waitcnt vmcnt(9)
    v_lshlrev_b32 v48, 16, v24
    v_and_b32 v49, 0xffff0000, v24
    v_lshlrev_b32 v50, 16, v25
    v_and_b32 v51, 0xffff0000, v25
    v_lshlrev_b32 v52, 16, v26
    v_and_b32 v53, 0xffff0000, v26
    v_lshlrev_b32 v54, 16, v27
    v_and_b32 v55, 0xffff0000, v27
    s_waitcnt vmcnt(8)
    v_lshlrev_b32 v56, 16, v28
    v_and_b32 v57, 0xffff0000, v28
    v_lshlrev_b32 v58, 16, v29
    v_and_b32 v59, 0xffff0000, v29
    v_lshlrev_b32 v60, 16, v30
    v_and_b32 v61, 0xffff0000, v30
    v_lshlrev_b32 v62, 16, v31
    v_and_b32 v63, 0xffff0000, v31
    v_pk_add_f32 v[64:65], v[32:33], 0 op_sel_hi:[1,0]
    v_pk_add_f32 v[66:67], v[34:35], 0 op_sel_hi:[1,0]
    v_pk_add_f32 v[68:69], v[36:37], 0 op_sel_hi:[1,0]
    v_pk_add_f32 v[70:71], v[38:39], 0 op_sel_hi:[1,0]
    v_pk_add_f32 v[64:65], v[40:41], v[64:65]
    v_pk_add_f32 v[66:67], v[42:43], v[66:67]
    v_pk_add_f32 v[68:69], v[44:45], v[68:69]
    v_pk_add_f32 v[70:71], v[46:47], v[70:71]
    v_pk_add_f32 v[64:65], v[48:49], v[64:65]
    v_pk_add_f32 v[66:67], v[50:51], v[66:67]
    v_pk_add_f32 v[68:69], v[52:53], v[68:69]
    v_pk_add_f32 v[70:71], v[54:55], v[70:71]
    v_pk_add_f32 v[64:65], v[56:57], v[64:65]
    v_pk_add_f32 v[66:67], v[58:59], v[66:67]
    v_pk_add_f32 v[68:69], v[60:61], v[68:69]
    v_pk_add_f32 v[70:71], v[62:63], v[70:71]
    v_pk_add_f32 v[64:65], v[64:65], v[66:67]
    v_pk_add_f32 v[68:69], v[68:69], v[70:71]
    v_pk_add_f32 v[64:65], v[64:65], v[68:69]
    v_add_f32 v64, v64, v65
    v_mov_b32 v65, v64
    s_nop 0
    s_nop 0
    v_permlane32_swap_b32 v64, v65
    v_add_f32 v64, v64, v65
    v_mov_b32 v65, v64
    s_nop 0
    s_nop 0
    v_permlane16_swap_b32 v64, v65
    v_add_f32 v64, v64, v65
    s_nop 1
    v_add_f32_dpp v64, v64, v64 row_ror:8 row_mask:0xf bank_mask:0xf
    v_mul_f32 v72, 0x3b800000, v64
    v_mov_b32 v73, v72
    v_pk_add_f32 v[80:81], v[32:33], v[72:73] neg_lo:[0,1] neg_hi:[0,1]
    v_pk_add_f32 v[82:83], v[34:35], v[72:73] neg_lo:[0,1] neg_hi:[0,1]
    v_pk_add_f32 v[84:85], v[36:37], v[72:73] neg_lo:[0,1] neg_hi:[0,1]
    v_pk_add_f32 v[86:87], v[38:39], v[72:73] neg_lo:[0,1] neg_hi:[0,1]
    v_pk_add_f32 v[88:89], v[40:41], v[72:73] neg_lo:[0,1] neg_hi:[0,1]
    v_pk_add_f32 v[90:91], v[42:43], v[72:73] neg_lo:[0,1] neg_hi:[0,1]
    v_pk_add_f32 v[92:93], v[44:45], v[72:73] neg_lo:[0,1] neg_hi:[0,1]
    v_pk_add_f32 v[94:95], v[46:47], v[72:73] neg_lo:[0,1] neg_hi:[0,1]
    v_pk_add_f32 v[96:97], v[48:49], v[72:73] neg_lo:[0,1] neg_hi:[0,1]
    v_pk_add_f32 v[98:99], v[50:51], v[72:73] neg_lo:[0,1] neg_hi:[0,1]
    v_pk_add_f32 v[100:101], v[52:53], v[72:73] neg_lo:[0,1] neg_hi:[0,1]
    v_pk_add_f32 v[102:103], v[54:55], v[72:73] neg_lo:[0,1] neg_hi:[0,1]
    v_pk_add_f32 v[104:105], v[56:57], v[72:73] neg_lo:[0,1] neg_hi:[0,1]
    v_pk_add_f32 v[106:107], v[58:59], v[72:73] neg_lo:[0,1] neg_hi:[0,1]
    v_pk_add_f32 v[108:109], v[60:61], v[72:73] neg_lo:[0,1] neg_hi:[0,1]
    v_pk_add_f32 v[110:111], v[62:63], v[72:73] neg_lo:[0,1] neg_hi:[0,1]
    v_pk_mul_f32 v[64:65], v[80:81], v[80:81]
    v_pk_mul_f32 v[66:67], v[82:83], v[82:83]
    v_pk_mul_f32 v[68:69], v[84:85], v[84:85]
    v_pk_mul_f32 v[70:71], v[86:87], v[86:87]
    v_pk_fma_f32 v[64:65], v[88:89], v[88:89], v[64:65]
    v_pk_fma_f32 v[66:67], v[90:91], v[90:91], v[66:67]
    v_pk_fma_f32 v[68:69], v[92:93], v[92:93], v[68:69]
    v_pk_fma_f32 v[70:71], v[94:95], v[94:95], v[70:71]
    v_pk_fma_f32 v[64:65], v[96:97], v[96:97], v[64:65]
    v_pk_fma_f32 v[66:67], v[98:99], v[98:99], v[66:67]
    v_pk_fma_f32 v[68:69], v[100:101], v[100:101], v[68:69]
    v_pk_fma_f32 v[70:71], v[102:103], v[102:103], v[70:71]
    v_pk_fma_f32 v[64:65], v[104:105], v[104:105], v[64:65]
    v_pk_fma_f32 v[66:67], v[106:107], v[106:107], v[66:67]
    v_pk_fma_f32 v[68:69], v[108:109], v[108:109], v[68:69]
    v_pk_fma_f32 v[70:71], v[110:111], v[110:111], v[70:71]
    v_pk_add_f32 v[64:65], v[64:65], v[66:67]
    v_pk_add_f32 v[68:69], v[68:69], v[70:71]
    v_pk_add_f32 v[64:65], v[64:65], v[68:69]
    v_add_f32 v64, v64, v65
    v_mov_b32 v65, v64
    s_nop 0
    s_nop 0
    v_permlane32_swap_b32 v64, v65
    v_add_f32 v64, v64, v65
    v_mov_b32 v65, v64
    s_nop 0
    s_nop 0
    v_permlane16_swap_b32 v64, v65
    v_add_f32 v64, v64, v65
    s_nop 1
    v_add_f32_dpp v64, v64, v64 row_ror:8 row_mask:0xf bank_mask:0xf
    v_mov_b32 v73, v64
    ds_write_b64 v2, v[72:73]
    s_waitcnt lgkmcnt(0)
    s_barrier
    ds_read_b128 v[64:67], v15
    ds_read_b128 v[68:71], v15 offset:16
    s_waitcnt lgkmcnt(0)
    v_add_f32 v72, v64, v66
    v_add_f32 v73, v68, v70
    v_add_f32 v72, v72, v73
    v_mul_f32 v72, 0.25, v72
    v_add_f32 v74, v65, v67
    v_add_f32 v75, v69, v71
    v_add_f32 v74, v74, v75
    v_sub_f32 v64, v64, v72
    v_sub_f32 v66, v66, v72
    v_sub_f32 v68, v68, v72
    v_sub_f32 v70, v70, v72
    v_mul_f32 v75, v64, v64
    v_fma_f32 v75, v66, v66, v75
    v_fma_f32 v75, v68, v68, v75
    v_fma_f32 v75, v70, v70, v75
    v_mul_f32 v74, 0x3a800000, v74
    v_mul_f32 v75, 0.25, v75
    v_add_f32 v74, v74, v75
    v_cvt_pk_bf16_f32 v75, v72, v74
    v_lshlrev_b32 v72, 16, v75
    v_and_b32 v74, 0xffff0000, v75
    v_mov_b32 v73, v72
    v_add_f32 v74, 0x3727c5ac, v74
    v_cvt_pk_bf16_f32 v74, v74, v74
    v_and_b32 v74, 0xffff0000, v74
    v_sqrt_f32 v74, v74
    v_pk_add_f32 v[80:81], v[32:33], v[72:73] neg_lo:[0,1] neg_hi:[0,1]
    v_pk_add_f32 v[82:83], v[34:35], v[72:73] neg_lo:[0,1] neg_hi:[0,1]
    v_pk_add_f32 v[84:85], v[36:37], v[72:73] neg_lo:[0,1] neg_hi:[0,1]
    v_pk_add_f32 v[86:87], v[38:39], v[72:73] neg_lo:[0,1] neg_hi:[0,1]
    v_pk_add_f32 v[88:89], v[40:41], v[72:73] neg_lo:[0,1] neg_hi:[0,1]
    v_pk_add_f32 v[90:91], v[42:43], v[72:73] neg_lo:[0,1] neg_hi:[0,1]
    v_pk_add_f32 v[92:93], v[44:45], v[72:73] neg_lo:[0,1] neg_hi:[0,1]
    v_pk_add_f32 v[94:95], v[46:47], v[72:73] neg_lo:[0,1] neg_hi:[0,1]
    v_pk_add_f32 v[96:97], v[48:49], v[72:73] neg_lo:[0,1] neg_hi:[0,1]
    v_pk_add_f32 v[98:99], v[50:51], v[72:73] neg_lo:[0,1] neg_hi:[0,1]
    v_pk_add_f32 v[100:101], v[52:53], v[72:73] neg_lo:[0,1] neg_hi:[0,1]
    v_pk_add_f32 v[102:103], v[54:55], v[72:73] neg_lo:[0,1] neg_hi:[0,1]
    v_pk_add_f32 v[104:105], v[56:57], v[72:73] neg_lo:[0,1] neg_hi:[0,1]
    v_pk_add_f32 v[106:107], v[58:59], v[72:73] neg_lo:[0,1] neg_hi:[0,1]
    v_pk_add_f32 v[108:109], v[60:61], v[72:73] neg_lo:[0,1] neg_hi:[0,1]
    v_pk_add_f32 v[110:111], v[62:63], v[72:73] neg_lo:[0,1] neg_hi:[0,1]
    v_cvt_pk_bf16_f32 v74, v74, v74
    v_and_b32 v74, 0xffff0000, v74
    v_rcp_f32 v76, v74
    v_cvt_pk_bf16_f32 v16, v80, v81
    v_cvt_pk_bf16_f32 v17, v82, v83
    v_cvt_pk_bf16_f32 v18, v84, v85
    v_cvt_pk_bf16_f32 v19, v86, v87
    v_cvt_pk_bf16_f32 v20, v88, v89
    v_cvt_pk_bf16_f32 v21, v90, v91
    v_cvt_pk_bf16_f32 v22, v92, v93
    v_cvt_pk_bf16_f32 v23, v94, v95
    v_cvt_pk_bf16_f32 v24, v96, v97
    v_cvt_pk_bf16_f32 v25, v98, v99
    v_cvt_pk_bf16_f32 v26, v100, v101
    v_cvt_pk_bf16_f32 v27, v102, v103
    v_cvt_pk_bf16_f32 v28, v104, v105
    v_cvt_pk_bf16_f32 v29, v106, v107
    v_cvt_pk_bf16_f32 v30, v108, v109
    v_cvt_pk_bf16_f32 v31, v110, v111
    v_mov_b32 v77, v76
    v_lshlrev_b32 v32, 16, v16
    v_and_b32 v33, 0xffff0000, v16
    v_lshlrev_b32 v34, 16, v17
    v_and_b32 v35, 0xffff0000, v17
    v_lshlrev_b32 v36, 16, v18
    v_and_b32 v37, 0xffff0000, v18
    v_lshlrev_b32 v38, 16, v19
    v_and_b32 v39, 0xffff0000, v19
    v_lshlrev_b32 v40, 16, v20
    v_and_b32 v41, 0xffff0000, v20
    v_lshlrev_b32 v42, 16, v21
    v_and_b32 v43, 0xffff0000, v21
    v_lshlrev_b32 v44, 16, v22
    v_and_b32 v45, 0xffff0000, v22
    v_lshlrev_b32 v46, 16, v23
    v_and_b32 v47, 0xffff0000, v23
    v_lshlrev_b32 v48, 16, v24
    v_and_b32 v49, 0xffff0000, v24
    v_lshlrev_b32 v50, 16, v25
    v_and_b32 v51, 0xffff0000, v25
    v_lshlrev_b32 v52, 16, v26
    v_and_b32 v53, 0xffff0000, v26
    v_lshlrev_b32 v54, 16, v27
    v_and_b32 v55, 0xffff0000, v27
    v_lshlrev_b32 v56, 16, v28
    v_and_b32 v57, 0xffff0000, v28
    v_lshlrev_b32 v58, 16, v29
    v_and_b32 v59, 0xffff0000, v29
    v_lshlrev_b32 v60, 16, v30
    v_and_b32 v61, 0xffff0000, v30
    v_lshlrev_b32 v62, 16, v31
    v_and_b32 v63, 0xffff0000, v31
    v_pk_mul_f32 v[32:33], v[32:33], v[76:77]
    v_pk_mul_f32 v[34:35], v[34:35], v[76:77]
    v_pk_mul_f32 v[36:37], v[36:37], v[76:77]
    v_pk_mul_f32 v[38:39], v[38:39], v[76:77]
    v_pk_mul_f32 v[40:41], v[40:41], v[76:77]
    v_pk_mul_f32 v[42:43], v[42:43], v[76:77]
    v_pk_mul_f32 v[44:45], v[44:45], v[76:77]
    v_pk_mul_f32 v[46:47], v[46:47], v[76:77]
    v_pk_mul_f32 v[48:49], v[48:49], v[76:77]
    v_pk_mul_f32 v[50:51], v[50:51], v[76:77]
    v_pk_mul_f32 v[52:53], v[52:53], v[76:77]
    v_pk_mul_f32 v[54:55], v[54:55], v[76:77]
    v_pk_mul_f32 v[56:57], v[56:57], v[76:77]
    v_pk_mul_f32 v[58:59], v[58:59], v[76:77]
    v_pk_mul_f32 v[60:61], v[60:61], v[76:77]
    v_pk_mul_f32 v[62:63], v[62:63], v[76:77]
    v_cvt_pk_bf16_f32 v16, v32, v33
    v_cvt_pk_bf16_f32 v17, v34, v35
    v_cvt_pk_bf16_f32 v18, v36, v37
    v_cvt_pk_bf16_f32 v19, v38, v39
    v_cvt_pk_bf16_f32 v20, v40, v41
    v_cvt_pk_bf16_f32 v21, v42, v43
    v_cvt_pk_bf16_f32 v22, v44, v45
    v_cvt_pk_bf16_f32 v23, v46, v47
    v_cvt_pk_bf16_f32 v24, v48, v49
    v_cvt_pk_bf16_f32 v25, v50, v51
    v_cvt_pk_bf16_f32 v26, v52, v53
    v_cvt_pk_bf16_f32 v27, v54, v55
    v_cvt_pk_bf16_f32 v28, v56, v57
    v_cvt_pk_bf16_f32 v29, v58, v59
    v_cvt_pk_bf16_f32 v30, v60, v61
    v_cvt_pk_bf16_f32 v31, v62, v63
    v_permlane16_swap_b32 v16, v18
    v_permlane16_swap_b32 v17, v19
    v_permlane16_swap_b32 v20, v22
    v_permlane16_swap_b32 v21, v23
    v_permlane16_swap_b32 v24, v26
    v_permlane16_swap_b32 v25, v27
    v_permlane16_swap_b32 v28, v30
    v_permlane16_swap_b32 v29, v31
    v_permlane32_swap_b32 v16, v18
    v_permlane32_swap_b32 v17, v19
    v_permlane32_swap_b32 v20, v22
    v_permlane32_swap_b32 v21, v23
    v_permlane32_swap_b32 v24, v26
    v_permlane32_swap_b32 v25, v27
    v_permlane32_swap_b32 v28, v30
    v_permlane32_swap_b32 v29, v31
    s_add_u32 s29, s28, 0
    buffer_store_dwordx4 v[16:19], v14, s[20:23], s29 offen sc1
    s_add_u32 s29, s28, 8192
    buffer_store_dwordx4 v[20:23], v14, s[20:23], s29 offen sc1
    s_add_u32 s29, s28, 16384
    buffer_store_dwordx4 v[24:27], v14, s[20:23], s29 offen sc1
    s_add_u32 s29, s28, 24576
    buffer_store_dwordx4 v[28:31], v14, s[20:23], s29 offen sc1
    s_lshl_b32 s28, s5, 5
    s_add_u32 s28, s28, s4
    s_lshl_b32 s28, s28, 6
    s_add_u32 s28, s28, 8388608
    v_and_b32 v32, 15, v1
    v_lshlrev_b32 v32, 2, v32
    v_mov_b32 v33, 0
    buffer_store_dword v33, v32, s[24:27], s28 offen sc1
    s_waitcnt vmcnt(0)
    s_barrier
    s_cmp_lg_u32 s3, 0
    s_cbranch_scc1 f_ln_pub
    s_add_u32 s28, s61, 4
    v_mov_b32 v32, 1
    s_mov_b64 exec, 1
    buffer_atomic_add v32, off, s[96:99], s28 sc1
    s_mov_b64 exec, -1
f_ln_pub:
    s_add_u32 s30, s30, 262144
    s_add_u32 m0, s52, 32768
    s_nop 0
    buffer_load_dwordx4 v160, s[12:15], s30 offen lds
    s_add_u32 m0, s52, 33792
    s_nop 0
    buffer_load_dwordx4 v161, s[12:15], s30 offen lds
    s_add_u32 s31, s31, 229376
    s_add_u32 m0, s52, 34816
    s_nop 0
    buffer_load_dwordx4 v162, s[16:19], s31 offen lds
    s_add_u32 m0, s52, 35840
    s_nop 0
    buffer_load_dwordx4 v163, s[16:19], s31 offen lds
    s_add_u32 s30, s30, 262144
    s_add_u32 m0, s52, 49152
    s_nop 0
    buffer_load_dwordx4 v160, s[12:15], s30 offen lds
    s_add_u32 m0, s52, 50176
    s_nop 0
    buffer_load_dwordx4 v161, s[12:15], s30 offen lds
    s_add_u32 s31, s31, 229376
    s_add_u32 m0, s52, 51200
    s_nop 0
    buffer_load_dwordx4 v162, s[16:19], s31 offen lds
    s_add_u32 m0, s52, 52224
    s_nop 0
    buffer_load_dwordx4 v163, s[16:19], s31 offen lds
    s_add_u32 s30, s30, 262144
    s_add_u32 m0, s52, 65536
    s_nop 0
    buffer_load_dwordx4 v160, s[12:15], s30 offen lds
    v_mov_b32 v4, 0
    v_mov_b32 v5, 0
    v_mov_b32 v6, 0
    v_mov_b32 v7, 0
    s_nop 0
    s_nop 0
    v_mfma_f32_16x16x32_bf16 a[0:3], v[4:7], v[4:7], 0
    v_mfma_f32_16x16x32_bf16 a[4:7], v[4:7], v[4:7], 0
    v_mfma_f32_16x16x32_bf16 a[8:11], v[4:7], v[4:7], 0
    v_mfma_f32_16x16x32_bf16 a[12:15], v[4:7], v[4:7], 0
    v_mfma_f32_16x16x32_bf16 a[16:19], v[4:7], v[4:7], 0
    v_mfma_f32_16x16x32_bf16 a[20:23], v[4:7], v[4:7], 0
    v_mfma_f32_16x16x32_bf16 a[24:27], v[4:7], v[4:7], 0
    v_mfma_f32_16x16x32_bf16 a[28:31], v[4:7], v[4:7], 0
    v_mfma_f32_16x16x32_bf16 a[32:35], v[4:7], v[4:7], 0
    v_mfma_f32_16x16x32_bf16 a[36:39], v[4:7], v[4:7], 0
    v_mfma_f32_16x16x32_bf16 a[40:43], v[4:7], v[4:7], 0
    v_mfma_f32_16x16x32_bf16 a[44:47], v[4:7], v[4:7], 0
    v_mfma_f32_16x16x32_bf16 a[48:51], v[4:7], v[4:7], 0
    v_mfma_f32_16x16x32_bf16 a[52:55], v[4:7], v[4:7], 0
    v_mfma_f32_16x16x32_bf16 a[56:59], v[4:7], v[4:7], 0
    v_mfma_f32_16x16x32_bf16 a[60:63], v[4:7], v[4:7], 0
    v_mfma_f32_16x16x32_bf16 a[64:67], v[4:7], v[4:7], 0
    v_mfma_f32_16x16x32_bf16 a[68:71], v[4:7], v[4:7], 0
    v_mfma_f32_16x16x32_bf16 a[72:75], v[4:7], v[4:7], 0
    v_mfma_f32_16x16x32_bf16 a[76:79], v[4:7], v[4:7], 0
    v_mfma_f32_16x16x32_bf16 a[80:83], v[4:7], v[4:7], 0
    v_mfma_f32_16x16x32_bf16 a[84:87], v[4:7], v[4:7], 0
    v_mfma_f32_16x16x32_bf16 a[88:91], v[4:7], v[4:7], 0
    v_mfma_f32_16x16x32_bf16 a[92:95], v[4:7], v[4:7], 0
    v_mfma_f32_16x16x32_bf16 a[96:99], v[4:7], v[4:7], 0
    v_mfma_f32_16x16x32_bf16 a[100:103], v[4:7], v[4:7], 0
    v_mfma_f32_16x16x32_bf16 a[104:107], v[4:7], v[4:7], 0
    v_mfma_f32_16x16x32_bf16 a[108:111], v[4:7], v[4:7], 0
    v_mfma_f32_16x16x32_bf16 a[112:115], v[4:7], v[4:7], 0
    v_mfma_f32_16x16x32_bf16 a[116:119], v[4:7], v[4:7], 0
    v_mfma_f32_16x16x32_bf16 a[120:123], v[4:7], v[4:7], 0
    v_mfma_f32_16x16x32_bf16 a[124:127], v[4:7], v[4:7], 0
    v_mov_b32 v16, 0
    v_mov_b32 v17, 0
    v_mov_b32 v18, 0
    v_mov_b32 v19, 0
    v_mov_b32 v20, 0
    v_mov_b32 v21, 0
    v_mov_b32 v22, 0
    v_mov_b32 v23, 0
    v_mov_b32 v24, 0
    v_mov_b32 v25, 0
    v_mov_b32 v26, 0
    v_mov_b32 v27, 0
    v_mov_b32 v28, 0
    v_mov_b32 v29, 0
    v_mov_b32 v30, 0
    v_mov_b32 v31, 0
    v_mov_b32 v32, 0
    v_mov_b32 v33, 0
    v_mov_b32 v34, 0
    v_mov_b32 v35, 0
    v_mov_b32 v36, 0
    v_mov_b32 v37, 0
    v_mov_b32 v38, 0
    v_mov_b32 v39, 0
    v_mov_b32 v40, 0
    v_mov_b32 v41, 0
    v_mov_b32 v42, 0
    v_mov_b32 v43, 0
    v_mov_b32 v44, 0
    v_mov_b32 v45, 0
    v_mov_b32 v46, 0
    v_mov_b32 v47, 0
    v_mov_b32 v48, 0
    v_mov_b32 v49, 0
    v_mov_b32 v50, 0
    v_mov_b32 v51, 0
    v_mov_b32 v52, 0
    v_mov_b32 v53, 0
    v_mov_b32 v54, 0
    v_mov_b32 v55, 0
    v_mov_b32 v56, 0
    v_mov_b32 v57, 0
    v_mov_b32 v58, 0
    v_mov_b32 v59, 0
    v_mov_b32 v60, 0
    v_mov_b32 v61, 0
    v_mov_b32 v62, 0
    v_mov_b32 v63, 0
    v_mov_b32 v64, 0
    v_mov_b32 v65, 0
    v_mov_b32 v66, 0
    v_mov_b32 v67, 0
    v_mov_b32 v68, 0
    v_mov_b32 v69, 0
    v_mov_b32 v70, 0
    v_mov_b32 v71, 0
    v_mov_b32 v72, 0
    v_mov_b32 v73, 0
    v_mov_b32 v74, 0
    v_mov_b32 v75, 0
    v_mov_b32 v76, 0
    v_mov_b32 v77, 0
    v_mov_b32 v78, 0
    v_mov_b32 v79, 0
    v_mov_b32 v80, 0
    v_mov_b32 v81, 0
    v_mov_b32 v82, 0
    v_mov_b32 v83, 0
    v_mov_b32 v84, 0
    v_mov_b32 v85, 0
    v_mov_b32 v86, 0
    v_mov_b32 v87, 0
    v_mov_b32 v88, 0
    v_mov_b32 v89, 0
    v_mov_b32 v90, 0
    v_mov_b32 v91, 0
    v_mov_b32 v92, 0
    v_mov_b32 v93, 0
    v_mov_b32 v94, 0
    v_mov_b32 v95, 0
    v_mov_b32 v96, 0
    v_mov_b32 v97, 0
    v_mov_b32 v98, 0
    v_mov_b32 v99, 0
    v_mov_b32 v100, 0
    v_mov_b32 v101, 0
    v_mov_b32 v102, 0
    v_mov_b32 v103, 0
    v_mov_b32 v104, 0
    v_mov_b32 v105, 0
    v_mov_b32 v106, 0
    v_mov_b32 v107, 0
    v_mov_b32 v108, 0
    v_mov_b32 v109, 0
    v_mov_b32 v110, 0
    v_mov_b32 v111, 0
    v_mov_b32 v112, 0
    v_mov_b32 v113, 0
    v_mov_b32 v114, 0
    v_mov_b32 v115, 0
    v_mov_b32 v116, 0
    v_mov_b32 v117, 0
    v_mov_b32 v118, 0
    v_mov_b32 v119, 0
    v_mov_b32 v120, 0
    v_mov_b32 v121, 0
    v_mov_b32 v122, 0
    v_mov_b32 v123, 0
    v_mov_b32 v124, 0
    v_mov_b32 v125, 0
    v_mov_b32 v126, 0
    v_mov_b32 v127, 0
    v_and_b32 v8, 15, v1
    v_lshrrev_b32 v9, 4, v1
    v_add_u32 v10, 0, v9
    v_xor_b32 v10, v10, v8
    v_lshlrev_b32 v10, 4, v10
    v_lshl_add_u32 v212, v8, 8, v10
    v_add_u32 v216, 0x10000, v212
    v_add_u32 v10, 4, v9
    v_xor_b32 v10, v10, v8
    v_lshlrev_b32 v10, 4, v10
    v_lshl_add_u32 v213, v8, 8, v10
    v_add_u32 v217, 0x10000, v213
    v_add_u32 v10, 8, v9
    v_xor_b32 v10, v10, v8
    v_lshlrev_b32 v10, 4, v10
    v_lshl_add_u32 v214, v8, 8, v10
    v_add_u32 v218, 0x10000, v214
    v_add_u32 v10, 12, v9
    v_xor_b32 v10, v10, v8
    v_lshlrev_b32 v10, 4, v10
    v_lshl_add_u32 v215, v8, 8, v10
    v_add_u32 v219, 0x10000, v215
    v_lshrrev_b32 v8, 2, v1
    v_and_b32 v9, 7, v8
    v_lshlrev_b32 v9, 1, v9
    v_bfe_u32 v10, v1, 1, 1
    v_xor_b32 v9, v9, v10
    v_lshlrev_b32 v8, 8, v8
    v_and_b32 v10, 1, v1
    v_lshl_add_u32 v8, v10, 3, v8
    v_xor_b32 v10, 0, v9
    v_lshl_add_u32 v220, v10, 4, v8
    v_xor_b32 v10, 2, v9
    v_lshl_add_u32 v221, v10, 4, v8
    v_xor_b32 v10, 4, v9
    v_lshl_add_u32 v222, v10, 4, v8
    v_xor_b32 v10, 6, v9
    v_lshl_add_u32 v223, v10, 4, v8
    v_xor_b32 v10, 8, v9
    v_lshl_add_u32 v224, v10, 4, v8
    v_xor_b32 v10, 10, v9
    v_lshl_add_u32 v225, v10, 4, v8
    v_xor_b32 v10, 12, v9
    v_lshl_add_u32 v226, v10, 4, v8
    v_xor_b32 v10, 14, v9
    v_lshl_add_u32 v227, v10, 4, v8
    v_add_u32 v228, 0x10000, v220
    v_add_u32 v229, 0x10000, v221
    v_add_u32 v230, 0x10000, v222
    v_add_u32 v231, 0x10000, v223
    v_add_u32 v232, 0x10000, v224
    v_add_u32 v233, 0x10000, v225
    v_add_u32 v234, 0x10000, v226
    v_add_u32 v235, 0x10000, v227
    v_lshrrev_b32 v8, 4, v1
    v_and_b32 v9, 15, v1
    s_lshl_b32 s53, s3, 12
    v_add_u32 v10, 0, v8
    v_xor_b32 v10, v10, v9
    v_lshlrev_b32 v10, 4, v10
    v_lshl_add_u32 v10, v8, 8, v10
    v_add_u32 v236, s53, v10
    v_add_u32 v10, 4, v8
    v_xor_b32 v10, v10, v9
    v_lshlrev_b32 v10, 4, v10
    v_lshl_add_u32 v10, v8, 8, v10
    v_add_u32 v237, s53, v10
    v_add_u32 v10, 8, v8
    v_xor_b32 v10, v10, v9
    v_lshlrev_b32 v10, 4, v10
    v_lshl_add_u32 v10, v8, 8, v10
    v_add_u32 v238, s53, v10
    v_add_u32 v10, 12, v8
    v_xor_b32 v10, v10, v9
    v_lshlrev_b32 v10, 4, v10
    v_lshl_add_u32 v10, v8, 8, v10
    v_add_u32 v239, s53, v10
    v_add_u32 v10, 0, v8
    v_lshlrev_b32 v10, 1, v10
    v_xor_b32 v10, v10, v9
    v_lshlrev_b32 v10, 4, v10
    v_lshl_add_u32 v10, v8, 8, v10
    v_add_u32 v240, s53, v10
    v_add_u32 v10, 4, v8
    v_lshlrev_b32 v10, 1, v10
    v_xor_b32 v10, v10, v9
    v_lshlrev_b32 v10, 4, v10
    v_lshl_add_u32 v10, v8, 8, v10
    v_add_u32 v241, s53, v10
    v_mov_b32 v208, 0x3f803f80
    v_mov_b32 v209, 0x3f803f80
    v_mov_b32 v210, 0x3f803f80
    v_mov_b32 v211, 0x3f803f80
    v_lshlrev_b32 v254, 4, v1
    v_and_b32 v8, 15, v1
    v_lshlrev_b32 v8, 12, v8
    v_lshrrev_b32 v9, 4, v1
    v_lshl_add_u32 v255, v9, 4, v8
    s_lshl_b32 s28, s4, 19
    s_add_u32 s36, s44, s28
    s_addc_u32 s37, s45, 0
    s_mov_b32 s38, 524288
    s_mov_b32 s39, 0x20000
    s_add_u32 s40, s46, s28
    s_addc_u32 s41, s47, 0
    s_mov_b32 s42, 524288
    s_mov_b32 s43, 0x20000
    s_lshl_b32 s34, s5, 13
    s_lshl_b32 s28, s3, 11
    s_add_u32 s34, s34, s28
    s_mov_b32 s35, 0x7f000000
    v_lshlrev_b32 v14, 5, v1
    s_lshr_b32 s28, s2, 3
    s_lshl_b32 s28, s28, 2
    s_add_u32 s28, s28, s3
    s_getpc_b64 s[62:63]
f_pc1:
    s_add_u32 s62, s62, f_p1_epi-f_pc1
    s_addc_u32 s63, s63, 0
    v_lshl_add_u32 v2, s28, 6, v1
    v_lshlrev_b32 v2, 3, v2
    v_min_u32 v2, f_l23-f_p1_epi-4, v2
    v_mov_b32 v3, s63
    v_add_co_u32 v2, vcc, s62, v2
    s_nop 1
    v_addc_co_u32 v3, vcc, 0, v3, vcc
    s_lshl_b32 s29, s3, 17
    s_sub_u32 s29, s29, 4096
    s_cmp_lg_u32 s3, 0
    s_cbranch_scc1 f_ln_rdy
    s_add_u32 s28, s61, 4
f_ln_spin:
    buffer_load_dword v8, off, s[96:99], s28 sc1
    s_waitcnt vmcnt(0)
    v_readfirstlane_b32 s60, v8
    s_cmp_lt_u32 s60, 32
    s_cbranch_scc1 f_ln_spin
f_ln_rdy:
    s_barrier
    buffer_load_dwordx2 v[12:13], off, s[96:99], 0 offset:16 sc1
    s_add_u32 s29, s29, 4096
    buffer_load_dwordx4 a[128:131], v164, s[20:23], s29 offen offset:0
    buffer_load_dwordx4 a[132:135], v164, s[20:23], s29 offen offset:1024
    buffer_load_dwordx4 a[136:139], v164, s[20:23], s29 offen offset:2048
    buffer_load_dwordx4 a[140:143], v164, s[20:23], s29 offen offset:3072
    s_add_u32 s29, s29, 4096
    buffer_load_dwordx4 a[144:147], v164, s[20:23], s29 offen offset:0
    buffer_load_dwordx4 a[148:151], v164, s[20:23], s29 offen offset:1024
    buffer_load_dwordx4 a[152:155], v164, s[20:23], s29 offen offset:2048
    buffer_load_dwordx4 a[156:159], v164, s[20:23], s29 offen offset:3072
    s_add_u32 s29, s29, 4096
    buffer_load_dwordx4 a[160:163], v164, s[20:23], s29 offen offset:0
    buffer_load_dwordx4 a[164:167], v164, s[20:23], s29 offen offset:1024
    buffer_load_dwordx4 a[168:171], v164, s[20:23], s29 offen offset:2048
    buffer_load_dwordx4 a[172:175], v164, s[20:23], s29 offen offset:3072
    s_add_u32 s29, s29, 4096
    buffer_load_dwordx4 a[176:179], v164, s[20:23], s29 offen offset:0
    buffer_load_dwordx4 a[180:183], v164, s[20:23], s29 offen offset:1024
    buffer_load_dwordx4 a[184:187], v164, s[20:23], s29 offen offset:2048
    buffer_load_dwordx4 a[188:191], v164, s[20:23], s29 offen offset:3072
    ds_read_b64_tr_b16 v[176:177], v152 offset:0
    ds_read_b64_tr_b16 v[178:179], v152 offset:8192
    ds_read_b64_tr_b16 v[180:181], v152 offset:16384
    ds_read_b64_tr_b16 v[182:183], v152 offset:24576
    ds_read_b64_tr_b16 v[184:185], v153 offset:0
    ds_read_b64_tr_b16 v[186:187], v153 offset:8192
    ds_read_b64_tr_b16 v[188:189], v153 offset:16384
    ds_read_b64_tr_b16 v[190:191], v153 offset:24576
    s_waitcnt vmcnt(8)
    s_waitcnt lgkmcnt(4)
    s_mov_b32 s32, 4
f_p1_loop:
    v_mfma_f32_16x16x32_bf16 a[0:3], v[176:179], a[128:131], a[0:3]
    s_add_u32 s29, s29, 4096
    ds_read_b64_tr_b16 v[192:193], v154 offset:0
    v_mfma_f32_16x16x32_bf16 a[0:3], v[180:183], a[144:147], a[0:3]
    buffer_load_dwordx4 a[192:195], v164, s[20:23], s29 offen offset:0
    v_mfma_f32_16x16x32_bf16 a[4:7], v[180:183], a[148:151], a[4:7]
    ds_read_b64_tr_b16 v[194:195], v154 offset:8192
    v_mfma_f32_16x16x32_bf16 a[4:7], v[176:179], a[132:135], a[4:7]
    v_mfma_f32_16x16x32_bf16 a[8:11], v[176:179], a[136:139], a[8:11]
    ds_read_b64_tr_b16 v[196:197], v154 offset:16384
    v_mfma_f32_16x16x32_bf16 a[8:11], v[180:183], a[152:155], a[8:11]
    v_mfma_f32_16x16x32_bf16 a[12:15], v[180:183], a[156:159], a[12:15]
    s_add_u32 m0, s52, 66560
    ds_read_b64_tr_b16 v[198:199], v154 offset:24576
    v_mfma_f32_16x16x32_bf16 a[12:15], v[176:179], a[140:143], a[12:15]
    s_waitcnt lgkmcnt(4)
    ds_read_b64_tr_b16 v[200:201], v155 offset:0
    v_mfma_f32_16x16x32_bf16 a[28:31], v[184:187], a[140:143], a[28:31]
    buffer_load_dwordx4 v161, s[12:15], s30 offen lds
    v_mfma_f32_16x16x32_bf16 a[28:31], v[188:191], a[156:159], a[28:31]
    v_mfma_f32_16x16x32_bf16 a[24:27], v[188:191], a[152:155], a[24:27]
    ds_read_b64_tr_b16 v[202:203], v155 offset:8192
    v_mfma_f32_16x16x32_bf16 a[24:27], v[184:187], a[136:139], a[24:27]
    v_mfma_f32_16x16x32_bf16 a[20:23], v[184:187], a[132:135], a[20:23]
    ds_read_b64_tr_b16 v[204:205], v155 offset:16384
    v_mfma_f32_16x16x32_bf16 a[20:23], v[188:191], a[148:151], a[20:23]
    ds_read_b64_tr_b16 v[206:207], v155 offset:24576
    v_mfma_f32_16x16x32_bf16 a[16:19], v[188:191], a[144:147], a[16:19]
    v_mfma_f32_16x16x32_bf16 a[16:19], v[184:187], a[128:131], a[16:19]
    s_waitcnt lgkmcnt(4)
    ds_read_b64_tr_b16 v[176:177], v156 offset:0
    v_mfma_f32_16x16x32_bf16 a[32:35], v[192:195], a[128:131], a[32:35]
    buffer_load_dwordx4 a[196:199], v164, s[20:23], s29 offen offset:1024
    v_mfma_f32_16x16x32_bf16 a[32:35], v[196:199], a[144:147], a[32:35]
    v_mfma_f32_16x16x32_bf16 a[36:39], v[196:199], a[148:151], a[36:39]
    ds_read_b64_tr_b16 v[178:179], v156 offset:8192
    v_mfma_f32_16x16x32_bf16 a[36:39], v[192:195], a[132:135], a[36:39]
    ds_read_b64_tr_b16 v[180:181], v156 offset:16384
    v_mfma_f32_16x16x32_bf16 a[40:43], v[192:195], a[136:139], a[40:43]
    v_mfma_f32_16x16x32_bf16 a[40:43], v[196:199], a[152:155], a[40:43]
    s_add_u32 s31, s31, 229376
    ds_read_b64_tr_b16 v[182:183], v156 offset:24576
    v_mfma_f32_16x16x32_bf16 a[44:47], v[196:199], a[156:159], a[44:47]
    s_add_u32 m0, s52, 67584
    v_mfma_f32_16x16x32_bf16 a[44:47], v[192:195], a[140:143], a[44:47]
    s_waitcnt lgkmcnt(4)
    ds_read_b64_tr_b16 v[184:185], v157 offset:0
    v_mfma_f32_16x16x32_bf16 a[60:63], v[200:203], a[140:143], a[60:63]
    buffer_load_dwordx4 v162, s[16:19], s31 offen lds
    v_mfma_f32_16x16x32_bf16 a[60:63], v[204:207], a[156:159], a[60:63]
    v_mfma_f32_16x16x32_bf16 a[56:59], v[204:207], a[152:155], a[56:59]
    ds_read_b64_tr_b16 v[186:187], v157 offset:8192
    v_mfma_f32_16x16x32_bf16 a[56:59], v[200:203], a[136:139], a[56:59]
    ds_read_b64_tr_b16 v[188:189], v157 offset:16384
    v_mfma_f32_16x16x32_bf16 a[52:55], v[200:203], a[132:135], a[52:55]
    v_mfma_f32_16x16x32_bf16 a[52:55], v[204:207], a[148:151], a[52:55]
    ds_read_b64_tr_b16 v[190:191], v157 offset:24576
    v_mfma_f32_16x16x32_bf16 a[48:51], v[204:207], a[144:147], a[48:51]
    v_mfma_f32_16x16x32_bf16 a[48:51], v[200:203], a[128:131], a[48:51]
    s_waitcnt lgkmcnt(4)
    ds_read_b64_tr_b16 v[192:193], v158 offset:0
    v_mfma_f32_16x16x32_bf16 a[64:67], v[176:179], a[128:131], a[64:67]
    buffer_load_dwordx4 a[200:203], v164, s[20:23], s29 offen offset:2048
    v_mfma_f32_16x16x32_bf16 a[64:67], v[180:183], a[144:147], a[64:67]
    ds_read_b64_tr_b16 v[194:195], v158 offset:8192
    v_mfma_f32_16x16x32_bf16 a[68:71], v[180:183], a[148:151], a[68:71]
    v_mfma_f32_16x16x32_bf16 a[68:71], v[176:179], a[132:135], a[68:71]
    ds_read_b64_tr_b16 v[196:197], v158 offset:16384
    v_mfma_f32_16x16x32_bf16 a[72:75], v[176:179], a[136:139], a[72:75]
    v_mfma_f32_16x16x32_bf16 a[72:75], v[180:183], a[152:155], a[72:75]
    s_add_u32 m0, s52, 68608
    ds_read_b64_tr_b16 v[198:199], v158 offset:24576
    v_mfma_f32_16x16x32_bf16 a[76:79], v[180:183], a[156:159], a[76:79]
    buffer_load_dwordx4 v163, s[16:19], s31 offen lds
    v_mfma_f32_16x16x32_bf16 a[76:79], v[176:179], a[140:143], a[76:79]
    s_waitcnt lgkmcnt(4)
    ds_read_b64_tr_b16 v[200:201], v159 offset:0
    v_mfma_f32_16x16x32_bf16 a[92:95], v[184:187], a[140:143], a[92:95]
    v_mfma_f32_16x16x32_bf16 a[92:95], v[188:191], a[156:159], a[92:95]
    ds_read_b64_tr_b16 v[202:203], v159 offset:8192
    v_mfma_f32_16x16x32_bf16 a[88:91], v[188:191], a[152:155], a[88:91]
    v_mfma_f32_16x16x32_bf16 a[88:91], v[184:187], a[136:139], a[88:91]
    ds_read_b64_tr_b16 v[204:205], v159 offset:16384
    v_mfma_f32_16x16x32_bf16 a[84:87], v[184:187], a[132:135], a[84:87]
    ds_read_b64_tr_b16 v[206:207], v159 offset:24576
    v_mfma_f32_16x16x32_bf16 a[84:87], v[188:191], a[148:151], a[84:87]
    v_mfma_f32_16x16x32_bf16 a[80:83], v[188:191], a[144:147], a[80:83]
    buffer_load_dwordx4 a[204:207], v164, s[20:23], s29 offen offset:3072
    v_mfma_f32_16x16x32_bf16 a[80:83], v[184:187], a[128:131], a[80:83]
    s_waitcnt lgkmcnt(4)
    ds_read_b64_tr_b16 v[176:177], v152 offset:2048
    v_mfma_f32_16x16x32_bf16 a[96:99], v[192:195], a[128:131], a[96:99]
    v_mfma_f32_16x16x32_bf16 a[96:99], v[196:199], a[144:147], a[96:99]
    ds_read_b64_tr_b16 v[178:179], v152 offset:10240
    v_mfma_f32_16x16x32_bf16 a[100:103], v[196:199], a[148:151], a[100:103]
    v_mfma_f32_16x16x32_bf16 a[100:103], v[192:195], a[132:135], a[100:103]
    s_add_u32 s30, s30, 262144
    ds_read_b64_tr_b16 v[180:181], v152 offset:18432
    v_mfma_f32_16x16x32_bf16 a[104:107], v[192:195], a[136:139], a[104:107]
    s_add_u32 m0, s52, 81920
    ds_read_b64_tr_b16 v[182:183], v152 offset:26624
    v_mfma_f32_16x16x32_bf16 a[104:107], v[196:199], a[152:155], a[104:107]
    buffer_load_dwordx4 v160, s[12:15], s30 offen lds
    v_mfma_f32_16x16x32_bf16 a[108:111], v[196:199], a[156:159], a[108:111]
    v_mfma_f32_16x16x32_bf16 a[108:111], v[192:195], a[140:143], a[108:111]
    s_waitcnt lgkmcnt(4)
    ds_read_b64_tr_b16 v[184:185], v153 offset:2048
    v_mfma_f32_16x16x32_bf16 a[124:127], v[200:203], a[140:143], a[124:127]
    v_mfma_f32_16x16x32_bf16 a[124:127], v[204:207], a[156:159], a[124:127]
    ds_read_b64_tr_b16 v[186:187], v153 offset:10240
    v_mfma_f32_16x16x32_bf16 a[120:123], v[204:207], a[152:155], a[120:123]
    ds_read_b64_tr_b16 v[188:189], v153 offset:18432
    v_mfma_f32_16x16x32_bf16 a[120:123], v[200:203], a[136:139], a[120:123]
    v_mfma_f32_16x16x32_bf16 a[116:119], v[200:203], a[132:135], a[116:119]
    s_add_u32 s29, s29, 4096
    ds_read_b64_tr_b16 v[190:191], v153 offset:26624
    v_mfma_f32_16x16x32_bf16 a[116:119], v[204:207], a[148:151], a[116:119]
    buffer_load_dwordx4 a[208:211], v164, s[20:23], s29 offen offset:0
    v_mfma_f32_16x16x32_bf16 a[112:115], v[204:207], a[144:147], a[112:115]
    v_mfma_f32_16x16x32_bf16 a[112:115], v[200:203], a[128:131], a[112:115]
    s_waitcnt lgkmcnt(4)
    ds_read_b64_tr_b16 v[192:193], v154 offset:2048
    v_mfma_f32_16x16x32_bf16 v[16:19], v[176:179], a[128:131], v[16:19]
    ds_read_b64_tr_b16 v[194:195], v154 offset:10240
    v_mfma_f32_16x16x32_bf16 v[16:19], v[180:183], a[144:147], v[16:19]
    v_mfma_f32_16x16x32_bf16 v[20:23], v[180:183], a[148:151], v[20:23]
    ds_read_b64_tr_b16 v[196:197], v154 offset:18432
    v_mfma_f32_16x16x32_bf16 v[20:23], v[176:179], a[132:135], v[20:23]
    s_add_u32 m0, s52, 82944
    v_mfma_f32_16x16x32_bf16 v[24:27], v[176:179], a[136:139], v[24:27]
    buffer_load_dwordx4 v161, s[12:15], s30 offen lds
    v_mfma_f32_16x16x32_bf16 v[24:27], v[180:183], a[152:155], v[24:27]
    ds_read_b64_tr_b16 v[198:199], v154 offset:26624
    v_mfma_f32_16x16x32_bf16 v[28:31], v[180:183], a[156:159], v[28:31]
    ds_read_b64_tr_b16 v[200:201], v155 offset:2048
    v_mfma_f32_16x16x32_bf16 v[28:31], v[176:179], a[140:143], v[28:31]
    s_waitcnt lgkmcnt(5)
    v_mfma_f32_16x16x32_bf16 v[44:47], v[184:187], a[140:143], v[44:47]
    ds_read_b64_tr_b16 v[202:203], v155 offset:10240
    v_mfma_f32_16x16x32_bf16 v[44:47], v[188:191], a[156:159], v[44:47]
    v_mfma_f32_16x16x32_bf16 v[40:43], v[188:191], a[152:155], v[40:43]
    ds_read_b64_tr_b16 v[204:205], v155 offset:18432
    v_mfma_f32_16x16x32_bf16 v[40:43], v[184:187], a[136:139], v[40:43]
    v_mfma_f32_16x16x32_bf16 v[36:39], v[184:187], a[132:135], v[36:39]
    buffer_load_dwordx4 a[212:215], v164, s[20:23], s29 offen offset:1024
    v_mfma_f32_16x16x32_bf16 v[36:39], v[188:191], a[148:151], v[36:39]
    ds_read_b64_tr_b16 v[206:207], v155 offset:26624
    v_mfma_f32_16x16x32_bf16 v[32:35], v[188:191], a[144:147], v[32:35]
    ds_read_b64_tr_b16 v[176:177], v156 offset:2048
    v_mfma_f32_16x16x32_bf16 v[32:35], v[184:187], a[128:131], v[32:35]
    s_waitcnt lgkmcnt(5)
    v_mfma_f32_16x16x32_bf16 v[48:51], v[192:195], a[128:131], v[48:51]
    ds_read_b64_tr_b16 v[178:179], v156 offset:10240
    v_mfma_f32_16x16x32_bf16 v[48:51], v[196:199], a[144:147], v[48:51]
    s_add_u32 s31, s31, 229376
    v_mfma_f32_16x16x32_bf16 v[52:55], v[196:199], a[148:151], v[52:55]
    s_add_u32 m0, s52, 83968
    ds_read_b64_tr_b16 v[180:181], v156 offset:18432
    v_mfma_f32_16x16x32_bf16 v[52:55], v[192:195], a[132:135], v[52:55]
    buffer_load_dwordx4 v162, s[16:19], s31 offen lds
    v_mfma_f32_16x16x32_bf16 v[56:59], v[192:195], a[136:139], v[56:59]
    ds_read_b64_tr_b16 v[182:183], v156 offset:26624
    v_mfma_f32_16x16x32_bf16 v[56:59], v[196:199], a[152:155], v[56:59]
    v_mfma_f32_16x16x32_bf16 v[60:63], v[196:199], a[156:159], v[60:63]
    ds_read_b64_tr_b16 v[184:185], v157 offset:2048
    v_mfma_f32_16x16x32_bf16 v[60:63], v[192:195], a[140:143], v[60:63]
    s_waitcnt lgkmcnt(5)
    v_mfma_f32_16x16x32_bf16 v[76:79], v[200:203], a[140:143], v[76:79]
    ds_read_b64_tr_b16 v[186:187], v157 offset:10240
    v_mfma_f32_16x16x32_bf16 v[76:79], v[204:207], a[156:159], v[76:79]
    ds_read_b64_tr_b16 v[188:189], v157 offset:18432
    v_mfma_f32_16x16x32_bf16 v[72:75], v[204:207], a[152:155], v[72:75]
    v_mfma_f32_16x16x32_bf16 v[72:75], v[200:203], a[136:139], v[72:75]
    buffer_load_dwordx4 a[216:219], v164, s[20:23], s29 offen offset:2048
    v_mfma_f32_16x16x32_bf16 v[68:71], v[200:203], a[132:135], v[68:71]
    ds_read_b64_tr_b16 v[190:191], v157 offset:26624
    v_mfma_f32_16x16x32_bf16 v[68:71], v[204:207], a[148:151], v[68:71]
    v_mfma_f32_16x16x32_bf16 v[64:67], v[204:207], a[144:147], v[64:67]
    ds_read_b64_tr_b16 v[192:193], v158 offset:2048
    v_mfma_f32_16x16x32_bf16 v[64:67], v[200:203], a[128:131], v[64:67]
    s_waitcnt lgkmcnt(5)
    ds_read_b64_tr_b16 v[194:195], v158 offset:10240
    v_mfma_f32_16x16x32_bf16 v[80:83], v[176:179], a[128:131], v[80:83]
    v_mfma_f32_16x16x32_bf16 v[80:83], v[180:183], a[144:147], v[80:83]
    s_add_u32 m0, s52, 84992
    ds_read_b64_tr_b16 v[196:197], v158 offset:18432
    v_mfma_f32_16x16x32_bf16 v[84:87], v[180:183], a[148:151], v[84:87]
    buffer_load_dwordx4 v163, s[16:19], s31 offen lds
    v_mfma_f32_16x16x32_bf16 v[84:87], v[176:179], a[132:135], v[84:87]
    v_mfma_f32_16x16x32_bf16 v[88:91], v[176:179], a[136:139], v[88:91]
    ds_read_b64_tr_b16 v[198:199], v158 offset:26624
    v_mfma_f32_16x16x32_bf16 v[88:91], v[180:183], a[152:155], v[88:91]
    s_waitcnt vmcnt(16)
    v_mfma_f32_16x16x32_bf16 v[92:95], v[180:183], a[156:159], v[92:95]
    s_barrier
    v_mfma_f32_16x16x32_bf16 v[92:95], v[176:179], a[140:143], v[92:95]
    s_waitcnt lgkmcnt(4)
    ds_read_b64_tr_b16 v[200:201], v152 offset:32768
    v_mfma_f32_16x16x32_bf16 v[108:111], v[184:187], a[140:143], v[108:111]
    ds_read_b64_tr_b16 v[202:203], v152 offset:40960
    v_mfma_f32_16x16x32_bf16 v[108:111], v[188:191], a[156:159], v[108:111]
    v_mfma_f32_16x16x32_bf16 v[104:107], v[188:191], a[152:155], v[104:107]
    buffer_load_dwordx4 a[220:223], v164, s[20:23], s29 offen offset:3072
    v_mfma_f32_16x16x32_bf16 v[104:107], v[184:187], a[136:139], v[104:107]
    ds_read_b64_tr_b16 v[204:205], v152 offset:49152
    v_mfma_f32_16x16x32_bf16 v[100:103], v[184:187], a[132:135], v[100:103]
    v_mfma_f32_16x16x32_bf16 v[100:103], v[188:191], a[148:151], v[100:103]
    ds_read_b64_tr_b16 v[206:207], v152 offset:57344
    v_mfma_f32_16x16x32_bf16 v[96:99], v[188:191], a[144:147], v[96:99]
    s_add_u32 s30, s30, 262144
    ds_read_b64_tr_b16 v[176:177], v153 offset:32768
    v_mfma_f32_16x16x32_bf16 v[96:99], v[184:187], a[128:131], v[96:99]
    s_waitcnt lgkmcnt(5)
    v_mfma_f32_16x16x32_bf16 v[112:115], v[192:195], a[128:131], v[112:115]
    s_add_u32 m0, s52, 98304
    ds_read_b64_tr_b16 v[178:179], v153 offset:40960
    v_mfma_f32_16x16x32_bf16 v[112:115], v[196:199], a[144:147], v[112:115]
    buffer_load_dwordx4 v160, s[12:15], s30 offen lds
    v_mfma_f32_16x16x32_bf16 v[116:119], v[196:199], a[148:151], v[116:119]
    v_mfma_f32_16x16x32_bf16 v[116:119], v[192:195], a[132:135], v[116:119]
    ds_read_b64_tr_b16 v[180:181], v153 offset:49152
    v_mfma_f32_16x16x32_bf16 v[120:123], v[192:195], a[136:139], v[120:123]
    v_mfma_f32_16x16x32_bf16 v[120:123], v[196:199], a[152:155], v[120:123]
    ds_read_b64_tr_b16 v[182:183], v153 offset:57344
    v_mfma_f32_16x16x32_bf16 v[124:127], v[196:199], a[156:159], v[124:127]
    s_waitcnt vmcnt(16)
    ds_read_b64_tr_b16 v[184:185], v154 offset:32768
    v_mfma_f32_16x16x32_bf16 v[124:127], v[192:195], a[140:143], v[124:127]
    s_waitcnt lgkmcnt(5)
    v_mfma_f32_16x16x32_bf16 a[0:3], v[200:203], a[160:163], a[0:3]
    s_add_u32 s29, s29, 4096
    ds_read_b64_tr_b16 v[186:187], v154 offset:40960
    v_mfma_f32_16x16x32_bf16 a[0:3], v[204:207], a[176:179], a[0:3]
    buffer_load_dwordx4 a[224:227], v164, s[20:23], s29 offen offset:0
    v_mfma_f32_16x16x32_bf16 a[4:7], v[204:207], a[180:183], a[4:7]
    v_mfma_f32_16x16x32_bf16 a[4:7], v[200:203], a[164:167], a[4:7]
    ds_read_b64_tr_b16 v[188:189], v154 offset:49152
    v_mfma_f32_16x16x32_bf16 a[8:11], v[200:203], a[168:171], a[8:11]
    ds_read_b64_tr_b16 v[190:191], v154 offset:57344
    v_mfma_f32_16x16x32_bf16 a[8:11], v[204:207], a[184:187], a[8:11]
    v_mfma_f32_16x16x32_bf16 a[12:15], v[204:207], a[188:191], a[12:15]
    s_add_u32 m0, s52, 99328
    ds_read_b64_tr_b16 v[192:193], v155 offset:32768
    v_mfma_f32_16x16x32_bf16 a[12:15], v[200:203], a[172:175], a[12:15]
    s_waitcnt lgkmcnt(5)
    v_mfma_f32_16x16x32_bf16 a[28:31], v[176:179], a[172:175], a[28:31]
    buffer_load_dwordx4 v161, s[12:15], s30 offen lds
    v_mfma_f32_16x16x32_bf16 a[28:31], v[180:183], a[188:191], a[28:31]
    ds_read_b64_tr_b16 v[194:195], v155 offset:40960
    v_mfma_f32_16x16x32_bf16 a[24:27], v[180:183], a[184:187], a[24:27]
    v_mfma_f32_16x16x32_bf16 a[24:27], v[176:179], a[168:171], a[24:27]
    ds_read_b64_tr_b16 v[196:197], v155 offset:49152
    v_mfma_f32_16x16x32_bf16 a[20:23], v[176:179], a[164:167], a[20:23]
    ds_read_b64_tr_b16 v[198:199], v155 offset:57344
    v_mfma_f32_16x16x32_bf16 a[20:23], v[180:183], a[180:183], a[20:23]
    v_mfma_f32_16x16x32_bf16 a[16:19], v[180:183], a[176:179], a[16:19]
    ds_read_b64_tr_b16 v[200:201], v156 offset:32768
    v_mfma_f32_16x16x32_bf16 a[16:19], v[176:179], a[160:163], a[16:19]
    s_waitcnt lgkmcnt(5)
    v_mfma_f32_16x16x32_bf16 a[32:35], v[184:187], a[160:163], a[32:35]
    buffer_load_dwordx4 a[228:231], v164, s[20:23], s29 offen offset:1024
    v_mfma_f32_16x16x32_bf16 a[32:35], v[188:191], a[176:179], a[32:35]
    ds_read_b64_tr_b16 v[202:203], v156 offset:40960
    v_mfma_f32_16x16x32_bf16 a[36:39], v[188:191], a[180:183], a[36:39]
    ds_read_b64_tr_b16 v[204:205], v156 offset:49152
    v_mfma_f32_16x16x32_bf16 a[36:39], v[184:187], a[164:167], a[36:39]
    v_mfma_f32_16x16x32_bf16 a[40:43], v[184:187], a[168:171], a[40:43]
    ds_read_b64_tr_b16 v[206:207], v156 offset:57344
    v_mfma_f32_16x16x32_bf16 a[40:43], v[188:191], a[184:187], a[40:43]
    s_add_u32 s31, s31, 229376
    v_mfma_f32_16x16x32_bf16 a[44:47], v[188:191], a[188:191], a[44:47]
    s_add_u32 m0, s52, 100352
    ds_read_b64_tr_b16 v[176:177], v157 offset:32768
    v_mfma_f32_16x16x32_bf16 a[44:47], v[184:187], a[172:175], a[44:47]
    s_waitcnt lgkmcnt(5)
    v_mfma_f32_16x16x32_bf16 a[60:63], v[192:195], a[172:175], a[60:63]
    buffer_load_dwordx4 v162, s[16:19], s31 offen lds
    v_mfma_f32_16x16x32_bf16 a[60:63], v[196:199], a[188:191], a[60:63]
    ds_read_b64_tr_b16 v[178:179], v157 offset:40960
    v_mfma_f32_16x16x32_bf16 a[56:59], v[196:199], a[184:187], a[56:59]
    ds_read_b64_tr_b16 v[180:181], v157 offset:49152
    v_mfma_f32_16x16x32_bf16 a[56:59], v[192:195], a[168:171], a[56:59]
    v_mfma_f32_16x16x32_bf16 a[52:55], v[192:195], a[164:167], a[52:55]
    ds_read_b64_tr_b16 v[182:183], v157 offset:57344
    v_mfma_f32_16x16x32_bf16 a[52:55], v[196:199], a[180:183], a[52:55]
    v_mfma_f32_16x16x32_bf16 a[48:51], v[196:199], a[176:179], a[48:51]
    ds_read_b64_tr_b16 v[184:185], v158 offset:32768
    v_mfma_f32_16x16x32_bf16 a[48:51], v[192:195], a[160:163], a[48:51]
    s_waitcnt lgkmcnt(5)
    ds_read_b64_tr_b16 v[186:187], v158 offset:40960
    v_mfma_f32_16x16x32_bf16 a[64:67], v[200:203], a[160:163], a[64:67]
    buffer_load_dwordx4 a[232:235], v164, s[20:23], s29 offen offset:2048
    v_mfma_f32_16x16x32_bf16 a[64:67], v[204:207], a[176:179], a[64:67]
    v_mfma_f32_16x16x32_bf16 a[68:71], v[204:207], a[180:183], a[68:71]
    ds_read_b64_tr_b16 v[188:189], v158 offset:49152
    v_mfma_f32_16x16x32_bf16 a[68:71], v[200:203], a[164:167], a[68:71]
    v_mfma_f32_16x16x32_bf16 a[72:75], v[200:203], a[168:171], a[72:75]
    ds_read_b64_tr_b16 v[190:191], v158 offset:57344
    v_mfma_f32_16x16x32_bf16 a[72:75], v[204:207], a[184:187], a[72:75]
    s_add_u32 m0, s52, 101376
    v_mfma_f32_16x16x32_bf16 a[76:79], v[204:207], a[188:191], a[76:79]
    buffer_load_dwordx4 v163, s[16:19], s31 offen lds
    v_mfma_f32_16x16x32_bf16 a[76:79], v[200:203], a[172:175], a[76:79]
    s_waitcnt lgkmcnt(4)
    ds_read_b64_tr_b16 v[192:193], v159 offset:32768
    v_mfma_f32_16x16x32_bf16 a[92:95], v[176:179], a[172:175], a[92:95]
    ds_read_b64_tr_b16 v[194:195], v159 offset:40960
    v_mfma_f32_16x16x32_bf16 a[92:95], v[180:183], a[188:191], a[92:95]
    v_mfma_f32_16x16x32_bf16 a[88:91], v[180:183], a[184:187], a[88:91]
    ds_read_b64_tr_b16 v[196:197], v159 offset:49152
    v_mfma_f32_16x16x32_bf16 a[88:91], v[176:179], a[168:171], a[88:91]
    v_mfma_f32_16x16x32_bf16 a[84:87], v[176:179], a[164:167], a[84:87]
    ds_read_b64_tr_b16 v[198:199], v159 offset:57344
    v_mfma_f32_16x16x32_bf16 a[84:87], v[180:183], a[180:183], a[84:87]
    ds_read_b64_tr_b16 v[200:201], v152 offset:34816
    v_mfma_f32_16x16x32_bf16 a[80:83], v[180:183], a[176:179], a[80:83]
    buffer_load_dwordx4 a[236:239], v164, s[20:23], s29 offen offset:3072
    v_mfma_f32_16x16x32_bf16 a[80:83], v[176:179], a[160:163], a[80:83]
    s_waitcnt lgkmcnt(5)
    v_mfma_f32_16x16x32_bf16 a[96:99], v[184:187], a[160:163], a[96:99]
    ds_read_b64_tr_b16 v[202:203], v152 offset:43008
    v_mfma_f32_16x16x32_bf16 a[96:99], v[188:191], a[176:179], a[96:99]
    v_mfma_f32_16x16x32_bf16 a[100:103], v[188:191], a[180:183], a[100:103]
    ds_read_b64_tr_b16 v[204:205], v152 offset:51200
    v_mfma_f32_16x16x32_bf16 a[100:103], v[184:187], a[164:167], a[100:103]
    s_add_u32 s30, s30, 262144
    v_mfma_f32_16x16x32_bf16 a[104:107], v[184:187], a[168:171], a[104:107]
    s_add_u32 m0, s52, 114688
    ds_read_b64_tr_b16 v[206:207], v152 offset:59392
    v_mfma_f32_16x16x32_bf16 a[104:107], v[188:191], a[184:187], a[104:107]
    buffer_load_dwordx4 v160, s[12:15], s30 offen lds
    v_mfma_f32_16x16x32_bf16 a[108:111], v[188:191], a[188:191], a[108:111]
    ds_read_b64_tr_b16 v[176:177], v153 offset:34816
    v_mfma_f32_16x16x32_bf16 a[108:111], v[184:187], a[172:175], a[108:111]
    s_waitcnt lgkmcnt(5)
    v_mfma_f32_16x16x32_bf16 a[124:127], v[192:195], a[172:175], a[124:127]
    ds_read_b64_tr_b16 v[178:179], v153 offset:43008
    v_mfma_f32_16x16x32_bf16 a[124:127], v[196:199], a[188:191], a[124:127]
    v_mfma_f32_16x16x32_bf16 a[120:123], v[196:199], a[184:187], a[120:123]
    ds_read_b64_tr_b16 v[180:181], v153 offset:51200
    v_mfma_f32_16x16x32_bf16 a[120:123], v[192:195], a[168:171], a[120:123]
    ds_read_b64_tr_b16 v[182:183], v153 offset:59392
    v_mfma_f32_16x16x32_bf16 a[116:119], v[192:195], a[164:167], a[116:119]
    s_add_u32 s29, s29, 4096
    v_mfma_f32_16x16x32_bf16 a[116:119], v[196:199], a[180:183], a[116:119]
    buffer_load_dwordx4 a[240:243], v164, s[20:23], s29 offen offset:0
    v_mfma_f32_16x16x32_bf16 a[112:115], v[196:199], a[176:179], a[112:115]
    ds_read_b64_tr_b16 v[184:185], v154 offset:34816
    v_mfma_f32_16x16x32_bf16 a[112:115], v[192:195], a[160:163], a[112:115]
    s_waitcnt lgkmcnt(5)
    v_mfma_f32_16x16x32_bf16 v[16:19], v[200:203], a[160:163], v[16:19]
    ds_read_b64_tr_b16 v[186:187], v154 offset:43008
    v_mfma_f32_16x16x32_bf16 v[16:19], v[204:207], a[176:179], v[16:19]
    v_mfma_f32_16x16x32_bf16 v[20:23], v[204:207], a[180:183], v[20:23]
    ds_read_b64_tr_b16 v[188:189], v154 offset:51200
    v_mfma_f32_16x16x32_bf16 v[20:23], v[200:203], a[164:167], v[20:23]
    s_add_u32 m0, s52, 115712
    ds_read_b64_tr_b16 v[190:191], v154 offset:59392
    v_mfma_f32_16x16x32_bf16 v[24:27], v[200:203], a[168:171], v[24:27]
    buffer_load_dwordx4 v161, s[12:15], s30 offen lds
    v_mfma_f32_16x16x32_bf16 v[24:27], v[204:207], a[184:187], v[24:27]
    v_mfma_f32_16x16x32_bf16 v[28:31], v[204:207], a[188:191], v[28:31]
    ds_read_b64_tr_b16 v[192:193], v155 offset:34816
    v_mfma_f32_16x16x32_bf16 v[28:31], v[200:203], a[172:175], v[28:31]
    s_waitcnt lgkmcnt(5)
    v_mfma_f32_16x16x32_bf16 v[44:47], v[176:179], a[172:175], v[44:47]
    ds_read_b64_tr_b16 v[194:195], v155 offset:43008
    v_mfma_f32_16x16x32_bf16 v[44:47], v[180:183], a[188:191], v[44:47]
    ds_read_b64_tr_b16 v[196:197], v155 offset:51200
    v_mfma_f32_16x16x32_bf16 v[40:43], v[180:183], a[184:187], v[40:43]
    v_mfma_f32_16x16x32_bf16 v[40:43], v[176:179], a[168:171], v[40:43]
    ds_read_b64_tr_b16 v[198:199], v155 offset:59392
    v_mfma_f32_16x16x32_bf16 v[36:39], v[176:179], a[164:167], v[36:39]
    buffer_load_dwordx4 a[244:247], v164, s[20:23], s29 offen offset:1024
    v_mfma_f32_16x16x32_bf16 v[36:39], v[180:183], a[180:183], v[36:39]
    v_mfma_f32_16x16x32_bf16 v[32:35], v[180:183], a[176:179], v[32:35]
    ds_read_b64_tr_b16 v[200:201], v156 offset:34816
    v_mfma_f32_16x16x32_bf16 v[32:35], v[176:179], a[160:163], v[32:35]
    s_waitcnt lgkmcnt(5)
    v_mfma_f32_16x16x32_bf16 v[48:51], v[184:187], a[160:163], v[48:51]
    ds_read_b64_tr_b16 v[202:203], v156 offset:43008
    v_mfma_f32_16x16x32_bf16 v[48:51], v[188:191], a[176:179], v[48:51]
    s_add_u32 s31, s31, 229376
    ds_read_b64_tr_b16 v[204:205], v156 offset:51200
    v_mfma_f32_16x16x32_bf16 v[52:55], v[188:191], a[180:183], v[52:55]
    s_add_u32 m0, s52, 116736
    v_mfma_f32_16x16x32_bf16 v[52:55], v[184:187], a[164:167], v[52:55]
    buffer_load_dwordx4 v162, s[16:19], s31 offen lds
    v_mfma_f32_16x16x32_bf16 v[56:59], v[184:187], a[168:171], v[56:59]
    ds_read_b64_tr_b16 v[206:207], v156 offset:59392
    v_mfma_f32_16x16x32_bf16 v[56:59], v[188:191], a[184:187], v[56:59]
    v_mfma_f32_16x16x32_bf16 v[60:63], v[188:191], a[188:191], v[60:63]
    ds_read_b64_tr_b16 v[176:177], v157 offset:34816
    v_mfma_f32_16x16x32_bf16 v[60:63], v[184:187], a[172:175], v[60:63]
    s_waitcnt lgkmcnt(5)
    ds_read_b64_tr_b16 v[178:179], v157 offset:43008
    v_mfma_f32_16x16x32_bf16 v[76:79], v[192:195], a[172:175], v[76:79]
    v_mfma_f32_16x16x32_bf16 v[76:79], v[196:199], a[188:191], v[76:79]
    ds_read_b64_tr_b16 v[180:181], v157 offset:51200
    v_mfma_f32_16x16x32_bf16 v[72:75], v[196:199], a[184:187], v[72:75]
    v_mfma_f32_16x16x32_bf16 v[72:75], v[192:195], a[168:171], v[72:75]
    buffer_load_dwordx4 a[248:251], v164, s[20:23], s29 offen offset:2048
    v_mfma_f32_16x16x32_bf16 v[68:71], v[192:195], a[164:167], v[68:71]
    ds_read_b64_tr_b16 v[182:183], v157 offset:59392
    v_mfma_f32_16x16x32_bf16 v[68:71], v[196:199], a[180:183], v[68:71]
    v_mfma_f32_16x16x32_bf16 v[64:67], v[196:199], a[176:179], v[64:67]
    ds_read_b64_tr_b16 v[184:185], v158 offset:34816
    v_mfma_f32_16x16x32_bf16 v[64:67], v[192:195], a[160:163], v[64:67]
    s_waitcnt lgkmcnt(5)
    ds_read_b64_tr_b16 v[186:187], v158 offset:43008
    v_mfma_f32_16x16x32_bf16 v[80:83], v[200:203], a[160:163], v[80:83]
    v_mfma_f32_16x16x32_bf16 v[80:83], v[204:207], a[176:179], v[80:83]
    s_add_u32 m0, s52, 117760
    ds_read_b64_tr_b16 v[188:189], v158 offset:51200
    v_mfma_f32_16x16x32_bf16 v[84:87], v[204:207], a[180:183], v[84:87]
    buffer_load_dwordx4 v163, s[16:19], s31 offen lds
    v_mfma_f32_16x16x32_bf16 v[84:87], v[200:203], a[164:167], v[84:87]
    v_mfma_f32_16x16x32_bf16 v[88:91], v[200:203], a[168:171], v[88:91]
    ds_read_b64_tr_b16 v[190:191], v158 offset:59392
    v_mfma_f32_16x16x32_bf16 v[88:91], v[204:207], a[184:187], v[88:91]
    s_waitcnt vmcnt(16)
    v_mfma_f32_16x16x32_bf16 v[92:95], v[204:207], a[188:191], v[92:95]
    s_barrier
    v_mfma_f32_16x16x32_bf16 v[92:95], v[200:203], a[172:175], v[92:95]
    s_waitcnt lgkmcnt(4)
    ds_read_b64_tr_b16 v[192:193], v168 offset:0
    v_mfma_f32_16x16x32_bf16 v[108:111], v[176:179], a[172:175], v[108:111]
    ds_read_b64_tr_b16 v[194:195], v168 offset:8192
    v_mfma_f32_16x16x32_bf16 v[108:111], v[180:183], a[188:191], v[108:111]
    v_mfma_f32_16x16x32_bf16 v[104:107], v[180:183], a[184:187], v[104:107]
    buffer_load_dwordx4 a[252:255], v164, s[20:23], s29 offen offset:3072
    v_mfma_f32_16x16x32_bf16 v[104:107], v[176:179], a[168:171], v[104:107]
    ds_read_b64_tr_b16 v[196:197], v168 offset:16384
    v_mfma_f32_16x16x32_bf16 v[100:103], v[176:179], a[164:167], v[100:103]
    v_mfma_f32_16x16x32_bf16 v[100:103], v[180:183], a[180:183], v[100:103]
    ds_read_b64_tr_b16 v[198:199], v168 offset:24576
    v_mfma_f32_16x16x32_bf16 v[96:99], v[180:183], a[176:179], v[96:99]
    s_add_u32 s30, s30, 262144
    ds_read_b64_tr_b16 v[200:201], v169 offset:0
    v_mfma_f32_16x16x32_bf16 v[96:99], v[176:179], a[160:163], v[96:99]
    s_waitcnt lgkmcnt(5)
    v_mfma_f32_16x16x32_bf16 v[112:115], v[184:187], a[160:163], v[112:115]
    s_add_u32 m0, s52, 0
    ds_read_b64_tr_b16 v[202:203], v169 offset:8192
    v_mfma_f32_16x16x32_bf16 v[112:115], v[188:191], a[176:179], v[112:115]
    buffer_load_dwordx4 v160, s[12:15], s30 offen lds
    v_mfma_f32_16x16x32_bf16 v[116:119], v[188:191], a[180:183], v[116:119]
    v_mfma_f32_16x16x32_bf16 v[116:119], v[184:187], a[164:167], v[116:119]
    ds_read_b64_tr_b16 v[204:205], v169 offset:16384
    v_mfma_f32_16x16x32_bf16 v[120:123], v[184:187], a[168:171], v[120:123]
    ds_read_b64_tr_b16 v[206:207], v169 offset:24576
    v_mfma_f32_16x16x32_bf16 v[120:123], v[188:191], a[184:187], v[120:123]
    v_mfma_f32_16x16x32_bf16 v[124:127], v[188:191], a[188:191], v[124:127]
    s_waitcnt vmcnt(17)
    ds_read_b64_tr_b16 v[176:177], v170 offset:0
    v_mfma_f32_16x16x32_bf16 v[124:127], v[184:187], a[172:175], v[124:127]
    s_waitcnt lgkmcnt(5)
    v_mfma_f32_16x16x32_bf16 a[0:3], v[192:195], a[192:195], a[0:3]
    s_add_u32 s29, s29, 4096
    ds_read_b64_tr_b16 v[178:179], v170 offset:8192
    v_mfma_f32_16x16x32_bf16 a[0:3], v[196:199], a[208:211], a[0:3]
    buffer_load_dwordx4 a[128:131], v164, s[20:23], s29 offen offset:0
    v_mfma_f32_16x16x32_bf16 a[4:7], v[196:199], a[212:215], a[4:7]
    ds_read_b64_tr_b16 v[180:181], v170 offset:16384
    v_mfma_f32_16x16x32_bf16 a[4:7], v[192:195], a[196:199], a[4:7]
    v_mfma_f32_16x16x32_bf16 a[8:11], v[192:195], a[200:203], a[8:11]
    ds_read_b64_tr_b16 v[182:183], v170 offset:24576
    v_mfma_f32_16x16x32_bf16 a[8:11], v[196:199], a[216:219], a[8:11]
    v_mfma_f32_16x16x32_bf16 a[12:15], v[196:199], a[220:223], a[12:15]
    s_add_u32 m0, s52, 1024
    ds_read_b64_tr_b16 v[184:185], v171 offset:0
    v_mfma_f32_16x16x32_bf16 a[12:15], v[192:195], a[204:207], a[12:15]
    s_waitcnt lgkmcnt(5)
    ds_read_b64_tr_b16 v[186:187], v171 offset:8192
    v_mfma_f32_16x16x32_bf16 a[28:31], v[200:203], a[204:207], a[28:31]
    buffer_load_dwordx4 v161, s[12:15], s30 offen lds
    v_mfma_f32_16x16x32_bf16 a[28:31], v[204:207], a[220:223], a[28:31]
    v_mfma_f32_16x16x32_bf16 a[24:27], v[204:207], a[216:219], a[24:27]
    ds_read_b64_tr_b16 v[188:189], v171 offset:16384
    v_mfma_f32_16x16x32_bf16 a[24:27], v[200:203], a[200:203], a[24:27]
    v_mfma_f32_16x16x32_bf16 a[20:23], v[200:203], a[196:199], a[20:23]
    ds_read_b64_tr_b16 v[190:191], v171 offset:24576
    v_mfma_f32_16x16x32_bf16 a[20:23], v[204:207], a[212:215], a[20:23]
    ds_read_b64_tr_b16 v[192:193], v172 offset:0
    v_mfma_f32_16x16x32_bf16 a[16:19], v[204:207], a[208:211], a[16:19]
    v_mfma_f32_16x16x32_bf16 a[16:19], v[200:203], a[192:195], a[16:19]
    s_waitcnt lgkmcnt(5)
    ds_read_b64_tr_b16 v[194:195], v172 offset:8192
    v_mfma_f32_16x16x32_bf16 a[32:35], v[176:179], a[192:195], a[32:35]
    buffer_load_dwordx4 a[132:135], v164, s[20:23], s29 offen offset:1024
    v_mfma_f32_16x16x32_bf16 a[32:35], v[180:183], a[208:211], a[32:35]
    v_mfma_f32_16x16x32_bf16 a[36:39], v[180:183], a[212:215], a[36:39]
    ds_read_b64_tr_b16 v[196:197], v172 offset:16384
    v_mfma_f32_16x16x32_bf16 a[36:39], v[176:179], a[196:199], a[36:39]
    ds_read_b64_tr_b16 v[198:199], v172 offset:24576
    v_mfma_f32_16x16x32_bf16 a[40:43], v[176:179], a[200:203], a[40:43]
    buffer_load_dword v15, v14, s[36:39], s35 offen
    v_mfma_f32_16x16x32_bf16 a[40:43], v[180:183], a[216:219], a[40:43]
    s_add_u32 s31, s31, 229376
    v_mfma_f32_16x16x32_bf16 a[44:47], v[180:183], a[220:223], a[44:47]
    s_add_u32 m0, s52, 2048
    ds_read_b64_tr_b16 v[200:201], v173 offset:0
    v_mfma_f32_16x16x32_bf16 a[44:47], v[176:179], a[204:207], a[44:47]
    s_waitcnt lgkmcnt(5)
    v_mfma_f32_16x16x32_bf16 a[60:63], v[184:187], a[204:207], a[60:63]
    buffer_load_dwordx4 v162, s[16:19], s31 offen lds
    v_mfma_f32_16x16x32_bf16 a[60:63], v[188:191], a[220:223], a[60:63]
    ds_read_b64_tr_b16 v[202:203], v173 offset:8192
    v_mfma_f32_16x16x32_bf16 a[56:59], v[188:191], a[216:219], a[56:59]
    ds_read_b64_tr_b16 v[204:205], v173 offset:16384
    v_mfma_f32_16x16x32_bf16 a[56:59], v[184:187], a[200:203], a[56:59]
    v_mfma_f32_16x16x32_bf16 a[52:55], v[184:187], a[196:199], a[52:55]
    ds_read_b64_tr_b16 v[206:207], v173 offset:24576
    v_mfma_f32_16x16x32_bf16 a[52:55], v[188:191], a[212:215], a[52:55]
    v_mfma_f32_16x16x32_bf16 a[48:51], v[188:191], a[208:211], a[48:51]
    ds_read_b64_tr_b16 v[176:177], v174 offset:0
    v_mfma_f32_16x16x32_bf16 a[48:51], v[184:187], a[192:195], a[48:51]
    s_waitcnt lgkmcnt(5)
    ds_read_b64_tr_b16 v[178:179], v174 offset:8192
    v_mfma_f32_16x16x32_bf16 a[64:67], v[192:195], a[192:195], a[64:67]
    buffer_load_dwordx4 a[136:139], v164, s[20:23], s29 offen offset:2048
    v_mfma_f32_16x16x32_bf16 a[64:67], v[196:199], a[208:211], a[64:67]
    v_mfma_f32_16x16x32_bf16 a[68:71], v[196:199], a[212:215], a[68:71]
    ds_read_b64_tr_b16 v[180:181], v174 offset:16384
    v_mfma_f32_16x16x32_bf16 a[68:71], v[192:195], a[196:199], a[68:71]
    v_mfma_f32_16x16x32_bf16 a[72:75], v[192:195], a[200:203], a[72:75]
    ds_read_b64_tr_b16 v[182:183], v174 offset:24576
    v_mfma_f32_16x16x32_bf16 a[72:75], v[196:199], a[216:219], a[72:75]
    s_add_u32 m0, s52, 3072
    ds_read_b64_tr_b16 v[184:185], v175 offset:0
    v_mfma_f32_16x16x32_bf16 a[76:79], v[196:199], a[220:223], a[76:79]
    buffer_load_dwordx4 v163, s[16:19], s31 offen lds
    v_mfma_f32_16x16x32_bf16 a[76:79], v[192:195], a[204:207], a[76:79]
    s_waitcnt lgkmcnt(5)
    v_mfma_f32_16x16x32_bf16 a[92:95], v[200:203], a[204:207], a[92:95]
    ds_read_b64_tr_b16 v[186:187], v175 offset:8192
    v_mfma_f32_16x16x32_bf16 a[92:95], v[204:207], a[220:223], a[92:95]
    v_mfma_f32_16x16x32_bf16 a[88:91], v[204:207], a[216:219], a[88:91]
    ds_read_b64_tr_b16 v[188:189], v175 offset:16384
    v_mfma_f32_16x16x32_bf16 a[88:91], v[200:203], a[200:203], a[88:91]
    ds_read_b64_tr_b16 v[190:191], v175 offset:24576
    v_mfma_f32_16x16x32_bf16 a[84:87], v[200:203], a[196:199], a[84:87]
    v_mfma_f32_16x16x32_bf16 a[84:87], v[204:207], a[212:215], a[84:87]
    ds_read_b64_tr_b16 v[192:193], v168 offset:2048
    v_mfma_f32_16x16x32_bf16 a[80:83], v[204:207], a[208:211], a[80:83]
    buffer_load_dwordx4 a[140:143], v164, s[20:23], s29 offen offset:3072
    v_mfma_f32_16x16x32_bf16 a[80:83], v[200:203], a[192:195], a[80:83]
    s_waitcnt lgkmcnt(5)
    v_mfma_f32_16x16x32_bf16 a[96:99], v[176:179], a[192:195], a[96:99]
    ds_read_b64_tr_b16 v[194:195], v168 offset:10240
    v_mfma_f32_16x16x32_bf16 a[96:99], v[180:183], a[208:211], a[96:99]
    ds_read_b64_tr_b16 v[196:197], v168 offset:18432
    v_mfma_f32_16x16x32_bf16 a[100:103], v[180:183], a[212:215], a[100:103]
    buffer_load_dword v15, v14, s[40:43], s35 offen
    v_mfma_f32_16x16x32_bf16 a[100:103], v[176:179], a[196:199], a[100:103]
    s_add_u32 s30, s30, 262144
    v_mfma_f32_16x16x32_bf16 a[104:107], v[176:179], a[200:203], a[104:107]
    s_add_u32 m0, s52, 16384
    ds_read_b64_tr_b16 v[198:199], v168 offset:26624
    v_mfma_f32_16x16x32_bf16 a[104:107], v[180:183], a[216:219], a[104:107]
    buffer_load_dwordx4 v160, s[12:15], s30 offen lds
    v_mfma_f32_16x16x32_bf16 a[108:111], v[180:183], a[220:223], a[108:111]
    v_mfma_f32_16x16x32_bf16 a[108:111], v[176:179], a[204:207], a[108:111]
    s_waitcnt lgkmcnt(4)
    ds_read_b64_tr_b16 v[200:201], v169 offset:2048
    v_mfma_f32_16x16x32_bf16 a[124:127], v[184:187], a[204:207], a[124:127]
    ds_read_b64_tr_b16 v[202:203], v169 offset:10240
    v_mfma_f32_16x16x32_bf16 a[124:127], v[188:191], a[220:223], a[124:127]
    v_mfma_f32_16x16x32_bf16 a[120:123], v[188:191], a[216:219], a[120:123]
    ds_read_b64_tr_b16 v[204:205], v169 offset:18432
    v_mfma_f32_16x16x32_bf16 a[120:123], v[184:187], a[200:203], a[120:123]
    v_mfma_f32_16x16x32_bf16 a[116:119], v[184:187], a[196:199], a[116:119]
    s_add_u32 s29, s29, 4096
    ds_read_b64_tr_b16 v[206:207], v169 offset:26624
    v_mfma_f32_16x16x32_bf16 a[116:119], v[188:191], a[212:215], a[116:119]
    buffer_load_dwordx4 a[144:147], v164, s[20:23], s29 offen offset:0
    v_mfma_f32_16x16x32_bf16 a[112:115], v[188:191], a[208:211], a[112:115]
    ds_read_b64_tr_b16 v[176:177], v170 offset:2048
    v_mfma_f32_16x16x32_bf16 a[112:115], v[184:187], a[192:195], a[112:115]
    s_waitcnt lgkmcnt(5)
    v_mfma_f32_16x16x32_bf16 v[16:19], v[192:195], a[192:195], v[16:19]
    ds_read_b64_tr_b16 v[178:179], v170 offset:10240
    v_mfma_f32_16x16x32_bf16 v[16:19], v[196:199], a[208:211], v[16:19]
    v_mfma_f32_16x16x32_bf16 v[20:23], v[196:199], a[212:215], v[20:23]
    ds_read_b64_tr_b16 v[180:181], v170 offset:18432
    v_mfma_f32_16x16x32_bf16 v[20:23], v[192:195], a[196:199], v[20:23]
    s_add_u32 m0, s52, 17408
    ds_read_b64_tr_b16 v[182:183], v170 offset:26624
    v_mfma_f32_16x16x32_bf16 v[24:27], v[192:195], a[200:203], v[24:27]
    buffer_load_dwordx4 v161, s[12:15], s30 offen lds
    v_mfma_f32_16x16x32_bf16 v[24:27], v[196:199], a[216:219], v[24:27]
    v_mfma_f32_16x16x32_bf16 v[28:31], v[196:199], a[220:223], v[28:31]
    ds_read_b64_tr_b16 v[184:185], v171 offset:2048
    v_mfma_f32_16x16x32_bf16 v[28:31], v[192:195], a[204:207], v[28:31]
    s_waitcnt lgkmcnt(5)
    v_mfma_f32_16x16x32_bf16 v[44:47], v[200:203], a[204:207], v[44:47]
    ds_read_b64_tr_b16 v[186:187], v171 offset:10240
    v_mfma_f32_16x16x32_bf16 v[44:47], v[204:207], a[220:223], v[44:47]
    ds_read_b64_tr_b16 v[188:189], v171 offset:18432
    v_mfma_f32_16x16x32_bf16 v[40:43], v[204:207], a[216:219], v[40:43]
    v_mfma_f32_16x16x32_bf16 v[40:43], v[200:203], a[200:203], v[40:43]
    ds_read_b64_tr_b16 v[190:191], v171 offset:26624
    v_mfma_f32_16x16x32_bf16 v[36:39], v[200:203], a[196:199], v[36:39]
    buffer_load_dwordx4 a[148:151], v164, s[20:23], s29 offen offset:1024
    v_mfma_f32_16x16x32_bf16 v[36:39], v[204:207], a[212:215], v[36:39]
    v_mfma_f32_16x16x32_bf16 v[32:35], v[204:207], a[208:211], v[32:35]
    ds_read_b64_tr_b16 v[192:193], v172 offset:2048
    v_mfma_f32_16x16x32_bf16 v[32:35], v[200:203], a[192:195], v[32:35]
    s_waitcnt lgkmcnt(5)
    ds_read_b64_tr_b16 v[194:195], v172 offset:10240
    v_mfma_f32_16x16x32_bf16 v[48:51], v[176:179], a[192:195], v[48:51]
    v_mfma_f32_16x16x32_bf16 v[48:51], v[180:183], a[208:211], v[48:51]
    s_add_u32 s31, s31, 229376
    ds_read_b64_tr_b16 v[196:197], v172 offset:18432
    v_mfma_f32_16x16x32_bf16 v[52:55], v[180:183], a[212:215], v[52:55]
    s_add_u32 m0, s52, 18432
    v_mfma_f32_16x16x32_bf16 v[52:55], v[176:179], a[196:199], v[52:55]
    buffer_load_dwordx4 v162, s[16:19], s31 offen lds
    v_mfma_f32_16x16x32_bf16 v[56:59], v[176:179], a[200:203], v[56:59]
    ds_read_b64_tr_b16 v[198:199], v172 offset:26624
    v_mfma_f32_16x16x32_bf16 v[56:59], v[180:183], a[216:219], v[56:59]
    ds_read_b64_tr_b16 v[200:201], v173 offset:2048
    v_mfma_f32_16x16x32_bf16 v[60:63], v[180:183], a[220:223], v[60:63]
    v_mfma_f32_16x16x32_bf16 v[60:63], v[176:179], a[204:207], v[60:63]
    s_waitcnt lgkmcnt(5)
    ds_read_b64_tr_b16 v[202:203], v173 offset:10240
    v_mfma_f32_16x16x32_bf16 v[76:79], v[184:187], a[204:207], v[76:79]
    v_mfma_f32_16x16x32_bf16 v[76:79], v[188:191], a[220:223], v[76:79]
    ds_read_b64_tr_b16 v[204:205], v173 offset:18432
    v_mfma_f32_16x16x32_bf16 v[72:75], v[188:191], a[216:219], v[72:75]
    global_load_dword v4, v[2:3], off
    v_mfma_f32_16x16x32_bf16 v[72:75], v[184:187], a[200:203], v[72:75]
    buffer_load_dwordx4 a[152:155], v164, s[20:23], s29 offen offset:2048
    v_mfma_f32_16x16x32_bf16 v[68:71], v[184:187], a[196:199], v[68:71]
    ds_read_b64_tr_b16 v[206:207], v173 offset:26624
    v_mfma_f32_16x16x32_bf16 v[68:71], v[188:191], a[212:215], v[68:71]
    v_mfma_f32_16x16x32_bf16 v[64:67], v[188:191], a[208:211], v[64:67]
    ds_read_b64_tr_b16 v[176:177], v174 offset:2048
    v_mfma_f32_16x16x32_bf16 v[64:67], v[184:187], a[192:195], v[64:67]
    s_waitcnt lgkmcnt(5)
    v_mfma_f32_16x16x32_bf16 v[80:83], v[192:195], a[192:195], v[80:83]
    ds_read_b64_tr_b16 v[178:179], v174 offset:10240
    v_mfma_f32_16x16x32_bf16 v[80:83], v[196:199], a[208:211], v[80:83]
    s_add_u32 m0, s52, 19456
    ds_read_b64_tr_b16 v[180:181], v174 offset:18432
    v_mfma_f32_16x16x32_bf16 v[84:87], v[196:199], a[212:215], v[84:87]
    buffer_load_dwordx4 v163, s[16:19], s31 offen lds
    v_mfma_f32_16x16x32_bf16 v[84:87], v[192:195], a[196:199], v[84:87]
    v_mfma_f32_16x16x32_bf16 v[88:91], v[192:195], a[200:203], v[88:91]
    ds_read_b64_tr_b16 v[182:183], v174 offset:26624
    v_mfma_f32_16x16x32_bf16 v[88:91], v[196:199], a[216:219], v[88:91]
    s_waitcnt vmcnt(19)
    v_mfma_f32_16x16x32_bf16 v[92:95], v[196:199], a[220:223], v[92:95]
    s_barrier
    v_mfma_f32_16x16x32_bf16 v[92:95], v[192:195], a[204:207], v[92:95]
    s_waitcnt lgkmcnt(4)
    ds_read_b64_tr_b16 v[184:185], v168 offset:32768
    v_mfma_f32_16x16x32_bf16 v[108:111], v[200:203], a[204:207], v[108:111]
    ds_read_b64_tr_b16 v[186:187], v168 offset:40960
    v_mfma_f32_16x16x32_bf16 v[108:111], v[204:207], a[220:223], v[108:111]
    v_mfma_f32_16x16x32_bf16 v[104:107], v[204:207], a[216:219], v[104:107]
    buffer_load_dwordx4 a[156:159], v164, s[20:23], s29 offen offset:3072
    v_mfma_f32_16x16x32_bf16 v[104:107], v[200:203], a[200:203], v[104:107]
    ds_read_b64_tr_b16 v[188:189], v168 offset:49152
    v_mfma_f32_16x16x32_bf16 v[100:103], v[200:203], a[196:199], v[100:103]
    v_mfma_f32_16x16x32_bf16 v[100:103], v[204:207], a[212:215], v[100:103]
    ds_read_b64_tr_b16 v[190:191], v168 offset:57344
    v_mfma_f32_16x16x32_bf16 v[96:99], v[204:207], a[208:211], v[96:99]
    s_add_u32 s30, s30, 262144
    ds_read_b64_tr_b16 v[192:193], v169 offset:32768
    v_mfma_f32_16x16x32_bf16 v[96:99], v[200:203], a[192:195], v[96:99]
    s_waitcnt lgkmcnt(5)
    v_mfma_f32_16x16x32_bf16 v[112:115], v[176:179], a[192:195], v[112:115]
    s_add_u32 m0, s52, 32768
    ds_read_b64_tr_b16 v[194:195], v169 offset:40960
    v_mfma_f32_16x16x32_bf16 v[112:115], v[180:183], a[208:211], v[112:115]
    buffer_load_dwordx4 v160, s[12:15], s30 offen lds
    v_mfma_f32_16x16x32_bf16 v[116:119], v[180:183], a[212:215], v[116:119]
    v_mfma_f32_16x16x32_bf16 v[116:119], v[176:179], a[196:199], v[116:119]
    ds_read_b64_tr_b16 v[196:197], v169 offset:49152
    v_mfma_f32_16x16x32_bf16 v[120:123], v[176:179], a[200:203], v[120:123]
    v_mfma_f32_16x16x32_bf16 v[120:123], v[180:183], a[216:219], v[120:123]
    ds_read_b64_tr_b16 v[198:199], v169 offset:57344
    v_mfma_f32_16x16x32_bf16 v[124:127], v[180:183], a[220:223], v[124:127]
    s_waitcnt vmcnt(20)
    ds_read_b64_tr_b16 v[200:201], v170 offset:32768
    v_mfma_f32_16x16x32_bf16 v[124:127], v[176:179], a[204:207], v[124:127]
    s_waitcnt lgkmcnt(5)
    v_mfma_f32_16x16x32_bf16 a[0:3], v[184:187], a[224:227], a[0:3]
    s_add_u32 s29, s29, 4096
    ds_read_b64_tr_b16 v[202:203], v170 offset:40960
    v_mfma_f32_16x16x32_bf16 a[0:3], v[188:191], a[240:243], a[0:3]
    buffer_load_dwordx4 a[160:163], v164, s[20:23], s29 offen offset:0
    v_mfma_f32_16x16x32_bf16 a[4:7], v[188:191], a[244:247], a[4:7]
    v_mfma_f32_16x16x32_bf16 a[4:7], v[184:187], a[228:231], a[4:7]
    ds_read_b64_tr_b16 v[204:205], v170 offset:49152
    v_mfma_f32_16x16x32_bf16 a[8:11], v[184:187], a[232:235], a[8:11]
    ds_read_b64_tr_b16 v[206:207], v170 offset:57344
    v_mfma_f32_16x16x32_bf16 a[8:11], v[188:191], a[248:251], a[8:11]
    v_mfma_f32_16x16x32_bf16 a[12:15], v[188:191], a[252:255], a[12:15]
    s_add_u32 m0, s52, 33792
    ds_read_b64_tr_b16 v[176:177], v171 offset:32768
    v_mfma_f32_16x16x32_bf16 a[12:15], v[184:187], a[236:239], a[12:15]
    s_waitcnt lgkmcnt(5)
    v_mfma_f32_16x16x32_bf16 a[28:31], v[192:195], a[236:239], a[28:31]
    buffer_load_dwordx4 v161, s[12:15], s30 offen lds
    v_mfma_f32_16x16x32_bf16 a[28:31], v[196:199], a[252:255], a[28:31]
    ds_read_b64_tr_b16 v[178:179], v171 offset:40960
    v_mfma_f32_16x16x32_bf16 a[24:27], v[196:199], a[248:251], a[24:27]
    v_mfma_f32_16x16x32_bf16 a[24:27], v[192:195], a[232:235], a[24:27]
    ds_read_b64_tr_b16 v[180:181], v171 offset:49152
    v_mfma_f32_16x16x32_bf16 a[20:23], v[192:195], a[228:231], a[20:23]
    ds_read_b64_tr_b16 v[182:183], v171 offset:57344
    v_mfma_f32_16x16x32_bf16 a[20:23], v[196:199], a[244:247], a[20:23]
    v_mfma_f32_16x16x32_bf16 a[16:19], v[196:199], a[240:243], a[16:19]
    ds_read_b64_tr_b16 v[184:185], v172 offset:32768
    v_mfma_f32_16x16x32_bf16 a[16:19], v[192:195], a[224:227], a[16:19]
    s_waitcnt lgkmcnt(5)
    v_mfma_f32_16x16x32_bf16 a[32:35], v[200:203], a[224:227], a[32:35]
    buffer_load_dwordx4 a[164:167], v164, s[20:23], s29 offen offset:1024
    v_mfma_f32_16x16x32_bf16 a[32:35], v[204:207], a[240:243], a[32:35]
    ds_read_b64_tr_b16 v[186:187], v172 offset:40960
    v_mfma_f32_16x16x32_bf16 a[36:39], v[204:207], a[244:247], a[36:39]
    ds_read_b64_tr_b16 v[188:189], v172 offset:49152
    v_mfma_f32_16x16x32_bf16 a[36:39], v[200:203], a[228:231], a[36:39]
    v_mfma_f32_16x16x32_bf16 a[40:43], v[200:203], a[232:235], a[40:43]
    ds_read_b64_tr_b16 v[190:191], v172 offset:57344
    v_mfma_f32_16x16x32_bf16 a[40:43], v[204:207], a[248:251], a[40:43]
    s_add_u32 s31, s31, 229376
    v_mfma_f32_16x16x32_bf16 a[44:47], v[204:207], a[252:255], a[44:47]
    s_add_u32 m0, s52, 34816
    ds_read_b64_tr_b16 v[192:193], v173 offset:32768
    v_mfma_f32_16x16x32_bf16 a[44:47], v[200:203], a[236:239], a[44:47]
    s_waitcnt lgkmcnt(5)
    v_mfma_f32_16x16x32_bf16 a[60:63], v[176:179], a[236:239], a[60:63]
    buffer_load_dwordx4 v162, s[16:19], s31 offen lds
    v_mfma_f32_16x16x32_bf16 a[60:63], v[180:183], a[252:255], a[60:63]
    ds_read_b64_tr_b16 v[194:195], v173 offset:40960
    v_mfma_f32_16x16x32_bf16 a[56:59], v[180:183], a[248:251], a[56:59]
    ds_read_b64_tr_b16 v[196:197], v173 offset:49152
    v_mfma_f32_16x16x32_bf16 a[56:59], v[176:179], a[232:235], a[56:59]
    v_mfma_f32_16x16x32_bf16 a[52:55], v[176:179], a[228:231], a[52:55]
    ds_read_b64_tr_b16 v[198:199], v173 offset:57344
    v_mfma_f32_16x16x32_bf16 a[52:55], v[180:183], a[244:247], a[52:55]
    v_mfma_f32_16x16x32_bf16 a[48:51], v[180:183], a[240:243], a[48:51]
    ds_read_b64_tr_b16 v[200:201], v174 offset:32768
    v_mfma_f32_16x16x32_bf16 a[48:51], v[176:179], a[224:227], a[48:51]
    s_waitcnt lgkmcnt(5)
    ds_read_b64_tr_b16 v[202:203], v174 offset:40960
    v_mfma_f32_16x16x32_bf16 a[64:67], v[184:187], a[224:227], a[64:67]
    buffer_load_dwordx4 a[168:171], v164, s[20:23], s29 offen offset:2048
    v_mfma_f32_16x16x32_bf16 a[64:67], v[188:191], a[240:243], a[64:67]
    v_mfma_f32_16x16x32_bf16 a[68:71], v[188:191], a[244:247], a[68:71]
    ds_read_b64_tr_b16 v[204:205], v174 offset:49152
    v_mfma_f32_16x16x32_bf16 a[68:71], v[184:187], a[228:231], a[68:71]
    v_mfma_f32_16x16x32_bf16 a[72:75], v[184:187], a[232:235], a[72:75]
    ds_read_b64_tr_b16 v[206:207], v174 offset:57344
    v_mfma_f32_16x16x32_bf16 a[72:75], v[188:191], a[248:251], a[72:75]
    s_add_u32 m0, s52, 35840
    v_mfma_f32_16x16x32_bf16 a[76:79], v[188:191], a[252:255], a[76:79]
    buffer_load_dwordx4 v163, s[16:19], s31 offen lds
    v_mfma_f32_16x16x32_bf16 a[76:79], v[184:187], a[236:239], a[76:79]
    s_waitcnt lgkmcnt(4)
    ds_read_b64_tr_b16 v[176:177], v175 offset:32768
    v_mfma_f32_16x16x32_bf16 a[92:95], v[192:195], a[236:239], a[92:95]
    ds_read_b64_tr_b16 v[178:179], v175 offset:40960
    v_mfma_f32_16x16x32_bf16 a[92:95], v[196:199], a[252:255], a[92:95]
    v_mfma_f32_16x16x32_bf16 a[88:91], v[196:199], a[248:251], a[88:91]
    ds_read_b64_tr_b16 v[180:181], v175 offset:49152
    v_mfma_f32_16x16x32_bf16 a[88:91], v[192:195], a[232:235], a[88:91]
    v_mfma_f32_16x16x32_bf16 a[84:87], v[192:195], a[228:231], a[84:87]
    ds_read_b64_tr_b16 v[182:183], v175 offset:57344
    v_mfma_f32_16x16x32_bf16 a[84:87], v[196:199], a[244:247], a[84:87]
    ds_read_b64_tr_b16 v[184:185], v168 offset:34816
    v_mfma_f32_16x16x32_bf16 a[80:83], v[196:199], a[240:243], a[80:83]
    buffer_load_dwordx4 a[172:175], v164, s[20:23], s29 offen offset:3072
    v_mfma_f32_16x16x32_bf16 a[80:83], v[192:195], a[224:227], a[80:83]
    s_waitcnt lgkmcnt(5)
    v_mfma_f32_16x16x32_bf16 a[96:99], v[200:203], a[224:227], a[96:99]
    ds_read_b64_tr_b16 v[186:187], v168 offset:43008
    v_mfma_f32_16x16x32_bf16 a[96:99], v[204:207], a[240:243], a[96:99]
    v_mfma_f32_16x16x32_bf16 a[100:103], v[204:207], a[244:247], a[100:103]
    ds_read_b64_tr_b16 v[188:189], v168 offset:51200
    v_mfma_f32_16x16x32_bf16 a[100:103], v[200:203], a[228:231], a[100:103]
    s_add_u32 s30, s30, 262144
    v_mfma_f32_16x16x32_bf16 a[104:107], v[200:203], a[232:235], a[104:107]
    s_add_u32 m0, s52, 49152
    ds_read_b64_tr_b16 v[190:191], v168 offset:59392
    v_mfma_f32_16x16x32_bf16 a[104:107], v[204:207], a[248:251], a[104:107]
    buffer_load_dwordx4 v160, s[12:15], s30 offen lds
    v_mfma_f32_16x16x32_bf16 a[108:111], v[204:207], a[252:255], a[108:111]
    ds_read_b64_tr_b16 v[192:193], v169 offset:34816
    v_mfma_f32_16x16x32_bf16 a[108:111], v[200:203], a[236:239], a[108:111]
    s_waitcnt lgkmcnt(5)
    v_mfma_f32_16x16x32_bf16 a[124:127], v[176:179], a[236:239], a[124:127]
    ds_read_b64_tr_b16 v[194:195], v169 offset:43008
    v_mfma_f32_16x16x32_bf16 a[124:127], v[180:183], a[252:255], a[124:127]
    v_mfma_f32_16x16x32_bf16 a[120:123], v[180:183], a[248:251], a[120:123]
    ds_read_b64_tr_b16 v[196:197], v169 offset:51200
    v_mfma_f32_16x16x32_bf16 a[120:123], v[176:179], a[232:235], a[120:123]
    ds_read_b64_tr_b16 v[198:199], v169 offset:59392
    v_mfma_f32_16x16x32_bf16 a[116:119], v[176:179], a[228:231], a[116:119]
    s_add_u32 s29, s29, 4096
    v_mfma_f32_16x16x32_bf16 a[116:119], v[180:183], a[244:247], a[116:119]
    buffer_load_dwordx4 a[176:179], v164, s[20:23], s29 offen offset:0
    v_mfma_f32_16x16x32_bf16 a[112:115], v[180:183], a[240:243], a[112:115]
    ds_read_b64_tr_b16 v[200:201], v170 offset:34816
    v_mfma_f32_16x16x32_bf16 a[112:115], v[176:179], a[224:227], a[112:115]
    s_waitcnt lgkmcnt(5)
    v_mfma_f32_16x16x32_bf16 v[16:19], v[184:187], a[224:227], v[16:19]
    ds_read_b64_tr_b16 v[202:203], v170 offset:43008
    v_mfma_f32_16x16x32_bf16 v[16:19], v[188:191], a[240:243], v[16:19]
    v_mfma_f32_16x16x32_bf16 v[20:23], v[188:191], a[244:247], v[20:23]
    ds_read_b64_tr_b16 v[204:205], v170 offset:51200
    v_mfma_f32_16x16x32_bf16 v[20:23], v[184:187], a[228:231], v[20:23]
    s_add_u32 m0, s52, 50176
    ds_read_b64_tr_b16 v[206:207], v170 offset:59392
    v_mfma_f32_16x16x32_bf16 v[24:27], v[184:187], a[232:235], v[24:27]
    buffer_load_dwordx4 v161, s[12:15], s30 offen lds
    v_mfma_f32_16x16x32_bf16 v[24:27], v[188:191], a[248:251], v[24:27]
    v_mfma_f32_16x16x32_bf16 v[28:31], v[188:191], a[252:255], v[28:31]
    ds_read_b64_tr_b16 v[176:177], v171 offset:34816
    v_mfma_f32_16x16x32_bf16 v[28:31], v[184:187], a[236:239], v[28:31]
    s_waitcnt lgkmcnt(5)
    v_mfma_f32_16x16x32_bf16 v[44:47], v[192:195], a[236:239], v[44:47]
    ds_read_b64_tr_b16 v[178:179], v171 offset:43008
    v_mfma_f32_16x16x32_bf16 v[44:47], v[196:199], a[252:255], v[44:47]
    ds_read_b64_tr_b16 v[180:181], v171 offset:51200
    v_mfma_f32_16x16x32_bf16 v[40:43], v[196:199], a[248:251], v[40:43]
    v_mfma_f32_16x16x32_bf16 v[40:43], v[192:195], a[232:235], v[40:43]
    ds_read_b64_tr_b16 v[182:183], v171 offset:59392
    v_mfma_f32_16x16x32_bf16 v[36:39], v[192:195], a[228:231], v[36:39]
    buffer_load_dwordx4 a[180:183], v164, s[20:23], s29 offen offset:1024
    v_mfma_f32_16x16x32_bf16 v[36:39], v[196:199], a[244:247], v[36:39]
    v_mfma_f32_16x16x32_bf16 v[32:35], v[196:199], a[240:243], v[32:35]
    ds_read_b64_tr_b16 v[184:185], v172 offset:34816
    v_mfma_f32_16x16x32_bf16 v[32:35], v[192:195], a[224:227], v[32:35]
    s_waitcnt lgkmcnt(5)
    v_mfma_f32_16x16x32_bf16 v[48:51], v[200:203], a[224:227], v[48:51]
    ds_read_b64_tr_b16 v[186:187], v172 offset:43008
    v_mfma_f32_16x16x32_bf16 v[48:51], v[204:207], a[240:243], v[48:51]
    s_add_u32 s31, s31, 229376
    ds_read_b64_tr_b16 v[188:189], v172 offset:51200
    v_mfma_f32_16x16x32_bf16 v[52:55], v[204:207], a[244:247], v[52:55]
    s_add_u32 m0, s52, 51200
    v_mfma_f32_16x16x32_bf16 v[52:55], v[200:203], a[228:231], v[52:55]
    buffer_load_dwordx4 v162, s[16:19], s31 offen lds
    v_mfma_f32_16x16x32_bf16 v[56:59], v[200:203], a[232:235], v[56:59]
    ds_read_b64_tr_b16 v[190:191], v172 offset:59392
    v_mfma_f32_16x16x32_bf16 v[56:59], v[204:207], a[248:251], v[56:59]
    v_mfma_f32_16x16x32_bf16 v[60:63], v[204:207], a[252:255], v[60:63]
    ds_read_b64_tr_b16 v[192:193], v173 offset:34816
    v_mfma_f32_16x16x32_bf16 v[60:63], v[200:203], a[236:239], v[60:63]
    s_waitcnt lgkmcnt(5)
    ds_read_b64_tr_b16 v[194:195], v173 offset:43008
    v_mfma_f32_16x16x32_bf16 v[76:79], v[176:179], a[236:239], v[76:79]
    v_mfma_f32_16x16x32_bf16 v[76:79], v[180:183], a[252:255], v[76:79]
    ds_read_b64_tr_b16 v[196:197], v173 offset:51200
    v_mfma_f32_16x16x32_bf16 v[72:75], v[180:183], a[248:251], v[72:75]
    v_mfma_f32_16x16x32_bf16 v[72:75], v[176:179], a[232:235], v[72:75]
    buffer_load_dwordx4 a[184:187], v164, s[20:23], s29 offen offset:2048
    v_mfma_f32_16x16x32_bf16 v[68:71], v[176:179], a[228:231], v[68:71]
    ds_read_b64_tr_b16 v[198:199], v173 offset:59392
    v_mfma_f32_16x16x32_bf16 v[68:71], v[180:183], a[244:247], v[68:71]
    v_mfma_f32_16x16x32_bf16 v[64:67], v[180:183], a[240:243], v[64:67]
    ds_read_b64_tr_b16 v[200:201], v174 offset:34816
    v_mfma_f32_16x16x32_bf16 v[64:67], v[176:179], a[224:227], v[64:67]
    s_waitcnt lgkmcnt(5)
    ds_read_b64_tr_b16 v[202:203], v174 offset:43008
    v_mfma_f32_16x16x32_bf16 v[80:83], v[184:187], a[224:227], v[80:83]
    v_mfma_f32_16x16x32_bf16 v[80:83], v[188:191], a[240:243], v[80:83]
    s_add_u32 m0, s52, 52224
    ds_read_b64_tr_b16 v[204:205], v174 offset:51200
    v_mfma_f32_16x16x32_bf16 v[84:87], v[188:191], a[244:247], v[84:87]
    buffer_load_dwordx4 v163, s[16:19], s31 offen lds
    v_mfma_f32_16x16x32_bf16 v[84:87], v[184:187], a[228:231], v[84:87]
    v_mfma_f32_16x16x32_bf16 v[88:91], v[184:187], a[232:235], v[88:91]
    ds_read_b64_tr_b16 v[206:207], v174 offset:59392
    v_mfma_f32_16x16x32_bf16 v[88:91], v[188:191], a[248:251], v[88:91]
    s_waitcnt vmcnt(16)
    v_mfma_f32_16x16x32_bf16 v[92:95], v[188:191], a[252:255], v[92:95]
    s_barrier
    v_mfma_f32_16x16x32_bf16 v[92:95], v[184:187], a[236:239], v[92:95]
    s_waitcnt lgkmcnt(4)
    ds_read_b64_tr_b16 v[176:177], v152 offset:0
    v_mfma_f32_16x16x32_bf16 v[108:111], v[192:195], a[236:239], v[108:111]
    ds_read_b64_tr_b16 v[178:179], v152 offset:8192
    v_mfma_f32_16x16x32_bf16 v[108:111], v[196:199], a[252:255], v[108:111]
    v_mfma_f32_16x16x32_bf16 v[104:107], v[196:199], a[248:251], v[104:107]
    buffer_load_dwordx4 a[188:191], v164, s[20:23], s29 offen offset:3072
    v_mfma_f32_16x16x32_bf16 v[104:107], v[192:195], a[232:235], v[104:107]
    ds_read_b64_tr_b16 v[180:181], v152 offset:16384
    v_mfma_f32_16x16x32_bf16 v[100:103], v[192:195], a[228:231], v[100:103]
    v_mfma_f32_16x16x32_bf16 v[100:103], v[196:199], a[244:247], v[100:103]
    ds_read_b64_tr_b16 v[182:183], v152 offset:24576
    v_mfma_f32_16x16x32_bf16 v[96:99], v[196:199], a[240:243], v[96:99]
    s_add_u32 s30, s30, 262144
    v_mfma_f32_16x16x32_bf16 v[96:99], v[192:195], a[224:227], v[96:99]
    s_waitcnt lgkmcnt(4)
    ds_read_b64_tr_b16 v[184:185], v153 offset:0
    v_mfma_f32_16x16x32_bf16 v[112:115], v[200:203], a[224:227], v[112:115]
    s_add_u32 m0, s52, 65536
    v_mfma_f32_16x16x32_bf16 v[112:115], v[204:207], a[240:243], v[112:115]
    buffer_load_dwordx4 v160, s[12:15], s30 offen lds
    v_mfma_f32_16x16x32_bf16 v[116:119], v[204:207], a[244:247], v[116:119]
    ds_read_b64_tr_b16 v[186:187], v153 offset:8192
    v_mfma_f32_16x16x32_bf16 v[116:119], v[200:203], a[228:231], v[116:119]
    v_mfma_f32_16x16x32_bf16 v[120:123], v[200:203], a[232:235], v[120:123]
    ds_read_b64_tr_b16 v[188:189], v153 offset:16384
    v_mfma_f32_16x16x32_bf16 v[120:123], v[204:207], a[248:251], v[120:123]
    v_mfma_f32_16x16x32_bf16 v[124:127], v[204:207], a[252:255], v[124:127]
    s_waitcnt vmcnt(17)
    ds_read_b64_tr_b16 v[190:191], v153 offset:24576
    v_mfma_f32_16x16x32_bf16 v[124:127], v[200:203], a[236:239], v[124:127]
    s_waitcnt lgkmcnt(4)
    s_sub_u32 s32, s32, 1
    s_cmp_eq_u32 s32, 1
    s_cselect_b32 s35, s34, s35
    s_cmp_lg_u32 s32, 0
    s_cbranch_scc1 f_p1_loop
    s_waitcnt lgkmcnt(0)
f_p1_epi:
    s_lshl_b32 s28, s5, 4
    s_lshl_b32 s29, s3, 2
    s_add_u32 s28, s28, s29
    s_mul_i32 s28, s28, 57344
    s_mul_i32 s29, s4, 3584
    s_add_u32 s28, s28, s29
    s_cmp_lt_u32 s4, 16
    s_cselect_b32 s28, s28, 0x7f000000
    v_lshlrev_b32 v9, 3, v1
    v_lshlrev_b32 v10, 4, v1
    v_mov_b32 v168, 0xc0135761
    v_mov_b32 v169, 0xc0135761
    v_mov_b32 v170, 0xbdd2d3e8
    v_mov_b32 v171, 0xbdd2d3e8
    v_mov_b32 v172, 0x3f800000
    v_mov_b32 v173, 0x3f800000
    v_mov_b32 v174, 0x3e0293ee
    v_mov_b32 v175, 0x3e0293ee
    v_pk_mul_f32 v[176:177], v[16:17], v[16:17]
    v_pk_mul_f32 v[178:179], v[18:19], v[18:19]
    v_pk_fma_f32 v[176:177], v[176:177], v[170:171], v[168:169]
    v_pk_fma_f32 v[178:179], v[178:179], v[170:171], v[168:169]
    v_pk_mul_f32 v[176:177], v[176:177], v[16:17]
    v_pk_mul_f32 v[178:179], v[178:179], v[18:19]
    v_exp_f32 v176, v176
    v_exp_f32 v177, v177
    v_exp_f32 v178, v178
    v_exp_f32 v179, v179
    v_pk_add_f32 v[176:177], v[176:177], v[172:173]
    v_pk_add_f32 v[178:179], v[178:179], v[172:173]
    v_rcp_f32 v176, v176
    v_pk_mul_f32 v[180:181], v[32:33], v[32:33]
    v_rcp_f32 v177, v177
    v_pk_mul_f32 v[182:183], v[34:35], v[34:35]
    v_rcp_f32 v178, v178
    v_pk_fma_f32 v[180:181], v[180:181], v[170:171], v[168:169]
    v_rcp_f32 v179, v179
    v_pk_fma_f32 v[182:183], v[182:183], v[170:171], v[168:169]
    v_pk_mul_f32 v[180:181], v[180:181], v[32:33]
    v_pk_mul_f32 v[182:183], v[182:183], v[34:35]
    s_waitcnt vmcnt(0)
    s_waitcnt lgkmcnt(0)
    s_barrier
    s_lshl_b32 s54, s4, 19
    s_add_u32 s12, s44, s54
    s_addc_u32 s13, s45, 0
    s_mov_b32 s14, 524288
    s_mov_b32 s15, 0x20000
    s_add_u32 s16, s46, s54
    s_addc_u32 s17, s47, 0
    s_mov_b32 s18, 524288
    s_mov_b32 s19, 0x20000
    s_mov_b32 s54, 4294950912
    s_mov_b32 s55, 4294950912
    s_mov_b32 s36, s56
    s_mov_b32 s37, s57
    s_mov_b32 s38, 8388608
    s_mov_b32 s39, 0x20000
    s_lshl_b32 s60, s2, 16
    s_lshl_b32 s29, s3, 14
    s_add_u32 s60, s60, s29
    s_sub_u32 s60, s60, 4096
    s_mov_b32 s44, s58
    s_mov_b32 s45, s59
    s_mov_b32 s46, 3670016
    s_mov_b32 s47, 0x20000
    s_add_u32 s54, s54, 16384
    s_add_u32 m0, s53, 98304
    s_nop 0
    buffer_load_dwordx4 v236, s[12:15], s54 offen offset:0 lds
    buffer_load_dwordx4 v237, s[12:15], s54 offen offset:1024 lds
    buffer_load_dwordx4 v238, s[12:15], s54 offen offset:2048 lds
    buffer_load_dwordx4 v239, s[12:15], s54 offen offset:3072 lds
    s_add_u32 s54, s54, 16384
    s_add_u32 m0, s53, 0
    s_nop 0
    buffer_load_dwordx4 v236, s[12:15], s54 offen offset:0 lds
    buffer_load_dwordx4 v237, s[12:15], s54 offen offset:1024 lds
    buffer_load_dwordx4 v238, s[12:15], s54 offen offset:2048 lds
    buffer_load_dwordx4 v239, s[12:15], s54 offen offset:3072 lds
    s_add_u32 s55, s55, 16384
    s_add_u32 m0, s53, 16384
    s_nop 0
    buffer_load_dwordx4 v240, s[16:19], s55 offen offset:0 lds
    buffer_load_dwordx4 v241, s[16:19], s55 offen offset:1024 lds
    buffer_load_dwordx4 v240, s[16:19], s55 offen offset:2048 lds
    buffer_load_dwordx4 v241, s[16:19], s55 offen offset:3072 lds
    v_pk_mul_f32 v[176:177], v[176:177], v[16:17]
    v_exp_f32 v180, v180
    v_pk_mul_f32 v[178:179], v[178:179], v[18:19]
    v_exp_f32 v181, v181
    v_cvt_pk_bf16_f32 v16, v176, v177
    v_exp_f32 v182, v182
    v_cvt_pk_bf16_f32 v17, v178, v179
    v_exp_f32 v183, v183
    v_accvgpr_write_b32 a208, v16
    v_accvgpr_write_b32 a209, v17
    s_add_u32 s54, s54, 16384
    s_add_u32 m0, s53, 32768
    s_nop 0
    buffer_load_dwordx4 v236, s[12:15], s54 offen offset:0 lds
    v_pk_add_f32 v[180:181], v[180:181], v[172:173]
    v_pk_add_f32 v[182:183], v[182:183], v[172:173]
    v_rcp_f32 v180, v180
    v_pk_mul_f32 v[184:185], v[48:49], v[48:49]
    v_rcp_f32 v181, v181
    v_pk_mul_f32 v[186:187], v[50:51], v[50:51]
    v_rcp_f32 v182, v182
    v_pk_fma_f32 v[184:185], v[184:185], v[170:171], v[168:169]
    v_rcp_f32 v183, v183
    v_pk_fma_f32 v[186:187], v[186:187], v[170:171], v[168:169]
    v_pk_mul_f32 v[184:185], v[184:185], v[48:49]
    v_pk_mul_f32 v[186:187], v[186:187], v[50:51]
    v_pk_mul_f32 v[180:181], v[180:181], v[32:33]
    v_exp_f32 v184, v184
    v_pk_mul_f32 v[182:183], v[182:183], v[34:35]
    v_exp_f32 v185, v185
    v_cvt_pk_bf16_f32 v18, v180, v181
    v_exp_f32 v186, v186
    v_cvt_pk_bf16_f32 v19, v182, v183
    v_exp_f32 v187, v187
    s_nop 0
    v_mfma_f32_16x16x32_bf16 v[128:131], v[208:211], v[16:19], 0
    v_mfma_f32_16x16x32_bf16 v[132:135], v[16:19], v[16:19], 0
    buffer_store_dwordx4 v[16:19], v10, s[24:27], s28 offen offset:0 sc1
    v_accvgpr_write_b32 a210, v18
    v_accvgpr_write_b32 a211, v19
    buffer_load_dwordx4 v237, s[12:15], s54 offen offset:1024 lds
    v_pk_add_f32 v[184:185], v[184:185], v[172:173]
    v_pk_add_f32 v[186:187], v[186:187], v[172:173]
    v_rcp_f32 v184, v184
    v_pk_mul_f32 v[188:189], v[64:65], v[64:65]
    v_rcp_f32 v185, v185
    v_pk_mul_f32 v[190:191], v[66:67], v[66:67]
    v_rcp_f32 v186, v186
    v_pk_fma_f32 v[188:189], v[188:189], v[170:171], v[168:169]
    v_rcp_f32 v187, v187
    v_pk_fma_f32 v[190:191], v[190:191], v[170:171], v[168:169]
    v_pk_mul_f32 v[188:189], v[188:189], v[64:65]
    v_pk_mul_f32 v[190:191], v[190:191], v[66:67]
    v_pk_mul_f32 v[184:185], v[184:185], v[48:49]
    v_exp_f32 v188, v188
    v_pk_mul_f32 v[186:187], v[186:187], v[50:51]
    v_exp_f32 v189, v189
    v_cvt_pk_bf16_f32 v48, v184, v185
    v_exp_f32 v190, v190
    v_cvt_pk_bf16_f32 v49, v186, v187
    v_exp_f32 v191, v191
    v_accvgpr_write_b32 a212, v48
    v_accvgpr_write_b32 a213, v49
    buffer_load_dwordx4 v238, s[12:15], s54 offen offset:2048 lds
    v_pk_add_f32 v[188:189], v[188:189], v[172:173]
    v_pk_add_f32 v[190:191], v[190:191], v[172:173]
    v_rcp_f32 v188, v188
    v_pk_mul_f32 v[176:177], v[80:81], v[80:81]
    v_rcp_f32 v189, v189
    v_pk_mul_f32 v[178:179], v[82:83], v[82:83]
    v_rcp_f32 v190, v190
    v_pk_fma_f32 v[176:177], v[176:177], v[170:171], v[168:169]
    v_rcp_f32 v191, v191
    v_pk_fma_f32 v[178:179], v[178:179], v[170:171], v[168:169]
    v_pk_mul_f32 v[176:177], v[176:177], v[80:81]
    v_pk_mul_f32 v[178:179], v[178:179], v[82:83]
    v_pk_mul_f32 v[188:189], v[188:189], v[64:65]
    v_exp_f32 v176, v176
    v_pk_mul_f32 v[190:191], v[190:191], v[66:67]
    v_exp_f32 v177, v177
    v_cvt_pk_bf16_f32 v50, v188, v189
    v_exp_f32 v178, v178
    v_cvt_pk_bf16_f32 v51, v190, v191
    v_exp_f32 v179, v179
    s_nop 0
    v_mfma_f32_16x16x32_bf16 v[128:131], v[208:211], v[48:51], v[128:131]
    v_mfma_f32_16x16x32_bf16 v[132:135], v[48:51], v[48:51], v[132:135]
    buffer_store_dwordx4 v[48:51], v10, s[24:27], s28 offen offset:1024 sc1
    v_accvgpr_write_b32 a214, v50
    v_accvgpr_write_b32 a215, v51
    buffer_load_dwordx4 v239, s[12:15], s54 offen offset:3072 lds
    v_pk_add_f32 v[176:177], v[176:177], v[172:173]
    v_pk_add_f32 v[178:179], v[178:179], v[172:173]
    v_rcp_f32 v176, v176
    v_pk_mul_f32 v[180:181], v[96:97], v[96:97]
    v_rcp_f32 v177, v177
    v_pk_mul_f32 v[182:183], v[98:99], v[98:99]
    v_rcp_f32 v178, v178
    v_pk_fma_f32 v[180:181], v[180:181], v[170:171], v[168:169]
    v_rcp_f32 v179, v179
    v_pk_fma_f32 v[182:183], v[182:183], v[170:171], v[168:169]
    v_pk_mul_f32 v[180:181], v[180:181], v[96:97]
    v_pk_mul_f32 v[182:183], v[182:183], v[98:99]
    v_pk_mul_f32 v[176:177], v[176:177], v[80:81]
    v_exp_f32 v180, v180
    v_pk_mul_f32 v[178:179], v[178:179], v[82:83]
    v_exp_f32 v181, v181
    v_cvt_pk_bf16_f32 v80, v176, v177
    v_exp_f32 v182, v182
    v_cvt_pk_bf16_f32 v81, v178, v179
    v_exp_f32 v183, v183
    v_accvgpr_write_b32 a216, v80
    v_accvgpr_write_b32 a217, v81
    s_add_u32 s55, s55, 16384
    s_add_u32 m0, s53, 49152
    s_nop 0
    buffer_load_dwordx4 v240, s[16:19], s55 offen offset:0 lds
    v_pk_add_f32 v[180:181], v[180:181], v[172:173]
    v_pk_add_f32 v[182:183], v[182:183], v[172:173]
    v_rcp_f32 v180, v180
    v_pk_mul_f32 v[184:185], v[112:113], v[112:113]
    v_rcp_f32 v181, v181
    v_pk_mul_f32 v[186:187], v[114:115], v[114:115]
    v_rcp_f32 v182, v182
    v_pk_fma_f32 v[184:185], v[184:185], v[170:171], v[168:169]
    v_rcp_f32 v183, v183
    v_pk_fma_f32 v[186:187], v[186:187], v[170:171], v[168:169]
    v_pk_mul_f32 v[184:185], v[184:185], v[112:113]
    v_pk_mul_f32 v[186:187], v[186:187], v[114:115]
    v_pk_mul_f32 v[180:181], v[180:181], v[96:97]
    v_exp_f32 v184, v184
    v_pk_mul_f32 v[182:183], v[182:183], v[98:99]
    v_exp_f32 v185, v185
    v_cvt_pk_bf16_f32 v82, v180, v181
    v_exp_f32 v186, v186
    v_cvt_pk_bf16_f32 v83, v182, v183
    v_exp_f32 v187, v187
    s_nop 0
    v_mfma_f32_16x16x32_bf16 v[128:131], v[208:211], v[80:83], v[128:131]
    v_mfma_f32_16x16x32_bf16 v[132:135], v[80:83], v[80:83], v[132:135]
    buffer_store_dwordx4 v[80:83], v10, s[24:27], s28 offen offset:2048 sc1
    v_accvgpr_write_b32 a218, v82
    v_accvgpr_write_b32 a219, v83
    buffer_load_dwordx4 v241, s[16:19], s55 offen offset:1024 lds
    v_pk_add_f32 v[184:185], v[184:185], v[172:173]
    v_pk_add_f32 v[186:187], v[186:187], v[172:173]
    v_rcp_f32 v184, v184
    v_pk_mul_f32 v[188:189], v[20:21], v[20:21]
    v_rcp_f32 v185, v185
    v_pk_mul_f32 v[190:191], v[22:23], v[22:23]
    v_rcp_f32 v186, v186
    v_pk_fma_f32 v[188:189], v[188:189], v[170:171], v[168:169]
    v_rcp_f32 v187, v187
    v_pk_fma_f32 v[190:191], v[190:191], v[170:171], v[168:169]
    v_pk_mul_f32 v[188:189], v[188:189], v[20:21]
    v_pk_mul_f32 v[190:191], v[190:191], v[22:23]
    v_pk_mul_f32 v[184:185], v[184:185], v[112:113]
    v_exp_f32 v188, v188
    v_pk_mul_f32 v[186:187], v[186:187], v[114:115]
    v_exp_f32 v189, v189
    v_cvt_pk_bf16_f32 v112, v184, v185
    v_exp_f32 v190, v190
    v_cvt_pk_bf16_f32 v113, v186, v187
    v_exp_f32 v191, v191
    v_mov_b32 v114, 0
    v_mov_b32 v115, 0
    s_nop 1
    v_mfma_f32_16x16x32_bf16 v[128:131], v[208:211], v[112:115], v[128:131]
    v_mfma_f32_16x16x32_bf16 v[132:135], v[112:115], v[112:115], v[132:135]
    buffer_store_dwordx2 v[112:113], v9, s[24:27], s28 offen offset:3072 sc1
    v_accvgpr_write_b32 a220, v112
    v_accvgpr_write_b32 a221, v113
    buffer_load_dwordx4 v240, s[16:19], s55 offen offset:2048 lds
    v_pk_add_f32 v[188:189], v[188:189], v[172:173]
    v_pk_add_f32 v[190:191], v[190:191], v[172:173]
    v_rcp_f32 v188, v188
    v_pk_mul_f32 v[176:177], v[36:37], v[36:37]
    v_rcp_f32 v189, v189
    v_pk_mul_f32 v[178:179], v[38:39], v[38:39]
    v_rcp_f32 v190, v190
    v_pk_fma_f32 v[176:177], v[176:177], v[170:171], v[168:169]
    v_rcp_f32 v191, v191
    v_pk_fma_f32 v[178:179], v[178:179], v[170:171], v[168:169]
    v_pk_mul_f32 v[176:177], v[176:177], v[36:37]
    v_pk_mul_f32 v[178:179], v[178:179], v[38:39]
    v_pk_mul_f32 v[188:189], v[188:189], v[20:21]
    v_exp_f32 v176, v176
    v_pk_mul_f32 v[190:191], v[190:191], v[22:23]
    v_exp_f32 v177, v177
    v_cvt_pk_bf16_f32 v20, v188, v189
    v_exp_f32 v178, v178
    v_cvt_pk_bf16_f32 v21, v190, v191
    v_exp_f32 v179, v179
    v_accvgpr_write_b32 a222, v20
    v_accvgpr_write_b32 a223, v21
    buffer_load_dwordx4 v241, s[16:19], s55 offen offset:3072 lds
    v_pk_add_f32 v[176:177], v[176:177], v[172:173]
    v_pk_add_f32 v[178:179], v[178:179], v[172:173]
    v_rcp_f32 v176, v176
    v_pk_mul_f32 v[180:181], v[52:53], v[52:53]
    v_rcp_f32 v177, v177
    v_pk_mul_f32 v[182:183], v[54:55], v[54:55]
    v_rcp_f32 v178, v178
    v_pk_fma_f32 v[180:181], v[180:181], v[170:171], v[168:169]
    v_rcp_f32 v179, v179
    v_pk_fma_f32 v[182:183], v[182:183], v[170:171], v[168:169]
    v_pk_mul_f32 v[180:181], v[180:181], v[52:53]
    v_pk_mul_f32 v[182:183], v[182:183], v[54:55]
    v_pk_mul_f32 v[176:177], v[176:177], v[36:37]
    v_exp_f32 v180, v180
    v_pk_mul_f32 v[178:179], v[178:179], v[38:39]
    v_exp_f32 v181, v181
    v_cvt_pk_bf16_f32 v22, v176, v177
    v_exp_f32 v182, v182
    v_cvt_pk_bf16_f32 v23, v178, v179
    v_exp_f32 v183, v183
    s_nop 0
    v_mfma_f32_16x16x32_bf16 v[136:139], v[208:211], v[20:23], 0
    v_mfma_f32_16x16x32_bf16 v[140:143], v[20:23], v[20:23], 0
    s_add_u32 s28, s28, 57344
    buffer_store_dwordx4 v[20:23], v10, s[24:27], s28 offen offset:0 sc1
    v_accvgpr_write_b32 a224, v22
    v_accvgpr_write_b32 a225, v23
    s_add_u32 s54, s54, 16384
    s_add_u32 m0, s53, 65536
    s_nop 0
    buffer_load_dwordx4 v236, s[12:15], s54 offen offset:0 lds
    v_pk_add_f32 v[180:181], v[180:181], v[172:173]
    v_pk_add_f32 v[182:183], v[182:183], v[172:173]
    v_rcp_f32 v180, v180
    v_pk_mul_f32 v[184:185], v[68:69], v[68:69]
    v_rcp_f32 v181, v181
    v_pk_mul_f32 v[186:187], v[70:71], v[70:71]
    v_rcp_f32 v182, v182
    v_pk_fma_f32 v[184:185], v[184:185], v[170:171], v[168:169]
    v_rcp_f32 v183, v183
    v_pk_fma_f32 v[186:187], v[186:187], v[170:171], v[168:169]
    v_pk_mul_f32 v[184:185], v[184:185], v[68:69]
    v_pk_mul_f32 v[186:187], v[186:187], v[70:71]
    v_pk_mul_f32 v[180:181], v[180:181], v[52:53]
    v_exp_f32 v184, v184
    v_pk_mul_f32 v[182:183], v[182:183], v[54:55]
    v_exp_f32 v185, v185
    v_cvt_pk_bf16_f32 v52, v180, v181
    v_exp_f32 v186, v186
    v_cvt_pk_bf16_f32 v53, v182, v183
    v_exp_f32 v187, v187
    v_accvgpr_write_b32 a226, v52
    v_accvgpr_write_b32 a227, v53
    buffer_load_dwordx4 v237, s[12:15], s54 offen offset:1024 lds
    v_pk_add_f32 v[184:185], v[184:185], v[172:173]
    v_pk_add_f32 v[186:187], v[186:187], v[172:173]
    v_rcp_f32 v184, v184
    v_pk_mul_f32 v[188:189], v[84:85], v[84:85]
    v_rcp_f32 v185, v185
    v_pk_mul_f32 v[190:191], v[86:87], v[86:87]
    v_rcp_f32 v186, v186
    v_pk_fma_f32 v[188:189], v[188:189], v[170:171], v[168:169]
    v_rcp_f32 v187, v187
    v_pk_fma_f32 v[190:191], v[190:191], v[170:171], v[168:169]
    v_pk_mul_f32 v[188:189], v[188:189], v[84:85]
    v_pk_mul_f32 v[190:191], v[190:191], v[86:87]
    v_pk_mul_f32 v[184:185], v[184:185], v[68:69]
    v_exp_f32 v188, v188
    v_pk_mul_f32 v[186:187], v[186:187], v[70:71]
    v_exp_f32 v189, v189
    v_cvt_pk_bf16_f32 v54, v184, v185
    v_exp_f32 v190, v190
    v_cvt_pk_bf16_f32 v55, v186, v187
    v_exp_f32 v191, v191
    s_nop 0
    v_mfma_f32_16x16x32_bf16 v[136:139], v[208:211], v[52:55], v[136:139]
    v_mfma_f32_16x16x32_bf16 v[140:143], v[52:55], v[52:55], v[140:143]
    buffer_store_dwordx4 v[52:55], v10, s[24:27], s28 offen offset:1024 sc1
    v_accvgpr_write_b32 a228, v54
    v_accvgpr_write_b32 a229, v55
    v_pk_add_f32 v[188:189], v[188:189], v[172:173]
    v_pk_add_f32 v[190:191], v[190:191], v[172:173]
    v_rcp_f32 v188, v188
    v_pk_mul_f32 v[176:177], v[100:101], v[100:101]
    v_rcp_f32 v189, v189
    v_pk_mul_f32 v[178:179], v[102:103], v[102:103]
    v_rcp_f32 v190, v190
    v_pk_fma_f32 v[176:177], v[176:177], v[170:171], v[168:169]
    v_rcp_f32 v191, v191
    v_pk_fma_f32 v[178:179], v[178:179], v[170:171], v[168:169]
    v_pk_mul_f32 v[176:177], v[176:177], v[100:101]
    v_pk_mul_f32 v[178:179], v[178:179], v[102:103]
    v_pk_mul_f32 v[188:189], v[188:189], v[84:85]
    v_exp_f32 v176, v176
    v_pk_mul_f32 v[190:191], v[190:191], v[86:87]
    v_exp_f32 v177, v177
    v_cvt_pk_bf16_f32 v84, v188, v189
    v_exp_f32 v178, v178
    v_cvt_pk_bf16_f32 v85, v190, v191
    v_exp_f32 v179, v179
    v_accvgpr_write_b32 a230, v84
    v_accvgpr_write_b32 a231, v85
    v_pk_add_f32 v[176:177], v[176:177], v[172:173]
    v_pk_add_f32 v[178:179], v[178:179], v[172:173]
    v_rcp_f32 v176, v176
    v_pk_mul_f32 v[180:181], v[116:117], v[116:117]
    v_rcp_f32 v177, v177
    v_pk_mul_f32 v[182:183], v[118:119], v[118:119]
    v_rcp_f32 v178, v178
    v_pk_fma_f32 v[180:181], v[180:181], v[170:171], v[168:169]
    v_rcp_f32 v179, v179
    v_pk_fma_f32 v[182:183], v[182:183], v[170:171], v[168:169]
    v_pk_mul_f32 v[180:181], v[180:181], v[116:117]
    v_pk_mul_f32 v[182:183], v[182:183], v[118:119]
    v_pk_mul_f32 v[176:177], v[176:177], v[100:101]
    v_exp_f32 v180, v180
    v_pk_mul_f32 v[178:179], v[178:179], v[102:103]
    v_exp_f32 v181, v181
    v_cvt_pk_bf16_f32 v86, v176, v177
    v_exp_f32 v182, v182
    v_cvt_pk_bf16_f32 v87, v178, v179
    v_exp_f32 v183, v183
    s_nop 0
    v_mfma_f32_16x16x32_bf16 v[136:139], v[208:211], v[84:87], v[136:139]
    v_mfma_f32_16x16x32_bf16 v[140:143], v[84:87], v[84:87], v[140:143]
    buffer_store_dwordx4 v[84:87], v10, s[24:27], s28 offen offset:2048 sc1
    v_accvgpr_write_b32 a232, v86
    v_accvgpr_write_b32 a233, v87
    v_pk_add_f32 v[180:181], v[180:181], v[172:173]
    v_pk_add_f32 v[182:183], v[182:183], v[172:173]
    v_rcp_f32 v180, v180
    v_pk_mul_f32 v[184:185], v[24:25], v[24:25]
    v_rcp_f32 v181, v181
    v_pk_mul_f32 v[186:187], v[26:27], v[26:27]
    v_rcp_f32 v182, v182
    v_pk_fma_f32 v[184:185], v[184:185], v[170:171], v[168:169]
    v_rcp_f32 v183, v183
    v_pk_fma_f32 v[186:187], v[186:187], v[170:171], v[168:169]
    v_pk_mul_f32 v[184:185], v[184:185], v[24:25]
    v_pk_mul_f32 v[186:187], v[186:187], v[26:27]
    v_pk_mul_f32 v[180:181], v[180:181], v[116:117]
    v_exp_f32 v184, v184
    v_pk_mul_f32 v[182:183], v[182:183], v[118:119]
    v_exp_f32 v185, v185
    v_cvt_pk_bf16_f32 v116, v180, v181
    v_exp_f32 v186, v186
    v_cvt_pk_bf16_f32 v117, v182, v183
    v_exp_f32 v187, v187
    v_mov_b32 v118, 0
    v_mov_b32 v119, 0
    s_nop 1
    v_mfma_f32_16x16x32_bf16 v[136:139], v[208:211], v[116:119], v[136:139]
    v_mfma_f32_16x16x32_bf16 v[140:143], v[116:119], v[116:119], v[140:143]
    buffer_store_dwordx2 v[116:117], v9, s[24:27], s28 offen offset:3072 sc1
    v_accvgpr_write_b32 a234, v116
    v_accvgpr_write_b32 a235, v117
    v_pk_add_f32 v[184:185], v[184:185], v[172:173]
    v_pk_add_f32 v[186:187], v[186:187], v[172:173]
    v_rcp_f32 v184, v184
    v_pk_mul_f32 v[188:189], v[40:41], v[40:41]
    v_rcp_f32 v185, v185
    v_pk_mul_f32 v[190:191], v[42:43], v[42:43]
    v_rcp_f32 v186, v186
    v_pk_fma_f32 v[188:189], v[188:189], v[170:171], v[168:169]
    v_rcp_f32 v187, v187
    v_pk_fma_f32 v[190:191], v[190:191], v[170:171], v[168:169]
    v_pk_mul_f32 v[188:189], v[188:189], v[40:41]
    v_pk_mul_f32 v[190:191], v[190:191], v[42:43]
    v_pk_mul_f32 v[184:185], v[184:185], v[24:25]
    v_exp_f32 v188, v188
    v_pk_mul_f32 v[186:187], v[186:187], v[26:27]
    v_exp_f32 v189, v189
    v_cvt_pk_bf16_f32 v24, v184, v185
    v_exp_f32 v190, v190
    v_cvt_pk_bf16_f32 v25, v186, v187
    v_exp_f32 v191, v191
    v_accvgpr_write_b32 a236, v24
    v_accvgpr_write_b32 a237, v25
    v_pk_add_f32 v[188:189], v[188:189], v[172:173]
    v_pk_add_f32 v[190:191], v[190:191], v[172:173]
    v_rcp_f32 v188, v188
    v_pk_mul_f32 v[176:177], v[56:57], v[56:57]
    v_rcp_f32 v189, v189
    v_pk_mul_f32 v[178:179], v[58:59], v[58:59]
    v_rcp_f32 v190, v190
    v_pk_fma_f32 v[176:177], v[176:177], v[170:171], v[168:169]
    v_rcp_f32 v191, v191
    v_pk_fma_f32 v[178:179], v[178:179], v[170:171], v[168:169]
    v_pk_mul_f32 v[176:177], v[176:177], v[56:57]
    v_pk_mul_f32 v[178:179], v[178:179], v[58:59]
    v_pk_mul_f32 v[188:189], v[188:189], v[40:41]
    v_exp_f32 v176, v176
    v_pk_mul_f32 v[190:191], v[190:191], v[42:43]
    v_exp_f32 v177, v177
    v_cvt_pk_bf16_f32 v26, v188, v189
    v_exp_f32 v178, v178
    v_cvt_pk_bf16_f32 v27, v190, v191
    v_exp_f32 v179, v179
    s_nop 0
    v_mfma_f32_16x16x32_bf16 v[144:147], v[208:211], v[24:27], 0
    v_mfma_f32_16x16x32_bf16 v[148:151], v[24:27], v[24:27], 0
    s_add_u32 s28, s28, 57344
    buffer_store_dwordx4 v[24:27], v10, s[24:27], s28 offen offset:0 sc1
    v_accvgpr_write_b32 a238, v26
    v_accvgpr_write_b32 a239, v27
    v_pk_add_f32 v[176:177], v[176:177], v[172:173]
    v_pk_add_f32 v[178:179], v[178:179], v[172:173]
    v_rcp_f32 v176, v176
    v_pk_mul_f32 v[180:181], v[72:73], v[72:73]
    v_rcp_f32 v177, v177
    v_pk_mul_f32 v[182:183], v[74:75], v[74:75]
    v_rcp_f32 v178, v178
    v_pk_fma_f32 v[180:181], v[180:181], v[170:171], v[168:169]
    v_rcp_f32 v179, v179
    v_pk_fma_f32 v[182:183], v[182:183], v[170:171], v[168:169]
    v_pk_mul_f32 v[180:181], v[180:181], v[72:73]
    v_pk_mul_f32 v[182:183], v[182:183], v[74:75]
    v_pk_mul_f32 v[176:177], v[176:177], v[56:57]
    v_exp_f32 v180, v180
    v_pk_mul_f32 v[178:179], v[178:179], v[58:59]
    v_exp_f32 v181, v181
    v_cvt_pk_bf16_f32 v56, v176, v177
    v_exp_f32 v182, v182
    v_cvt_pk_bf16_f32 v57, v178, v179
    v_exp_f32 v183, v183
    v_accvgpr_write_b32 a240, v56
    v_accvgpr_write_b32 a241, v57
    v_pk_add_f32 v[180:181], v[180:181], v[172:173]
    v_pk_add_f32 v[182:183], v[182:183], v[172:173]
    v_rcp_f32 v180, v180
    v_pk_mul_f32 v[184:185], v[88:89], v[88:89]
    v_rcp_f32 v181, v181
    v_pk_mul_f32 v[186:187], v[90:91], v[90:91]
    v_rcp_f32 v182, v182
    v_pk_fma_f32 v[184:185], v[184:185], v[170:171], v[168:169]
    v_rcp_f32 v183, v183
    v_pk_fma_f32 v[186:187], v[186:187], v[170:171], v[168:169]
    v_pk_mul_f32 v[184:185], v[184:185], v[88:89]
    v_pk_mul_f32 v[186:187], v[186:187], v[90:91]
    v_pk_mul_f32 v[180:181], v[180:181], v[72:73]
    v_exp_f32 v184, v184
    v_pk_mul_f32 v[182:183], v[182:183], v[74:75]
    v_exp_f32 v185, v185
    v_cvt_pk_bf16_f32 v58, v180, v181
    v_exp_f32 v186, v186
    v_cvt_pk_bf16_f32 v59, v182, v183
    v_exp_f32 v187, v187
    s_nop 0
    v_mfma_f32_16x16x32_bf16 v[144:147], v[208:211], v[56:59], v[144:147]
    v_mfma_f32_16x16x32_bf16 v[148:151], v[56:59], v[56:59], v[148:151]
    buffer_store_dwordx4 v[56:59], v10, s[24:27], s28 offen offset:1024 sc1
    v_accvgpr_write_b32 a242, v58
    v_accvgpr_write_b32 a243, v59
    v_pk_add_f32 v[184:185], v[184:185], v[172:173]
    v_pk_add_f32 v[186:187], v[186:187], v[172:173]
    v_rcp_f32 v184, v184
    v_pk_mul_f32 v[188:189], v[104:105], v[104:105]
    v_rcp_f32 v185, v185
    v_pk_mul_f32 v[190:191], v[106:107], v[106:107]
    v_rcp_f32 v186, v186
    v_pk_fma_f32 v[188:189], v[188:189], v[170:171], v[168:169]
    v_rcp_f32 v187, v187
    v_pk_fma_f32 v[190:191], v[190:191], v[170:171], v[168:169]
    v_pk_mul_f32 v[188:189], v[188:189], v[104:105]
    v_pk_mul_f32 v[190:191], v[190:191], v[106:107]
    v_pk_mul_f32 v[184:185], v[184:185], v[88:89]
    v_exp_f32 v188, v188
    v_pk_mul_f32 v[186:187], v[186:187], v[90:91]
    v_exp_f32 v189, v189
    v_cvt_pk_bf16_f32 v88, v184, v185
    v_exp_f32 v190, v190
    v_cvt_pk_bf16_f32 v89, v186, v187
    v_exp_f32 v191, v191
    v_accvgpr_write_b32 a244, v88
    v_accvgpr_write_b32 a245, v89
    v_pk_add_f32 v[188:189], v[188:189], v[172:173]
    v_pk_add_f32 v[190:191], v[190:191], v[172:173]
    v_rcp_f32 v188, v188
    v_pk_mul_f32 v[176:177], v[120:121], v[120:121]
    v_rcp_f32 v189, v189
    v_pk_mul_f32 v[178:179], v[122:123], v[122:123]
    v_rcp_f32 v190, v190
    v_pk_fma_f32 v[176:177], v[176:177], v[170:171], v[168:169]
    v_rcp_f32 v191, v191
    v_pk_fma_f32 v[178:179], v[178:179], v[170:171], v[168:169]
    v_pk_mul_f32 v[176:177], v[176:177], v[120:121]
    v_pk_mul_f32 v[178:179], v[178:179], v[122:123]
    v_pk_mul_f32 v[188:189], v[188:189], v[104:105]
    v_exp_f32 v176, v176
    v_pk_mul_f32 v[190:191], v[190:191], v[106:107]
    v_exp_f32 v177, v177
    v_cvt_pk_bf16_f32 v90, v188, v189
    v_exp_f32 v178, v178
    v_cvt_pk_bf16_f32 v91, v190, v191
    v_exp_f32 v179, v179
    s_nop 0
    v_mfma_f32_16x16x32_bf16 v[144:147], v[208:211], v[88:91], v[144:147]
    v_mfma_f32_16x16x32_bf16 v[148:151], v[88:91], v[88:91], v[148:151]
    buffer_store_dwordx4 v[88:91], v10, s[24:27], s28 offen offset:2048 sc1
    v_accvgpr_write_b32 a246, v90
    v_accvgpr_write_b32 a247, v91
    v_pk_add_f32 v[176:177], v[176:177], v[172:173]
    v_pk_add_f32 v[178:179], v[178:179], v[172:173]
    v_rcp_f32 v176, v176
    v_pk_mul_f32 v[180:181], v[28:29], v[28:29]
    v_rcp_f32 v177, v177
    v_pk_mul_f32 v[182:183], v[30:31], v[30:31]
    v_rcp_f32 v178, v178
    v_pk_fma_f32 v[180:181], v[180:181], v[170:171], v[168:169]
    v_rcp_f32 v179, v179
    v_pk_fma_f32 v[182:183], v[182:183], v[170:171], v[168:169]
    v_pk_mul_f32 v[180:181], v[180:181], v[28:29]
    v_pk_mul_f32 v[182:183], v[182:183], v[30:31]
    v_pk_mul_f32 v[176:177], v[176:177], v[120:121]
    v_exp_f32 v180, v180
    v_pk_mul_f32 v[178:179], v[178:179], v[122:123]
    v_exp_f32 v181, v181
    v_cvt_pk_bf16_f32 v120, v176, v177
    v_exp_f32 v182, v182
    v_cvt_pk_bf16_f32 v121, v178, v179
    v_exp_f32 v183, v183
    v_mov_b32 v122, 0
    v_mov_b32 v123, 0
    s_nop 1
    v_mfma_f32_16x16x32_bf16 v[144:147], v[208:211], v[120:123], v[144:147]
    v_mfma_f32_16x16x32_bf16 v[148:151], v[120:123], v[120:123], v[148:151]
    buffer_store_dwordx2 v[120:121], v9, s[24:27], s28 offen offset:3072 sc1
    v_accvgpr_write_b32 a248, v120
    v_accvgpr_write_b32 a249, v121
    v_pk_add_f32 v[180:181], v[180:181], v[172:173]
    v_pk_add_f32 v[182:183], v[182:183], v[172:173]
    v_rcp_f32 v180, v180
    v_pk_mul_f32 v[184:185], v[44:45], v[44:45]
    v_rcp_f32 v181, v181
    v_pk_mul_f32 v[186:187], v[46:47], v[46:47]
    v_rcp_f32 v182, v182
    v_pk_fma_f32 v[184:185], v[184:185], v[170:171], v[168:169]
    v_rcp_f32 v183, v183
    v_pk_fma_f32 v[186:187], v[186:187], v[170:171], v[168:169]
    v_pk_mul_f32 v[184:185], v[184:185], v[44:45]
    v_pk_mul_f32 v[186:187], v[186:187], v[46:47]
    v_pk_mul_f32 v[180:181], v[180:181], v[28:29]
    v_exp_f32 v184, v184
    v_pk_mul_f32 v[182:183], v[182:183], v[30:31]
    v_exp_f32 v185, v185
    v_cvt_pk_bf16_f32 v28, v180, v181
    v_exp_f32 v186, v186
    v_cvt_pk_bf16_f32 v29, v182, v183
    v_exp_f32 v187, v187
    v_accvgpr_write_b32 a250, v28
    v_accvgpr_write_b32 a251, v29
    v_pk_add_f32 v[184:185], v[184:185], v[172:173]
    v_pk_add_f32 v[186:187], v[186:187], v[172:173]
    v_rcp_f32 v184, v184
    v_pk_mul_f32 v[188:189], v[60:61], v[60:61]
    v_rcp_f32 v185, v185
    v_pk_mul_f32 v[190:191], v[62:63], v[62:63]
    v_rcp_f32 v186, v186
    v_pk_fma_f32 v[188:189], v[188:189], v[170:171], v[168:169]
    v_rcp_f32 v187, v187
    v_pk_fma_f32 v[190:191], v[190:191], v[170:171], v[168:169]
    v_pk_mul_f32 v[188:189], v[188:189], v[60:61]
    v_pk_mul_f32 v[190:191], v[190:191], v[62:63]
    v_pk_mul_f32 v[184:185], v[184:185], v[44:45]
    v_exp_f32 v188, v188
    v_pk_mul_f32 v[186:187], v[186:187], v[46:47]
    v_exp_f32 v189, v189
    v_cvt_pk_bf16_f32 v30, v184, v185
    v_exp_f32 v190, v190
    v_cvt_pk_bf16_f32 v31, v186, v187
    v_exp_f32 v191, v191
    s_nop 0
    v_mfma_f32_16x16x32_bf16 v[152:155], v[208:211], v[28:31], 0
    v_mfma_f32_16x16x32_bf16 v[156:159], v[28:31], v[28:31], 0
    s_add_u32 s28, s28, 57344
    buffer_store_dwordx4 v[28:31], v10, s[24:27], s28 offen offset:0 sc1
    v_accvgpr_write_b32 a252, v30
    v_accvgpr_write_b32 a253, v31
    v_pk_add_f32 v[188:189], v[188:189], v[172:173]
    v_pk_add_f32 v[190:191], v[190:191], v[172:173]
    v_rcp_f32 v188, v188
    v_pk_mul_f32 v[176:177], v[76:77], v[76:77]
    v_rcp_f32 v189, v189
    v_pk_mul_f32 v[178:179], v[78:79], v[78:79]
    v_rcp_f32 v190, v190
    v_pk_fma_f32 v[176:177], v[176:177], v[170:171], v[168:169]
    v_rcp_f32 v191, v191
    v_pk_fma_f32 v[178:179], v[178:179], v[170:171], v[168:169]
    v_pk_mul_f32 v[176:177], v[176:177], v[76:77]
    v_pk_mul_f32 v[178:179], v[178:179], v[78:79]
    v_pk_mul_f32 v[188:189], v[188:189], v[60:61]
    v_exp_f32 v176, v176
    v_pk_mul_f32 v[190:191], v[190:191], v[62:63]
    v_exp_f32 v177, v177
    v_cvt_pk_bf16_f32 v60, v188, v189
    v_exp_f32 v178, v178
    v_cvt_pk_bf16_f32 v61, v190, v191
    v_exp_f32 v179, v179
    v_accvgpr_write_b32 a254, v60
    v_accvgpr_write_b32 a255, v61
    v_pk_add_f32 v[176:177], v[176:177], v[172:173]
    v_pk_add_f32 v[178:179], v[178:179], v[172:173]
    v_rcp_f32 v176, v176
    v_pk_mul_f32 v[180:181], v[92:93], v[92:93]
    v_rcp_f32 v177, v177
    v_pk_mul_f32 v[182:183], v[94:95], v[94:95]
    v_rcp_f32 v178, v178
    v_pk_fma_f32 v[180:181], v[180:181], v[170:171], v[168:169]
    v_rcp_f32 v179, v179
    v_pk_fma_f32 v[182:183], v[182:183], v[170:171], v[168:169]
    v_pk_mul_f32 v[180:181], v[180:181], v[92:93]
    v_pk_mul_f32 v[182:183], v[182:183], v[94:95]
    v_pk_mul_f32 v[176:177], v[176:177], v[76:77]
    v_exp_f32 v180, v180
    v_pk_mul_f32 v[178:179], v[178:179], v[78:79]
    v_exp_f32 v181, v181
    v_cvt_pk_bf16_f32 v62, v176, v177
    v_exp_f32 v182, v182
    v_cvt_pk_bf16_f32 v63, v178, v179
    v_exp_f32 v183, v183
    s_nop 0
    v_mfma_f32_16x16x32_bf16 v[152:155], v[208:211], v[60:63], v[152:155]
    v_mfma_f32_16x16x32_bf16 v[156:159], v[60:63], v[60:63], v[156:159]
    buffer_store_dwordx4 v[60:63], v10, s[24:27], s28 offen offset:1024 sc1
    v_mov_b32 v242, v62
    v_mov_b32 v243, v63
    v_pk_add_f32 v[180:181], v[180:181], v[172:173]
    v_pk_add_f32 v[182:183], v[182:183], v[172:173]
    v_rcp_f32 v180, v180
    v_pk_mul_f32 v[184:185], v[108:109], v[108:109]
    v_rcp_f32 v181, v181
    v_pk_mul_f32 v[186:187], v[110:111], v[110:111]
    v_rcp_f32 v182, v182
    v_pk_fma_f32 v[184:185], v[184:185], v[170:171], v[168:169]
    v_rcp_f32 v183, v183
    v_pk_fma_f32 v[186:187], v[186:187], v[170:171], v[168:169]
    v_pk_mul_f32 v[184:185], v[184:185], v[108:109]
    v_pk_mul_f32 v[186:187], v[186:187], v[110:111]
    v_pk_mul_f32 v[180:181], v[180:181], v[92:93]
    v_exp_f32 v184, v184
    v_pk_mul_f32 v[182:183], v[182:183], v[94:95]
    v_exp_f32 v185, v185
    v_cvt_pk_bf16_f32 v92, v180, v181
    v_exp_f32 v186, v186
    v_cvt_pk_bf16_f32 v93, v182, v183
    v_exp_f32 v187, v187
    v_mov_b32 v244, v92
    v_mov_b32 v245, v93
    v_pk_add_f32 v[184:185], v[184:185], v[172:173]
    v_pk_add_f32 v[186:187], v[186:187], v[172:173]
    v_rcp_f32 v184, v184
    v_pk_mul_f32 v[188:189], v[124:125], v[124:125]
    v_rcp_f32 v185, v185
    v_pk_mul_f32 v[190:191], v[126:127], v[126:127]
    v_rcp_f32 v186, v186
    v_pk_fma_f32 v[188:189], v[188:189], v[170:171], v[168:169]
    v_rcp_f32 v187, v187
    v_pk_fma_f32 v[190:191], v[190:191], v[170:171], v[168:169]
    v_pk_mul_f32 v[188:189], v[188:189], v[124:125]
    v_pk_mul_f32 v[190:191], v[190:191], v[126:127]
    v_pk_mul_f32 v[184:185], v[184:185], v[108:109]
    v_exp_f32 v188, v188
    v_pk_mul_f32 v[186:187], v[186:187], v[110:111]
    v_exp_f32 v189, v189
    v_cvt_pk_bf16_f32 v94, v184, v185
    v_exp_f32 v190, v190
    v_cvt_pk_bf16_f32 v95, v186, v187
    v_exp_f32 v191, v191
    s_nop 0
    v_mfma_f32_16x16x32_bf16 v[152:155], v[208:211], v[92:95], v[152:155]
    v_mfma_f32_16x16x32_bf16 v[156:159], v[92:95], v[92:95], v[156:159]
    buffer_store_dwordx4 v[92:95], v10, s[24:27], s28 offen offset:2048 sc1
    v_mov_b32 v246, v94
    v_mov_b32 v247, v95
    v_pk_add_f32 v[188:189], v[188:189], v[172:173]
    v_pk_add_f32 v[190:191], v[190:191], v[172:173]
    v_rcp_f32 v188, v188
    v_rcp_f32 v189, v189
    v_rcp_f32 v190, v190
    v_rcp_f32 v191, v191
    v_pk_mul_f32 v[188:189], v[188:189], v[124:125]
    v_pk_mul_f32 v[190:191], v[190:191], v[126:127]
    v_cvt_pk_bf16_f32 v124, v188, v189
    v_cvt_pk_bf16_f32 v125, v190, v191
    v_mov_b32 v126, 0
    v_mov_b32 v127, 0
    s_nop 0
    s_nop 0
    v_mfma_f32_16x16x32_bf16 v[152:155], v[208:211], v[124:127], v[152:155]
    v_mfma_f32_16x16x32_bf16 v[156:159], v[124:127], v[124:127], v[156:159]
    buffer_store_dwordx2 v[124:125], v9, s[24:27], s28 offen offset:3072 sc1
    v_mov_b32 v248, v124
    v_mov_b32 v249, v125
    s_lshl_b32 s62, s5, 11
    s_add_u32 s62, s62, 8388608
    s_cmp_lt_u32 s4, 16
    s_cbranch_scc1 f_nostat
    v_and_b32 v8, 15, v1
    s_lshl_b32 s28, s3, 6
    v_add_u32 v9, s28, v8
    v_lshlrev_b32 v9, 3, v9
    v_lshrrev_b32 v10, 2, v8
    v_lshrrev_b32 v11, 4, v1
    v_and_b32 v8, 3, v1
    v_cmp_eq_u32 s[6:7], 1, v8
    v_cmp_eq_u32 s[8:9], 2, v8
    v_cmp_eq_u32 s[30:31], 3, v8
    v_cmp_eq_u32 vcc, v10, v11
    v_cndmask_b32 v132, v132, v133, s[6:7]
    v_cndmask_b32 v132, v132, v134, s[8:9]
    v_cndmask_b32 v132, v132, v135, s[30:31]
    v_cndmask_b32 v140, v140, v141, s[6:7]
    v_cndmask_b32 v140, v140, v142, s[8:9]
    v_cndmask_b32 v140, v140, v143, s[30:31]
    v_cndmask_b32 v148, v148, v149, s[6:7]
    v_cndmask_b32 v148, v148, v150, s[8:9]
    v_cndmask_b32 v148, v148, v151, s[30:31]
    v_cndmask_b32 v156, v156, v157, s[6:7]
    v_cndmask_b32 v156, v156, v158, s[8:9]
    v_cndmask_b32 v156, v156, v159, s[30:31]
    s_mov_b64 exec, vcc
    buffer_atomic_add_f32 v128, v9, s[24:27], s62 offen offset:0 sc1
    buffer_atomic_add_f32 v132, v9, s[24:27], s62 offen offset:4 sc1
    buffer_atomic_add_f32 v136, v9, s[24:27], s62 offen offset:128 sc1
    buffer_atomic_add_f32 v140, v9, s[24:27], s62 offen offset:132 sc1
    buffer_atomic_add_f32 v144, v9, s[24:27], s62 offen offset:256 sc1
    buffer_atomic_add_f32 v148, v9, s[24:27], s62 offen offset:260 sc1
    buffer_atomic_add_f32 v152, v9, s[24:27], s62 offen offset:384 sc1
    buffer_atomic_add_f32 v156, v9, s[24:27], s62 offen offset:388 sc1
    s_mov_b64 exec, -1
f_nostat:
    v_mov_b32 v152, 0
    v_mov_b32 v153, 0
    v_mov_b32 v154, 0
    v_mov_b32 v155, 0
    v_accvgpr_read_b32 v176, a0
    v_accvgpr_read_b32 v177, a1
    v_accvgpr_read_b32 v178, a2
    v_accvgpr_read_b32 v179, a3
    v_accvgpr_read_b32 v180, a16
    v_accvgpr_read_b32 v181, a17
    v_accvgpr_read_b32 v182, a18
    v_accvgpr_read_b32 v183, a19
    v_pk_mul_f32 v[176:177], v[176:177], v[174:175]
    v_pk_mul_f32 v[178:179], v[178:179], v[174:175]
    v_pk_mul_f32 v[180:181], v[180:181], v[174:175]
    v_pk_mul_f32 v[182:183], v[182:183], v[174:175]
    v_cvt_pk_bf16_f32 v192, v176, v177
    v_cvt_pk_bf16_f32 v193, v178, v179
    v_cvt_pk_bf16_f32 v194, v180, v181
    v_cvt_pk_bf16_f32 v195, v182, v183
    v_mfma_f32_16x16x32_bf16 a[0:3], v[152:155], v[152:155], 0
    v_mfma_f32_16x16x32_bf16 a[16:19], v[152:155], v[152:155], 0
    v_permlane32_swap_b32 v192, v194
    v_permlane32_swap_b32 v193, v195
    s_nop 0
    v_permlane16_swap_b32 v192, v194
    v_permlane16_swap_b32 v193, v195
    v_accvgpr_write_b32 a144, v192
    v_accvgpr_write_b32 a145, v193
    v_accvgpr_write_b32 a146, v194
    v_accvgpr_write_b32 a147, v195
    v_accvgpr_read_b32 v184, a32
    v_accvgpr_read_b32 v185, a33
    v_accvgpr_read_b32 v186, a34
    v_accvgpr_read_b32 v187, a35
    v_accvgpr_read_b32 v188, a48
    v_accvgpr_read_b32 v189, a49
    v_accvgpr_read_b32 v190, a50
    v_accvgpr_read_b32 v191, a51
    v_pk_mul_f32 v[184:185], v[184:185], v[174:175]
    v_pk_mul_f32 v[186:187], v[186:187], v[174:175]
    v_pk_mul_f32 v[188:189], v[188:189], v[174:175]
    v_pk_mul_f32 v[190:191], v[190:191], v[174:175]
    v_cvt_pk_bf16_f32 v196, v184, v185
    v_cvt_pk_bf16_f32 v197, v186, v187
    v_cvt_pk_bf16_f32 v198, v188, v189
    v_cvt_pk_bf16_f32 v199, v190, v191
    v_mfma_f32_16x16x32_bf16 a[32:35], v[152:155], v[152:155], 0
    v_mfma_f32_16x16x32_bf16 a[48:51], v[152:155], v[152:155], 0
    v_permlane32_swap_b32 v196, v198
    v_permlane32_swap_b32 v197, v199
    s_nop 0
    v_permlane16_swap_b32 v196, v198
    v_permlane16_swap_b32 v197, v199
    v_accvgpr_write_b32 a148, v196
    v_accvgpr_write_b32 a149, v197
    v_accvgpr_write_b32 a150, v198
    v_accvgpr_write_b32 a151, v199
    v_accvgpr_read_b32 v176, a64
    v_accvgpr_read_b32 v177, a65
    v_accvgpr_read_b32 v178, a66
    v_accvgpr_read_b32 v179, a67
    v_accvgpr_read_b32 v180, a80
    v_accvgpr_read_b32 v181, a81
    v_accvgpr_read_b32 v182, a82
    v_accvgpr_read_b32 v183, a83
    v_pk_mul_f32 v[176:177], v[176:177], v[174:175]
    v_pk_mul_f32 v[178:179], v[178:179], v[174:175]
    v_pk_mul_f32 v[180:181], v[180:181], v[174:175]
    v_pk_mul_f32 v[182:183], v[182:183], v[174:175]
    v_cvt_pk_bf16_f32 v200, v176, v177
    v_cvt_pk_bf16_f32 v201, v178, v179
    v_cvt_pk_bf16_f32 v202, v180, v181
    v_cvt_pk_bf16_f32 v203, v182, v183
    v_mfma_f32_16x16x32_bf16 a[64:67], v[152:155], v[152:155], 0
    v_mfma_f32_16x16x32_bf16 a[80:83], v[152:155], v[152:155], 0
    v_permlane32_swap_b32 v200, v202
    v_permlane32_swap_b32 v201, v203
    s_nop 0
    v_permlane16_swap_b32 v200, v202
    v_permlane16_swap_b32 v201, v203
    v_accvgpr_write_b32 a152, v200
    v_accvgpr_write_b32 a153, v201
    v_accvgpr_write_b32 a154, v202
    v_accvgpr_write_b32 a155, v203
    v_accvgpr_read_b32 v184, a96
    v_accvgpr_read_b32 v185, a97
    v_accvgpr_read_b32 v186, a98
    v_accvgpr_read_b32 v187, a99
    v_accvgpr_read_b32 v188, a112
    v_accvgpr_read_b32 v189, a113
    v_accvgpr_read_b32 v190, a114
    v_accvgpr_read_b32 v191, a115
    v_pk_mul_f32 v[184:185], v[184:185], v[174:175]
    v_pk_mul_f32 v[186:187], v[186:187], v[174:175]
    v_pk_mul_f32 v[188:189], v[188:189], v[174:175]
    v_pk_mul_f32 v[190:191], v[190:191], v[174:175]
    v_cvt_pk_bf16_f32 v204, v184, v185
    v_cvt_pk_bf16_f32 v205, v186, v187
    v_cvt_pk_bf16_f32 v206, v188, v189
    v_cvt_pk_bf16_f32 v207, v190, v191
    v_mfma_f32_16x16x32_bf16 a[96:99], v[152:155], v[152:155], 0
    v_mfma_f32_16x16x32_bf16 a[112:115], v[152:155], v[152:155], 0
    v_permlane32_swap_b32 v204, v206
    v_permlane32_swap_b32 v205, v207
    s_nop 0
    v_permlane16_swap_b32 v204, v206
    v_permlane16_swap_b32 v205, v207
    v_accvgpr_write_b32 a156, v204
    v_accvgpr_write_b32 a157, v205
    v_accvgpr_write_b32 a158, v206
    v_accvgpr_write_b32 a159, v207
    v_accvgpr_read_b32 v176, a4
    v_accvgpr_read_b32 v177, a5
    v_accvgpr_read_b32 v178, a6
    v_accvgpr_read_b32 v179, a7
    v_accvgpr_read_b32 v180, a20
    v_accvgpr_read_b32 v181, a21
    v_accvgpr_read_b32 v182, a22
    v_accvgpr_read_b32 v183, a23
    v_pk_mul_f32 v[176:177], v[176:177], v[174:175]
    v_pk_mul_f32 v[178:179], v[178:179], v[174:175]
    v_pk_mul_f32 v[180:181], v[180:181], v[174:175]
    v_pk_mul_f32 v[182:183], v[182:183], v[174:175]
    v_cvt_pk_bf16_f32 v192, v176, v177
    v_cvt_pk_bf16_f32 v193, v178, v179
    v_cvt_pk_bf16_f32 v194, v180, v181
    v_cvt_pk_bf16_f32 v195, v182, v183
    v_mfma_f32_16x16x32_bf16 a[4:7], v[152:155], v[152:155], 0
    v_mfma_f32_16x16x32_bf16 a[20:23], v[152:155], v[152:155], 0
    v_permlane32_swap_b32 v192, v194
    v_permlane32_swap_b32 v193, v195
    s_nop 0
    v_permlane16_swap_b32 v192, v194
    v_permlane16_swap_b32 v193, v195
    v_accvgpr_write_b32 a160, v192
    v_accvgpr_write_b32 a161, v193
    v_accvgpr_write_b32 a162, v194
    v_accvgpr_write_b32 a163, v195
    v_accvgpr_read_b32 v184, a36
    v_accvgpr_read_b32 v185, a37
    v_accvgpr_read_b32 v186, a38
    v_accvgpr_read_b32 v187, a39
    v_accvgpr_read_b32 v188, a52
    v_accvgpr_read_b32 v189, a53
    v_accvgpr_read_b32 v190, a54
    v_accvgpr_read_b32 v191, a55
    v_pk_mul_f32 v[184:185], v[184:185], v[174:175]
    v_pk_mul_f32 v[186:187], v[186:187], v[174:175]
    v_pk_mul_f32 v[188:189], v[188:189], v[174:175]
    v_pk_mul_f32 v[190:191], v[190:191], v[174:175]
    v_cvt_pk_bf16_f32 v196, v184, v185
    v_cvt_pk_bf16_f32 v197, v186, v187
    v_cvt_pk_bf16_f32 v198, v188, v189
    v_cvt_pk_bf16_f32 v199, v190, v191
    v_mfma_f32_16x16x32_bf16 a[36:39], v[152:155], v[152:155], 0
    v_mfma_f32_16x16x32_bf16 a[52:55], v[152:155], v[152:155], 0
    v_permlane32_swap_b32 v196, v198
    v_permlane32_swap_b32 v197, v199
    s_nop 0
    v_permlane16_swap_b32 v196, v198
    v_permlane16_swap_b32 v197, v199
    v_accvgpr_write_b32 a164, v196
    v_accvgpr_write_b32 a165, v197
    v_accvgpr_write_b32 a166, v198
    v_accvgpr_write_b32 a167, v199
    v_accvgpr_read_b32 v176, a68
    v_accvgpr_read_b32 v177, a69
    v_accvgpr_read_b32 v178, a70
    v_accvgpr_read_b32 v179, a71
    v_accvgpr_read_b32 v180, a84
    v_accvgpr_read_b32 v181, a85
    v_accvgpr_read_b32 v182, a86
    v_accvgpr_read_b32 v183, a87
    v_pk_mul_f32 v[176:177], v[176:177], v[174:175]
    v_pk_mul_f32 v[178:179], v[178:179], v[174:175]
    v_pk_mul_f32 v[180:181], v[180:181], v[174:175]
    v_pk_mul_f32 v[182:183], v[182:183], v[174:175]
    v_cvt_pk_bf16_f32 v200, v176, v177
    v_cvt_pk_bf16_f32 v201, v178, v179
    v_cvt_pk_bf16_f32 v202, v180, v181
    v_cvt_pk_bf16_f32 v203, v182, v183
    v_mfma_f32_16x16x32_bf16 a[68:71], v[152:155], v[152:155], 0
    v_mfma_f32_16x16x32_bf16 a[84:87], v[152:155], v[152:155], 0
    v_permlane32_swap_b32 v200, v202
    v_permlane32_swap_b32 v201, v203
    s_nop 0
    v_permlane16_swap_b32 v200, v202
    v_permlane16_swap_b32 v201, v203
    v_accvgpr_write_b32 a168, v200
    v_accvgpr_write_b32 a169, v201
    v_accvgpr_write_b32 a170, v202
    v_accvgpr_write_b32 a171, v203
    v_accvgpr_read_b32 v184, a100
    v_accvgpr_read_b32 v185, a101
    v_accvgpr_read_b32 v186, a102
    v_accvgpr_read_b32 v187, a103
    v_accvgpr_read_b32 v188, a116
    v_accvgpr_read_b32 v189, a117
    v_accvgpr_read_b32 v190, a118
    v_accvgpr_read_b32 v191, a119
    v_pk_mul_f32 v[184:185], v[184:185], v[174:175]
    v_pk_mul_f32 v[186:187], v[186:187], v[174:175]
    v_pk_mul_f32 v[188:189], v[188:189], v[174:175]
    v_pk_mul_f32 v[190:191], v[190:191], v[174:175]
    v_cvt_pk_bf16_f32 v204, v184, v185
    v_cvt_pk_bf16_f32 v205, v186, v187
    v_cvt_pk_bf16_f32 v206, v188, v189
    v_cvt_pk_bf16_f32 v207, v190, v191
    v_mfma_f32_16x16x32_bf16 a[100:103], v[152:155], v[152:155], 0
    v_mfma_f32_16x16x32_bf16 a[116:119], v[152:155], v[152:155], 0
    v_permlane32_swap_b32 v204, v206
    v_permlane32_swap_b32 v205, v207
    s_nop 0
    v_permlane16_swap_b32 v204, v206
    v_permlane16_swap_b32 v205, v207
    v_accvgpr_write_b32 a172, v204
    v_accvgpr_write_b32 a173, v205
    v_accvgpr_write_b32 a174, v206
    v_accvgpr_write_b32 a175, v207
    v_accvgpr_read_b32 v176, a8
    v_accvgpr_read_b32 v177, a9
    v_accvgpr_read_b32 v178, a10
    v_accvgpr_read_b32 v179, a11
    v_accvgpr_read_b32 v180, a24
    v_accvgpr_read_b32 v181, a25
    v_accvgpr_read_b32 v182, a26
    v_accvgpr_read_b32 v183, a27
    v_pk_mul_f32 v[176:177], v[176:177], v[174:175]
    v_pk_mul_f32 v[178:179], v[178:179], v[174:175]
    v_pk_mul_f32 v[180:181], v[180:181], v[174:175]
    v_pk_mul_f32 v[182:183], v[182:183], v[174:175]
    v_cvt_pk_bf16_f32 v192, v176, v177
    v_cvt_pk_bf16_f32 v193, v178, v179
    v_cvt_pk_bf16_f32 v194, v180, v181
    v_cvt_pk_bf16_f32 v195, v182, v183
    v_mfma_f32_16x16x32_bf16 a[8:11], v[152:155], v[152:155], 0
    v_mfma_f32_16x16x32_bf16 a[24:27], v[152:155], v[152:155], 0
    v_permlane32_swap_b32 v192, v194
    v_permlane32_swap_b32 v193, v195
    s_nop 0
    v_permlane16_swap_b32 v192, v194
    v_permlane16_swap_b32 v193, v195
    v_accvgpr_write_b32 a176, v192
    v_accvgpr_write_b32 a177, v193
    v_accvgpr_write_b32 a178, v194
    v_accvgpr_write_b32 a179, v195
    v_accvgpr_read_b32 v184, a40
    v_accvgpr_read_b32 v185, a41
    v_accvgpr_read_b32 v186, a42
    v_accvgpr_read_b32 v187, a43
    v_accvgpr_read_b32 v188, a56
    v_accvgpr_read_b32 v189, a57
    v_accvgpr_read_b32 v190, a58
    v_accvgpr_read_b32 v191, a59
    v_pk_mul_f32 v[184:185], v[184:185], v[174:175]
    v_pk_mul_f32 v[186:187], v[186:187], v[174:175]
    v_pk_mul_f32 v[188:189], v[188:189], v[174:175]
    v_pk_mul_f32 v[190:191], v[190:191], v[174:175]
    v_cvt_pk_bf16_f32 v196, v184, v185
    v_cvt_pk_bf16_f32 v197, v186, v187
    v_cvt_pk_bf16_f32 v198, v188, v189
    v_cvt_pk_bf16_f32 v199, v190, v191
    v_mfma_f32_16x16x32_bf16 a[40:43], v[152:155], v[152:155], 0
    v_mfma_f32_16x16x32_bf16 a[56:59], v[152:155], v[152:155], 0
    v_permlane32_swap_b32 v196, v198
    v_permlane32_swap_b32 v197, v199
    s_nop 0
    v_permlane16_swap_b32 v196, v198
    v_permlane16_swap_b32 v197, v199
    v_accvgpr_write_b32 a180, v196
    v_accvgpr_write_b32 a181, v197
    v_accvgpr_write_b32 a182, v198
    v_accvgpr_write_b32 a183, v199
    v_accvgpr_read_b32 v176, a72
    v_accvgpr_read_b32 v177, a73
    v_accvgpr_read_b32 v178, a74
    v_accvgpr_read_b32 v179, a75
    v_accvgpr_read_b32 v180, a88
    v_accvgpr_read_b32 v181, a89
    v_accvgpr_read_b32 v182, a90
    v_accvgpr_read_b32 v183, a91
    v_pk_mul_f32 v[176:177], v[176:177], v[174:175]
    v_pk_mul_f32 v[178:179], v[178:179], v[174:175]
    v_pk_mul_f32 v[180:181], v[180:181], v[174:175]
    v_pk_mul_f32 v[182:183], v[182:183], v[174:175]
    v_cvt_pk_bf16_f32 v200, v176, v177
    v_cvt_pk_bf16_f32 v201, v178, v179
    v_cvt_pk_bf16_f32 v202, v180, v181
    v_cvt_pk_bf16_f32 v203, v182, v183
    v_mfma_f32_16x16x32_bf16 a[72:75], v[152:155], v[152:155], 0
    v_mfma_f32_16x16x32_bf16 a[88:91], v[152:155], v[152:155], 0
    v_permlane32_swap_b32 v200, v202
    v_permlane32_swap_b32 v201, v203
    s_nop 0
    v_permlane16_swap_b32 v200, v202
    v_permlane16_swap_b32 v201, v203
    v_accvgpr_write_b32 a184, v200
    v_accvgpr_write_b32 a185, v201
    v_accvgpr_write_b32 a186, v202
    v_accvgpr_write_b32 a187, v203
    v_accvgpr_read_b32 v184, a104
    v_accvgpr_read_b32 v185, a105
    v_accvgpr_read_b32 v186, a106
    v_accvgpr_read_b32 v187, a107
    v_accvgpr_read_b32 v188, a120
    v_accvgpr_read_b32 v189, a121
    v_accvgpr_read_b32 v190, a122
    v_accvgpr_read_b32 v191, a123
    v_pk_mul_f32 v[184:185], v[184:185], v[174:175]
    v_pk_mul_f32 v[186:187], v[186:187], v[174:175]
    v_pk_mul_f32 v[188:189], v[188:189], v[174:175]
    v_pk_mul_f32 v[190:191], v[190:191], v[174:175]
    v_cvt_pk_bf16_f32 v204, v184, v185
    v_cvt_pk_bf16_f32 v205, v186, v187
    v_cvt_pk_bf16_f32 v206, v188, v189
    v_cvt_pk_bf16_f32 v207, v190, v191
    v_mfma_f32_16x16x32_bf16 a[104:107], v[152:155], v[152:155], 0
    v_mfma_f32_16x16x32_bf16 a[120:123], v[152:155], v[152:155], 0
    v_permlane32_swap_b32 v204, v206
    v_permlane32_swap_b32 v205, v207
    s_nop 0
    v_permlane16_swap_b32 v204, v206
    v_permlane16_swap_b32 v205, v207
    v_accvgpr_write_b32 a188, v204
    v_accvgpr_write_b32 a189, v205
    v_accvgpr_write_b32 a190, v206
    v_accvgpr_write_b32 a191, v207
    v_accvgpr_read_b32 v176, a12
    v_accvgpr_read_b32 v177, a13
    v_accvgpr_read_b32 v178, a14
    v_accvgpr_read_b32 v179, a15
    v_accvgpr_read_b32 v180, a28
    v_accvgpr_read_b32 v181, a29
    v_accvgpr_read_b32 v182, a30
    v_accvgpr_read_b32 v183, a31
    v_pk_mul_f32 v[176:177], v[176:177], v[174:175]
    v_pk_mul_f32 v[178:179], v[178:179], v[174:175]
    v_pk_mul_f32 v[180:181], v[180:181], v[174:175]
    v_pk_mul_f32 v[182:183], v[182:183], v[174:175]
    v_cvt_pk_bf16_f32 v192, v176, v177
    v_cvt_pk_bf16_f32 v193, v178, v179
    v_cvt_pk_bf16_f32 v194, v180, v181
    v_cvt_pk_bf16_f32 v195, v182, v183
    v_mfma_f32_16x16x32_bf16 a[12:15], v[152:155], v[152:155], 0
    v_mfma_f32_16x16x32_bf16 a[28:31], v[152:155], v[152:155], 0
    v_permlane32_swap_b32 v192, v194
    v_permlane32_swap_b32 v193, v195
    s_nop 0
    v_permlane16_swap_b32 v192, v194
    v_permlane16_swap_b32 v193, v195
    v_accvgpr_write_b32 a192, v192
    v_accvgpr_write_b32 a193, v193
    v_accvgpr_write_b32 a194, v194
    v_accvgpr_write_b32 a195, v195
    v_accvgpr_read_b32 v184, a44
    v_accvgpr_read_b32 v185, a45
    v_accvgpr_read_b32 v186, a46
    v_accvgpr_read_b32 v187, a47
    v_accvgpr_read_b32 v188, a60
    v_accvgpr_read_b32 v189, a61
    v_accvgpr_read_b32 v190, a62
    v_accvgpr_read_b32 v191, a63
    v_pk_mul_f32 v[184:185], v[184:185], v[174:175]
    v_pk_mul_f32 v[186:187], v[186:187], v[174:175]
    v_pk_mul_f32 v[188:189], v[188:189], v[174:175]
    v_pk_mul_f32 v[190:191], v[190:191], v[174:175]
    v_cvt_pk_bf16_f32 v196, v184, v185
    v_cvt_pk_bf16_f32 v197, v186, v187
    v_cvt_pk_bf16_f32 v198, v188, v189
    v_cvt_pk_bf16_f32 v199, v190, v191
    v_mfma_f32_16x16x32_bf16 a[44:47], v[152:155], v[152:155], 0
    v_mfma_f32_16x16x32_bf16 a[60:63], v[152:155], v[152:155], 0
    v_permlane32_swap_b32 v196, v198
    v_permlane32_swap_b32 v197, v199
    s_nop 0
    v_permlane16_swap_b32 v196, v198
    v_permlane16_swap_b32 v197, v199
    v_accvgpr_write_b32 a196, v196
    v_accvgpr_write_b32 a197, v197
    v_accvgpr_write_b32 a198, v198
    v_accvgpr_write_b32 a199, v199
    v_accvgpr_read_b32 v176, a76
    v_accvgpr_read_b32 v177, a77
    v_accvgpr_read_b32 v178, a78
    v_accvgpr_read_b32 v179, a79
    v_accvgpr_read_b32 v180, a92
    v_accvgpr_read_b32 v181, a93
    v_accvgpr_read_b32 v182, a94
    v_accvgpr_read_b32 v183, a95
    v_pk_mul_f32 v[176:177], v[176:177], v[174:175]
    v_pk_mul_f32 v[178:179], v[178:179], v[174:175]
    v_pk_mul_f32 v[180:181], v[180:181], v[174:175]
    v_pk_mul_f32 v[182:183], v[182:183], v[174:175]
    v_cvt_pk_bf16_f32 v200, v176, v177
    v_cvt_pk_bf16_f32 v201, v178, v179
    v_cvt_pk_bf16_f32 v202, v180, v181
    v_cvt_pk_bf16_f32 v203, v182, v183
    v_mfma_f32_16x16x32_bf16 a[76:79], v[152:155], v[152:155], 0
    v_mfma_f32_16x16x32_bf16 a[92:95], v[152:155], v[152:155], 0
    v_permlane32_swap_b32 v200, v202
    v_permlane32_swap_b32 v201, v203
    s_nop 0
    v_permlane16_swap_b32 v200, v202
    v_permlane16_swap_b32 v201, v203
    v_accvgpr_write_b32 a200, v200
    v_accvgpr_write_b32 a201, v201
    v_accvgpr_write_b32 a202, v202
    v_accvgpr_write_b32 a203, v203
    v_accvgpr_read_b32 v184, a108
    v_accvgpr_read_b32 v185, a109
    v_accvgpr_read_b32 v186, a110
    v_accvgpr_read_b32 v187, a111
    v_accvgpr_read_b32 v188, a124
    v_accvgpr_read_b32 v189, a125
    v_accvgpr_read_b32 v190, a126
    v_accvgpr_read_b32 v191, a127
    v_pk_mul_f32 v[184:185], v[184:185], v[174:175]
    v_pk_mul_f32 v[186:187], v[186:187], v[174:175]
    v_pk_mul_f32 v[188:189], v[188:189], v[174:175]
    v_pk_mul_f32 v[190:191], v[190:191], v[174:175]
    v_cvt_pk_bf16_f32 v204, v184, v185
    v_cvt_pk_bf16_f32 v205, v186, v187
    v_cvt_pk_bf16_f32 v206, v188, v189
    v_cvt_pk_bf16_f32 v207, v190, v191
    v_mfma_f32_16x16x32_bf16 a[108:111], v[152:155], v[152:155], 0
    v_mfma_f32_16x16x32_bf16 a[124:127], v[152:155], v[152:155], 0
    v_permlane32_swap_b32 v204, v206
    v_permlane32_swap_b32 v205, v207
    s_nop 0
    v_permlane16_swap_b32 v204, v206
    v_permlane16_swap_b32 v205, v207
    v_accvgpr_write_b32 a204, v204
    v_accvgpr_write_b32 a205, v205
    v_accvgpr_write_b32 a206, v206
    v_accvgpr_write_b32 a207, v207
    v_mfma_f32_16x16x32_bf16 a[128:131], v[152:155], v[152:155], 0
    v_mfma_f32_16x16x32_bf16 a[132:135], v[152:155], v[152:155], 0
    v_mfma_f32_16x16x32_bf16 a[136:139], v[152:155], v[152:155], 0
    v_mfma_f32_16x16x32_bf16 a[140:143], v[152:155], v[152:155], 0
    s_cmp_ge_u32 s4, 16
    s_cselect_b32 s95, 7, 3
    s_cmp_eq_u32 s3, 0
    s_cselect_b32 s95, s95, -1
    s_mov_b32 s94, 4
f_non_chk:
    v_readfirstlane_b32 s92, v12
    v_readfirstlane_b32 s93, v13
    s_cmp_lg_u64 s[92:93], 0
    s_cbranch_scc1 f_non_ok
    buffer_load_dwordx2 v[12:13], off, s[96:99], 0 offset:16 sc1
    s_waitcnt vmcnt(0)
    s_branch f_non_chk
f_non_ok:
    s_waitcnt vmcnt(26)
    s_barrier
f_att_go:
    s_mov_b32 s20, s48
    s_mov_b32 s21, s49
    s_mov_b32 s22, 8388608
    s_mov_b32 s23, 0x20000
    s_add_u32 s40, s10, 62914560
    s_addc_u32 s41, s11, 0
    s_mov_b32 s42, 12648448
    s_mov_b32 s43, 0x20000
    s_lshr_b32 s30, s2, 3
    s_lshl_b32 s30, s30, 2
    s_and_b32 s31, s2, 3
    s_add_u32 s30, s30, s31
    s_lshl_b32 s31, s30, 2
    s_add_u32 s31, s31, s3
    s_mul_i32 s28, s31, 2341
    s_lshr_b32 s28, s28, 16
    s_mul_i32 s29, s28, 28
    s_sub_u32 s29, s31, s29
    s_lshl_b32 s29, s29, 17
    s_lshl_b32 s28, s28, 7
    s_add_u32 s6, s29, s28
    s_lshl_b32 s7, s31, 13
    s_add_u32 s7, s7, 8387584
    s_cmp_lt_u32 s31, 448
    s_cselect_b32 s6, s6, 0x7f000000
    s_cselect_b32 s7, s7, 0x7f000000
    s_lshl_b32 s28, s30, 16
    s_lshl_b32 s29, s3, 10
    s_add_u32 s63, s28, s29
    s_lshl_b32 s29, s3, 14
    s_add_u32 s34, s28, s29
    s_sub_u32 s34, s34, 4096
    s_lshl_b32 s60, s30, 16
    s_lshl_b32 s29, s3, 14
    s_add_u32 s60, s60, s29
    s_sub_u32 s60, s60, 4096
    s_cmp_ge_u32 s4, 16
    s_cselect_b32 s30, 1, s33
    s_cmp_lg_u32 s30, 0
    s_cselect_b32 s6, 0x7f000000, s6
    s_cselect_b32 s34, 0x7f000000, s34
    s_cselect_b32 s63, 0x7f000000, s63
    v_lshrrev_b32 v204, 3, v1
    v_bfe_u32 v205, v1, 4, 2
    v_lshlrev_b32 v205, 1, v205
    v_and_b32 v206, 7, v1
    v_xor_b32 v205, v205, v206
    v_lshlrev_b32 v205, 4, v205
    v_lshl_add_u32 v201, v204, 11, v205
    v_lshlrev_b32 v203, 6, v1
    buffer_load_dwordx4 v[192:195], v255, s[20:23], s63 offen offset:0
    buffer_load_dwordx4 v[250:253], v255, s[20:23], s63 offen offset:64
    s_add_u32 s30, s6, 65536
    buffer_load_dwordx4 v[204:207], v201, s[44:47], s6 offen
    buffer_load_dwordx4 v[10:13], v201, s[44:47], s30 offen
    v_mov_b32 v198, 0
    v_lshlrev_b32 v200, 3, v0
    ds_read_b128 v[112:115], v216 offset:32768
    ds_read_b128 v[116:119], v217 offset:32768
    ds_read_b128 v[120:123], v218 offset:32768
    ds_read_b128 v[124:127], v219 offset:32768
    ds_read_b128 v[128:131], v216 offset:36864
    ds_read_b128 v[132:135], v217 offset:36864
    ds_read_b128 v[136:139], v218 offset:36864
    ds_read_b128 v[140:143], v219 offset:36864
    s_waitcnt lgkmcnt(7)
    v_mfma_f32_16x16x32_bf16 v[80:83], v[112:115], a[144:147], 0
    v_mfma_f32_16x16x32_bf16 v[84:87], v[112:115], a[160:163], 0
    v_mfma_f32_16x16x32_bf16 v[88:91], v[112:115], a[176:179], 0
    v_mfma_f32_16x16x32_bf16 v[92:95], v[112:115], a[192:195], 0
    s_waitcnt lgkmcnt(6)
    v_mfma_f32_16x16x32_bf16 v[80:83], v[116:119], a[148:151], v[80:83]
    v_mfma_f32_16x16x32_bf16 v[84:87], v[116:119], a[164:167], v[84:87]
    v_mfma_f32_16x16x32_bf16 v[88:91], v[116:119], a[180:183], v[88:91]
    v_mfma_f32_16x16x32_bf16 v[92:95], v[116:119], a[196:199], v[92:95]
    s_waitcnt lgkmcnt(5)
    v_mfma_f32_16x16x32_bf16 v[80:83], v[120:123], a[152:155], v[80:83]
    v_mfma_f32_16x16x32_bf16 v[84:87], v[120:123], a[168:171], v[84:87]
    v_mfma_f32_16x16x32_bf16 v[88:91], v[120:123], a[184:187], v[88:91]
    v_mfma_f32_16x16x32_bf16 v[92:95], v[120:123], a[200:203], v[92:95]
    s_waitcnt lgkmcnt(4)
    v_mfma_f32_16x16x32_bf16 v[80:83], v[124:127], a[156:159], v[80:83]
    v_mfma_f32_16x16x32_bf16 v[84:87], v[124:127], a[172:175], v[84:87]
    v_mfma_f32_16x16x32_bf16 v[88:91], v[124:127], a[188:191], v[88:91]
    v_mfma_f32_16x16x32_bf16 v[92:95], v[124:127], a[204:207], v[92:95]
    s_waitcnt lgkmcnt(3)
    v_mfma_f32_16x16x32_bf16 v[64:67], v[128:131], a[144:147], 0
    v_mfma_f32_16x16x32_bf16 v[68:71], v[128:131], a[160:163], 0
    v_mfma_f32_16x16x32_bf16 v[72:75], v[128:131], a[176:179], 0
    v_mfma_f32_16x16x32_bf16 v[76:79], v[128:131], a[192:195], 0
    s_waitcnt lgkmcnt(2)
    v_mfma_f32_16x16x32_bf16 v[64:67], v[132:135], a[148:151], v[64:67]
    v_mfma_f32_16x16x32_bf16 v[68:71], v[132:135], a[164:167], v[68:71]
    v_mfma_f32_16x16x32_bf16 v[72:75], v[132:135], a[180:183], v[72:75]
    v_mfma_f32_16x16x32_bf16 v[76:79], v[132:135], a[196:199], v[76:79]
    s_waitcnt lgkmcnt(1)
    v_mfma_f32_16x16x32_bf16 v[64:67], v[136:139], a[152:155], v[64:67]
    v_mfma_f32_16x16x32_bf16 v[68:71], v[136:139], a[168:171], v[68:71]
    v_mfma_f32_16x16x32_bf16 v[72:75], v[136:139], a[184:187], v[72:75]
    v_mfma_f32_16x16x32_bf16 v[76:79], v[136:139], a[200:203], v[76:79]
    s_waitcnt lgkmcnt(0)
    v_mfma_f32_16x16x32_bf16 v[64:67], v[140:143], a[156:159], v[64:67]
    v_mfma_f32_16x16x32_bf16 v[68:71], v[140:143], a[172:175], v[68:71]
    v_mfma_f32_16x16x32_bf16 v[72:75], v[140:143], a[188:191], v[72:75]
    v_mfma_f32_16x16x32_bf16 v[76:79], v[140:143], a[204:207], v[76:79]
    ds_read_b128 v[112:115], v216 offset:40960
    ds_read_b128 v[116:119], v217 offset:40960
    ds_read_b128 v[120:123], v218 offset:40960
    ds_read_b128 v[124:127], v219 offset:40960
    ds_read_b128 v[128:131], v216 offset:45056
    ds_read_b128 v[132:135], v217 offset:45056
    ds_read_b128 v[136:139], v218 offset:45056
    ds_read_b128 v[140:143], v219 offset:45056
    s_waitcnt lgkmcnt(7)
    v_mfma_f32_16x16x32_bf16 v[96:99], v[112:115], a[144:147], 0
    v_mfma_f32_16x16x32_bf16 v[100:103], v[112:115], a[160:163], 0
    v_mfma_f32_16x16x32_bf16 v[104:107], v[112:115], a[176:179], 0
    v_mfma_f32_16x16x32_bf16 v[108:111], v[112:115], a[192:195], 0
    s_waitcnt lgkmcnt(6)
    v_mfma_f32_16x16x32_bf16 v[96:99], v[116:119], a[148:151], v[96:99]
    v_mfma_f32_16x16x32_bf16 v[100:103], v[116:119], a[164:167], v[100:103]
    v_mfma_f32_16x16x32_bf16 v[104:107], v[116:119], a[180:183], v[104:107]
    v_mfma_f32_16x16x32_bf16 v[108:111], v[116:119], a[196:199], v[108:111]
    s_waitcnt lgkmcnt(5)
    v_mfma_f32_16x16x32_bf16 v[96:99], v[120:123], a[152:155], v[96:99]
    v_mfma_f32_16x16x32_bf16 v[100:103], v[120:123], a[168:171], v[100:103]
    v_mfma_f32_16x16x32_bf16 v[104:107], v[120:123], a[184:187], v[104:107]
    v_mfma_f32_16x16x32_bf16 v[108:111], v[120:123], a[200:203], v[108:111]
    s_waitcnt lgkmcnt(4)
    v_mfma_f32_16x16x32_bf16 v[96:99], v[124:127], a[156:159], v[96:99]
    v_mfma_f32_16x16x32_bf16 v[100:103], v[124:127], a[172:175], v[100:103]
    v_mfma_f32_16x16x32_bf16 v[104:107], v[124:127], a[188:191], v[104:107]
    v_mfma_f32_16x16x32_bf16 v[108:111], v[124:127], a[204:207], v[108:111]
    s_waitcnt lgkmcnt(3)
    v_mfma_f32_16x16x32_bf16 v[48:51], v[128:131], a[144:147], 0
    v_mfma_f32_16x16x32_bf16 v[52:55], v[128:131], a[160:163], 0
    v_mfma_f32_16x16x32_bf16 v[56:59], v[128:131], a[176:179], 0
    v_mfma_f32_16x16x32_bf16 v[60:63], v[128:131], a[192:195], 0
    s_waitcnt lgkmcnt(2)
    v_mfma_f32_16x16x32_bf16 v[48:51], v[132:135], a[148:151], v[48:51]
    v_mfma_f32_16x16x32_bf16 v[52:55], v[132:135], a[164:167], v[52:55]
    v_mfma_f32_16x16x32_bf16 v[56:59], v[132:135], a[180:183], v[56:59]
    v_mfma_f32_16x16x32_bf16 v[60:63], v[132:135], a[196:199], v[60:63]
    s_waitcnt lgkmcnt(1)
    v_mfma_f32_16x16x32_bf16 v[48:51], v[136:139], a[152:155], v[48:51]
    v_mfma_f32_16x16x32_bf16 v[52:55], v[136:139], a[168:171], v[52:55]
    v_mfma_f32_16x16x32_bf16 v[56:59], v[136:139], a[184:187], v[56:59]
    v_mfma_f32_16x16x32_bf16 v[60:63], v[136:139], a[200:203], v[60:63]
    s_waitcnt lgkmcnt(0)
    v_mfma_f32_16x16x32_bf16 v[48:51], v[140:143], a[156:159], v[48:51]
    v_mfma_f32_16x16x32_bf16 v[52:55], v[140:143], a[172:175], v[52:55]
    v_mfma_f32_16x16x32_bf16 v[56:59], v[140:143], a[188:191], v[56:59]
    v_mfma_f32_16x16x32_bf16 v[60:63], v[140:143], a[204:207], v[60:63]
    ds_read_b128 v[112:115], v212 offset:0
    ds_read_b128 v[116:119], v213 offset:0
    ds_read_b128 v[120:123], v214 offset:0
    ds_read_b128 v[124:127], v215 offset:0
    ds_read_b128 v[128:131], v212 offset:4096
    ds_read_b128 v[132:135], v213 offset:4096
    s_cmp_lg_u32 s33, 0
    s_cbranch_scc1 f_havemax
    v_max3_f32 v2, v80, v81, v82
    v_max3_f32 v2, v2, v83, v64
    v_max3_f32 v2, v2, v65, v66
    v_max3_f32 v2, v2, v67, v96
    v_max3_f32 v2, v2, v97, v98
    v_max3_f32 v2, v2, v99, v48
    v_max3_f32 v2, v2, v49, v50
    v_max_f32 v2, v2, v51
    v_max3_f32 v3, v84, v85, v86
    v_max3_f32 v3, v3, v87, v68
    v_max3_f32 v3, v3, v69, v70
    v_max3_f32 v3, v3, v71, v100
    v_max3_f32 v3, v3, v101, v102
    v_max3_f32 v3, v3, v103, v52
    v_max3_f32 v3, v3, v53, v54
    v_max_f32 v3, v3, v55
    v_max3_f32 v4, v88, v89, v90
    v_max3_f32 v4, v4, v91, v72
    v_max3_f32 v4, v4, v73, v74
    v_max3_f32 v4, v4, v75, v104
    v_max3_f32 v4, v4, v105, v106
    v_max3_f32 v4, v4, v107, v56
    v_max3_f32 v4, v4, v57, v58
    v_max_f32 v4, v4, v59
    v_max3_f32 v5, v92, v93, v94
    v_max3_f32 v5, v5, v95, v76
    v_max3_f32 v5, v5, v77, v78
    v_max3_f32 v5, v5, v79, v108
    v_max3_f32 v5, v5, v109, v110
    v_max3_f32 v5, v5, v111, v60
    v_max3_f32 v5, v5, v61, v62
    v_max_f32 v5, v5, v63
    v_mov_b32 v6, v2
    v_mov_b32 v7, v3
    v_mov_b32 v8, v4
    v_mov_b32 v9, v5
    v_permlane32_swap_b32 v2, v6
    v_permlane32_swap_b32 v3, v7
    v_permlane32_swap_b32 v4, v8
    v_permlane32_swap_b32 v5, v9
    v_max_f32 v2, v2, v6
    v_max_f32 v3, v3, v7
    v_max_f32 v4, v4, v8
    v_max_f32 v5, v5, v9
    v_mov_b32 v6, v2
    v_mov_b32 v7, v3
    v_mov_b32 v8, v4
    v_mov_b32 v9, v5
    v_permlane16_swap_b32 v2, v6
    v_permlane16_swap_b32 v3, v7
    v_permlane16_swap_b32 v4, v8
    v_permlane16_swap_b32 v5, v9
    v_max_f32 v2, v2, v6
    v_max_f32 v3, v3, v7
    v_max_f32 v4, v4, v8
    v_max_f32 v5, v5, v9
    v_sub_f32 v176, 0, v2
    v_sub_f32 v177, 0, v2
    v_sub_f32 v178, 0, v2
    v_sub_f32 v179, 0, v2
    v_sub_f32 v180, 0, v3
    v_sub_f32 v181, 0, v3
    v_sub_f32 v182, 0, v3
    v_sub_f32 v183, 0, v3
    v_sub_f32 v184, 0, v4
    v_sub_f32 v185, 0, v4
    v_sub_f32 v186, 0, v4
    v_sub_f32 v187, 0, v4
    v_sub_f32 v188, 0, v5
    v_sub_f32 v189, 0, v5
    v_sub_f32 v190, 0, v5
    v_sub_f32 v191, 0, v5
f_havemax:
    v_pk_add_f32 v[80:81], v[80:81], v[176:177]
    v_pk_add_f32 v[82:83], v[82:83], v[176:177]
    v_pk_add_f32 v[84:85], v[84:85], v[180:181]
    v_pk_add_f32 v[86:87], v[86:87], v[180:181]
    v_pk_add_f32 v[88:89], v[88:89], v[184:185]
    v_pk_add_f32 v[90:91], v[90:91], v[184:185]
    v_pk_add_f32 v[92:93], v[92:93], v[188:189]
    v_pk_add_f32 v[94:95], v[94:95], v[188:189]
    v_pk_add_f32 v[64:65], v[64:65], v[176:177]
    v_pk_add_f32 v[66:67], v[66:67], v[176:177]
    v_pk_add_f32 v[68:69], v[68:69], v[180:181]
    v_pk_add_f32 v[70:71], v[70:71], v[180:181]
    v_pk_add_f32 v[72:73], v[72:73], v[184:185]
    v_pk_add_f32 v[74:75], v[74:75], v[184:185]
    v_pk_add_f32 v[76:77], v[76:77], v[188:189]
    v_pk_add_f32 v[78:79], v[78:79], v[188:189]
    v_pk_add_f32 v[96:97], v[96:97], v[176:177]
    v_pk_add_f32 v[98:99], v[98:99], v[176:177]
    v_pk_add_f32 v[100:101], v[100:101], v[180:181]
    v_pk_add_f32 v[102:103], v[102:103], v[180:181]
    v_pk_add_f32 v[104:105], v[104:105], v[184:185]
    v_pk_add_f32 v[106:107], v[106:107], v[184:185]
    v_pk_add_f32 v[108:109], v[108:109], v[188:189]
    v_pk_add_f32 v[110:111], v[110:111], v[188:189]
    v_pk_add_f32 v[48:49], v[48:49], v[176:177]
    v_pk_add_f32 v[50:51], v[50:51], v[176:177]
    v_pk_add_f32 v[52:53], v[52:53], v[180:181]
    v_pk_add_f32 v[54:55], v[54:55], v[180:181]
    v_pk_add_f32 v[56:57], v[56:57], v[184:185]
    v_pk_add_f32 v[58:59], v[58:59], v[184:185]
    v_pk_add_f32 v[60:61], v[60:61], v[188:189]
    v_pk_add_f32 v[62:63], v[62:63], v[188:189]
    v_exp_f32 v80, v80
    v_exp_f32 v81, v81
    s_nop 0
    v_cvt_pk_bf16_f32 v80, v80, v81
    v_exp_f32 v82, v82
    v_exp_f32 v83, v83
    s_nop 0
    v_cvt_pk_bf16_f32 v81, v82, v83
    v_exp_f32 v64, v64
    v_exp_f32 v65, v65
    s_nop 0
    v_cvt_pk_bf16_f32 v82, v64, v65
    v_exp_f32 v66, v66
    v_exp_f32 v67, v67
    s_nop 0
    v_cvt_pk_bf16_f32 v83, v66, v67
    v_exp_f32 v84, v84
    v_exp_f32 v85, v85
    s_nop 0
    v_cvt_pk_bf16_f32 v84, v84, v85
    v_exp_f32 v86, v86
    v_exp_f32 v87, v87
    s_nop 0
    v_cvt_pk_bf16_f32 v85, v86, v87
    v_exp_f32 v68, v68
    v_exp_f32 v69, v69
    s_nop 0
    v_cvt_pk_bf16_f32 v86, v68, v69
    v_exp_f32 v70, v70
    v_exp_f32 v71, v71
    s_nop 0
    v_cvt_pk_bf16_f32 v87, v70, v71
    v_exp_f32 v88, v88
    v_exp_f32 v89, v89
    s_nop 0
    v_cvt_pk_bf16_f32 v88, v88, v89
    v_exp_f32 v90, v90
    v_exp_f32 v91, v91
    s_nop 0
    v_cvt_pk_bf16_f32 v89, v90, v91
    v_exp_f32 v72, v72
    v_exp_f32 v73, v73
    s_nop 0
    v_cvt_pk_bf16_f32 v90, v72, v73
    v_exp_f32 v74, v74
    v_exp_f32 v75, v75
    s_nop 0
    v_cvt_pk_bf16_f32 v91, v74, v75
    v_exp_f32 v92, v92
    v_exp_f32 v93, v93
    s_nop 0
    v_cvt_pk_bf16_f32 v92, v92, v93
    v_exp_f32 v94, v94
    v_exp_f32 v95, v95
    s_nop 0
    v_cvt_pk_bf16_f32 v93, v94, v95
    v_exp_f32 v76, v76
    v_exp_f32 v77, v77
    s_nop 0
    v_cvt_pk_bf16_f32 v94, v76, v77
    v_exp_f32 v78, v78
    v_exp_f32 v79, v79
    s_nop 0
    v_cvt_pk_bf16_f32 v95, v78, v79
    v_exp_f32 v96, v96
    v_exp_f32 v97, v97
    s_nop 0
    v_cvt_pk_bf16_f32 v96, v96, v97
    v_exp_f32 v98, v98
    v_exp_f32 v99, v99
    s_nop 0
    v_cvt_pk_bf16_f32 v97, v98, v99
    v_exp_f32 v48, v48
    v_exp_f32 v49, v49
    s_nop 0
    v_cvt_pk_bf16_f32 v98, v48, v49
    v_exp_f32 v50, v50
    v_exp_f32 v51, v51
    s_nop 0
    v_cvt_pk_bf16_f32 v99, v50, v51
    v_exp_f32 v100, v100
    v_exp_f32 v101, v101
    s_nop 0
    v_cvt_pk_bf16_f32 v100, v100, v101
    v_exp_f32 v102, v102
    v_exp_f32 v103, v103
    s_nop 0
    v_cvt_pk_bf16_f32 v101, v102, v103
    v_exp_f32 v52, v52
    v_exp_f32 v53, v53
    s_nop 0
    v_cvt_pk_bf16_f32 v102, v52, v53
    v_exp_f32 v54, v54
    v_exp_f32 v55, v55
    s_nop 0
    v_cvt_pk_bf16_f32 v103, v54, v55
    s_lshr_b32 s28, s2, 3
    s_lshl_b32 s28, s28, 2
    s_add_u32 s28, s28, s3
    s_getpc_b64 s[30:31]
f_pc2:
    s_add_u32 s30, s30, f_l23-f_pc2
    s_addc_u32 s31, s31, 0
    v_lshl_add_u32 v14, s28, 6, v1
    v_lshlrev_b32 v14, 3, v14
    v_min_u32 v14, f_code_end-f_l23-4, v14
    v_mov_b32 v15, s31
    v_add_co_u32 v14, vcc, s30, v14
    s_nop 1
    v_addc_co_u32 v15, vcc, 0, v15, vcc
    s_waitcnt lgkmcnt(0)
    s_mov_b32 s32, 8
    s_cmp_ge_u32 s4, 16
    s_cbranch_scc1 f_att_hi
    s_cmp_lg_u32 s33, 0
    s_cbranch_scc1 f_att_hi
    buffer_load_dwordx4 v[2:5], v255, s[20:23], s63 offen offset:128
    buffer_load_dwordx4 v[6:9], v255, s[20:23], s63 offen offset:192
f_att_loop2:
    v_mfma_f32_16x16x32_bf16 v[16:19], v[112:115], a[144:147], v[176:179]
    v_exp_f32 v104, v104
    v_mfma_f32_16x16x32_bf16 v[16:19], v[116:119], a[148:151], v[16:19]
    v_exp_f32 v105, v105
    v_mfma_f32_16x16x32_bf16 v[16:19], v[120:123], a[152:155], v[16:19]
    ds_read_b128 v[136:139], v214 offset:4096
    v_cvt_pk_bf16_f32 v104, v104, v105
    v_mfma_f32_16x16x32_bf16 v[16:19], v[124:127], a[156:159], v[16:19]
    v_exp_f32 v106, v106
    v_mfma_f32_16x16x32_bf16 v[20:23], v[124:127], a[172:175], v[180:183]
    v_exp_f32 v107, v107
    v_mfma_f32_16x16x32_bf16 v[20:23], v[120:123], a[168:171], v[20:23]
    ds_read_b128 v[140:143], v215 offset:4096
    v_cvt_pk_bf16_f32 v105, v106, v107
    v_mfma_f32_16x16x32_bf16 v[20:23], v[116:119], a[164:167], v[20:23]
    ds_read_b64_tr_b16 v[144:145], v220 offset:16384
    v_mfma_f32_16x16x32_bf16 v[20:23], v[112:115], a[160:163], v[20:23]
    v_exp_f32 v56, v56
    v_mfma_f32_16x16x32_bf16 v[24:27], v[112:115], a[176:179], v[184:187]
    v_exp_f32 v57, v57
    v_mfma_f32_16x16x32_bf16 v[24:27], v[116:119], a[180:183], v[24:27]
    buffer_load_dwordx4 v238, s[12:15], s54 offen offset:2048 lds
    v_mfma_f32_16x16x32_bf16 v[24:27], v[120:123], a[184:187], v[24:27]
    ds_read_b64_tr_b16 v[146:147], v220 offset:20480
    v_cvt_pk_bf16_f32 v106, v56, v57
    v_mfma_f32_16x16x32_bf16 v[24:27], v[124:127], a[188:191], v[24:27]
    v_exp_f32 v58, v58
    v_mfma_f32_16x16x32_bf16 v[28:31], v[124:127], a[204:207], v[188:191]
    v_exp_f32 v59, v59
    v_mfma_f32_16x16x32_bf16 v[28:31], v[120:123], a[200:203], v[28:31]
    ds_read_b64_tr_b16 v[148:149], v220 offset:24576
    v_cvt_pk_bf16_f32 v107, v58, v59
    v_mfma_f32_16x16x32_bf16 v[28:31], v[116:119], a[196:199], v[28:31]
    ds_read_b64_tr_b16 v[150:151], v220 offset:28672
    v_mfma_f32_16x16x32_bf16 v[28:31], v[112:115], a[192:195], v[28:31]
    s_waitcnt lgkmcnt(6)
    v_mfma_f32_16x16x32_bf16 v[32:35], v[128:131], a[144:147], v[176:179]
    v_mfma_f32_16x16x32_bf16 v[32:35], v[132:135], a[148:151], v[32:35]
    s_waitcnt lgkmcnt(5)
    v_exp_f32 v108, v108
    v_mfma_f32_16x16x32_bf16 v[32:35], v[136:139], a[152:155], v[32:35]
    s_waitcnt lgkmcnt(4)
    v_exp_f32 v109, v109
    v_mfma_f32_16x16x32_bf16 v[32:35], v[140:143], a[156:159], v[32:35]
    ds_read_b128 v[112:115], v212 offset:8192
    v_cvt_pk_bf16_f32 v108, v108, v109
    v_mfma_f32_16x16x32_bf16 v[36:39], v[140:143], a[172:175], v[180:183]
    v_exp_f32 v110, v110
    v_mfma_f32_16x16x32_bf16 v[36:39], v[136:139], a[168:171], v[36:39]
    v_exp_f32 v111, v111
    v_mfma_f32_16x16x32_bf16 v[36:39], v[132:135], a[164:167], v[36:39]
    ds_read_b128 v[116:119], v213 offset:8192
    v_cvt_pk_bf16_f32 v109, v110, v111
    v_mfma_f32_16x16x32_bf16 v[36:39], v[128:131], a[160:163], v[36:39]
    ds_read_b128 v[120:123], v214 offset:8192
    v_mfma_f32_16x16x32_bf16 v[40:43], v[128:131], a[176:179], v[184:187]
    v_exp_f32 v60, v60
    v_mfma_f32_16x16x32_bf16 v[40:43], v[132:135], a[180:183], v[40:43]
    v_exp_f32 v61, v61
    v_mfma_f32_16x16x32_bf16 v[40:43], v[136:139], a[184:187], v[40:43]
    buffer_load_dwordx4 v239, s[12:15], s54 offen offset:3072 lds
    v_mfma_f32_16x16x32_bf16 v[40:43], v[140:143], a[188:191], v[40:43]
    ds_read_b128 v[124:127], v215 offset:8192
    v_cvt_pk_bf16_f32 v110, v60, v61
    v_mfma_f32_16x16x32_bf16 v[44:47], v[140:143], a[204:207], v[188:191]
    v_exp_f32 v62, v62
    v_mfma_f32_16x16x32_bf16 v[44:47], v[136:139], a[200:203], v[44:47]
    v_exp_f32 v63, v63
    v_mfma_f32_16x16x32_bf16 v[44:47], v[132:135], a[196:199], v[44:47]
    s_add_u32 s60, s60, 4096
    ds_read_b64_tr_b16 v[152:153], v221 offset:16384
    v_cvt_pk_bf16_f32 v111, v62, v63
    v_mfma_f32_16x16x32_bf16 v[44:47], v[128:131], a[192:195], v[44:47]
    s_waitcnt lgkmcnt(2)
    ds_read_b64_tr_b16 v[154:155], v221 offset:20480
    v_mfma_f32_16x16x32_bf16 v[48:51], v[112:115], a[144:147], v[176:179]
    buffer_load_dword v202, v203, s[36:39], s60 offen
    v_mfma_f32_16x16x32_bf16 v[48:51], v[116:119], a[148:151], v[48:51]
    v_mfma_f32_16x16x32_bf16 v[48:51], v[120:123], a[152:155], v[48:51]
    s_waitcnt lgkmcnt(2)
    v_exp_f32 v16, v16
    v_mfma_f32_16x16x32_bf16 v[48:51], v[124:127], a[156:159], v[48:51]
    v_exp_f32 v17, v17
    v_mfma_f32_16x16x32_bf16 v[52:55], v[124:127], a[172:175], v[180:183]
    ds_read_b128 v[128:131], v212 offset:12288
    v_cvt_pk_bf16_f32 v16, v16, v17
    v_mfma_f32_16x16x32_bf16 v[52:55], v[120:123], a[168:171], v[52:55]
    v_exp_f32 v18, v18
    v_mfma_f32_16x16x32_bf16 v[52:55], v[116:119], a[164:167], v[52:55]
    v_exp_f32 v19, v19
    v_mfma_f32_16x16x32_bf16 v[52:55], v[112:115], a[160:163], v[52:55]
    ds_read_b128 v[132:135], v213 offset:12288
    v_cvt_pk_bf16_f32 v17, v18, v19
    v_mfma_f32_16x16x32_bf16 v[56:59], v[112:115], a[176:179], v[184:187]
    ds_read_b128 v[136:139], v214 offset:12288
    v_mfma_f32_16x16x32_bf16 v[56:59], v[116:119], a[180:183], v[56:59]
    s_add_u32 s55, s55, 16384
    v_exp_f32 v32, v32
    v_mfma_f32_16x16x32_bf16 v[56:59], v[120:123], a[184:187], v[56:59]
    s_add_u32 m0, s53, 81920
    v_exp_f32 v33, v33
    v_mfma_f32_16x16x32_bf16 v[56:59], v[124:127], a[188:191], v[56:59]
    buffer_load_dwordx4 v240, s[16:19], s55 offen offset:0 lds
    v_mfma_f32_16x16x32_bf16 v[60:63], v[124:127], a[204:207], v[188:191]
    ds_read_b128 v[140:143], v215 offset:12288
    v_cvt_pk_bf16_f32 v18, v32, v33
    v_mfma_f32_16x16x32_bf16 v[60:63], v[120:123], a[200:203], v[60:63]
    v_exp_f32 v34, v34
    v_mfma_f32_16x16x32_bf16 v[60:63], v[116:119], a[196:199], v[60:63]
    v_exp_f32 v35, v35
    v_mfma_f32_16x16x32_bf16 v[60:63], v[112:115], a[192:195], v[60:63]
    s_waitcnt lgkmcnt(1)
    ds_read_b64_tr_b16 v[156:157], v221 offset:24576
    v_cvt_pk_bf16_f32 v19, v34, v35
    v_mfma_f32_16x16x32_bf16 v[64:67], v[128:131], a[144:147], v[176:179]
    ds_read_b64_tr_b16 v[158:159], v221 offset:28672
    v_mfma_f32_16x16x32_bf16 v[64:67], v[132:135], a[148:151], v[64:67]
    v_mfma_f32_16x16x32_bf16 v[64:67], v[136:139], a[152:155], v[64:67]
    s_waitcnt lgkmcnt(2)
    v_mfma_f32_16x16x32_bf16 v[64:67], v[140:143], a[156:159], v[64:67]
    v_exp_f32 v20, v20
    v_mfma_f32_16x16x32_bf16 v[68:71], v[140:143], a[172:175], v[180:183]
    v_exp_f32 v21, v21
    v_mfma_f32_16x16x32_bf16 v[68:71], v[136:139], a[168:171], v[68:71]
    ds_read_b64_tr_b16 v[160:161], v222 offset:16384
    v_cvt_pk_bf16_f32 v20, v20, v21
    v_mfma_f32_16x16x32_bf16 v[68:71], v[132:135], a[164:167], v[68:71]
    v_exp_f32 v22, v22
    v_mfma_f32_16x16x32_bf16 v[68:71], v[128:131], a[160:163], v[68:71]
    v_exp_f32 v23, v23
    v_mfma_f32_16x16x32_bf16 v[72:75], v[128:131], a[176:179], v[184:187]
    ds_read_b64_tr_b16 v[162:163], v222 offset:20480
    v_cvt_pk_bf16_f32 v21, v22, v23
    v_mfma_f32_16x16x32_bf16 v[72:75], v[132:135], a[180:183], v[72:75]
    ds_read_b64_tr_b16 v[164:165], v222 offset:24576
    v_mfma_f32_16x16x32_bf16 v[72:75], v[136:139], a[184:187], v[72:75]
    v_exp_f32 v36, v36
    v_mfma_f32_16x16x32_bf16 v[72:75], v[140:143], a[188:191], v[72:75]
    v_exp_f32 v37, v37
    v_mfma_f32_16x16x32_bf16 v[76:79], v[140:143], a[204:207], v[188:191]
    buffer_load_dwordx4 v241, s[16:19], s55 offen offset:1024 lds
    v_mfma_f32_16x16x32_bf16 v[76:79], v[136:139], a[200:203], v[76:79]
    ds_read_b64_tr_b16 v[166:167], v222 offset:28672
    v_cvt_pk_bf16_f32 v22, v36, v37
    v_mfma_f32_16x16x32_bf16 v[76:79], v[132:135], a[196:199], v[76:79]
    v_exp_f32 v38, v38
    v_mfma_f32_16x16x32_bf16 v[76:79], v[128:131], a[192:195], v[76:79]
    v_exp_f32 v39, v39
    v_mfma_f32_16x16x32_bf16 a[0:3], v[144:147], v[80:83], a[0:3]
    ds_read_b64_tr_b16 v[168:169], v223 offset:16384
    v_cvt_pk_bf16_f32 v23, v38, v39
    v_mfma_f32_16x16x32_bf16 a[0:3], v[148:151], v[96:99], a[0:3]
    ds_read_b64_tr_b16 v[170:171], v223 offset:20480
    v_mfma_f32_16x16x32_bf16 a[4:7], v[148:151], v[100:103], a[4:7]
    v_mfma_f32_16x16x32_bf16 a[4:7], v[144:147], v[84:87], a[4:7]
    v_mfma_f32_16x16x32_bf16 a[8:11], v[144:147], v[88:91], a[8:11]
    v_exp_f32 v24, v24
    v_mfma_f32_16x16x32_bf16 a[8:11], v[148:151], v[104:107], a[8:11]
    v_exp_f32 v25, v25
    v_mfma_f32_16x16x32_bf16 a[12:15], v[148:151], v[108:111], a[12:15]
    ds_read_b64_tr_b16 v[172:173], v223 offset:24576
    v_cvt_pk_bf16_f32 v24, v24, v25
    v_mfma_f32_16x16x32_bf16 a[12:15], v[144:147], v[92:95], a[12:15]
    s_waitcnt lgkmcnt(7)
    v_exp_f32 v26, v26
    v_mfma_f32_16x16x32_bf16 a[28:31], v[152:155], v[92:95], a[28:31]
    v_exp_f32 v27, v27
    v_mfma_f32_16x16x32_bf16 a[28:31], v[156:159], v[108:111], a[28:31]
    ds_read_b64_tr_b16 v[174:175], v223 offset:28672
    v_cvt_pk_bf16_f32 v25, v26, v27
    v_mfma_f32_16x16x32_bf16 a[24:27], v[156:159], v[104:107], a[24:27]
    ds_read_b64_tr_b16 v[144:145], v224 offset:16384
    v_mfma_f32_16x16x32_bf16 a[24:27], v[152:155], v[88:91], a[24:27]
    v_exp_f32 v40, v40
    v_mfma_f32_16x16x32_bf16 a[20:23], v[152:155], v[84:87], a[20:23]
    v_exp_f32 v41, v41
    v_mfma_f32_16x16x32_bf16 a[20:23], v[156:159], v[100:103], a[20:23]
    buffer_load_dwordx4 v240, s[16:19], s55 offen offset:2048 lds
    v_mfma_f32_16x16x32_bf16 a[16:19], v[156:159], v[96:99], a[16:19]
    ds_read_b64_tr_b16 v[146:147], v224 offset:20480
    v_cvt_pk_bf16_f32 v26, v40, v41
    v_mfma_f32_16x16x32_bf16 a[16:19], v[152:155], v[80:83], a[16:19]
    s_waitcnt lgkmcnt(6)
    v_exp_f32 v42, v42
    v_mfma_f32_16x16x32_bf16 a[32:35], v[160:163], v[80:83], a[32:35]
    v_exp_f32 v43, v43
    v_mfma_f32_16x16x32_bf16 a[32:35], v[164:167], v[96:99], a[32:35]
    ds_read_b64_tr_b16 v[148:149], v224 offset:24576
    v_cvt_pk_bf16_f32 v27, v42, v43
    v_mfma_f32_16x16x32_bf16 a[36:39], v[164:167], v[100:103], a[36:39]
    ds_read_b64_tr_b16 v[150:151], v224 offset:28672
    v_mfma_f32_16x16x32_bf16 a[36:39], v[160:163], v[84:87], a[36:39]
    ds_read_b64_tr_b16 v[152:153], v225 offset:16384
    v_mfma_f32_16x16x32_bf16 a[40:43], v[160:163], v[88:91], a[40:43]
    ds_read_b64_tr_b16 v[154:155], v225 offset:20480
    v_mfma_f32_16x16x32_bf16 a[40:43], v[164:167], v[104:107], a[40:43]
    v_exp_f32 v28, v28
    v_mfma_f32_16x16x32_bf16 a[44:47], v[164:167], v[108:111], a[44:47]
    v_exp_f32 v29, v29
    v_mfma_f32_16x16x32_bf16 a[44:47], v[160:163], v[92:95], a[44:47]
    s_waitcnt lgkmcnt(6)
    ds_read_b64_tr_b16 v[156:157], v225 offset:24576
    v_cvt_pk_bf16_f32 v28, v28, v29
    v_mfma_f32_16x16x32_bf16 a[60:63], v[168:171], v[92:95], a[60:63]
    s_waitcnt vmcnt(11)
    v_exp_f32 v30, v30
    v_mfma_f32_16x16x32_bf16 a[60:63], v[172:175], v[108:111], a[60:63]
    v_exp_f32 v31, v31
    v_mfma_f32_16x16x32_bf16 a[56:59], v[172:175], v[104:107], a[56:59]
    ds_read_b64_tr_b16 v[158:159], v225 offset:28672
    v_cvt_pk_bf16_f32 v29, v30, v31
    v_mfma_f32_16x16x32_bf16 a[56:59], v[168:171], v[88:91], a[56:59]
    ds_read_b64_tr_b16 v[160:161], v226 offset:16384
    v_mfma_f32_16x16x32_bf16 a[52:55], v[168:171], v[84:87], a[52:55]
    v_exp_f32 v44, v44
    v_mfma_f32_16x16x32_bf16 a[52:55], v[172:175], v[100:103], a[52:55]
    v_exp_f32 v45, v45
    v_mfma_f32_16x16x32_bf16 a[48:51], v[172:175], v[96:99], a[48:51]
    buffer_load_dwordx4 v241, s[16:19], s55 offen offset:3072 lds
    v_mfma_f32_16x16x32_bf16 a[48:51], v[168:171], v[80:83], a[48:51]
    s_waitcnt lgkmcnt(5)
    ds_read_b64_tr_b16 v[162:163], v226 offset:20480
    v_cvt_pk_bf16_f32 v30, v44, v45
    v_mfma_f32_16x16x32_bf16 a[64:67], v[144:147], v[80:83], a[64:67]
    v_exp_f32 v46, v46
    v_mfma_f32_16x16x32_bf16 a[64:67], v[148:151], v[96:99], a[64:67]
    v_exp_f32 v47, v47
    v_mfma_f32_16x16x32_bf16 a[68:71], v[148:151], v[100:103], a[68:71]
    ds_read_b64_tr_b16 v[164:165], v226 offset:24576
    v_cvt_pk_bf16_f32 v31, v46, v47
    v_mfma_f32_16x16x32_bf16 a[68:71], v[144:147], v[84:87], a[68:71]
    s_add_u32 s34, s34, 4096
    ds_read_b64_tr_b16 v[166:167], v226 offset:28672
    v_mfma_f32_16x16x32_bf16 a[72:75], v[144:147], v[88:91], a[72:75]
    buffer_store_dwordx4 v[192:195], v254, s[40:43], s34 offen offset:0 sc1
    v_mfma_f32_16x16x32_bf16 a[72:75], v[148:151], v[104:107], a[72:75]
    s_waitcnt vmcnt(12)
    v_mfma_f32_16x16x32_bf16 a[76:79], v[148:151], v[108:111], a[76:79]
    s_barrier
    v_exp_f32 v48, v48
    v_mfma_f32_16x16x32_bf16 a[76:79], v[144:147], v[92:95], a[76:79]
    s_waitcnt lgkmcnt(4)
    v_exp_f32 v49, v49
    v_mfma_f32_16x16x32_bf16 a[92:95], v[152:155], v[92:95], a[92:95]
    ds_read_b64_tr_b16 v[168:169], v227 offset:16384
    v_cvt_pk_bf16_f32 v48, v48, v49
    v_mfma_f32_16x16x32_bf16 a[92:95], v[156:159], v[108:111], a[92:95]
    v_exp_f32 v50, v50
    v_mfma_f32_16x16x32_bf16 a[88:91], v[156:159], v[104:107], a[88:91]
    v_exp_f32 v51, v51
    v_mfma_f32_16x16x32_bf16 a[88:91], v[152:155], v[88:91], a[88:91]
    ds_read_b64_tr_b16 v[170:171], v227 offset:20480
    v_cvt_pk_bf16_f32 v49, v50, v51
    v_mfma_f32_16x16x32_bf16 a[84:87], v[152:155], v[84:87], a[84:87]
    s_add_u32 s54, s54, 16384
    ds_read_b64_tr_b16 v[172:173], v227 offset:24576
    v_mfma_f32_16x16x32_bf16 a[84:87], v[156:159], v[100:103], a[84:87]
    s_add_u32 m0, s53, 98304
    v_exp_f32 v64, v64
    v_mfma_f32_16x16x32_bf16 a[80:83], v[156:159], v[96:99], a[80:83]
    s_waitcnt lgkmcnt(3)
    v_exp_f32 v65, v65
    v_mfma_f32_16x16x32_bf16 a[80:83], v[152:155], v[80:83], a[80:83]
    buffer_load_dwordx4 v236, s[12:15], s54 offen offset:0 lds
    v_mfma_f32_16x16x32_bf16 a[96:99], v[160:163], v[80:83], a[96:99]
    ds_read_b64_tr_b16 v[174:175], v227 offset:28672
    v_cvt_pk_bf16_f32 v50, v64, v65
    v_mfma_f32_16x16x32_bf16 a[96:99], v[164:167], v[96:99], a[96:99]
    v_exp_f32 v66, v66
    v_mfma_f32_16x16x32_bf16 a[100:103], v[164:167], v[100:103], a[100:103]
    v_exp_f32 v67, v67
    v_mfma_f32_16x16x32_bf16 a[100:103], v[160:163], v[84:87], a[100:103]
    ds_read_b128 v[112:115], v212 offset:32768
    v_cvt_pk_bf16_f32 v51, v66, v67
    v_mfma_f32_16x16x32_bf16 a[104:107], v[160:163], v[88:91], a[104:107]
    ds_read_b128 v[116:119], v213 offset:32768
    v_mfma_f32_16x16x32_bf16 a[104:107], v[164:167], v[104:107], a[104:107]
    v_mfma_f32_16x16x32_bf16 a[108:111], v[164:167], v[108:111], a[108:111]
    v_mfma_f32_16x16x32_bf16 a[108:111], v[160:163], v[92:95], a[108:111]
    s_waitcnt lgkmcnt(2)
    v_exp_f32 v52, v52
    v_mfma_f32_16x16x32_bf16 a[124:127], v[168:171], v[92:95], a[124:127]
    v_exp_f32 v53, v53
    v_mfma_f32_16x16x32_bf16 a[124:127], v[172:175], v[108:111], a[124:127]
    ds_read_b128 v[120:123], v214 offset:32768
    v_cvt_pk_bf16_f32 v52, v52, v53
    v_mfma_f32_16x16x32_bf16 a[120:123], v[172:175], v[104:107], a[120:123]
    v_exp_f32 v54, v54
    v_mfma_f32_16x16x32_bf16 a[120:123], v[168:171], v[88:91], a[120:123]
    v_exp_f32 v55, v55
    v_mfma_f32_16x16x32_bf16 a[116:119], v[168:171], v[84:87], a[116:119]
    ds_read_b128 v[124:127], v215 offset:32768
    v_cvt_pk_bf16_f32 v53, v54, v55
    v_mfma_f32_16x16x32_bf16 a[116:119], v[172:175], v[100:103], a[116:119]
    ds_read_b128 v[128:131], v212 offset:36864
    v_mfma_f32_16x16x32_bf16 a[112:115], v[172:175], v[96:99], a[112:115]
    v_exp_f32 v68, v68
    v_mfma_f32_16x16x32_bf16 a[112:115], v[168:171], v[80:83], a[112:115]
    v_exp_f32 v69, v69
    v_mfma_f32_16x16x32_bf16 a[128:131], v[208:211], v[80:83], a[128:131]
    buffer_load_dwordx4 v237, s[12:15], s54 offen offset:1024 lds
    v_mfma_f32_16x16x32_bf16 a[128:131], v[208:211], v[96:99], a[128:131]
    ds_read_b128 v[132:135], v213 offset:36864
    v_cvt_pk_bf16_f32 v54, v68, v69
    v_mfma_f32_16x16x32_bf16 a[132:135], v[208:211], v[100:103], a[132:135]
    v_exp_f32 v70, v70
    v_mfma_f32_16x16x32_bf16 a[132:135], v[208:211], v[84:87], a[132:135]
    v_exp_f32 v71, v71
    v_mfma_f32_16x16x32_bf16 a[136:139], v[208:211], v[88:91], a[136:139]
    v_cvt_pk_bf16_f32 v55, v70, v71
    v_mfma_f32_16x16x32_bf16 a[136:139], v[208:211], v[104:107], a[136:139]
    v_mfma_f32_16x16x32_bf16 a[140:143], v[208:211], v[108:111], a[140:143]
    v_mfma_f32_16x16x32_bf16 a[140:143], v[208:211], v[92:95], a[140:143]
    s_waitcnt lgkmcnt(2)
    v_mfma_f32_16x16x32_bf16 v[80:83], v[112:115], a[144:147], v[176:179]
    v_exp_f32 v56, v56
    v_mfma_f32_16x16x32_bf16 v[80:83], v[116:119], a[148:151], v[80:83]
    v_exp_f32 v57, v57
    v_mfma_f32_16x16x32_bf16 v[80:83], v[120:123], a[152:155], v[80:83]
    ds_read_b128 v[136:139], v214 offset:36864
    v_cvt_pk_bf16_f32 v56, v56, v57
    v_mfma_f32_16x16x32_bf16 v[80:83], v[124:127], a[156:159], v[80:83]
    v_exp_f32 v58, v58
    v_mfma_f32_16x16x32_bf16 v[84:87], v[124:127], a[172:175], v[180:183]
    v_exp_f32 v59, v59
    v_mfma_f32_16x16x32_bf16 v[84:87], v[120:123], a[168:171], v[84:87]
    ds_read_b128 v[140:143], v215 offset:36864
    v_cvt_pk_bf16_f32 v57, v58, v59
    v_mfma_f32_16x16x32_bf16 v[84:87], v[116:119], a[164:167], v[84:87]
    ds_read_b64_tr_b16 v[144:145], v220 offset:49152
    v_mfma_f32_16x16x32_bf16 v[84:87], v[112:115], a[160:163], v[84:87]
    v_exp_f32 v72, v72
    v_mfma_f32_16x16x32_bf16 v[88:91], v[112:115], a[176:179], v[184:187]
    v_exp_f32 v73, v73
    v_mfma_f32_16x16x32_bf16 v[88:91], v[116:119], a[180:183], v[88:91]
    buffer_load_dwordx4 v238, s[12:15], s54 offen offset:2048 lds
    v_mfma_f32_16x16x32_bf16 v[88:91], v[120:123], a[184:187], v[88:91]
    ds_read_b64_tr_b16 v[146:147], v220 offset:53248
    v_cvt_pk_bf16_f32 v58, v72, v73
    v_mfma_f32_16x16x32_bf16 v[88:91], v[124:127], a[188:191], v[88:91]
    v_exp_f32 v74, v74
    v_mfma_f32_16x16x32_bf16 v[92:95], v[124:127], a[204:207], v[188:191]
    v_exp_f32 v75, v75
    v_mfma_f32_16x16x32_bf16 v[92:95], v[120:123], a[200:203], v[92:95]
    ds_read_b64_tr_b16 v[148:149], v220 offset:57344
    v_cvt_pk_bf16_f32 v59, v74, v75
    v_mfma_f32_16x16x32_bf16 v[92:95], v[116:119], a[196:199], v[92:95]
    ds_read_b64_tr_b16 v[150:151], v220 offset:61440
    v_mfma_f32_16x16x32_bf16 v[92:95], v[112:115], a[192:195], v[92:95]
    s_waitcnt lgkmcnt(6)
    v_mfma_f32_16x16x32_bf16 v[96:99], v[128:131], a[144:147], v[176:179]
    v_mfma_f32_16x16x32_bf16 v[96:99], v[132:135], a[148:151], v[96:99]
    s_waitcnt lgkmcnt(5)
    v_exp_f32 v60, v60
    v_mfma_f32_16x16x32_bf16 v[96:99], v[136:139], a[152:155], v[96:99]
    s_waitcnt lgkmcnt(4)
    v_exp_f32 v61, v61
    v_mfma_f32_16x16x32_bf16 v[96:99], v[140:143], a[156:159], v[96:99]
    ds_read_b128 v[112:115], v212 offset:40960
    v_cvt_pk_bf16_f32 v60, v60, v61
    v_mfma_f32_16x16x32_bf16 v[100:103], v[140:143], a[172:175], v[180:183]
    s_waitcnt vmcnt(15)
    v_exp_f32 v62, v62
    v_mfma_f32_16x16x32_bf16 v[100:103], v[136:139], a[168:171], v[100:103]
    v_exp_f32 v63, v63
    v_mfma_f32_16x16x32_bf16 v[100:103], v[132:135], a[164:167], v[100:103]
    ds_read_b128 v[116:119], v213 offset:40960
    v_cvt_pk_bf16_f32 v61, v62, v63
    v_mfma_f32_16x16x32_bf16 v[100:103], v[128:131], a[160:163], v[100:103]
    ds_read_b128 v[120:123], v214 offset:40960
    v_mfma_f32_16x16x32_bf16 v[104:107], v[128:131], a[176:179], v[184:187]
    v_exp_f32 v76, v76
    v_mfma_f32_16x16x32_bf16 v[104:107], v[132:135], a[180:183], v[104:107]
    v_exp_f32 v77, v77
    v_mfma_f32_16x16x32_bf16 v[104:107], v[136:139], a[184:187], v[104:107]
    buffer_load_dwordx4 v239, s[12:15], s54 offen offset:3072 lds
    v_mfma_f32_16x16x32_bf16 v[104:107], v[140:143], a[188:191], v[104:107]
    ds_read_b128 v[124:127], v215 offset:40960
    v_cvt_pk_bf16_f32 v62, v76, v77
    v_mfma_f32_16x16x32_bf16 v[108:111], v[140:143], a[204:207], v[188:191]
    v_exp_f32 v78, v78
    v_mfma_f32_16x16x32_bf16 v[108:111], v[136:139], a[200:203], v[108:111]
    v_exp_f32 v79, v79
    v_mfma_f32_16x16x32_bf16 v[108:111], v[132:135], a[196:199], v[108:111]
    ds_read_b64_tr_b16 v[152:153], v221 offset:49152
    v_cvt_pk_bf16_f32 v63, v78, v79
    v_mfma_f32_16x16x32_bf16 v[108:111], v[128:131], a[192:195], v[108:111]
    s_waitcnt lgkmcnt(2)
    ds_read_b64_tr_b16 v[154:155], v221 offset:53248
    v_mfma_f32_16x16x32_bf16 v[64:67], v[112:115], a[144:147], v[176:179]
    buffer_store_dwordx4 v[250:253], v254, s[40:43], s34 offen offset:1024 sc1
    v_mfma_f32_16x16x32_bf16 v[64:67], v[116:119], a[148:151], v[64:67]
    v_mfma_f32_16x16x32_bf16 v[64:67], v[120:123], a[152:155], v[64:67]
    s_waitcnt lgkmcnt(2)
    v_exp_f32 v80, v80
    v_mfma_f32_16x16x32_bf16 v[64:67], v[124:127], a[156:159], v[64:67]
    v_exp_f32 v81, v81
    v_mfma_f32_16x16x32_bf16 v[68:71], v[124:127], a[172:175], v[180:183]
    ds_read_b128 v[128:131], v212 offset:45056
    v_cvt_pk_bf16_f32 v80, v80, v81
    v_mfma_f32_16x16x32_bf16 v[68:71], v[120:123], a[168:171], v[68:71]
    v_exp_f32 v82, v82
    v_mfma_f32_16x16x32_bf16 v[68:71], v[116:119], a[164:167], v[68:71]
    v_exp_f32 v83, v83
    v_mfma_f32_16x16x32_bf16 v[68:71], v[112:115], a[160:163], v[68:71]
    ds_read_b128 v[132:135], v213 offset:45056
    v_cvt_pk_bf16_f32 v81, v82, v83
    v_mfma_f32_16x16x32_bf16 v[72:75], v[112:115], a[176:179], v[184:187]
    ds_read_b128 v[136:139], v214 offset:45056
    v_mfma_f32_16x16x32_bf16 v[72:75], v[116:119], a[180:183], v[72:75]
    s_add_u32 s55, s55, 16384
    v_exp_f32 v96, v96
    v_mfma_f32_16x16x32_bf16 v[72:75], v[120:123], a[184:187], v[72:75]
    s_add_u32 m0, s53, 114688
    v_exp_f32 v97, v97
    v_mfma_f32_16x16x32_bf16 v[72:75], v[124:127], a[188:191], v[72:75]
    buffer_load_dwordx4 v240, s[16:19], s55 offen offset:0 lds
    v_mfma_f32_16x16x32_bf16 v[76:79], v[124:127], a[204:207], v[188:191]
    ds_read_b128 v[140:143], v215 offset:45056
    v_cvt_pk_bf16_f32 v82, v96, v97
    v_mfma_f32_16x16x32_bf16 v[76:79], v[120:123], a[200:203], v[76:79]
    v_exp_f32 v98, v98
    v_mfma_f32_16x16x32_bf16 v[76:79], v[116:119], a[196:199], v[76:79]
    v_exp_f32 v99, v99
    v_mfma_f32_16x16x32_bf16 v[76:79], v[112:115], a[192:195], v[76:79]
    s_waitcnt lgkmcnt(1)
    ds_read_b64_tr_b16 v[156:157], v221 offset:57344
    v_cvt_pk_bf16_f32 v83, v98, v99
    v_mfma_f32_16x16x32_bf16 v[32:35], v[128:131], a[144:147], v[176:179]
    s_add_u32 s63, s63, 256
    ds_read_b64_tr_b16 v[158:159], v221 offset:61440
    v_mfma_f32_16x16x32_bf16 v[32:35], v[132:135], a[148:151], v[32:35]
    buffer_load_dwordx4 v[192:195], v255, s[20:23], s63 offen offset:0
    v_mfma_f32_16x16x32_bf16 v[32:35], v[136:139], a[152:155], v[32:35]
    s_waitcnt lgkmcnt(2)
    v_mfma_f32_16x16x32_bf16 v[32:35], v[140:143], a[156:159], v[32:35]
    v_exp_f32 v84, v84
    v_mfma_f32_16x16x32_bf16 v[36:39], v[140:143], a[172:175], v[180:183]
    v_exp_f32 v85, v85
    v_mfma_f32_16x16x32_bf16 v[36:39], v[136:139], a[168:171], v[36:39]
    ds_read_b64_tr_b16 v[160:161], v222 offset:49152
    v_cvt_pk_bf16_f32 v84, v84, v85
    v_mfma_f32_16x16x32_bf16 v[36:39], v[132:135], a[164:167], v[36:39]
    v_exp_f32 v86, v86
    v_mfma_f32_16x16x32_bf16 v[36:39], v[128:131], a[160:163], v[36:39]
    v_exp_f32 v87, v87
    v_mfma_f32_16x16x32_bf16 v[40:43], v[128:131], a[176:179], v[184:187]
    ds_read_b64_tr_b16 v[162:163], v222 offset:53248
    v_cvt_pk_bf16_f32 v85, v86, v87
    v_mfma_f32_16x16x32_bf16 v[40:43], v[132:135], a[180:183], v[40:43]
    ds_read_b64_tr_b16 v[164:165], v222 offset:57344
    v_mfma_f32_16x16x32_bf16 v[40:43], v[136:139], a[184:187], v[40:43]
    v_exp_f32 v100, v100
    v_mfma_f32_16x16x32_bf16 v[40:43], v[140:143], a[188:191], v[40:43]
    v_exp_f32 v101, v101
    v_mfma_f32_16x16x32_bf16 v[44:47], v[140:143], a[204:207], v[188:191]
    buffer_load_dwordx4 v241, s[16:19], s55 offen offset:1024 lds
    v_mfma_f32_16x16x32_bf16 v[44:47], v[136:139], a[200:203], v[44:47]
    ds_read_b64_tr_b16 v[166:167], v222 offset:61440
    v_cvt_pk_bf16_f32 v86, v100, v101
    v_mfma_f32_16x16x32_bf16 v[44:47], v[132:135], a[196:199], v[44:47]
    v_exp_f32 v102, v102
    v_mfma_f32_16x16x32_bf16 v[44:47], v[128:131], a[192:195], v[44:47]
    v_exp_f32 v103, v103
    v_mfma_f32_16x16x32_bf16 a[0:3], v[144:147], v[16:19], a[0:3]
    ds_read_b64_tr_b16 v[168:169], v223 offset:49152
    v_cvt_pk_bf16_f32 v87, v102, v103
    v_mfma_f32_16x16x32_bf16 a[0:3], v[148:151], v[48:51], a[0:3]
    ds_read_b64_tr_b16 v[170:171], v223 offset:53248
    v_mfma_f32_16x16x32_bf16 a[4:7], v[148:151], v[52:55], a[4:7]
    v_mfma_f32_16x16x32_bf16 a[4:7], v[144:147], v[20:23], a[4:7]
    v_mfma_f32_16x16x32_bf16 a[8:11], v[144:147], v[24:27], a[8:11]
    v_exp_f32 v88, v88
    v_mfma_f32_16x16x32_bf16 a[8:11], v[148:151], v[56:59], a[8:11]
    v_exp_f32 v89, v89
    v_mfma_f32_16x16x32_bf16 a[12:15], v[148:151], v[60:63], a[12:15]
    ds_read_b64_tr_b16 v[172:173], v223 offset:57344
    v_cvt_pk_bf16_f32 v88, v88, v89
    v_mfma_f32_16x16x32_bf16 a[12:15], v[144:147], v[28:31], a[12:15]
    s_waitcnt lgkmcnt(7)
    v_exp_f32 v90, v90
    v_mfma_f32_16x16x32_bf16 a[28:31], v[152:155], v[28:31], a[28:31]
    v_exp_f32 v91, v91
    v_mfma_f32_16x16x32_bf16 a[28:31], v[156:159], v[60:63], a[28:31]
    ds_read_b64_tr_b16 v[174:175], v223 offset:61440
    v_cvt_pk_bf16_f32 v89, v90, v91
    v_mfma_f32_16x16x32_bf16 a[24:27], v[156:159], v[56:59], a[24:27]
    ds_read_b64_tr_b16 v[144:145], v224 offset:49152
    v_mfma_f32_16x16x32_bf16 a[24:27], v[152:155], v[24:27], a[24:27]
    v_exp_f32 v104, v104
    v_mfma_f32_16x16x32_bf16 a[20:23], v[152:155], v[20:23], a[20:23]
    v_exp_f32 v105, v105
    v_mfma_f32_16x16x32_bf16 a[20:23], v[156:159], v[52:55], a[20:23]
    buffer_load_dwordx4 v240, s[16:19], s55 offen offset:2048 lds
    v_mfma_f32_16x16x32_bf16 a[16:19], v[156:159], v[48:51], a[16:19]
    ds_read_b64_tr_b16 v[146:147], v224 offset:53248
    v_cvt_pk_bf16_f32 v90, v104, v105
    v_mfma_f32_16x16x32_bf16 a[16:19], v[152:155], v[16:19], a[16:19]
    s_waitcnt lgkmcnt(6)
    v_exp_f32 v106, v106
    v_mfma_f32_16x16x32_bf16 a[32:35], v[160:163], v[16:19], a[32:35]
    v_exp_f32 v107, v107
    v_mfma_f32_16x16x32_bf16 a[32:35], v[164:167], v[48:51], a[32:35]
    ds_read_b64_tr_b16 v[148:149], v224 offset:57344
    v_cvt_pk_bf16_f32 v91, v106, v107
    v_mfma_f32_16x16x32_bf16 a[36:39], v[164:167], v[52:55], a[36:39]
    ds_read_b64_tr_b16 v[150:151], v224 offset:61440
    v_mfma_f32_16x16x32_bf16 a[36:39], v[160:163], v[20:23], a[36:39]
    ds_read_b64_tr_b16 v[152:153], v225 offset:49152
    v_mfma_f32_16x16x32_bf16 a[40:43], v[160:163], v[24:27], a[40:43]
    ds_read_b64_tr_b16 v[154:155], v225 offset:53248
    v_mfma_f32_16x16x32_bf16 a[40:43], v[164:167], v[56:59], a[40:43]
    v_exp_f32 v92, v92
    v_mfma_f32_16x16x32_bf16 a[44:47], v[164:167], v[60:63], a[44:47]
    v_exp_f32 v93, v93
    v_mfma_f32_16x16x32_bf16 a[44:47], v[160:163], v[28:31], a[44:47]
    s_waitcnt lgkmcnt(6)
    ds_read_b64_tr_b16 v[156:157], v225 offset:57344
    v_cvt_pk_bf16_f32 v92, v92, v93
    v_mfma_f32_16x16x32_bf16 a[60:63], v[168:171], v[28:31], a[60:63]
    v_exp_f32 v94, v94
    v_mfma_f32_16x16x32_bf16 a[60:63], v[172:175], v[60:63], a[60:63]
    v_exp_f32 v95, v95
    v_mfma_f32_16x16x32_bf16 a[56:59], v[172:175], v[56:59], a[56:59]
    ds_read_b64_tr_b16 v[158:159], v225 offset:61440
    v_cvt_pk_bf16_f32 v93, v94, v95
    v_mfma_f32_16x16x32_bf16 a[56:59], v[168:171], v[24:27], a[56:59]
    ds_read_b64_tr_b16 v[160:161], v226 offset:49152
    v_mfma_f32_16x16x32_bf16 a[52:55], v[168:171], v[20:23], a[52:55]
    v_exp_f32 v108, v108
    v_mfma_f32_16x16x32_bf16 a[52:55], v[172:175], v[52:55], a[52:55]
    v_exp_f32 v109, v109
    v_mfma_f32_16x16x32_bf16 a[48:51], v[172:175], v[48:51], a[48:51]
    buffer_load_dwordx4 v241, s[16:19], s55 offen offset:3072 lds
    v_mfma_f32_16x16x32_bf16 a[48:51], v[168:171], v[16:19], a[48:51]
    s_waitcnt lgkmcnt(5)
    ds_read_b64_tr_b16 v[162:163], v226 offset:53248
    v_cvt_pk_bf16_f32 v94, v108, v109
    v_mfma_f32_16x16x32_bf16 a[64:67], v[144:147], v[16:19], a[64:67]
    v_exp_f32 v110, v110
    v_mfma_f32_16x16x32_bf16 a[64:67], v[148:151], v[48:51], a[64:67]
    v_exp_f32 v111, v111
    v_mfma_f32_16x16x32_bf16 a[68:71], v[148:151], v[52:55], a[68:71]
    ds_read_b64_tr_b16 v[164:165], v226 offset:57344
    v_cvt_pk_bf16_f32 v95, v110, v111
    v_mfma_f32_16x16x32_bf16 a[68:71], v[144:147], v[20:23], a[68:71]
    ds_read_b64_tr_b16 v[166:167], v226 offset:61440
    v_mfma_f32_16x16x32_bf16 a[72:75], v[144:147], v[24:27], a[72:75]
    buffer_load_dwordx4 v[250:253], v255, s[20:23], s63 offen offset:64
    v_mfma_f32_16x16x32_bf16 a[72:75], v[148:151], v[56:59], a[72:75]
    s_waitcnt vmcnt(12)
    v_mfma_f32_16x16x32_bf16 a[76:79], v[148:151], v[60:63], a[76:79]
    s_barrier
    v_exp_f32 v64, v64
    v_mfma_f32_16x16x32_bf16 a[76:79], v[144:147], v[28:31], a[76:79]
    s_waitcnt lgkmcnt(4)
    v_exp_f32 v65, v65
    v_mfma_f32_16x16x32_bf16 a[92:95], v[152:155], v[28:31], a[92:95]
    ds_read_b64_tr_b16 v[168:169], v227 offset:49152
    v_cvt_pk_bf16_f32 v64, v64, v65
    v_mfma_f32_16x16x32_bf16 a[92:95], v[156:159], v[60:63], a[92:95]
    v_exp_f32 v66, v66
    v_mfma_f32_16x16x32_bf16 a[88:91], v[156:159], v[56:59], a[88:91]
    v_exp_f32 v67, v67
    v_mfma_f32_16x16x32_bf16 a[88:91], v[152:155], v[24:27], a[88:91]
    s_add_u32 s54, s54, 16384
    ds_read_b64_tr_b16 v[170:171], v227 offset:53248
    v_cvt_pk_bf16_f32 v65, v66, v67
    v_mfma_f32_16x16x32_bf16 a[84:87], v[152:155], v[20:23], a[84:87]
    ds_read_b64_tr_b16 v[172:173], v227 offset:57344
    v_mfma_f32_16x16x32_bf16 a[84:87], v[156:159], v[52:55], a[84:87]
    s_add_u32 m0, s53, 0
    v_exp_f32 v32, v32
    v_mfma_f32_16x16x32_bf16 a[80:83], v[156:159], v[48:51], a[80:83]
    s_waitcnt lgkmcnt(3)
    v_exp_f32 v33, v33
    v_mfma_f32_16x16x32_bf16 a[80:83], v[152:155], v[16:19], a[80:83]
    buffer_load_dwordx4 v236, s[12:15], s54 offen offset:0 lds
    v_mfma_f32_16x16x32_bf16 a[96:99], v[160:163], v[16:19], a[96:99]
    ds_read_b64_tr_b16 v[174:175], v227 offset:61440
    v_cvt_pk_bf16_f32 v66, v32, v33
    v_mfma_f32_16x16x32_bf16 a[96:99], v[164:167], v[48:51], a[96:99]
    v_exp_f32 v34, v34
    v_mfma_f32_16x16x32_bf16 a[100:103], v[164:167], v[52:55], a[100:103]
    v_exp_f32 v35, v35
    v_mfma_f32_16x16x32_bf16 a[100:103], v[160:163], v[20:23], a[100:103]
    ds_read_b128 v[112:115], v216 offset:0
    v_cvt_pk_bf16_f32 v67, v34, v35
    v_mfma_f32_16x16x32_bf16 a[104:107], v[160:163], v[24:27], a[104:107]
    s_add_u32 s7, s7, 1024
    ds_read_b128 v[116:119], v217 offset:0
    v_mfma_f32_16x16x32_bf16 a[104:107], v[164:167], v[56:59], a[104:107]
    buffer_store_dwordx4 v[204:207], v254, s[40:43], s7 offen sc1
    v_mfma_f32_16x16x32_bf16 a[108:111], v[164:167], v[60:63], a[108:111]
    v_mfma_f32_16x16x32_bf16 a[108:111], v[160:163], v[28:31], a[108:111]
    s_waitcnt lgkmcnt(2)
    v_exp_f32 v68, v68
    v_mfma_f32_16x16x32_bf16 a[124:127], v[168:171], v[28:31], a[124:127]
    v_exp_f32 v69, v69
    v_mfma_f32_16x16x32_bf16 a[124:127], v[172:175], v[60:63], a[124:127]
    ds_read_b128 v[120:123], v218 offset:0
    v_cvt_pk_bf16_f32 v68, v68, v69
    v_mfma_f32_16x16x32_bf16 a[120:123], v[172:175], v[56:59], a[120:123]
    v_exp_f32 v70, v70
    v_mfma_f32_16x16x32_bf16 a[120:123], v[168:171], v[24:27], a[120:123]
    v_exp_f32 v71, v71
    v_mfma_f32_16x16x32_bf16 a[116:119], v[168:171], v[20:23], a[116:119]
    ds_read_b128 v[124:127], v219 offset:0
    v_cvt_pk_bf16_f32 v69, v70, v71
    v_mfma_f32_16x16x32_bf16 a[116:119], v[172:175], v[52:55], a[116:119]
    ds_read_b128 v[128:131], v216 offset:4096
    v_mfma_f32_16x16x32_bf16 a[112:115], v[172:175], v[48:51], a[112:115]
    v_exp_f32 v36, v36
    v_mfma_f32_16x16x32_bf16 a[112:115], v[168:171], v[16:19], a[112:115]
    v_exp_f32 v37, v37
    v_mfma_f32_16x16x32_bf16 a[128:131], v[208:211], v[16:19], a[128:131]
    buffer_load_dwordx4 v237, s[12:15], s54 offen offset:1024 lds
    v_mfma_f32_16x16x32_bf16 a[128:131], v[208:211], v[48:51], a[128:131]
    ds_read_b128 v[132:135], v217 offset:4096
    v_cvt_pk_bf16_f32 v70, v36, v37
    v_mfma_f32_16x16x32_bf16 a[132:135], v[208:211], v[52:55], a[132:135]
    v_exp_f32 v38, v38
    v_mfma_f32_16x16x32_bf16 a[132:135], v[208:211], v[20:23], a[132:135]
    v_exp_f32 v39, v39
    v_mfma_f32_16x16x32_bf16 a[136:139], v[208:211], v[24:27], a[136:139]
    v_cvt_pk_bf16_f32 v71, v38, v39
    v_mfma_f32_16x16x32_bf16 a[136:139], v[208:211], v[56:59], a[136:139]
    v_mfma_f32_16x16x32_bf16 a[140:143], v[208:211], v[60:63], a[140:143]
    v_mfma_f32_16x16x32_bf16 a[140:143], v[208:211], v[28:31], a[140:143]
    s_waitcnt lgkmcnt(2)
    v_mfma_f32_16x16x32_bf16 v[16:19], v[112:115], a[144:147], v[176:179]
    v_exp_f32 v72, v72
    v_mfma_f32_16x16x32_bf16 v[16:19], v[116:119], a[148:151], v[16:19]
    v_exp_f32 v73, v73
    v_mfma_f32_16x16x32_bf16 v[16:19], v[120:123], a[152:155], v[16:19]
    ds_read_b128 v[136:139], v218 offset:4096
    v_cvt_pk_bf16_f32 v72, v72, v73
    v_mfma_f32_16x16x32_bf16 v[16:19], v[124:127], a[156:159], v[16:19]
    v_exp_f32 v74, v74
    v_mfma_f32_16x16x32_bf16 v[20:23], v[124:127], a[172:175], v[180:183]
    v_exp_f32 v75, v75
    v_mfma_f32_16x16x32_bf16 v[20:23], v[120:123], a[168:171], v[20:23]
    s_add_u32 s35, s7, 4096
    ds_read_b128 v[140:143], v219 offset:4096
    v_cvt_pk_bf16_f32 v73, v74, v75
    v_mfma_f32_16x16x32_bf16 v[20:23], v[116:119], a[164:167], v[20:23]
    ds_read_b64_tr_b16 v[144:145], v228 offset:16384
    v_mfma_f32_16x16x32_bf16 v[20:23], v[112:115], a[160:163], v[20:23]
    v_exp_f32 v40, v40
    v_mfma_f32_16x16x32_bf16 v[24:27], v[112:115], a[176:179], v[184:187]
    v_exp_f32 v41, v41
    v_mfma_f32_16x16x32_bf16 v[24:27], v[116:119], a[180:183], v[24:27]
    buffer_load_dwordx4 v238, s[12:15], s54 offen offset:2048 lds
    v_mfma_f32_16x16x32_bf16 v[24:27], v[120:123], a[184:187], v[24:27]
    ds_read_b64_tr_b16 v[146:147], v228 offset:20480
    v_cvt_pk_bf16_f32 v74, v40, v41
    v_mfma_f32_16x16x32_bf16 v[24:27], v[124:127], a[188:191], v[24:27]
    v_exp_f32 v42, v42
    v_mfma_f32_16x16x32_bf16 v[28:31], v[124:127], a[204:207], v[188:191]
    v_exp_f32 v43, v43
    v_mfma_f32_16x16x32_bf16 v[28:31], v[120:123], a[200:203], v[28:31]
    ds_read_b64_tr_b16 v[148:149], v228 offset:24576
    v_cvt_pk_bf16_f32 v75, v42, v43
    v_mfma_f32_16x16x32_bf16 v[28:31], v[116:119], a[196:199], v[28:31]
    ds_read_b64_tr_b16 v[150:151], v228 offset:28672
    v_mfma_f32_16x16x32_bf16 v[28:31], v[112:115], a[192:195], v[28:31]
    s_waitcnt lgkmcnt(6)
    v_mfma_f32_16x16x32_bf16 v[48:51], v[128:131], a[144:147], v[176:179]
    v_mfma_f32_16x16x32_bf16 v[48:51], v[132:135], a[148:151], v[48:51]
    s_waitcnt lgkmcnt(5)
    v_exp_f32 v76, v76
    v_mfma_f32_16x16x32_bf16 v[48:51], v[136:139], a[152:155], v[48:51]
    s_waitcnt lgkmcnt(4)
    v_exp_f32 v77, v77
    v_mfma_f32_16x16x32_bf16 v[48:51], v[140:143], a[156:159], v[48:51]
    ds_read_b128 v[112:115], v216 offset:8192
    v_cvt_pk_bf16_f32 v76, v76, v77
    v_mfma_f32_16x16x32_bf16 v[52:55], v[140:143], a[172:175], v[180:183]
    v_exp_f32 v78, v78
    v_mfma_f32_16x16x32_bf16 v[52:55], v[136:139], a[168:171], v[52:55]
    v_exp_f32 v79, v79
    v_mfma_f32_16x16x32_bf16 v[52:55], v[132:135], a[164:167], v[52:55]
    ds_read_b128 v[116:119], v217 offset:8192
    v_cvt_pk_bf16_f32 v77, v78, v79
    v_mfma_f32_16x16x32_bf16 v[52:55], v[128:131], a[160:163], v[52:55]
    ds_read_b128 v[120:123], v218 offset:8192
    v_mfma_f32_16x16x32_bf16 v[56:59], v[128:131], a[176:179], v[184:187]
    v_exp_f32 v44, v44
    v_mfma_f32_16x16x32_bf16 v[56:59], v[132:135], a[180:183], v[56:59]
    v_exp_f32 v45, v45
    v_mfma_f32_16x16x32_bf16 v[56:59], v[136:139], a[184:187], v[56:59]
    buffer_load_dwordx4 v239, s[12:15], s54 offen offset:3072 lds
    v_mfma_f32_16x16x32_bf16 v[56:59], v[140:143], a[188:191], v[56:59]
    ds_read_b128 v[124:127], v219 offset:8192
    v_cvt_pk_bf16_f32 v78, v44, v45
    v_mfma_f32_16x16x32_bf16 v[60:63], v[140:143], a[204:207], v[188:191]
    v_exp_f32 v46, v46
    v_mfma_f32_16x16x32_bf16 v[60:63], v[136:139], a[200:203], v[60:63]
    v_exp_f32 v47, v47
    v_mfma_f32_16x16x32_bf16 v[60:63], v[132:135], a[196:199], v[60:63]
    s_add_u32 s6, s6, 16384
    ds_read_b64_tr_b16 v[152:153], v229 offset:16384
    v_cvt_pk_bf16_f32 v79, v46, v47
    v_mfma_f32_16x16x32_bf16 v[60:63], v[128:131], a[192:195], v[60:63]
    s_waitcnt lgkmcnt(2)
    ds_read_b64_tr_b16 v[154:155], v229 offset:20480
    v_mfma_f32_16x16x32_bf16 v[32:35], v[112:115], a[144:147], v[176:179]
    buffer_load_dwordx4 v[204:207], v201, s[44:47], s6 offen
    v_mfma_f32_16x16x32_bf16 v[32:35], v[116:119], a[148:151], v[32:35]
    v_mfma_f32_16x16x32_bf16 v[32:35], v[120:123], a[152:155], v[32:35]
    s_waitcnt lgkmcnt(2)
    v_exp_f32 v16, v16
    v_mfma_f32_16x16x32_bf16 v[32:35], v[124:127], a[156:159], v[32:35]
    v_exp_f32 v17, v17
    v_mfma_f32_16x16x32_bf16 v[36:39], v[124:127], a[172:175], v[180:183]
    ds_read_b128 v[128:131], v216 offset:12288
    v_cvt_pk_bf16_f32 v16, v16, v17
    v_mfma_f32_16x16x32_bf16 v[36:39], v[120:123], a[168:171], v[36:39]
    v_exp_f32 v18, v18
    v_mfma_f32_16x16x32_bf16 v[36:39], v[116:119], a[164:167], v[36:39]
    v_exp_f32 v19, v19
    v_mfma_f32_16x16x32_bf16 v[36:39], v[112:115], a[160:163], v[36:39]
    ds_read_b128 v[132:135], v217 offset:12288
    v_cvt_pk_bf16_f32 v17, v18, v19
    v_mfma_f32_16x16x32_bf16 v[40:43], v[112:115], a[176:179], v[184:187]
    ds_read_b128 v[136:139], v218 offset:12288
    v_mfma_f32_16x16x32_bf16 v[40:43], v[116:119], a[180:183], v[40:43]
    s_add_u32 s55, s55, 16384
    v_exp_f32 v48, v48
    v_mfma_f32_16x16x32_bf16 v[40:43], v[120:123], a[184:187], v[40:43]
    s_add_u32 m0, s53, 16384
    v_exp_f32 v49, v49
    v_mfma_f32_16x16x32_bf16 v[40:43], v[124:127], a[188:191], v[40:43]
    buffer_load_dwordx4 v240, s[16:19], s55 offen offset:0 lds
    v_mfma_f32_16x16x32_bf16 v[44:47], v[124:127], a[204:207], v[188:191]
    ds_read_b128 v[140:143], v219 offset:12288
    v_cvt_pk_bf16_f32 v18, v48, v49
    v_mfma_f32_16x16x32_bf16 v[44:47], v[120:123], a[200:203], v[44:47]
    v_exp_f32 v50, v50
    v_mfma_f32_16x16x32_bf16 v[44:47], v[116:119], a[196:199], v[44:47]
    v_exp_f32 v51, v51
    v_mfma_f32_16x16x32_bf16 v[44:47], v[112:115], a[192:195], v[44:47]
    s_waitcnt lgkmcnt(1)
    ds_read_b64_tr_b16 v[156:157], v229 offset:24576
    v_cvt_pk_bf16_f32 v19, v50, v51
    v_mfma_f32_16x16x32_bf16 v[96:99], v[128:131], a[144:147], v[176:179]
    ds_read_b64_tr_b16 v[158:159], v229 offset:28672
    v_mfma_f32_16x16x32_bf16 v[96:99], v[132:135], a[148:151], v[96:99]
    buffer_store_dwordx4 v[10:13], v254, s[40:43], s35 offen sc1
    v_mfma_f32_16x16x32_bf16 v[96:99], v[136:139], a[152:155], v[96:99]
    s_waitcnt lgkmcnt(2)
    v_mfma_f32_16x16x32_bf16 v[96:99], v[140:143], a[156:159], v[96:99]
    v_exp_f32 v20, v20
    v_mfma_f32_16x16x32_bf16 v[100:103], v[140:143], a[172:175], v[180:183]
    v_exp_f32 v21, v21
    v_mfma_f32_16x16x32_bf16 v[100:103], v[136:139], a[168:171], v[100:103]
    ds_read_b64_tr_b16 v[160:161], v230 offset:16384
    v_cvt_pk_bf16_f32 v20, v20, v21
    v_mfma_f32_16x16x32_bf16 v[100:103], v[132:135], a[164:167], v[100:103]
    v_exp_f32 v22, v22
    v_mfma_f32_16x16x32_bf16 v[100:103], v[128:131], a[160:163], v[100:103]
    v_exp_f32 v23, v23
    v_mfma_f32_16x16x32_bf16 v[104:107], v[128:131], a[176:179], v[184:187]
    ds_read_b64_tr_b16 v[162:163], v230 offset:20480
    v_cvt_pk_bf16_f32 v21, v22, v23
    v_mfma_f32_16x16x32_bf16 v[104:107], v[132:135], a[180:183], v[104:107]
    ds_read_b64_tr_b16 v[164:165], v230 offset:24576
    v_mfma_f32_16x16x32_bf16 v[104:107], v[136:139], a[184:187], v[104:107]
    v_exp_f32 v52, v52
    v_mfma_f32_16x16x32_bf16 v[104:107], v[140:143], a[188:191], v[104:107]
    v_exp_f32 v53, v53
    v_mfma_f32_16x16x32_bf16 v[108:111], v[140:143], a[204:207], v[188:191]
    buffer_load_dwordx4 v241, s[16:19], s55 offen offset:1024 lds
    v_mfma_f32_16x16x32_bf16 v[108:111], v[136:139], a[200:203], v[108:111]
    ds_read_b64_tr_b16 v[166:167], v230 offset:28672
    v_cvt_pk_bf16_f32 v22, v52, v53
    v_mfma_f32_16x16x32_bf16 v[108:111], v[132:135], a[196:199], v[108:111]
    v_exp_f32 v54, v54
    v_mfma_f32_16x16x32_bf16 v[108:111], v[128:131], a[192:195], v[108:111]
    v_exp_f32 v55, v55
    v_mfma_f32_16x16x32_bf16 a[0:3], v[144:147], v[80:83], a[0:3]
    ds_read_b64_tr_b16 v[168:169], v231 offset:16384
    v_cvt_pk_bf16_f32 v23, v54, v55
    v_mfma_f32_16x16x32_bf16 a[0:3], v[148:151], v[64:67], a[0:3]
    ds_read_b64_tr_b16 v[170:171], v231 offset:20480
    v_mfma_f32_16x16x32_bf16 a[4:7], v[148:151], v[68:71], a[4:7]
    v_mfma_f32_16x16x32_bf16 a[4:7], v[144:147], v[84:87], a[4:7]
    v_mfma_f32_16x16x32_bf16 a[8:11], v[144:147], v[88:91], a[8:11]
    v_exp_f32 v24, v24
    v_mfma_f32_16x16x32_bf16 a[8:11], v[148:151], v[72:75], a[8:11]
    v_exp_f32 v25, v25
    v_mfma_f32_16x16x32_bf16 a[12:15], v[148:151], v[76:79], a[12:15]
    ds_read_b64_tr_b16 v[172:173], v231 offset:24576
    v_cvt_pk_bf16_f32 v24, v24, v25
    v_mfma_f32_16x16x32_bf16 a[12:15], v[144:147], v[92:95], a[12:15]
    s_waitcnt lgkmcnt(7)
    v_exp_f32 v26, v26
    v_mfma_f32_16x16x32_bf16 a[28:31], v[152:155], v[92:95], a[28:31]
    v_exp_f32 v27, v27
    v_mfma_f32_16x16x32_bf16 a[28:31], v[156:159], v[76:79], a[28:31]
    ds_read_b64_tr_b16 v[174:175], v231 offset:28672
    v_cvt_pk_bf16_f32 v25, v26, v27
    v_mfma_f32_16x16x32_bf16 a[24:27], v[156:159], v[72:75], a[24:27]
    ds_read_b64_tr_b16 v[144:145], v232 offset:16384
    v_mfma_f32_16x16x32_bf16 a[24:27], v[152:155], v[88:91], a[24:27]
    v_exp_f32 v56, v56
    v_mfma_f32_16x16x32_bf16 a[20:23], v[152:155], v[84:87], a[20:23]
    v_exp_f32 v57, v57
    v_mfma_f32_16x16x32_bf16 a[20:23], v[156:159], v[68:71], a[20:23]
    buffer_load_dwordx4 v240, s[16:19], s55 offen offset:2048 lds
    v_mfma_f32_16x16x32_bf16 a[16:19], v[156:159], v[64:67], a[16:19]
    ds_read_b64_tr_b16 v[146:147], v232 offset:20480
    v_cvt_pk_bf16_f32 v26, v56, v57
    v_mfma_f32_16x16x32_bf16 a[16:19], v[152:155], v[80:83], a[16:19]
    s_waitcnt lgkmcnt(6)
    v_exp_f32 v58, v58
    v_mfma_f32_16x16x32_bf16 a[32:35], v[160:163], v[80:83], a[32:35]
    v_exp_f32 v59, v59
    v_mfma_f32_16x16x32_bf16 a[32:35], v[164:167], v[64:67], a[32:35]
    ds_read_b64_tr_b16 v[148:149], v232 offset:24576
    v_cvt_pk_bf16_f32 v27, v58, v59
    v_mfma_f32_16x16x32_bf16 a[36:39], v[164:167], v[68:71], a[36:39]
    ds_read_b64_tr_b16 v[150:151], v232 offset:28672
    v_mfma_f32_16x16x32_bf16 a[36:39], v[160:163], v[84:87], a[36:39]
    ds_read_b64_tr_b16 v[152:153], v233 offset:16384
    v_mfma_f32_16x16x32_bf16 a[40:43], v[160:163], v[88:91], a[40:43]
    ds_read_b64_tr_b16 v[154:155], v233 offset:20480
    v_mfma_f32_16x16x32_bf16 a[40:43], v[164:167], v[72:75], a[40:43]
    v_exp_f32 v28, v28
    v_mfma_f32_16x16x32_bf16 a[44:47], v[164:167], v[76:79], a[44:47]
    v_exp_f32 v29, v29
    v_mfma_f32_16x16x32_bf16 a[44:47], v[160:163], v[92:95], a[44:47]
    s_waitcnt lgkmcnt(6)
    ds_read_b64_tr_b16 v[156:157], v233 offset:24576
    v_cvt_pk_bf16_f32 v28, v28, v29
    v_mfma_f32_16x16x32_bf16 a[60:63], v[168:171], v[92:95], a[60:63]
    v_exp_f32 v30, v30
    v_mfma_f32_16x16x32_bf16 a[60:63], v[172:175], v[76:79], a[60:63]
    v_exp_f32 v31, v31
    v_mfma_f32_16x16x32_bf16 a[56:59], v[172:175], v[72:75], a[56:59]
    ds_read_b64_tr_b16 v[158:159], v233 offset:28672
    v_cvt_pk_bf16_f32 v29, v30, v31
    v_mfma_f32_16x16x32_bf16 a[56:59], v[168:171], v[88:91], a[56:59]
    ds_read_b64_tr_b16 v[160:161], v234 offset:16384
    v_mfma_f32_16x16x32_bf16 a[52:55], v[168:171], v[84:87], a[52:55]
    v_exp_f32 v60, v60
    v_mfma_f32_16x16x32_bf16 a[52:55], v[172:175], v[68:71], a[52:55]
    v_exp_f32 v61, v61
    v_mfma_f32_16x16x32_bf16 a[48:51], v[172:175], v[64:67], a[48:51]
    buffer_load_dwordx4 v241, s[16:19], s55 offen offset:3072 lds
    v_mfma_f32_16x16x32_bf16 a[48:51], v[168:171], v[80:83], a[48:51]
    s_waitcnt lgkmcnt(5)
    ds_read_b64_tr_b16 v[162:163], v234 offset:20480
    v_cvt_pk_bf16_f32 v30, v60, v61
    v_mfma_f32_16x16x32_bf16 a[64:67], v[144:147], v[80:83], a[64:67]
    v_exp_f32 v62, v62
    v_mfma_f32_16x16x32_bf16 a[64:67], v[148:151], v[64:67], a[64:67]
    v_exp_f32 v63, v63
    v_mfma_f32_16x16x32_bf16 a[68:71], v[148:151], v[68:71], a[68:71]
    ds_read_b64_tr_b16 v[164:165], v234 offset:24576
    v_cvt_pk_bf16_f32 v31, v62, v63
    v_mfma_f32_16x16x32_bf16 a[68:71], v[144:147], v[84:87], a[68:71]
    ds_read_b64_tr_b16 v[166:167], v234 offset:28672
    v_mfma_f32_16x16x32_bf16 a[72:75], v[144:147], v[88:91], a[72:75]
    buffer_store_dwordx4 v[2:5], v254, s[40:43], s34 offen offset:2048 sc1
    v_mfma_f32_16x16x32_bf16 a[72:75], v[148:151], v[72:75], a[72:75]
    s_waitcnt vmcnt(13)
    v_mfma_f32_16x16x32_bf16 a[76:79], v[148:151], v[76:79], a[76:79]
    s_barrier
    v_exp_f32 v32, v32
    v_mfma_f32_16x16x32_bf16 a[76:79], v[144:147], v[92:95], a[76:79]
    s_waitcnt lgkmcnt(4)
    v_exp_f32 v33, v33
    v_mfma_f32_16x16x32_bf16 a[92:95], v[152:155], v[92:95], a[92:95]
    ds_read_b64_tr_b16 v[168:169], v235 offset:16384
    v_cvt_pk_bf16_f32 v32, v32, v33
    v_mfma_f32_16x16x32_bf16 a[92:95], v[156:159], v[76:79], a[92:95]
    v_exp_f32 v34, v34
    v_mfma_f32_16x16x32_bf16 a[88:91], v[156:159], v[72:75], a[88:91]
    v_exp_f32 v35, v35
    v_mfma_f32_16x16x32_bf16 a[88:91], v[152:155], v[88:91], a[88:91]
    ds_read_b64_tr_b16 v[170:171], v235 offset:20480
    v_cvt_pk_bf16_f32 v33, v34, v35
    v_mfma_f32_16x16x32_bf16 a[84:87], v[152:155], v[84:87], a[84:87]
    s_add_u32 s54, s54, 16384
    ds_read_b64_tr_b16 v[172:173], v235 offset:24576
    v_mfma_f32_16x16x32_bf16 a[84:87], v[156:159], v[68:71], a[84:87]
    s_add_u32 m0, s53, 32768
    v_exp_f32 v96, v96
    v_mfma_f32_16x16x32_bf16 a[80:83], v[156:159], v[64:67], a[80:83]
    s_waitcnt lgkmcnt(3)
    v_exp_f32 v97, v97
    v_mfma_f32_16x16x32_bf16 a[80:83], v[152:155], v[80:83], a[80:83]
    buffer_load_dwordx4 v236, s[12:15], s54 offen offset:0 lds
    v_mfma_f32_16x16x32_bf16 a[96:99], v[160:163], v[80:83], a[96:99]
    ds_read_b64_tr_b16 v[174:175], v235 offset:28672
    v_cvt_pk_bf16_f32 v34, v96, v97
    v_mfma_f32_16x16x32_bf16 a[96:99], v[164:167], v[64:67], a[96:99]
    v_exp_f32 v98, v98
    v_mfma_f32_16x16x32_bf16 a[100:103], v[164:167], v[68:71], a[100:103]
    v_exp_f32 v99, v99
    v_mfma_f32_16x16x32_bf16 a[100:103], v[160:163], v[84:87], a[100:103]
    ds_read_b128 v[112:115], v216 offset:32768
    v_cvt_pk_bf16_f32 v35, v98, v99
    v_mfma_f32_16x16x32_bf16 a[104:107], v[160:163], v[88:91], a[104:107]
    s_add_u32 s30, s6, 65536
    ds_read_b128 v[116:119], v217 offset:32768
    v_mfma_f32_16x16x32_bf16 a[104:107], v[164:167], v[72:75], a[104:107]
    buffer_load_dwordx4 v[10:13], v201, s[44:47], s30 offen
    v_mfma_f32_16x16x32_bf16 a[108:111], v[164:167], v[76:79], a[108:111]
    v_mfma_f32_16x16x32_bf16 a[108:111], v[160:163], v[92:95], a[108:111]
    s_waitcnt lgkmcnt(2)
    v_exp_f32 v36, v36
    v_mfma_f32_16x16x32_bf16 a[124:127], v[168:171], v[92:95], a[124:127]
    v_exp_f32 v37, v37
    v_mfma_f32_16x16x32_bf16 a[124:127], v[172:175], v[76:79], a[124:127]
    ds_read_b128 v[120:123], v218 offset:32768
    v_cvt_pk_bf16_f32 v36, v36, v37
    v_mfma_f32_16x16x32_bf16 a[120:123], v[172:175], v[72:75], a[120:123]
    v_exp_f32 v38, v38
    v_mfma_f32_16x16x32_bf16 a[120:123], v[168:171], v[88:91], a[120:123]
    v_exp_f32 v39, v39
    v_mfma_f32_16x16x32_bf16 a[116:119], v[168:171], v[84:87], a[116:119]
    ds_read_b128 v[124:127], v219 offset:32768
    v_cvt_pk_bf16_f32 v37, v38, v39
    v_mfma_f32_16x16x32_bf16 a[116:119], v[172:175], v[68:71], a[116:119]
    ds_read_b128 v[128:131], v216 offset:36864
    v_mfma_f32_16x16x32_bf16 a[112:115], v[172:175], v[64:67], a[112:115]
    v_exp_f32 v100, v100
    v_mfma_f32_16x16x32_bf16 a[112:115], v[168:171], v[80:83], a[112:115]
    v_exp_f32 v101, v101
    v_mfma_f32_16x16x32_bf16 a[128:131], v[208:211], v[80:83], a[128:131]
    buffer_load_dwordx4 v237, s[12:15], s54 offen offset:1024 lds
    v_mfma_f32_16x16x32_bf16 a[128:131], v[208:211], v[64:67], a[128:131]
    ds_read_b128 v[132:135], v217 offset:36864
    v_cvt_pk_bf16_f32 v38, v100, v101
    v_mfma_f32_16x16x32_bf16 a[132:135], v[208:211], v[68:71], a[132:135]
    v_exp_f32 v102, v102
    v_mfma_f32_16x16x32_bf16 a[132:135], v[208:211], v[84:87], a[132:135]
    v_exp_f32 v103, v103
    v_mfma_f32_16x16x32_bf16 a[136:139], v[208:211], v[88:91], a[136:139]
    v_cvt_pk_bf16_f32 v39, v102, v103
    v_mfma_f32_16x16x32_bf16 a[136:139], v[208:211], v[72:75], a[136:139]
    v_mfma_f32_16x16x32_bf16 a[140:143], v[208:211], v[76:79], a[140:143]
    v_mfma_f32_16x16x32_bf16 a[140:143], v[208:211], v[92:95], a[140:143]
    s_waitcnt lgkmcnt(2)
    v_mfma_f32_16x16x32_bf16 v[80:83], v[112:115], a[144:147], v[176:179]
    v_exp_f32 v40, v40
    v_mfma_f32_16x16x32_bf16 v[80:83], v[116:119], a[148:151], v[80:83]
    v_exp_f32 v41, v41
    v_mfma_f32_16x16x32_bf16 v[80:83], v[120:123], a[152:155], v[80:83]
    ds_read_b128 v[136:139], v218 offset:36864
    v_cvt_pk_bf16_f32 v40, v40, v41
    v_mfma_f32_16x16x32_bf16 v[80:83], v[124:127], a[156:159], v[80:83]
    v_exp_f32 v42, v42
    v_mfma_f32_16x16x32_bf16 v[84:87], v[124:127], a[172:175], v[180:183]
    v_exp_f32 v43, v43
    v_mfma_f32_16x16x32_bf16 v[84:87], v[120:123], a[168:171], v[84:87]
    ds_read_b128 v[140:143], v219 offset:36864
    v_cvt_pk_bf16_f32 v41, v42, v43
    v_mfma_f32_16x16x32_bf16 v[84:87], v[116:119], a[164:167], v[84:87]
    ds_read_b64_tr_b16 v[144:145], v228 offset:49152
    v_mfma_f32_16x16x32_bf16 v[84:87], v[112:115], a[160:163], v[84:87]
    v_exp_f32 v104, v104
    v_mfma_f32_16x16x32_bf16 v[88:91], v[112:115], a[176:179], v[184:187]
    v_exp_f32 v105, v105
    v_mfma_f32_16x16x32_bf16 v[88:91], v[116:119], a[180:183], v[88:91]
    buffer_load_dwordx4 v238, s[12:15], s54 offen offset:2048 lds
    v_mfma_f32_16x16x32_bf16 v[88:91], v[120:123], a[184:187], v[88:91]
    ds_read_b64_tr_b16 v[146:147], v228 offset:53248
    v_cvt_pk_bf16_f32 v42, v104, v105
    v_mfma_f32_16x16x32_bf16 v[88:91], v[124:127], a[188:191], v[88:91]
    v_exp_f32 v106, v106
    v_mfma_f32_16x16x32_bf16 v[92:95], v[124:127], a[204:207], v[188:191]
    v_exp_f32 v107, v107
    v_mfma_f32_16x16x32_bf16 v[92:95], v[120:123], a[200:203], v[92:95]
    ds_read_b64_tr_b16 v[148:149], v228 offset:57344
    v_cvt_pk_bf16_f32 v43, v106, v107
    v_mfma_f32_16x16x32_bf16 v[92:95], v[116:119], a[196:199], v[92:95]
    ds_read_b64_tr_b16 v[150:151], v228 offset:61440
    v_mfma_f32_16x16x32_bf16 v[92:95], v[112:115], a[192:195], v[92:95]
    s_waitcnt lgkmcnt(6)
    v_mfma_f32_16x16x32_bf16 v[64:67], v[128:131], a[144:147], v[176:179]
    v_mfma_f32_16x16x32_bf16 v[64:67], v[132:135], a[148:151], v[64:67]
    s_waitcnt lgkmcnt(5)
    v_exp_f32 v44, v44
    v_mfma_f32_16x16x32_bf16 v[64:67], v[136:139], a[152:155], v[64:67]
    s_waitcnt lgkmcnt(4)
    v_exp_f32 v45, v45
    v_mfma_f32_16x16x32_bf16 v[64:67], v[140:143], a[156:159], v[64:67]
    ds_read_b128 v[112:115], v216 offset:40960
    v_cvt_pk_bf16_f32 v44, v44, v45
    v_mfma_f32_16x16x32_bf16 v[68:71], v[140:143], a[172:175], v[180:183]
    v_exp_f32 v46, v46
    v_mfma_f32_16x16x32_bf16 v[68:71], v[136:139], a[168:171], v[68:71]
    v_exp_f32 v47, v47
    v_mfma_f32_16x16x32_bf16 v[68:71], v[132:135], a[164:167], v[68:71]
    ds_read_b128 v[116:119], v217 offset:40960
    v_cvt_pk_bf16_f32 v45, v46, v47
    v_mfma_f32_16x16x32_bf16 v[68:71], v[128:131], a[160:163], v[68:71]
    ds_read_b128 v[120:123], v218 offset:40960
    v_mfma_f32_16x16x32_bf16 v[72:75], v[128:131], a[176:179], v[184:187]
    v_exp_f32 v108, v108
    v_mfma_f32_16x16x32_bf16 v[72:75], v[132:135], a[180:183], v[72:75]
    v_exp_f32 v109, v109
    v_mfma_f32_16x16x32_bf16 v[72:75], v[136:139], a[184:187], v[72:75]
    buffer_load_dwordx4 v239, s[12:15], s54 offen offset:3072 lds
    v_mfma_f32_16x16x32_bf16 v[72:75], v[140:143], a[188:191], v[72:75]
    ds_read_b128 v[124:127], v219 offset:40960
    v_cvt_pk_bf16_f32 v46, v108, v109
    v_mfma_f32_16x16x32_bf16 v[76:79], v[140:143], a[204:207], v[188:191]
    v_exp_f32 v110, v110
    v_mfma_f32_16x16x32_bf16 v[76:79], v[136:139], a[200:203], v[76:79]
    v_exp_f32 v111, v111
    v_mfma_f32_16x16x32_bf16 v[76:79], v[132:135], a[196:199], v[76:79]
    ds_read_b64_tr_b16 v[152:153], v229 offset:49152
    v_cvt_pk_bf16_f32 v47, v110, v111
    v_mfma_f32_16x16x32_bf16 v[76:79], v[128:131], a[192:195], v[76:79]
    s_waitcnt lgkmcnt(2)
    ds_read_b64_tr_b16 v[154:155], v229 offset:53248
    v_mfma_f32_16x16x32_bf16 v[96:99], v[112:115], a[144:147], v[176:179]
    buffer_store_dwordx4 v[6:9], v254, s[40:43], s34 offen offset:3072 sc1
    v_mfma_f32_16x16x32_bf16 v[96:99], v[116:119], a[148:151], v[96:99]
    v_mfma_f32_16x16x32_bf16 v[96:99], v[120:123], a[152:155], v[96:99]
    s_waitcnt lgkmcnt(2)
    v_exp_f32 v80, v80
    v_mfma_f32_16x16x32_bf16 v[96:99], v[124:127], a[156:159], v[96:99]
    v_exp_f32 v81, v81
    v_mfma_f32_16x16x32_bf16 v[100:103], v[124:127], a[172:175], v[180:183]
    ds_read_b128 v[128:131], v216 offset:45056
    v_cvt_pk_bf16_f32 v80, v80, v81
    v_mfma_f32_16x16x32_bf16 v[100:103], v[120:123], a[168:171], v[100:103]
    v_exp_f32 v82, v82
    v_mfma_f32_16x16x32_bf16 v[100:103], v[116:119], a[164:167], v[100:103]
    v_exp_f32 v83, v83
    v_mfma_f32_16x16x32_bf16 v[100:103], v[112:115], a[160:163], v[100:103]
    ds_read_b128 v[132:135], v217 offset:45056
    v_cvt_pk_bf16_f32 v81, v82, v83
    v_mfma_f32_16x16x32_bf16 v[104:107], v[112:115], a[176:179], v[184:187]
    ds_read_b128 v[136:139], v218 offset:45056
    v_mfma_f32_16x16x32_bf16 v[104:107], v[116:119], a[180:183], v[104:107]
    s_add_u32 s55, s55, 16384
    v_exp_f32 v64, v64
    v_mfma_f32_16x16x32_bf16 v[104:107], v[120:123], a[184:187], v[104:107]
    s_add_u32 m0, s53, 49152
    v_exp_f32 v65, v65
    v_mfma_f32_16x16x32_bf16 v[104:107], v[124:127], a[188:191], v[104:107]
    buffer_load_dwordx4 v240, s[16:19], s55 offen offset:0 lds
    v_mfma_f32_16x16x32_bf16 v[108:111], v[124:127], a[204:207], v[188:191]
    ds_read_b128 v[140:143], v219 offset:45056
    v_cvt_pk_bf16_f32 v82, v64, v65
    v_mfma_f32_16x16x32_bf16 v[108:111], v[120:123], a[200:203], v[108:111]
    v_exp_f32 v66, v66
    v_mfma_f32_16x16x32_bf16 v[108:111], v[116:119], a[196:199], v[108:111]
    v_exp_f32 v67, v67
    v_mfma_f32_16x16x32_bf16 v[108:111], v[112:115], a[192:195], v[108:111]
    s_waitcnt lgkmcnt(1)
    ds_read_b64_tr_b16 v[156:157], v229 offset:57344
    v_cvt_pk_bf16_f32 v83, v66, v67
    v_mfma_f32_16x16x32_bf16 v[48:51], v[128:131], a[144:147], v[176:179]
    ds_read_b64_tr_b16 v[158:159], v229 offset:61440
    v_mfma_f32_16x16x32_bf16 v[48:51], v[132:135], a[148:151], v[48:51]
    buffer_load_dwordx4 v[2:5], v255, s[20:23], s63 offen offset:128
    v_mfma_f32_16x16x32_bf16 v[48:51], v[136:139], a[152:155], v[48:51]
    s_waitcnt lgkmcnt(2)
    v_mfma_f32_16x16x32_bf16 v[48:51], v[140:143], a[156:159], v[48:51]
    v_exp_f32 v84, v84
    v_mfma_f32_16x16x32_bf16 v[52:55], v[140:143], a[172:175], v[180:183]
    v_exp_f32 v85, v85
    v_mfma_f32_16x16x32_bf16 v[52:55], v[136:139], a[168:171], v[52:55]
    ds_read_b64_tr_b16 v[160:161], v230 offset:49152
    v_cvt_pk_bf16_f32 v84, v84, v85
    v_mfma_f32_16x16x32_bf16 v[52:55], v[132:135], a[164:167], v[52:55]
    v_exp_f32 v86, v86
    v_mfma_f32_16x16x32_bf16 v[52:55], v[128:131], a[160:163], v[52:55]
    v_exp_f32 v87, v87
    v_mfma_f32_16x16x32_bf16 v[56:59], v[128:131], a[176:179], v[184:187]
    ds_read_b64_tr_b16 v[162:163], v230 offset:53248
    v_cvt_pk_bf16_f32 v85, v86, v87
    v_mfma_f32_16x16x32_bf16 v[56:59], v[132:135], a[180:183], v[56:59]
    ds_read_b64_tr_b16 v[164:165], v230 offset:57344
    v_mfma_f32_16x16x32_bf16 v[56:59], v[136:139], a[184:187], v[56:59]
    v_exp_f32 v68, v68
    v_mfma_f32_16x16x32_bf16 v[56:59], v[140:143], a[188:191], v[56:59]
    v_exp_f32 v69, v69
    v_mfma_f32_16x16x32_bf16 v[60:63], v[140:143], a[204:207], v[188:191]
    buffer_load_dwordx4 v241, s[16:19], s55 offen offset:1024 lds
    v_mfma_f32_16x16x32_bf16 v[60:63], v[136:139], a[200:203], v[60:63]
    ds_read_b64_tr_b16 v[166:167], v230 offset:61440
    v_cvt_pk_bf16_f32 v86, v68, v69
    v_mfma_f32_16x16x32_bf16 v[60:63], v[132:135], a[196:199], v[60:63]
    v_exp_f32 v70, v70
    v_mfma_f32_16x16x32_bf16 v[60:63], v[128:131], a[192:195], v[60:63]
    v_exp_f32 v71, v71
    v_mfma_f32_16x16x32_bf16 a[0:3], v[144:147], v[16:19], a[0:3]
    ds_read_b64_tr_b16 v[168:169], v231 offset:49152
    v_cvt_pk_bf16_f32 v87, v70, v71
    v_mfma_f32_16x16x32_bf16 a[0:3], v[148:151], v[32:35], a[0:3]
    ds_read_b64_tr_b16 v[170:171], v231 offset:53248
    v_mfma_f32_16x16x32_bf16 a[4:7], v[148:151], v[36:39], a[4:7]
    v_mfma_f32_16x16x32_bf16 a[4:7], v[144:147], v[20:23], a[4:7]
    v_mfma_f32_16x16x32_bf16 a[8:11], v[144:147], v[24:27], a[8:11]
    v_exp_f32 v88, v88
    v_mfma_f32_16x16x32_bf16 a[8:11], v[148:151], v[40:43], a[8:11]
    v_exp_f32 v89, v89
    v_mfma_f32_16x16x32_bf16 a[12:15], v[148:151], v[44:47], a[12:15]
    ds_read_b64_tr_b16 v[172:173], v231 offset:57344
    v_cvt_pk_bf16_f32 v88, v88, v89
    v_mfma_f32_16x16x32_bf16 a[12:15], v[144:147], v[28:31], a[12:15]
    s_waitcnt lgkmcnt(7)
    v_exp_f32 v90, v90
    v_mfma_f32_16x16x32_bf16 a[28:31], v[152:155], v[28:31], a[28:31]
    v_exp_f32 v91, v91
    v_mfma_f32_16x16x32_bf16 a[28:31], v[156:159], v[44:47], a[28:31]
    ds_read_b64_tr_b16 v[174:175], v231 offset:61440
    v_cvt_pk_bf16_f32 v89, v90, v91
    v_mfma_f32_16x16x32_bf16 a[24:27], v[156:159], v[40:43], a[24:27]
    ds_read_b64_tr_b16 v[144:145], v232 offset:49152
    v_mfma_f32_16x16x32_bf16 a[24:27], v[152:155], v[24:27], a[24:27]
    v_exp_f32 v72, v72
    v_mfma_f32_16x16x32_bf16 a[20:23], v[152:155], v[20:23], a[20:23]
    v_exp_f32 v73, v73
    v_mfma_f32_16x16x32_bf16 a[20:23], v[156:159], v[36:39], a[20:23]
    buffer_load_dwordx4 v240, s[16:19], s55 offen offset:2048 lds
    v_mfma_f32_16x16x32_bf16 a[16:19], v[156:159], v[32:35], a[16:19]
    ds_read_b64_tr_b16 v[146:147], v232 offset:53248
    v_cvt_pk_bf16_f32 v90, v72, v73
    v_mfma_f32_16x16x32_bf16 a[16:19], v[152:155], v[16:19], a[16:19]
    s_waitcnt lgkmcnt(6)
    v_exp_f32 v74, v74
    v_mfma_f32_16x16x32_bf16 a[32:35], v[160:163], v[16:19], a[32:35]
    v_exp_f32 v75, v75
    v_mfma_f32_16x16x32_bf16 a[32:35], v[164:167], v[32:35], a[32:35]
    ds_read_b64_tr_b16 v[148:149], v232 offset:57344
    v_cvt_pk_bf16_f32 v91, v74, v75
    v_mfma_f32_16x16x32_bf16 a[36:39], v[164:167], v[36:39], a[36:39]
    ds_read_b64_tr_b16 v[150:151], v232 offset:61440
    v_mfma_f32_16x16x32_bf16 a[36:39], v[160:163], v[20:23], a[36:39]
    ds_read_b64_tr_b16 v[152:153], v233 offset:49152
    v_mfma_f32_16x16x32_bf16 a[40:43], v[160:163], v[24:27], a[40:43]
    ds_read_b64_tr_b16 v[154:155], v233 offset:53248
    v_mfma_f32_16x16x32_bf16 a[40:43], v[164:167], v[40:43], a[40:43]
    v_exp_f32 v92, v92
    v_mfma_f32_16x16x32_bf16 a[44:47], v[164:167], v[44:47], a[44:47]
    v_exp_f32 v93, v93
    v_mfma_f32_16x16x32_bf16 a[44:47], v[160:163], v[28:31], a[44:47]
    s_waitcnt lgkmcnt(6)
    ds_read_b64_tr_b16 v[156:157], v233 offset:57344
    v_cvt_pk_bf16_f32 v92, v92, v93
    v_mfma_f32_16x16x32_bf16 a[60:63], v[168:171], v[28:31], a[60:63]
    v_exp_f32 v94, v94
    v_mfma_f32_16x16x32_bf16 a[60:63], v[172:175], v[44:47], a[60:63]
    v_exp_f32 v95, v95
    v_mfma_f32_16x16x32_bf16 a[56:59], v[172:175], v[40:43], a[56:59]
    ds_read_b64_tr_b16 v[158:159], v233 offset:61440
    v_cvt_pk_bf16_f32 v93, v94, v95
    v_mfma_f32_16x16x32_bf16 a[56:59], v[168:171], v[24:27], a[56:59]
    ds_read_b64_tr_b16 v[160:161], v234 offset:49152
    v_mfma_f32_16x16x32_bf16 a[52:55], v[168:171], v[20:23], a[52:55]
    v_exp_f32 v76, v76
    v_mfma_f32_16x16x32_bf16 a[52:55], v[172:175], v[36:39], a[52:55]
    v_exp_f32 v77, v77
    v_mfma_f32_16x16x32_bf16 a[48:51], v[172:175], v[32:35], a[48:51]
    buffer_load_dwordx4 v241, s[16:19], s55 offen offset:3072 lds
    v_mfma_f32_16x16x32_bf16 a[48:51], v[168:171], v[16:19], a[48:51]
    s_waitcnt lgkmcnt(5)
    ds_read_b64_tr_b16 v[162:163], v234 offset:53248
    v_cvt_pk_bf16_f32 v94, v76, v77
    v_mfma_f32_16x16x32_bf16 a[64:67], v[144:147], v[16:19], a[64:67]
    v_exp_f32 v78, v78
    v_mfma_f32_16x16x32_bf16 a[64:67], v[148:151], v[32:35], a[64:67]
    v_exp_f32 v79, v79
    v_mfma_f32_16x16x32_bf16 a[68:71], v[148:151], v[36:39], a[68:71]
    ds_read_b64_tr_b16 v[164:165], v234 offset:57344
    v_cvt_pk_bf16_f32 v95, v78, v79
    v_mfma_f32_16x16x32_bf16 a[68:71], v[144:147], v[20:23], a[68:71]
    ds_read_b64_tr_b16 v[166:167], v234 offset:61440
    v_mfma_f32_16x16x32_bf16 a[72:75], v[144:147], v[24:27], a[72:75]
    buffer_load_dwordx4 v[6:9], v255, s[20:23], s63 offen offset:192
    v_mfma_f32_16x16x32_bf16 a[72:75], v[148:151], v[40:43], a[72:75]
    s_waitcnt vmcnt(13)
    v_mfma_f32_16x16x32_bf16 a[76:79], v[148:151], v[44:47], a[76:79]
    s_barrier
    v_exp_f32 v96, v96
    v_mfma_f32_16x16x32_bf16 a[76:79], v[144:147], v[28:31], a[76:79]
    s_waitcnt lgkmcnt(4)
    v_exp_f32 v97, v97
    v_mfma_f32_16x16x32_bf16 a[92:95], v[152:155], v[28:31], a[92:95]
    ds_read_b64_tr_b16 v[168:169], v235 offset:49152
    v_cvt_pk_bf16_f32 v96, v96, v97
    v_mfma_f32_16x16x32_bf16 a[92:95], v[156:159], v[44:47], a[92:95]
    v_exp_f32 v98, v98
    v_mfma_f32_16x16x32_bf16 a[88:91], v[156:159], v[40:43], a[88:91]
    v_exp_f32 v99, v99
    v_mfma_f32_16x16x32_bf16 a[88:91], v[152:155], v[24:27], a[88:91]
    ds_read_b64_tr_b16 v[170:171], v235 offset:53248
    v_cvt_pk_bf16_f32 v97, v98, v99
    v_mfma_f32_16x16x32_bf16 a[84:87], v[152:155], v[20:23], a[84:87]
    s_add_u32 s54, s54, 16384
    ds_read_b64_tr_b16 v[172:173], v235 offset:57344
    v_mfma_f32_16x16x32_bf16 a[84:87], v[156:159], v[36:39], a[84:87]
    s_add_u32 m0, s53, 65536
    v_exp_f32 v48, v48
    v_mfma_f32_16x16x32_bf16 a[80:83], v[156:159], v[32:35], a[80:83]
    s_waitcnt lgkmcnt(3)
    v_exp_f32 v49, v49
    v_mfma_f32_16x16x32_bf16 a[80:83], v[152:155], v[16:19], a[80:83]
    buffer_load_dwordx4 v236, s[12:15], s54 offen offset:0 lds
    v_mfma_f32_16x16x32_bf16 a[96:99], v[160:163], v[16:19], a[96:99]
    ds_read_b64_tr_b16 v[174:175], v235 offset:61440
    v_cvt_pk_bf16_f32 v98, v48, v49
    v_mfma_f32_16x16x32_bf16 a[96:99], v[164:167], v[32:35], a[96:99]
    v_exp_f32 v50, v50
    v_mfma_f32_16x16x32_bf16 a[100:103], v[164:167], v[36:39], a[100:103]
    v_exp_f32 v51, v51
    v_mfma_f32_16x16x32_bf16 a[100:103], v[160:163], v[20:23], a[100:103]
    ds_read_b128 v[112:115], v212 offset:0
    v_cvt_pk_bf16_f32 v99, v50, v51
    v_mfma_f32_16x16x32_bf16 a[104:107], v[160:163], v[24:27], a[104:107]
    ds_read_b128 v[116:119], v213 offset:0
    v_mfma_f32_16x16x32_bf16 a[104:107], v[164:167], v[40:43], a[104:107]
    global_load_dword v202, v[14:15], off
    v_mfma_f32_16x16x32_bf16 a[108:111], v[164:167], v[44:47], a[108:111]
    v_mfma_f32_16x16x32_bf16 a[108:111], v[160:163], v[28:31], a[108:111]
    s_waitcnt lgkmcnt(2)
    v_exp_f32 v100, v100
    v_mfma_f32_16x16x32_bf16 a[124:127], v[168:171], v[28:31], a[124:127]
    v_exp_f32 v101, v101
    v_mfma_f32_16x16x32_bf16 a[124:127], v[172:175], v[44:47], a[124:127]
    ds_read_b128 v[120:123], v214 offset:0
    v_cvt_pk_bf16_f32 v100, v100, v101
    v_mfma_f32_16x16x32_bf16 a[120:123], v[172:175], v[40:43], a[120:123]
    v_exp_f32 v102, v102
    v_mfma_f32_16x16x32_bf16 a[120:123], v[168:171], v[24:27], a[120:123]
    v_exp_f32 v103, v103
    v_mfma_f32_16x16x32_bf16 a[116:119], v[168:171], v[20:23], a[116:119]
    ds_read_b128 v[124:127], v215 offset:0
    v_cvt_pk_bf16_f32 v101, v102, v103
    v_mfma_f32_16x16x32_bf16 a[116:119], v[172:175], v[36:39], a[116:119]
    ds_read_b128 v[128:131], v212 offset:4096
    v_mfma_f32_16x16x32_bf16 a[112:115], v[172:175], v[32:35], a[112:115]
    v_exp_f32 v52, v52
    v_mfma_f32_16x16x32_bf16 a[112:115], v[168:171], v[16:19], a[112:115]
    v_exp_f32 v53, v53
    v_mfma_f32_16x16x32_bf16 a[128:131], v[208:211], v[16:19], a[128:131]
    buffer_load_dwordx4 v237, s[12:15], s54 offen offset:1024 lds
    v_mfma_f32_16x16x32_bf16 a[128:131], v[208:211], v[32:35], a[128:131]
    ds_read_b128 v[132:135], v213 offset:4096
    v_cvt_pk_bf16_f32 v102, v52, v53
    v_mfma_f32_16x16x32_bf16 a[132:135], v[208:211], v[36:39], a[132:135]
    v_exp_f32 v54, v54
    v_mfma_f32_16x16x32_bf16 a[132:135], v[208:211], v[20:23], a[132:135]
    v_exp_f32 v55, v55
    v_mfma_f32_16x16x32_bf16 a[136:139], v[208:211], v[24:27], a[136:139]
    v_cvt_pk_bf16_f32 v103, v54, v55
    v_mfma_f32_16x16x32_bf16 a[136:139], v[208:211], v[40:43], a[136:139]
    v_mfma_f32_16x16x32_bf16 a[140:143], v[208:211], v[44:47], a[140:143]
    v_mfma_f32_16x16x32_bf16 a[140:143], v[208:211], v[28:31], a[140:143]
    s_waitcnt lgkmcnt(2)
    s_sub_u32 s32, s32, 1
    s_cmp_gt_u32 s32, 4
    s_cbranch_scc1 f_att_loop2
f_att_hi:
f_att_loop:
    v_mfma_f32_16x16x32_bf16 v[16:19], v[112:115], a[144:147], v[176:179]
    v_exp_f32 v104, v104
    v_mfma_f32_16x16x32_bf16 v[16:19], v[116:119], a[148:151], v[16:19]
    v_exp_f32 v105, v105
    v_mfma_f32_16x16x32_bf16 v[16:19], v[120:123], a[152:155], v[16:19]
    ds_read_b128 v[136:139], v214 offset:4096
    v_cvt_pk_bf16_f32 v104, v104, v105
    v_mfma_f32_16x16x32_bf16 v[16:19], v[124:127], a[156:159], v[16:19]
    v_exp_f32 v106, v106
    v_mfma_f32_16x16x32_bf16 v[20:23], v[124:127], a[172:175], v[180:183]
    v_exp_f32 v107, v107
    v_mfma_f32_16x16x32_bf16 v[20:23], v[120:123], a[168:171], v[20:23]
    ds_read_b128 v[140:143], v215 offset:4096
    v_cvt_pk_bf16_f32 v105, v106, v107
    v_mfma_f32_16x16x32_bf16 v[20:23], v[116:119], a[164:167], v[20:23]
    ds_read_b64_tr_b16 v[144:145], v220 offset:16384
    v_mfma_f32_16x16x32_bf16 v[20:23], v[112:115], a[160:163], v[20:23]
    v_exp_f32 v56, v56
    v_mfma_f32_16x16x32_bf16 v[24:27], v[112:115], a[176:179], v[184:187]
    v_exp_f32 v57, v57
    v_mfma_f32_16x16x32_bf16 v[24:27], v[116:119], a[180:183], v[24:27]
    buffer_load_dwordx4 v238, s[12:15], s54 offen offset:2048 lds
    v_mfma_f32_16x16x32_bf16 v[24:27], v[120:123], a[184:187], v[24:27]
    ds_read_b64_tr_b16 v[146:147], v220 offset:20480
    v_cvt_pk_bf16_f32 v106, v56, v57
    v_mfma_f32_16x16x32_bf16 v[24:27], v[124:127], a[188:191], v[24:27]
    v_exp_f32 v58, v58
    v_mfma_f32_16x16x32_bf16 v[28:31], v[124:127], a[204:207], v[188:191]
    v_exp_f32 v59, v59
    v_mfma_f32_16x16x32_bf16 v[28:31], v[120:123], a[200:203], v[28:31]
    ds_read_b64_tr_b16 v[148:149], v220 offset:24576
    v_cvt_pk_bf16_f32 v107, v58, v59
    v_mfma_f32_16x16x32_bf16 v[28:31], v[116:119], a[196:199], v[28:31]
    ds_read_b64_tr_b16 v[150:151], v220 offset:28672
    v_mfma_f32_16x16x32_bf16 v[28:31], v[112:115], a[192:195], v[28:31]
    s_waitcnt lgkmcnt(6)
    v_mfma_f32_16x16x32_bf16 v[32:35], v[128:131], a[144:147], v[176:179]
    v_mfma_f32_16x16x32_bf16 v[32:35], v[132:135], a[148:151], v[32:35]
    s_waitcnt lgkmcnt(5)
    v_exp_f32 v108, v108
    v_mfma_f32_16x16x32_bf16 v[32:35], v[136:139], a[152:155], v[32:35]
    s_waitcnt lgkmcnt(4)
    v_exp_f32 v109, v109
    v_mfma_f32_16x16x32_bf16 v[32:35], v[140:143], a[156:159], v[32:35]
    ds_read_b128 v[112:115], v212 offset:8192
    v_cvt_pk_bf16_f32 v108, v108, v109
    v_mfma_f32_16x16x32_bf16 v[36:39], v[140:143], a[172:175], v[180:183]
    v_exp_f32 v110, v110
    v_mfma_f32_16x16x32_bf16 v[36:39], v[136:139], a[168:171], v[36:39]
    v_exp_f32 v111, v111
    v_mfma_f32_16x16x32_bf16 v[36:39], v[132:135], a[164:167], v[36:39]
    ds_read_b128 v[116:119], v213 offset:8192
    v_cvt_pk_bf16_f32 v109, v110, v111
    v_mfma_f32_16x16x32_bf16 v[36:39], v[128:131], a[160:163], v[36:39]
    ds_read_b128 v[120:123], v214 offset:8192
    v_mfma_f32_16x16x32_bf16 v[40:43], v[128:131], a[176:179], v[184:187]
    v_exp_f32 v60, v60
    v_mfma_f32_16x16x32_bf16 v[40:43], v[132:135], a[180:183], v[40:43]
    v_exp_f32 v61, v61
    v_mfma_f32_16x16x32_bf16 v[40:43], v[136:139], a[184:187], v[40:43]
    buffer_load_dwordx4 v239, s[12:15], s54 offen offset:3072 lds
    v_mfma_f32_16x16x32_bf16 v[40:43], v[140:143], a[188:191], v[40:43]
    ds_read_b128 v[124:127], v215 offset:8192
    v_cvt_pk_bf16_f32 v110, v60, v61
    v_mfma_f32_16x16x32_bf16 v[44:47], v[140:143], a[204:207], v[188:191]
    v_exp_f32 v62, v62
    v_mfma_f32_16x16x32_bf16 v[44:47], v[136:139], a[200:203], v[44:47]
    v_exp_f32 v63, v63
    v_mfma_f32_16x16x32_bf16 v[44:47], v[132:135], a[196:199], v[44:47]
    ds_read_b64_tr_b16 v[152:153], v221 offset:16384
    v_cvt_pk_bf16_f32 v111, v62, v63
    v_mfma_f32_16x16x32_bf16 v[44:47], v[128:131], a[192:195], v[44:47]
    s_waitcnt lgkmcnt(2)
    ds_read_b64_tr_b16 v[154:155], v221 offset:20480
    v_mfma_f32_16x16x32_bf16 v[48:51], v[112:115], a[144:147], v[176:179]
    v_mov_b32 v199, v198
    v_mfma_f32_16x16x32_bf16 v[48:51], v[116:119], a[148:151], v[48:51]
    buffer_load_dwordx2 v[196:197], v200, s[24:27], s62 offen sc1
    v_mfma_f32_16x16x32_bf16 v[48:51], v[120:123], a[152:155], v[48:51]
    s_waitcnt lgkmcnt(2)
    v_exp_f32 v16, v16
    v_mfma_f32_16x16x32_bf16 v[48:51], v[124:127], a[156:159], v[48:51]
    v_exp_f32 v17, v17
    v_mfma_f32_16x16x32_bf16 v[52:55], v[124:127], a[172:175], v[180:183]
    ds_read_b128 v[128:131], v212 offset:12288
    v_cvt_pk_bf16_f32 v16, v16, v17
    v_mfma_f32_16x16x32_bf16 v[52:55], v[120:123], a[168:171], v[52:55]
    v_exp_f32 v18, v18
    v_mfma_f32_16x16x32_bf16 v[52:55], v[116:119], a[164:167], v[52:55]
    v_exp_f32 v19, v19
    v_mfma_f32_16x16x32_bf16 v[52:55], v[112:115], a[160:163], v[52:55]
    ds_read_b128 v[132:135], v213 offset:12288
    v_cvt_pk_bf16_f32 v17, v18, v19
    v_mfma_f32_16x16x32_bf16 v[56:59], v[112:115], a[176:179], v[184:187]
    ds_read_b128 v[136:139], v214 offset:12288
    v_mfma_f32_16x16x32_bf16 v[56:59], v[116:119], a[180:183], v[56:59]
    s_add_u32 s55, s55, 16384
    v_exp_f32 v32, v32
    v_mfma_f32_16x16x32_bf16 v[56:59], v[120:123], a[184:187], v[56:59]
    s_add_u32 m0, s53, 81920
    v_exp_f32 v33, v33
    v_mfma_f32_16x16x32_bf16 v[56:59], v[124:127], a[188:191], v[56:59]
    buffer_load_dwordx4 v240, s[16:19], s55 offen offset:0 lds
    v_mfma_f32_16x16x32_bf16 v[60:63], v[124:127], a[204:207], v[188:191]
    ds_read_b128 v[140:143], v215 offset:12288
    v_cvt_pk_bf16_f32 v18, v32, v33
    v_mfma_f32_16x16x32_bf16 v[60:63], v[120:123], a[200:203], v[60:63]
    v_exp_f32 v34, v34
    v_mfma_f32_16x16x32_bf16 v[60:63], v[116:119], a[196:199], v[60:63]
    v_exp_f32 v35, v35
    v_mfma_f32_16x16x32_bf16 v[60:63], v[112:115], a[192:195], v[60:63]
    s_waitcnt lgkmcnt(1)
    ds_read_b64_tr_b16 v[156:157], v221 offset:24576
    v_cvt_pk_bf16_f32 v19, v34, v35
    v_mfma_f32_16x16x32_bf16 v[64:67], v[128:131], a[144:147], v[176:179]
    ds_read_b64_tr_b16 v[158:159], v221 offset:28672
    v_mfma_f32_16x16x32_bf16 v[64:67], v[132:135], a[148:151], v[64:67]
    v_mfma_f32_16x16x32_bf16 v[64:67], v[136:139], a[152:155], v[64:67]
    s_waitcnt lgkmcnt(2)
    v_mfma_f32_16x16x32_bf16 v[64:67], v[140:143], a[156:159], v[64:67]
    v_exp_f32 v20, v20
    v_mfma_f32_16x16x32_bf16 v[68:71], v[140:143], a[172:175], v[180:183]
    v_exp_f32 v21, v21
    v_mfma_f32_16x16x32_bf16 v[68:71], v[136:139], a[168:171], v[68:71]
    ds_read_b64_tr_b16 v[160:161], v222 offset:16384
    v_cvt_pk_bf16_f32 v20, v20, v21
    v_mfma_f32_16x16x32_bf16 v[68:71], v[132:135], a[164:167], v[68:71]
    v_exp_f32 v22, v22
    v_mfma_f32_16x16x32_bf16 v[68:71], v[128:131], a[160:163], v[68:71]
    v_exp_f32 v23, v23
    v_mfma_f32_16x16x32_bf16 v[72:75], v[128:131], a[176:179], v[184:187]
    ds_read_b64_tr_b16 v[162:163], v222 offset:20480
    v_cvt_pk_bf16_f32 v21, v22, v23
    v_mfma_f32_16x16x32_bf16 v[72:75], v[132:135], a[180:183], v[72:75]
    ds_read_b64_tr_b16 v[164:165], v222 offset:24576
    v_mfma_f32_16x16x32_bf16 v[72:75], v[136:139], a[184:187], v[72:75]
    v_exp_f32 v36, v36
    v_mfma_f32_16x16x32_bf16 v[72:75], v[140:143], a[188:191], v[72:75]
    v_exp_f32 v37, v37
    v_mfma_f32_16x16x32_bf16 v[76:79], v[140:143], a[204:207], v[188:191]
    buffer_load_dwordx4 v241, s[16:19], s55 offen offset:1024 lds
    v_mfma_f32_16x16x32_bf16 v[76:79], v[136:139], a[200:203], v[76:79]
    ds_read_b64_tr_b16 v[166:167], v222 offset:28672
    v_cvt_pk_bf16_f32 v22, v36, v37
    v_mfma_f32_16x16x32_bf16 v[76:79], v[132:135], a[196:199], v[76:79]
    v_exp_f32 v38, v38
    v_mfma_f32_16x16x32_bf16 v[76:79], v[128:131], a[192:195], v[76:79]
    v_exp_f32 v39, v39
    v_mfma_f32_16x16x32_bf16 a[0:3], v[144:147], v[80:83], a[0:3]
    ds_read_b64_tr_b16 v[168:169], v223 offset:16384
    v_cvt_pk_bf16_f32 v23, v38, v39
    v_mfma_f32_16x16x32_bf16 a[0:3], v[148:151], v[96:99], a[0:3]
    ds_read_b64_tr_b16 v[170:171], v223 offset:20480
    v_mfma_f32_16x16x32_bf16 a[4:7], v[148:151], v[100:103], a[4:7]
    v_mfma_f32_16x16x32_bf16 a[4:7], v[144:147], v[84:87], a[4:7]
    v_mfma_f32_16x16x32_bf16 a[8:11], v[144:147], v[88:91], a[8:11]
    v_exp_f32 v24, v24
    v_mfma_f32_16x16x32_bf16 a[8:11], v[148:151], v[104:107], a[8:11]
    v_exp_f32 v25, v25
    v_mfma_f32_16x16x32_bf16 a[12:15], v[148:151], v[108:111], a[12:15]
    ds_read_b64_tr_b16 v[172:173], v223 offset:24576
    v_cvt_pk_bf16_f32 v24, v24, v25
    v_mfma_f32_16x16x32_bf16 a[12:15], v[144:147], v[92:95], a[12:15]
    s_waitcnt lgkmcnt(7)
    v_exp_f32 v26, v26
    v_mfma_f32_16x16x32_bf16 a[28:31], v[152:155], v[92:95], a[28:31]
    v_exp_f32 v27, v27
    v_mfma_f32_16x16x32_bf16 a[28:31], v[156:159], v[108:111], a[28:31]
    ds_read_b64_tr_b16 v[174:175], v223 offset:28672
    v_cvt_pk_bf16_f32 v25, v26, v27
    v_mfma_f32_16x16x32_bf16 a[24:27], v[156:159], v[104:107], a[24:27]
    ds_read_b64_tr_b16 v[144:145], v224 offset:16384
    v_mfma_f32_16x16x32_bf16 a[24:27], v[152:155], v[88:91], a[24:27]
    v_exp_f32 v40, v40
    v_mfma_f32_16x16x32_bf16 a[20:23], v[152:155], v[84:87], a[20:23]
    v_exp_f32 v41, v41
    v_mfma_f32_16x16x32_bf16 a[20:23], v[156:159], v[100:103], a[20:23]
    buffer_load_dwordx4 v240, s[16:19], s55 offen offset:2048 lds
    v_mfma_f32_16x16x32_bf16 a[16:19], v[156:159], v[96:99], a[16:19]
    ds_read_b64_tr_b16 v[146:147], v224 offset:20480
    v_cvt_pk_bf16_f32 v26, v40, v41
    v_mfma_f32_16x16x32_bf16 a[16:19], v[152:155], v[80:83], a[16:19]
    s_waitcnt lgkmcnt(6)
    v_exp_f32 v42, v42
    v_mfma_f32_16x16x32_bf16 a[32:35], v[160:163], v[80:83], a[32:35]
    v_exp_f32 v43, v43
    v_mfma_f32_16x16x32_bf16 a[32:35], v[164:167], v[96:99], a[32:35]
    ds_read_b64_tr_b16 v[148:149], v224 offset:24576
    v_cvt_pk_bf16_f32 v27, v42, v43
    v_mfma_f32_16x16x32_bf16 a[36:39], v[164:167], v[100:103], a[36:39]
    ds_read_b64_tr_b16 v[150:151], v224 offset:28672
    v_mfma_f32_16x16x32_bf16 a[36:39], v[160:163], v[84:87], a[36:39]
    ds_read_b64_tr_b16 v[152:153], v225 offset:16384
    v_mfma_f32_16x16x32_bf16 a[40:43], v[160:163], v[88:91], a[40:43]
    ds_read_b64_tr_b16 v[154:155], v225 offset:20480
    v_mfma_f32_16x16x32_bf16 a[40:43], v[164:167], v[104:107], a[40:43]
    v_exp_f32 v28, v28
    v_mfma_f32_16x16x32_bf16 a[44:47], v[164:167], v[108:111], a[44:47]
    v_exp_f32 v29, v29
    v_mfma_f32_16x16x32_bf16 a[44:47], v[160:163], v[92:95], a[44:47]
    s_waitcnt lgkmcnt(6)
    ds_read_b64_tr_b16 v[156:157], v225 offset:24576
    v_cvt_pk_bf16_f32 v28, v28, v29
    v_mfma_f32_16x16x32_bf16 a[60:63], v[168:171], v[92:95], a[60:63]
    v_exp_f32 v30, v30
    v_mfma_f32_16x16x32_bf16 a[60:63], v[172:175], v[108:111], a[60:63]
    v_exp_f32 v31, v31
    v_mfma_f32_16x16x32_bf16 a[56:59], v[172:175], v[104:107], a[56:59]
    ds_read_b64_tr_b16 v[158:159], v225 offset:28672
    v_cvt_pk_bf16_f32 v29, v30, v31
    v_mfma_f32_16x16x32_bf16 a[56:59], v[168:171], v[88:91], a[56:59]
    ds_read_b64_tr_b16 v[160:161], v226 offset:16384
    v_mfma_f32_16x16x32_bf16 a[52:55], v[168:171], v[84:87], a[52:55]
    v_exp_f32 v44, v44
    v_mfma_f32_16x16x32_bf16 a[52:55], v[172:175], v[100:103], a[52:55]
    v_exp_f32 v45, v45
    v_mfma_f32_16x16x32_bf16 a[48:51], v[172:175], v[96:99], a[48:51]
    buffer_load_dwordx4 v241, s[16:19], s55 offen offset:3072 lds
    v_mfma_f32_16x16x32_bf16 a[48:51], v[168:171], v[80:83], a[48:51]
    s_waitcnt lgkmcnt(5)
    ds_read_b64_tr_b16 v[162:163], v226 offset:20480
    v_cvt_pk_bf16_f32 v30, v44, v45
    v_mfma_f32_16x16x32_bf16 a[64:67], v[144:147], v[80:83], a[64:67]
    v_exp_f32 v46, v46
    v_mfma_f32_16x16x32_bf16 a[64:67], v[148:151], v[96:99], a[64:67]
    v_exp_f32 v47, v47
    v_mfma_f32_16x16x32_bf16 a[68:71], v[148:151], v[100:103], a[68:71]
    ds_read_b64_tr_b16 v[164:165], v226 offset:24576
    v_cvt_pk_bf16_f32 v31, v46, v47
    v_mfma_f32_16x16x32_bf16 a[68:71], v[144:147], v[84:87], a[68:71]
    ds_read_b64_tr_b16 v[166:167], v226 offset:28672
    v_mfma_f32_16x16x32_bf16 a[72:75], v[144:147], v[88:91], a[72:75]
    buffer_load_dword v198, off, s[96:99], s61 sc1
    v_mfma_f32_16x16x32_bf16 a[72:75], v[148:151], v[104:107], a[72:75]
    s_waitcnt vmcnt(10)
    v_mfma_f32_16x16x32_bf16 a[76:79], v[148:151], v[108:111], a[76:79]
    s_barrier
    v_exp_f32 v48, v48
    v_mfma_f32_16x16x32_bf16 a[76:79], v[144:147], v[92:95], a[76:79]
    s_waitcnt lgkmcnt(4)
    v_exp_f32 v49, v49
    v_mfma_f32_16x16x32_bf16 a[92:95], v[152:155], v[92:95], a[92:95]
    ds_read_b64_tr_b16 v[168:169], v227 offset:16384
    v_cvt_pk_bf16_f32 v48, v48, v49
    v_mfma_f32_16x16x32_bf16 a[92:95], v[156:159], v[108:111], a[92:95]
    v_exp_f32 v50, v50
    v_mfma_f32_16x16x32_bf16 a[88:91], v[156:159], v[104:107], a[88:91]
    v_exp_f32 v51, v51
    v_mfma_f32_16x16x32_bf16 a[88:91], v[152:155], v[88:91], a[88:91]
    ds_read_b64_tr_b16 v[170:171], v227 offset:20480
    v_cvt_pk_bf16_f32 v49, v50, v51
    v_mfma_f32_16x16x32_bf16 a[84:87], v[152:155], v[84:87], a[84:87]
    s_add_u32 s54, s54, 16384
    ds_read_b64_tr_b16 v[172:173], v227 offset:24576
    v_mfma_f32_16x16x32_bf16 a[84:87], v[156:159], v[100:103], a[84:87]
    s_add_u32 m0, s53, 98304
    v_exp_f32 v64, v64
    v_mfma_f32_16x16x32_bf16 a[80:83], v[156:159], v[96:99], a[80:83]
    s_waitcnt lgkmcnt(3)
    v_exp_f32 v65, v65
    v_mfma_f32_16x16x32_bf16 a[80:83], v[152:155], v[80:83], a[80:83]
    buffer_load_dwordx4 v236, s[12:15], s54 offen offset:0 lds
    v_mfma_f32_16x16x32_bf16 a[96:99], v[160:163], v[80:83], a[96:99]
    ds_read_b64_tr_b16 v[174:175], v227 offset:28672
    v_cvt_pk_bf16_f32 v50, v64, v65
    v_mfma_f32_16x16x32_bf16 a[96:99], v[164:167], v[96:99], a[96:99]
    v_exp_f32 v66, v66
    v_mfma_f32_16x16x32_bf16 a[100:103], v[164:167], v[100:103], a[100:103]
    v_exp_f32 v67, v67
    v_mfma_f32_16x16x32_bf16 a[100:103], v[160:163], v[84:87], a[100:103]
    ds_read_b128 v[112:115], v212 offset:32768
    v_cvt_pk_bf16_f32 v51, v66, v67
    v_mfma_f32_16x16x32_bf16 a[104:107], v[160:163], v[88:91], a[104:107]
    ds_read_b128 v[116:119], v213 offset:32768
    v_mfma_f32_16x16x32_bf16 a[104:107], v[164:167], v[104:107], a[104:107]
    v_mfma_f32_16x16x32_bf16 a[108:111], v[164:167], v[108:111], a[108:111]
    v_mfma_f32_16x16x32_bf16 a[108:111], v[160:163], v[92:95], a[108:111]
    s_waitcnt lgkmcnt(2)
    v_exp_f32 v52, v52
    v_mfma_f32_16x16x32_bf16 a[124:127], v[168:171], v[92:95], a[124:127]
    v_exp_f32 v53, v53
    v_mfma_f32_16x16x32_bf16 a[124:127], v[172:175], v[108:111], a[124:127]
    ds_read_b128 v[120:123], v214 offset:32768
    v_cvt_pk_bf16_f32 v52, v52, v53
    v_mfma_f32_16x16x32_bf16 a[120:123], v[172:175], v[104:107], a[120:123]
    v_exp_f32 v54, v54
    v_mfma_f32_16x16x32_bf16 a[120:123], v[168:171], v[88:91], a[120:123]
    v_exp_f32 v55, v55
    v_mfma_f32_16x16x32_bf16 a[116:119], v[168:171], v[84:87], a[116:119]
    ds_read_b128 v[124:127], v215 offset:32768
    v_cvt_pk_bf16_f32 v53, v54, v55
    v_mfma_f32_16x16x32_bf16 a[116:119], v[172:175], v[100:103], a[116:119]
    ds_read_b128 v[128:131], v212 offset:36864
    v_mfma_f32_16x16x32_bf16 a[112:115], v[172:175], v[96:99], a[112:115]
    v_exp_f32 v68, v68
    v_mfma_f32_16x16x32_bf16 a[112:115], v[168:171], v[80:83], a[112:115]
    v_exp_f32 v69, v69
    v_mfma_f32_16x16x32_bf16 a[128:131], v[208:211], v[80:83], a[128:131]
    buffer_load_dwordx4 v237, s[12:15], s54 offen offset:1024 lds
    v_mfma_f32_16x16x32_bf16 a[128:131], v[208:211], v[96:99], a[128:131]
    ds_read_b128 v[132:135], v213 offset:36864
    v_cvt_pk_bf16_f32 v54, v68, v69
    v_mfma_f32_16x16x32_bf16 a[132:135], v[208:211], v[100:103], a[132:135]
    v_exp_f32 v70, v70
    v_mfma_f32_16x16x32_bf16 a[132:135], v[208:211], v[84:87], a[132:135]
    v_exp_f32 v71, v71
    v_mfma_f32_16x16x32_bf16 a[136:139], v[208:211], v[88:91], a[136:139]
    v_cvt_pk_bf16_f32 v55, v70, v71
    v_mfma_f32_16x16x32_bf16 a[136:139], v[208:211], v[104:107], a[136:139]
    v_mfma_f32_16x16x32_bf16 a[140:143], v[208:211], v[108:111], a[140:143]
    v_mfma_f32_16x16x32_bf16 a[140:143], v[208:211], v[92:95], a[140:143]
    s_waitcnt lgkmcnt(2)
    v_mfma_f32_16x16x32_bf16 v[80:83], v[112:115], a[144:147], v[176:179]
    v_exp_f32 v56, v56
    v_mfma_f32_16x16x32_bf16 v[80:83], v[116:119], a[148:151], v[80:83]
    v_exp_f32 v57, v57
    v_mfma_f32_16x16x32_bf16 v[80:83], v[120:123], a[152:155], v[80:83]
    ds_read_b128 v[136:139], v214 offset:36864
    v_cvt_pk_bf16_f32 v56, v56, v57
    v_mfma_f32_16x16x32_bf16 v[80:83], v[124:127], a[156:159], v[80:83]
    v_exp_f32 v58, v58
    v_mfma_f32_16x16x32_bf16 v[84:87], v[124:127], a[172:175], v[180:183]
    v_exp_f32 v59, v59
    v_mfma_f32_16x16x32_bf16 v[84:87], v[120:123], a[168:171], v[84:87]
    ds_read_b128 v[140:143], v215 offset:36864
    v_cvt_pk_bf16_f32 v57, v58, v59
    v_mfma_f32_16x16x32_bf16 v[84:87], v[116:119], a[164:167], v[84:87]
    ds_read_b64_tr_b16 v[144:145], v220 offset:49152
    v_mfma_f32_16x16x32_bf16 v[84:87], v[112:115], a[160:163], v[84:87]
    v_exp_f32 v72, v72
    v_mfma_f32_16x16x32_bf16 v[88:91], v[112:115], a[176:179], v[184:187]
    v_exp_f32 v73, v73
    v_mfma_f32_16x16x32_bf16 v[88:91], v[116:119], a[180:183], v[88:91]
    buffer_load_dwordx4 v238, s[12:15], s54 offen offset:2048 lds
    v_mfma_f32_16x16x32_bf16 v[88:91], v[120:123], a[184:187], v[88:91]
    ds_read_b64_tr_b16 v[146:147], v220 offset:53248
    v_cvt_pk_bf16_f32 v58, v72, v73
    v_mfma_f32_16x16x32_bf16 v[88:91], v[124:127], a[188:191], v[88:91]
    v_exp_f32 v74, v74
    v_mfma_f32_16x16x32_bf16 v[92:95], v[124:127], a[204:207], v[188:191]
    v_exp_f32 v75, v75
    v_mfma_f32_16x16x32_bf16 v[92:95], v[120:123], a[200:203], v[92:95]
    ds_read_b64_tr_b16 v[148:149], v220 offset:57344
    v_cvt_pk_bf16_f32 v59, v74, v75
    v_mfma_f32_16x16x32_bf16 v[92:95], v[116:119], a[196:199], v[92:95]
    ds_read_b64_tr_b16 v[150:151], v220 offset:61440
    v_mfma_f32_16x16x32_bf16 v[92:95], v[112:115], a[192:195], v[92:95]
    s_waitcnt lgkmcnt(6)
    v_mfma_f32_16x16x32_bf16 v[96:99], v[128:131], a[144:147], v[176:179]
    v_mfma_f32_16x16x32_bf16 v[96:99], v[132:135], a[148:151], v[96:99]
    s_waitcnt lgkmcnt(5)
    v_exp_f32 v60, v60
    v_mfma_f32_16x16x32_bf16 v[96:99], v[136:139], a[152:155], v[96:99]
    s_waitcnt lgkmcnt(4)
    v_exp_f32 v61, v61
    v_mfma_f32_16x16x32_bf16 v[96:99], v[140:143], a[156:159], v[96:99]
    ds_read_b128 v[112:115], v212 offset:40960
    v_cvt_pk_bf16_f32 v60, v60, v61
    v_mfma_f32_16x16x32_bf16 v[100:103], v[140:143], a[172:175], v[180:183]
    v_exp_f32 v62, v62
    v_mfma_f32_16x16x32_bf16 v[100:103], v[136:139], a[168:171], v[100:103]
    v_exp_f32 v63, v63
    v_mfma_f32_16x16x32_bf16 v[100:103], v[132:135], a[164:167], v[100:103]
    ds_read_b128 v[116:119], v213 offset:40960
    v_cvt_pk_bf16_f32 v61, v62, v63
    v_mfma_f32_16x16x32_bf16 v[100:103], v[128:131], a[160:163], v[100:103]
    ds_read_b128 v[120:123], v214 offset:40960
    v_mfma_f32_16x16x32_bf16 v[104:107], v[128:131], a[176:179], v[184:187]
    v_exp_f32 v76, v76
    v_mfma_f32_16x16x32_bf16 v[104:107], v[132:135], a[180:183], v[104:107]
    v_exp_f32 v77, v77
    v_mfma_f32_16x16x32_bf16 v[104:107], v[136:139], a[184:187], v[104:107]
    buffer_load_dwordx4 v239, s[12:15], s54 offen offset:3072 lds
    v_mfma_f32_16x16x32_bf16 v[104:107], v[140:143], a[188:191], v[104:107]
    ds_read_b128 v[124:127], v215 offset:40960
    v_cvt_pk_bf16_f32 v62, v76, v77
    v_mfma_f32_16x16x32_bf16 v[108:111], v[140:143], a[204:207], v[188:191]
    v_exp_f32 v78, v78
    v_mfma_f32_16x16x32_bf16 v[108:111], v[136:139], a[200:203], v[108:111]
    v_exp_f32 v79, v79
    v_mfma_f32_16x16x32_bf16 v[108:111], v[132:135], a[196:199], v[108:111]
    ds_read_b64_tr_b16 v[152:153], v221 offset:49152
    v_cvt_pk_bf16_f32 v63, v78, v79
    v_mfma_f32_16x16x32_bf16 v[108:111], v[128:131], a[192:195], v[108:111]
    s_waitcnt lgkmcnt(2)
    ds_read_b64_tr_b16 v[154:155], v221 offset:53248
    v_mfma_f32_16x16x32_bf16 v[64:67], v[112:115], a[144:147], v[176:179]
    v_mfma_f32_16x16x32_bf16 v[64:67], v[116:119], a[148:151], v[64:67]
    v_mfma_f32_16x16x32_bf16 v[64:67], v[120:123], a[152:155], v[64:67]
    s_waitcnt lgkmcnt(2)
    v_exp_f32 v80, v80
    v_mfma_f32_16x16x32_bf16 v[64:67], v[124:127], a[156:159], v[64:67]
    v_exp_f32 v81, v81
    v_mfma_f32_16x16x32_bf16 v[68:71], v[124:127], a[172:175], v[180:183]
    ds_read_b128 v[128:131], v212 offset:45056
    v_cvt_pk_bf16_f32 v80, v80, v81
    v_mfma_f32_16x16x32_bf16 v[68:71], v[120:123], a[168:171], v[68:71]
    v_exp_f32 v82, v82
    v_mfma_f32_16x16x32_bf16 v[68:71], v[116:119], a[164:167], v[68:71]
    v_exp_f32 v83, v83
    v_mfma_f32_16x16x32_bf16 v[68:71], v[112:115], a[160:163], v[68:71]
    ds_read_b128 v[132:135], v213 offset:45056
    v_cvt_pk_bf16_f32 v81, v82, v83
    v_mfma_f32_16x16x32_bf16 v[72:75], v[112:115], a[176:179], v[184:187]
    ds_read_b128 v[136:139], v214 offset:45056
    v_mfma_f32_16x16x32_bf16 v[72:75], v[116:119], a[180:183], v[72:75]
    s_add_u32 s55, s55, 16384
    v_exp_f32 v96, v96
    v_mfma_f32_16x16x32_bf16 v[72:75], v[120:123], a[184:187], v[72:75]
    s_add_u32 m0, s53, 114688
    v_exp_f32 v97, v97
    v_mfma_f32_16x16x32_bf16 v[72:75], v[124:127], a[188:191], v[72:75]
    buffer_load_dwordx4 v240, s[16:19], s55 offen offset:0 lds
    v_mfma_f32_16x16x32_bf16 v[76:79], v[124:127], a[204:207], v[188:191]
    ds_read_b128 v[140:143], v215 offset:45056
    v_cvt_pk_bf16_f32 v82, v96, v97
    v_mfma_f32_16x16x32_bf16 v[76:79], v[120:123], a[200:203], v[76:79]
    v_exp_f32 v98, v98
    v_mfma_f32_16x16x32_bf16 v[76:79], v[116:119], a[196:199], v[76:79]
    v_exp_f32 v99, v99
    v_mfma_f32_16x16x32_bf16 v[76:79], v[112:115], a[192:195], v[76:79]
    s_waitcnt lgkmcnt(1)
    ds_read_b64_tr_b16 v[156:157], v221 offset:57344
    v_cvt_pk_bf16_f32 v83, v98, v99
    v_mfma_f32_16x16x32_bf16 v[32:35], v[128:131], a[144:147], v[176:179]
    ds_read_b64_tr_b16 v[158:159], v221 offset:61440
    v_mfma_f32_16x16x32_bf16 v[32:35], v[132:135], a[148:151], v[32:35]
    v_mfma_f32_16x16x32_bf16 v[32:35], v[136:139], a[152:155], v[32:35]
    s_waitcnt lgkmcnt(2)
    v_mfma_f32_16x16x32_bf16 v[32:35], v[140:143], a[156:159], v[32:35]
    v_exp_f32 v84, v84
    v_mfma_f32_16x16x32_bf16 v[36:39], v[140:143], a[172:175], v[180:183]
    v_exp_f32 v85, v85
    v_mfma_f32_16x16x32_bf16 v[36:39], v[136:139], a[168:171], v[36:39]
    ds_read_b64_tr_b16 v[160:161], v222 offset:49152
    v_cvt_pk_bf16_f32 v84, v84, v85
    v_mfma_f32_16x16x32_bf16 v[36:39], v[132:135], a[164:167], v[36:39]
    v_exp_f32 v86, v86
    v_mfma_f32_16x16x32_bf16 v[36:39], v[128:131], a[160:163], v[36:39]
    v_exp_f32 v87, v87
    v_mfma_f32_16x16x32_bf16 v[40:43], v[128:131], a[176:179], v[184:187]
    ds_read_b64_tr_b16 v[162:163], v222 offset:53248
    v_cvt_pk_bf16_f32 v85, v86, v87
    v_mfma_f32_16x16x32_bf16 v[40:43], v[132:135], a[180:183], v[40:43]
    ds_read_b64_tr_b16 v[164:165], v222 offset:57344
    v_mfma_f32_16x16x32_bf16 v[40:43], v[136:139], a[184:187], v[40:43]
    v_exp_f32 v100, v100
    v_mfma_f32_16x16x32_bf16 v[40:43], v[140:143], a[188:191], v[40:43]
    v_exp_f32 v101, v101
    v_mfma_f32_16x16x32_bf16 v[44:47], v[140:143], a[204:207], v[188:191]
    buffer_load_dwordx4 v241, s[16:19], s55 offen offset:1024 lds
    v_mfma_f32_16x16x32_bf16 v[44:47], v[136:139], a[200:203], v[44:47]
    ds_read_b64_tr_b16 v[166:167], v222 offset:61440
    v_cvt_pk_bf16_f32 v86, v100, v101
    v_mfma_f32_16x16x32_bf16 v[44:47], v[132:135], a[196:199], v[44:47]
    v_exp_f32 v102, v102
    v_mfma_f32_16x16x32_bf16 v[44:47], v[128:131], a[192:195], v[44:47]
    v_exp_f32 v103, v103
    v_mfma_f32_16x16x32_bf16 a[0:3], v[144:147], v[16:19], a[0:3]
    ds_read_b64_tr_b16 v[168:169], v223 offset:49152
    v_cvt_pk_bf16_f32 v87, v102, v103
    v_mfma_f32_16x16x32_bf16 a[0:3], v[148:151], v[48:51], a[0:3]
    ds_read_b64_tr_b16 v[170:171], v223 offset:53248
    v_mfma_f32_16x16x32_bf16 a[4:7], v[148:151], v[52:55], a[4:7]
    v_mfma_f32_16x16x32_bf16 a[4:7], v[144:147], v[20:23], a[4:7]
    v_mfma_f32_16x16x32_bf16 a[8:11], v[144:147], v[24:27], a[8:11]
    v_exp_f32 v88, v88
    v_mfma_f32_16x16x32_bf16 a[8:11], v[148:151], v[56:59], a[8:11]
    v_exp_f32 v89, v89
    v_mfma_f32_16x16x32_bf16 a[12:15], v[148:151], v[60:63], a[12:15]
    ds_read_b64_tr_b16 v[172:173], v223 offset:57344
    v_cvt_pk_bf16_f32 v88, v88, v89
    v_mfma_f32_16x16x32_bf16 a[12:15], v[144:147], v[28:31], a[12:15]
    s_waitcnt lgkmcnt(7)
    v_exp_f32 v90, v90
    v_mfma_f32_16x16x32_bf16 a[28:31], v[152:155], v[28:31], a[28:31]
    v_exp_f32 v91, v91
    v_mfma_f32_16x16x32_bf16 a[28:31], v[156:159], v[60:63], a[28:31]
    ds_read_b64_tr_b16 v[174:175], v223 offset:61440
    v_cvt_pk_bf16_f32 v89, v90, v91
    v_mfma_f32_16x16x32_bf16 a[24:27], v[156:159], v[56:59], a[24:27]
    ds_read_b64_tr_b16 v[144:145], v224 offset:49152
    v_mfma_f32_16x16x32_bf16 a[24:27], v[152:155], v[24:27], a[24:27]
    v_exp_f32 v104, v104
    v_mfma_f32_16x16x32_bf16 a[20:23], v[152:155], v[20:23], a[20:23]
    v_exp_f32 v105, v105
    v_mfma_f32_16x16x32_bf16 a[20:23], v[156:159], v[52:55], a[20:23]
    buffer_load_dwordx4 v240, s[16:19], s55 offen offset:2048 lds
    v_mfma_f32_16x16x32_bf16 a[16:19], v[156:159], v[48:51], a[16:19]
    ds_read_b64_tr_b16 v[146:147], v224 offset:53248
    v_cvt_pk_bf16_f32 v90, v104, v105
    v_mfma_f32_16x16x32_bf16 a[16:19], v[152:155], v[16:19], a[16:19]
    s_waitcnt lgkmcnt(6)
    v_exp_f32 v106, v106
    v_mfma_f32_16x16x32_bf16 a[32:35], v[160:163], v[16:19], a[32:35]
    v_exp_f32 v107, v107
    v_mfma_f32_16x16x32_bf16 a[32:35], v[164:167], v[48:51], a[32:35]
    ds_read_b64_tr_b16 v[148:149], v224 offset:57344
    v_cvt_pk_bf16_f32 v91, v106, v107
    v_mfma_f32_16x16x32_bf16 a[36:39], v[164:167], v[52:55], a[36:39]
    ds_read_b64_tr_b16 v[150:151], v224 offset:61440
    v_mfma_f32_16x16x32_bf16 a[36:39], v[160:163], v[20:23], a[36:39]
    ds_read_b64_tr_b16 v[152:153], v225 offset:49152
    v_mfma_f32_16x16x32_bf16 a[40:43], v[160:163], v[24:27], a[40:43]
    ds_read_b64_tr_b16 v[154:155], v225 offset:53248
    v_mfma_f32_16x16x32_bf16 a[40:43], v[164:167], v[56:59], a[40:43]
    v_exp_f32 v92, v92
    v_mfma_f32_16x16x32_bf16 a[44:47], v[164:167], v[60:63], a[44:47]
    v_exp_f32 v93, v93
    v_mfma_f32_16x16x32_bf16 a[44:47], v[160:163], v[28:31], a[44:47]
    s_waitcnt lgkmcnt(6)
    ds_read_b64_tr_b16 v[156:157], v225 offset:57344
    v_cvt_pk_bf16_f32 v92, v92, v93
    v_mfma_f32_16x16x32_bf16 a[60:63], v[168:171], v[28:31], a[60:63]
    v_exp_f32 v94, v94
    v_mfma_f32_16x16x32_bf16 a[60:63], v[172:175], v[60:63], a[60:63]
    v_exp_f32 v95, v95
    v_mfma_f32_16x16x32_bf16 a[56:59], v[172:175], v[56:59], a[56:59]
    ds_read_b64_tr_b16 v[158:159], v225 offset:61440
    v_cvt_pk_bf16_f32 v93, v94, v95
    v_mfma_f32_16x16x32_bf16 a[56:59], v[168:171], v[24:27], a[56:59]
    ds_read_b64_tr_b16 v[160:161], v226 offset:49152
    v_mfma_f32_16x16x32_bf16 a[52:55], v[168:171], v[20:23], a[52:55]
    v_exp_f32 v108, v108
    v_mfma_f32_16x16x32_bf16 a[52:55], v[172:175], v[52:55], a[52:55]
    v_exp_f32 v109, v109
    v_mfma_f32_16x16x32_bf16 a[48:51], v[172:175], v[48:51], a[48:51]
    buffer_load_dwordx4 v241, s[16:19], s55 offen offset:3072 lds
    v_mfma_f32_16x16x32_bf16 a[48:51], v[168:171], v[16:19], a[48:51]
    s_waitcnt lgkmcnt(5)
    ds_read_b64_tr_b16 v[162:163], v226 offset:53248
    v_cvt_pk_bf16_f32 v94, v108, v109
    v_mfma_f32_16x16x32_bf16 a[64:67], v[144:147], v[16:19], a[64:67]
    v_exp_f32 v110, v110
    v_mfma_f32_16x16x32_bf16 a[64:67], v[148:151], v[48:51], a[64:67]
    v_exp_f32 v111, v111
    v_mfma_f32_16x16x32_bf16 a[68:71], v[148:151], v[52:55], a[68:71]
    ds_read_b64_tr_b16 v[164:165], v226 offset:57344
    v_cvt_pk_bf16_f32 v95, v110, v111
    v_mfma_f32_16x16x32_bf16 a[68:71], v[144:147], v[20:23], a[68:71]
    ds_read_b64_tr_b16 v[166:167], v226 offset:61440
    v_mfma_f32_16x16x32_bf16 a[72:75], v[144:147], v[24:27], a[72:75]
    v_mfma_f32_16x16x32_bf16 a[72:75], v[148:151], v[56:59], a[72:75]
    s_waitcnt vmcnt(9)
    v_mfma_f32_16x16x32_bf16 a[76:79], v[148:151], v[60:63], a[76:79]
    s_barrier
    v_exp_f32 v64, v64
    v_mfma_f32_16x16x32_bf16 a[76:79], v[144:147], v[28:31], a[76:79]
    s_waitcnt lgkmcnt(4)
    v_exp_f32 v65, v65
    v_mfma_f32_16x16x32_bf16 a[92:95], v[152:155], v[28:31], a[92:95]
    ds_read_b64_tr_b16 v[168:169], v227 offset:49152
    v_cvt_pk_bf16_f32 v64, v64, v65
    v_mfma_f32_16x16x32_bf16 a[92:95], v[156:159], v[60:63], a[92:95]
    v_exp_f32 v66, v66
    v_mfma_f32_16x16x32_bf16 a[88:91], v[156:159], v[56:59], a[88:91]
    v_exp_f32 v67, v67
    v_mfma_f32_16x16x32_bf16 a[88:91], v[152:155], v[24:27], a[88:91]
    ds_read_b64_tr_b16 v[170:171], v227 offset:53248
    v_cvt_pk_bf16_f32 v65, v66, v67
    v_mfma_f32_16x16x32_bf16 a[84:87], v[152:155], v[20:23], a[84:87]
    s_add_u32 s54, s54, 16384
    ds_read_b64_tr_b16 v[172:173], v227 offset:57344
    v_mfma_f32_16x16x32_bf16 a[84:87], v[156:159], v[52:55], a[84:87]
    s_add_u32 m0, s53, 0
    v_exp_f32 v32, v32
    v_mfma_f32_16x16x32_bf16 a[80:83], v[156:159], v[48:51], a[80:83]
    s_waitcnt lgkmcnt(3)
    v_exp_f32 v33, v33
    v_mfma_f32_16x16x32_bf16 a[80:83], v[152:155], v[16:19], a[80:83]
    buffer_load_dwordx4 v236, s[12:15], s54 offen offset:0 lds
    v_mfma_f32_16x16x32_bf16 a[96:99], v[160:163], v[16:19], a[96:99]
    ds_read_b64_tr_b16 v[174:175], v227 offset:61440
    v_cvt_pk_bf16_f32 v66, v32, v33
    v_mfma_f32_16x16x32_bf16 a[96:99], v[164:167], v[48:51], a[96:99]
    v_exp_f32 v34, v34
    v_mfma_f32_16x16x32_bf16 a[100:103], v[164:167], v[52:55], a[100:103]
    v_exp_f32 v35, v35
    v_mfma_f32_16x16x32_bf16 a[100:103], v[160:163], v[20:23], a[100:103]
    ds_read_b128 v[112:115], v216 offset:0
    v_cvt_pk_bf16_f32 v67, v34, v35
    v_mfma_f32_16x16x32_bf16 a[104:107], v[160:163], v[24:27], a[104:107]
    ds_read_b128 v[116:119], v217 offset:0
    v_mfma_f32_16x16x32_bf16 a[104:107], v[164:167], v[56:59], a[104:107]
    v_mfma_f32_16x16x32_bf16 a[108:111], v[164:167], v[60:63], a[108:111]
    v_mfma_f32_16x16x32_bf16 a[108:111], v[160:163], v[28:31], a[108:111]
    s_waitcnt lgkmcnt(2)
    v_exp_f32 v68, v68
    v_mfma_f32_16x16x32_bf16 a[124:127], v[168:171], v[28:31], a[124:127]
    v_exp_f32 v69, v69
    v_mfma_f32_16x16x32_bf16 a[124:127], v[172:175], v[60:63], a[124:127]
    ds_read_b128 v[120:123], v218 offset:0
    v_cvt_pk_bf16_f32 v68, v68, v69
    v_mfma_f32_16x16x32_bf16 a[120:123], v[172:175], v[56:59], a[120:123]
    v_exp_f32 v70, v70
    v_mfma_f32_16x16x32_bf16 a[120:123], v[168:171], v[24:27], a[120:123]
    v_exp_f32 v71, v71
    v_mfma_f32_16x16x32_bf16 a[116:119], v[168:171], v[20:23], a[116:119]
    ds_read_b128 v[124:127], v219 offset:0
    v_cvt_pk_bf16_f32 v69, v70, v71
    v_mfma_f32_16x16x32_bf16 a[116:119], v[172:175], v[52:55], a[116:119]
    ds_read_b128 v[128:131], v216 offset:4096
    v_mfma_f32_16x16x32_bf16 a[112:115], v[172:175], v[48:51], a[112:115]
    v_exp_f32 v36, v36
    v_mfma_f32_16x16x32_bf16 a[112:115], v[168:171], v[16:19], a[112:115]
    v_exp_f32 v37, v37
    v_mfma_f32_16x16x32_bf16 a[128:131], v[208:211], v[16:19], a[128:131]
    buffer_load_dwordx4 v237, s[12:15], s54 offen offset:1024 lds
    v_mfma_f32_16x16x32_bf16 a[128:131], v[208:211], v[48:51], a[128:131]
    ds_read_b128 v[132:135], v217 offset:4096
    v_cvt_pk_bf16_f32 v70, v36, v37
    v_mfma_f32_16x16x32_bf16 a[132:135], v[208:211], v[52:55], a[132:135]
    v_exp_f32 v38, v38
    v_mfma_f32_16x16x32_bf16 a[132:135], v[208:211], v[20:23], a[132:135]
    v_exp_f32 v39, v39
    v_mfma_f32_16x16x32_bf16 a[136:139], v[208:211], v[24:27], a[136:139]
    v_cvt_pk_bf16_f32 v71, v38, v39
    v_mfma_f32_16x16x32_bf16 a[136:139], v[208:211], v[56:59], a[136:139]
    v_mfma_f32_16x16x32_bf16 a[140:143], v[208:211], v[60:63], a[140:143]
    v_mfma_f32_16x16x32_bf16 a[140:143], v[208:211], v[28:31], a[140:143]
    s_waitcnt lgkmcnt(2)
    v_mfma_f32_16x16x32_bf16 v[16:19], v[112:115], a[144:147], v[176:179]
    v_exp_f32 v72, v72
    v_mfma_f32_16x16x32_bf16 v[16:19], v[116:119], a[148:151], v[16:19]
    v_exp_f32 v73, v73
    v_mfma_f32_16x16x32_bf16 v[16:19], v[120:123], a[152:155], v[16:19]
    ds_read_b128 v[136:139], v218 offset:4096
    v_cvt_pk_bf16_f32 v72, v72, v73
    v_mfma_f32_16x16x32_bf16 v[16:19], v[124:127], a[156:159], v[16:19]
    v_exp_f32 v74, v74
    v_mfma_f32_16x16x32_bf16 v[20:23], v[124:127], a[172:175], v[180:183]
    v_exp_f32 v75, v75
    v_mfma_f32_16x16x32_bf16 v[20:23], v[120:123], a[168:171], v[20:23]
    ds_read_b128 v[140:143], v219 offset:4096
    v_cvt_pk_bf16_f32 v73, v74, v75
    v_mfma_f32_16x16x32_bf16 v[20:23], v[116:119], a[164:167], v[20:23]
    ds_read_b64_tr_b16 v[144:145], v228 offset:16384
    v_mfma_f32_16x16x32_bf16 v[20:23], v[112:115], a[160:163], v[20:23]
    v_exp_f32 v40, v40
    v_mfma_f32_16x16x32_bf16 v[24:27], v[112:115], a[176:179], v[184:187]
    v_exp_f32 v41, v41
    v_mfma_f32_16x16x32_bf16 v[24:27], v[116:119], a[180:183], v[24:27]
    buffer_load_dwordx4 v238, s[12:15], s54 offen offset:2048 lds
    v_mfma_f32_16x16x32_bf16 v[24:27], v[120:123], a[184:187], v[24:27]
    ds_read_b64_tr_b16 v[146:147], v228 offset:20480
    v_cvt_pk_bf16_f32 v74, v40, v41
    v_mfma_f32_16x16x32_bf16 v[24:27], v[124:127], a[188:191], v[24:27]
    v_exp_f32 v42, v42
    v_mfma_f32_16x16x32_bf16 v[28:31], v[124:127], a[204:207], v[188:191]
    v_exp_f32 v43, v43
    v_mfma_f32_16x16x32_bf16 v[28:31], v[120:123], a[200:203], v[28:31]
    ds_read_b64_tr_b16 v[148:149], v228 offset:24576
    v_cvt_pk_bf16_f32 v75, v42, v43
    v_mfma_f32_16x16x32_bf16 v[28:31], v[116:119], a[196:199], v[28:31]
    ds_read_b64_tr_b16 v[150:151], v228 offset:28672
    v_mfma_f32_16x16x32_bf16 v[28:31], v[112:115], a[192:195], v[28:31]
    s_waitcnt lgkmcnt(6)
    v_mfma_f32_16x16x32_bf16 v[48:51], v[128:131], a[144:147], v[176:179]
    v_mfma_f32_16x16x32_bf16 v[48:51], v[132:135], a[148:151], v[48:51]
    s_waitcnt lgkmcnt(5)
    v_exp_f32 v76, v76
    v_mfma_f32_16x16x32_bf16 v[48:51], v[136:139], a[152:155], v[48:51]
    s_waitcnt lgkmcnt(4)
    v_exp_f32 v77, v77
    v_mfma_f32_16x16x32_bf16 v[48:51], v[140:143], a[156:159], v[48:51]
    ds_read_b128 v[112:115], v216 offset:8192
    v_cvt_pk_bf16_f32 v76, v76, v77
    v_mfma_f32_16x16x32_bf16 v[52:55], v[140:143], a[172:175], v[180:183]
    v_exp_f32 v78, v78
    v_mfma_f32_16x16x32_bf16 v[52:55], v[136:139], a[168:171], v[52:55]
    v_exp_f32 v79, v79
    v_mfma_f32_16x16x32_bf16 v[52:55], v[132:135], a[164:167], v[52:55]
    ds_read_b128 v[116:119], v217 offset:8192
    v_cvt_pk_bf16_f32 v77, v78, v79
    v_mfma_f32_16x16x32_bf16 v[52:55], v[128:131], a[160:163], v[52:55]
    ds_read_b128 v[120:123], v218 offset:8192
    v_mfma_f32_16x16x32_bf16 v[56:59], v[128:131], a[176:179], v[184:187]
    v_exp_f32 v44, v44
    v_mfma_f32_16x16x32_bf16 v[56:59], v[132:135], a[180:183], v[56:59]
    v_exp_f32 v45, v45
    v_mfma_f32_16x16x32_bf16 v[56:59], v[136:139], a[184:187], v[56:59]
    buffer_load_dwordx4 v239, s[12:15], s54 offen offset:3072 lds
    v_mfma_f32_16x16x32_bf16 v[56:59], v[140:143], a[188:191], v[56:59]
    ds_read_b128 v[124:127], v219 offset:8192
    v_cvt_pk_bf16_f32 v78, v44, v45
    v_mfma_f32_16x16x32_bf16 v[60:63], v[140:143], a[204:207], v[188:191]
    v_exp_f32 v46, v46
    v_mfma_f32_16x16x32_bf16 v[60:63], v[136:139], a[200:203], v[60:63]
    v_exp_f32 v47, v47
    v_mfma_f32_16x16x32_bf16 v[60:63], v[132:135], a[196:199], v[60:63]
    ds_read_b64_tr_b16 v[152:153], v229 offset:16384
    v_cvt_pk_bf16_f32 v79, v46, v47
    v_mfma_f32_16x16x32_bf16 v[60:63], v[128:131], a[192:195], v[60:63]
    s_waitcnt lgkmcnt(2)
    ds_read_b64_tr_b16 v[154:155], v229 offset:20480
    v_mfma_f32_16x16x32_bf16 v[32:35], v[112:115], a[144:147], v[176:179]
    v_mfma_f32_16x16x32_bf16 v[32:35], v[116:119], a[148:151], v[32:35]
    v_mfma_f32_16x16x32_bf16 v[32:35], v[120:123], a[152:155], v[32:35]
    s_waitcnt lgkmcnt(2)
    v_exp_f32 v16, v16
    v_mfma_f32_16x16x32_bf16 v[32:35], v[124:127], a[156:159], v[32:35]
    v_exp_f32 v17, v17
    v_mfma_f32_16x16x32_bf16 v[36:39], v[124:127], a[172:175], v[180:183]
    ds_read_b128 v[128:131], v216 offset:12288
    v_cvt_pk_bf16_f32 v16, v16, v17
    v_mfma_f32_16x16x32_bf16 v[36:39], v[120:123], a[168:171], v[36:39]
    v_exp_f32 v18, v18
    v_mfma_f32_16x16x32_bf16 v[36:39], v[116:119], a[164:167], v[36:39]
    v_exp_f32 v19, v19
    v_mfma_f32_16x16x32_bf16 v[36:39], v[112:115], a[160:163], v[36:39]
    ds_read_b128 v[132:135], v217 offset:12288
    v_cvt_pk_bf16_f32 v17, v18, v19
    v_mfma_f32_16x16x32_bf16 v[40:43], v[112:115], a[176:179], v[184:187]
    ds_read_b128 v[136:139], v218 offset:12288
    v_mfma_f32_16x16x32_bf16 v[40:43], v[116:119], a[180:183], v[40:43]
    s_add_u32 s55, s55, 16384
    v_exp_f32 v48, v48
    v_mfma_f32_16x16x32_bf16 v[40:43], v[120:123], a[184:187], v[40:43]
    s_add_u32 m0, s53, 16384
    v_exp_f32 v49, v49
    v_mfma_f32_16x16x32_bf16 v[40:43], v[124:127], a[188:191], v[40:43]
    buffer_load_dwordx4 v240, s[16:19], s55 offen offset:0 lds
    v_mfma_f32_16x16x32_bf16 v[44:47], v[124:127], a[204:207], v[188:191]
    ds_read_b128 v[140:143], v219 offset:12288
    v_cvt_pk_bf16_f32 v18, v48, v49
    v_mfma_f32_16x16x32_bf16 v[44:47], v[120:123], a[200:203], v[44:47]
    v_exp_f32 v50, v50
    v_mfma_f32_16x16x32_bf16 v[44:47], v[116:119], a[196:199], v[44:47]
    v_exp_f32 v51, v51
    v_mfma_f32_16x16x32_bf16 v[44:47], v[112:115], a[192:195], v[44:47]
    s_waitcnt lgkmcnt(1)
    ds_read_b64_tr_b16 v[156:157], v229 offset:24576
    v_cvt_pk_bf16_f32 v19, v50, v51
    v_mfma_f32_16x16x32_bf16 v[96:99], v[128:131], a[144:147], v[176:179]
    ds_read_b64_tr_b16 v[158:159], v229 offset:28672
    v_mfma_f32_16x16x32_bf16 v[96:99], v[132:135], a[148:151], v[96:99]
    global_load_dword v202, v[14:15], off
    v_mfma_f32_16x16x32_bf16 v[96:99], v[136:139], a[152:155], v[96:99]
    s_waitcnt lgkmcnt(2)
    v_mfma_f32_16x16x32_bf16 v[96:99], v[140:143], a[156:159], v[96:99]
    v_exp_f32 v20, v20
    v_mfma_f32_16x16x32_bf16 v[100:103], v[140:143], a[172:175], v[180:183]
    v_exp_f32 v21, v21
    v_mfma_f32_16x16x32_bf16 v[100:103], v[136:139], a[168:171], v[100:103]
    ds_read_b64_tr_b16 v[160:161], v230 offset:16384
    v_cvt_pk_bf16_f32 v20, v20, v21
    v_mfma_f32_16x16x32_bf16 v[100:103], v[132:135], a[164:167], v[100:103]
    v_exp_f32 v22, v22
    v_mfma_f32_16x16x32_bf16 v[100:103], v[128:131], a[160:163], v[100:103]
    v_exp_f32 v23, v23
    v_mfma_f32_16x16x32_bf16 v[104:107], v[128:131], a[176:179], v[184:187]
    ds_read_b64_tr_b16 v[162:163], v230 offset:20480
    v_cvt_pk_bf16_f32 v21, v22, v23
    v_mfma_f32_16x16x32_bf16 v[104:107], v[132:135], a[180:183], v[104:107]
    ds_read_b64_tr_b16 v[164:165], v230 offset:24576
    v_mfma_f32_16x16x32_bf16 v[104:107], v[136:139], a[184:187], v[104:107]
    v_exp_f32 v52, v52
    v_mfma_f32_16x16x32_bf16 v[104:107], v[140:143], a[188:191], v[104:107]
    v_exp_f32 v53, v53
    v_mfma_f32_16x16x32_bf16 v[108:111], v[140:143], a[204:207], v[188:191]
    buffer_load_dwordx4 v241, s[16:19], s55 offen offset:1024 lds
    v_mfma_f32_16x16x32_bf16 v[108:111], v[136:139], a[200:203], v[108:111]
    ds_read_b64_tr_b16 v[166:167], v230 offset:28672
    v_cvt_pk_bf16_f32 v22, v52, v53
    v_mfma_f32_16x16x32_bf16 v[108:111], v[132:135], a[196:199], v[108:111]
    v_exp_f32 v54, v54
    v_mfma_f32_16x16x32_bf16 v[108:111], v[128:131], a[192:195], v[108:111]
    v_exp_f32 v55, v55
    v_mfma_f32_16x16x32_bf16 a[0:3], v[144:147], v[80:83], a[0:3]
    ds_read_b64_tr_b16 v[168:169], v231 offset:16384
    v_cvt_pk_bf16_f32 v23, v54, v55
    v_mfma_f32_16x16x32_bf16 a[0:3], v[148:151], v[64:67], a[0:3]
    ds_read_b64_tr_b16 v[170:171], v231 offset:20480
    v_mfma_f32_16x16x32_bf16 a[4:7], v[148:151], v[68:71], a[4:7]
    v_mfma_f32_16x16x32_bf16 a[4:7], v[144:147], v[84:87], a[4:7]
    v_mfma_f32_16x16x32_bf16 a[8:11], v[144:147], v[88:91], a[8:11]
    v_exp_f32 v24, v24
    v_mfma_f32_16x16x32_bf16 a[8:11], v[148:151], v[72:75], a[8:11]
    v_exp_f32 v25, v25
    v_mfma_f32_16x16x32_bf16 a[12:15], v[148:151], v[76:79], a[12:15]
    ds_read_b64_tr_b16 v[172:173], v231 offset:24576
    v_cvt_pk_bf16_f32 v24, v24, v25
    v_mfma_f32_16x16x32_bf16 a[12:15], v[144:147], v[92:95], a[12:15]
    s_waitcnt lgkmcnt(7)
    v_exp_f32 v26, v26
    v_mfma_f32_16x16x32_bf16 a[28:31], v[152:155], v[92:95], a[28:31]
    v_exp_f32 v27, v27
    v_mfma_f32_16x16x32_bf16 a[28:31], v[156:159], v[76:79], a[28:31]
    ds_read_b64_tr_b16 v[174:175], v231 offset:28672
    v_cvt_pk_bf16_f32 v25, v26, v27
    v_mfma_f32_16x16x32_bf16 a[24:27], v[156:159], v[72:75], a[24:27]
    ds_read_b64_tr_b16 v[144:145], v232 offset:16384
    v_mfma_f32_16x16x32_bf16 a[24:27], v[152:155], v[88:91], a[24:27]
    v_exp_f32 v56, v56
    v_mfma_f32_16x16x32_bf16 a[20:23], v[152:155], v[84:87], a[20:23]
    v_exp_f32 v57, v57
    v_mfma_f32_16x16x32_bf16 a[20:23], v[156:159], v[68:71], a[20:23]
    buffer_load_dwordx4 v240, s[16:19], s55 offen offset:2048 lds
    v_mfma_f32_16x16x32_bf16 a[16:19], v[156:159], v[64:67], a[16:19]
    ds_read_b64_tr_b16 v[146:147], v232 offset:20480
    v_cvt_pk_bf16_f32 v26, v56, v57
    v_mfma_f32_16x16x32_bf16 a[16:19], v[152:155], v[80:83], a[16:19]
    s_waitcnt lgkmcnt(6)
    v_exp_f32 v58, v58
    v_mfma_f32_16x16x32_bf16 a[32:35], v[160:163], v[80:83], a[32:35]
    v_exp_f32 v59, v59
    v_mfma_f32_16x16x32_bf16 a[32:35], v[164:167], v[64:67], a[32:35]
    ds_read_b64_tr_b16 v[148:149], v232 offset:24576
    v_cvt_pk_bf16_f32 v27, v58, v59
    v_mfma_f32_16x16x32_bf16 a[36:39], v[164:167], v[68:71], a[36:39]
    ds_read_b64_tr_b16 v[150:151], v232 offset:28672
    v_mfma_f32_16x16x32_bf16 a[36:39], v[160:163], v[84:87], a[36:39]
    ds_read_b64_tr_b16 v[152:153], v233 offset:16384
    v_mfma_f32_16x16x32_bf16 a[40:43], v[160:163], v[88:91], a[40:43]
    ds_read_b64_tr_b16 v[154:155], v233 offset:20480
    v_mfma_f32_16x16x32_bf16 a[40:43], v[164:167], v[72:75], a[40:43]
    v_exp_f32 v28, v28
    v_mfma_f32_16x16x32_bf16 a[44:47], v[164:167], v[76:79], a[44:47]
    v_exp_f32 v29, v29
    v_mfma_f32_16x16x32_bf16 a[44:47], v[160:163], v[92:95], a[44:47]
    s_waitcnt lgkmcnt(6)
    ds_read_b64_tr_b16 v[156:157], v233 offset:24576
    v_cvt_pk_bf16_f32 v28, v28, v29
    v_mfma_f32_16x16x32_bf16 a[60:63], v[168:171], v[92:95], a[60:63]
    v_exp_f32 v30, v30
    v_mfma_f32_16x16x32_bf16 a[60:63], v[172:175], v[76:79], a[60:63]
    v_exp_f32 v31, v31
    v_mfma_f32_16x16x32_bf16 a[56:59], v[172:175], v[72:75], a[56:59]
    ds_read_b64_tr_b16 v[158:159], v233 offset:28672
    v_cvt_pk_bf16_f32 v29, v30, v31
    v_mfma_f32_16x16x32_bf16 a[56:59], v[168:171], v[88:91], a[56:59]
    ds_read_b64_tr_b16 v[160:161], v234 offset:16384
    v_mfma_f32_16x16x32_bf16 a[52:55], v[168:171], v[84:87], a[52:55]
    v_exp_f32 v60, v60
    v_mfma_f32_16x16x32_bf16 a[52:55], v[172:175], v[68:71], a[52:55]
    v_exp_f32 v61, v61
    v_mfma_f32_16x16x32_bf16 a[48:51], v[172:175], v[64:67], a[48:51]
    buffer_load_dwordx4 v241, s[16:19], s55 offen offset:3072 lds
    v_mfma_f32_16x16x32_bf16 a[48:51], v[168:171], v[80:83], a[48:51]
    s_waitcnt lgkmcnt(5)
    ds_read_b64_tr_b16 v[162:163], v234 offset:20480
    v_cvt_pk_bf16_f32 v30, v60, v61
    v_mfma_f32_16x16x32_bf16 a[64:67], v[144:147], v[80:83], a[64:67]
    v_exp_f32 v62, v62
    v_mfma_f32_16x16x32_bf16 a[64:67], v[148:151], v[64:67], a[64:67]
    v_exp_f32 v63, v63
    v_mfma_f32_16x16x32_bf16 a[68:71], v[148:151], v[68:71], a[68:71]
    ds_read_b64_tr_b16 v[164:165], v234 offset:24576
    v_cvt_pk_bf16_f32 v31, v62, v63
    v_mfma_f32_16x16x32_bf16 a[68:71], v[144:147], v[84:87], a[68:71]
    ds_read_b64_tr_b16 v[166:167], v234 offset:28672
    v_mfma_f32_16x16x32_bf16 a[72:75], v[144:147], v[88:91], a[72:75]
    v_mfma_f32_16x16x32_bf16 a[72:75], v[148:151], v[72:75], a[72:75]
    s_waitcnt vmcnt(9)
    v_mfma_f32_16x16x32_bf16 a[76:79], v[148:151], v[76:79], a[76:79]
    s_barrier
    v_exp_f32 v32, v32
    v_mfma_f32_16x16x32_bf16 a[76:79], v[144:147], v[92:95], a[76:79]
    s_waitcnt lgkmcnt(4)
    v_exp_f32 v33, v33
    v_mfma_f32_16x16x32_bf16 a[92:95], v[152:155], v[92:95], a[92:95]
    ds_read_b64_tr_b16 v[168:169], v235 offset:16384
    v_cvt_pk_bf16_f32 v32, v32, v33
    v_mfma_f32_16x16x32_bf16 a[92:95], v[156:159], v[76:79], a[92:95]
    v_exp_f32 v34, v34
    v_mfma_f32_16x16x32_bf16 a[88:91], v[156:159], v[72:75], a[88:91]
    v_exp_f32 v35, v35
    v_mfma_f32_16x16x32_bf16 a[88:91], v[152:155], v[88:91], a[88:91]
    ds_read_b64_tr_b16 v[170:171], v235 offset:20480
    v_cvt_pk_bf16_f32 v33, v34, v35
    v_mfma_f32_16x16x32_bf16 a[84:87], v[152:155], v[84:87], a[84:87]
    s_add_u32 s54, s54, 16384
    ds_read_b64_tr_b16 v[172:173], v235 offset:24576
    v_mfma_f32_16x16x32_bf16 a[84:87], v[156:159], v[68:71], a[84:87]
    s_add_u32 m0, s53, 32768
    v_exp_f32 v96, v96
    v_mfma_f32_16x16x32_bf16 a[80:83], v[156:159], v[64:67], a[80:83]
    s_waitcnt lgkmcnt(3)
    v_exp_f32 v97, v97
    v_mfma_f32_16x16x32_bf16 a[80:83], v[152:155], v[80:83], a[80:83]
    buffer_load_dwordx4 v236, s[12:15], s54 offen offset:0 lds
    v_mfma_f32_16x16x32_bf16 a[96:99], v[160:163], v[80:83], a[96:99]
    ds_read_b64_tr_b16 v[174:175], v235 offset:28672
    v_cvt_pk_bf16_f32 v34, v96, v97
    v_mfma_f32_16x16x32_bf16 a[96:99], v[164:167], v[64:67], a[96:99]
    v_exp_f32 v98, v98
    v_mfma_f32_16x16x32_bf16 a[100:103], v[164:167], v[68:71], a[100:103]
    v_exp_f32 v99, v99
    v_mfma_f32_16x16x32_bf16 a[100:103], v[160:163], v[84:87], a[100:103]
    ds_read_b128 v[112:115], v216 offset:32768
    v_cvt_pk_bf16_f32 v35, v98, v99
    v_mfma_f32_16x16x32_bf16 a[104:107], v[160:163], v[88:91], a[104:107]
    ds_read_b128 v[116:119], v217 offset:32768
    v_mfma_f32_16x16x32_bf16 a[104:107], v[164:167], v[72:75], a[104:107]
    v_mfma_f32_16x16x32_bf16 a[108:111], v[164:167], v[76:79], a[108:111]
    v_mfma_f32_16x16x32_bf16 a[108:111], v[160:163], v[92:95], a[108:111]
    s_waitcnt lgkmcnt(2)
    v_exp_f32 v36, v36
    v_mfma_f32_16x16x32_bf16 a[124:127], v[168:171], v[92:95], a[124:127]
    v_exp_f32 v37, v37
    v_mfma_f32_16x16x32_bf16 a[124:127], v[172:175], v[76:79], a[124:127]
    ds_read_b128 v[120:123], v218 offset:32768
    v_cvt_pk_bf16_f32 v36, v36, v37
    v_mfma_f32_16x16x32_bf16 a[120:123], v[172:175], v[72:75], a[120:123]
    v_exp_f32 v38, v38
    v_mfma_f32_16x16x32_bf16 a[120:123], v[168:171], v[88:91], a[120:123]
    v_exp_f32 v39, v39
    v_mfma_f32_16x16x32_bf16 a[116:119], v[168:171], v[84:87], a[116:119]
    ds_read_b128 v[124:127], v219 offset:32768
    v_cvt_pk_bf16_f32 v37, v38, v39
    v_mfma_f32_16x16x32_bf16 a[116:119], v[172:175], v[68:71], a[116:119]
    ds_read_b128 v[128:131], v216 offset:36864
    v_mfma_f32_16x16x32_bf16 a[112:115], v[172:175], v[64:67], a[112:115]
    v_exp_f32 v100, v100
    v_mfma_f32_16x16x32_bf16 a[112:115], v[168:171], v[80:83], a[112:115]
    v_exp_f32 v101, v101
    v_mfma_f32_16x16x32_bf16 a[128:131], v[208:211], v[80:83], a[128:131]
    buffer_load_dwordx4 v237, s[12:15], s54 offen offset:1024 lds
    v_mfma_f32_16x16x32_bf16 a[128:131], v[208:211], v[64:67], a[128:131]
    ds_read_b128 v[132:135], v217 offset:36864
    v_cvt_pk_bf16_f32 v38, v100, v101
    v_mfma_f32_16x16x32_bf16 a[132:135], v[208:211], v[68:71], a[132:135]
    v_exp_f32 v102, v102
    v_mfma_f32_16x16x32_bf16 a[132:135], v[208:211], v[84:87], a[132:135]
    v_exp_f32 v103, v103
    v_mfma_f32_16x16x32_bf16 a[136:139], v[208:211], v[88:91], a[136:139]
    v_cvt_pk_bf16_f32 v39, v102, v103
    v_mfma_f32_16x16x32_bf16 a[136:139], v[208:211], v[72:75], a[136:139]
    v_mfma_f32_16x16x32_bf16 a[140:143], v[208:211], v[76:79], a[140:143]
    v_mfma_f32_16x16x32_bf16 a[140:143], v[208:211], v[92:95], a[140:143]
    s_waitcnt lgkmcnt(2)
    v_mfma_f32_16x16x32_bf16 v[80:83], v[112:115], a[144:147], v[176:179]
    v_exp_f32 v40, v40
    v_mfma_f32_16x16x32_bf16 v[80:83], v[116:119], a[148:151], v[80:83]
    v_exp_f32 v41, v41
    v_mfma_f32_16x16x32_bf16 v[80:83], v[120:123], a[152:155], v[80:83]
    ds_read_b128 v[136:139], v218 offset:36864
    v_cvt_pk_bf16_f32 v40, v40, v41
    v_mfma_f32_16x16x32_bf16 v[80:83], v[124:127], a[156:159], v[80:83]
    v_exp_f32 v42, v42
    v_mfma_f32_16x16x32_bf16 v[84:87], v[124:127], a[172:175], v[180:183]
    v_exp_f32 v43, v43
    v_mfma_f32_16x16x32_bf16 v[84:87], v[120:123], a[168:171], v[84:87]
    ds_read_b128 v[140:143], v219 offset:36864
    v_cvt_pk_bf16_f32 v41, v42, v43
    v_mfma_f32_16x16x32_bf16 v[84:87], v[116:119], a[164:167], v[84:87]
    ds_read_b64_tr_b16 v[144:145], v228 offset:49152
    v_mfma_f32_16x16x32_bf16 v[84:87], v[112:115], a[160:163], v[84:87]
    v_exp_f32 v104, v104
    v_mfma_f32_16x16x32_bf16 v[88:91], v[112:115], a[176:179], v[184:187]
    v_exp_f32 v105, v105
    v_mfma_f32_16x16x32_bf16 v[88:91], v[116:119], a[180:183], v[88:91]
    buffer_load_dwordx4 v238, s[12:15], s54 offen offset:2048 lds
    v_mfma_f32_16x16x32_bf16 v[88:91], v[120:123], a[184:187], v[88:91]
    ds_read_b64_tr_b16 v[146:147], v228 offset:53248
    v_cvt_pk_bf16_f32 v42, v104, v105
    v_mfma_f32_16x16x32_bf16 v[88:91], v[124:127], a[188:191], v[88:91]
    v_exp_f32 v106, v106
    v_mfma_f32_16x16x32_bf16 v[92:95], v[124:127], a[204:207], v[188:191]
    v_exp_f32 v107, v107
    v_mfma_f32_16x16x32_bf16 v[92:95], v[120:123], a[200:203], v[92:95]
    ds_read_b64_tr_b16 v[148:149], v228 offset:57344
    v_cvt_pk_bf16_f32 v43, v106, v107
    v_mfma_f32_16x16x32_bf16 v[92:95], v[116:119], a[196:199], v[92:95]
    ds_read_b64_tr_b16 v[150:151], v228 offset:61440
    v_mfma_f32_16x16x32_bf16 v[92:95], v[112:115], a[192:195], v[92:95]
    s_waitcnt lgkmcnt(6)
    v_mfma_f32_16x16x32_bf16 v[64:67], v[128:131], a[144:147], v[176:179]
    v_mfma_f32_16x16x32_bf16 v[64:67], v[132:135], a[148:151], v[64:67]
    s_waitcnt lgkmcnt(5)
    v_exp_f32 v44, v44
    v_mfma_f32_16x16x32_bf16 v[64:67], v[136:139], a[152:155], v[64:67]
    s_waitcnt lgkmcnt(4)
    v_exp_f32 v45, v45
    v_mfma_f32_16x16x32_bf16 v[64:67], v[140:143], a[156:159], v[64:67]
    ds_read_b128 v[112:115], v216 offset:40960
    v_cvt_pk_bf16_f32 v44, v44, v45
    v_mfma_f32_16x16x32_bf16 v[68:71], v[140:143], a[172:175], v[180:183]
    v_exp_f32 v46, v46
    v_mfma_f32_16x16x32_bf16 v[68:71], v[136:139], a[168:171], v[68:71]
    v_exp_f32 v47, v47
    v_mfma_f32_16x16x32_bf16 v[68:71], v[132:135], a[164:167], v[68:71]
    ds_read_b128 v[116:119], v217 offset:40960
    v_cvt_pk_bf16_f32 v45, v46, v47
    v_mfma_f32_16x16x32_bf16 v[68:71], v[128:131], a[160:163], v[68:71]
    ds_read_b128 v[120:123], v218 offset:40960
    v_mfma_f32_16x16x32_bf16 v[72:75], v[128:131], a[176:179], v[184:187]
    v_exp_f32 v108, v108
    v_mfma_f32_16x16x32_bf16 v[72:75], v[132:135], a[180:183], v[72:75]
    v_exp_f32 v109, v109
    v_mfma_f32_16x16x32_bf16 v[72:75], v[136:139], a[184:187], v[72:75]
    buffer_load_dwordx4 v239, s[12:15], s54 offen offset:3072 lds
    v_mfma_f32_16x16x32_bf16 v[72:75], v[140:143], a[188:191], v[72:75]
    ds_read_b128 v[124:127], v219 offset:40960
    v_cvt_pk_bf16_f32 v46, v108, v109
    v_mfma_f32_16x16x32_bf16 v[76:79], v[140:143], a[204:207], v[188:191]
    v_exp_f32 v110, v110
    v_mfma_f32_16x16x32_bf16 v[76:79], v[136:139], a[200:203], v[76:79]
    v_exp_f32 v111, v111
    v_mfma_f32_16x16x32_bf16 v[76:79], v[132:135], a[196:199], v[76:79]
    ds_read_b64_tr_b16 v[152:153], v229 offset:49152
    v_cvt_pk_bf16_f32 v47, v110, v111
    v_mfma_f32_16x16x32_bf16 v[76:79], v[128:131], a[192:195], v[76:79]
    s_waitcnt lgkmcnt(2)
    ds_read_b64_tr_b16 v[154:155], v229 offset:53248
    v_mfma_f32_16x16x32_bf16 v[96:99], v[112:115], a[144:147], v[176:179]
    v_mfma_f32_16x16x32_bf16 v[96:99], v[116:119], a[148:151], v[96:99]
    v_mfma_f32_16x16x32_bf16 v[96:99], v[120:123], a[152:155], v[96:99]
    s_waitcnt lgkmcnt(2)
    v_exp_f32 v80, v80
    v_mfma_f32_16x16x32_bf16 v[96:99], v[124:127], a[156:159], v[96:99]
    v_exp_f32 v81, v81
    v_mfma_f32_16x16x32_bf16 v[100:103], v[124:127], a[172:175], v[180:183]
    ds_read_b128 v[128:131], v216 offset:45056
    v_cvt_pk_bf16_f32 v80, v80, v81
    v_mfma_f32_16x16x32_bf16 v[100:103], v[120:123], a[168:171], v[100:103]
    v_exp_f32 v82, v82
    v_mfma_f32_16x16x32_bf16 v[100:103], v[116:119], a[164:167], v[100:103]
    v_exp_f32 v83, v83
    v_mfma_f32_16x16x32_bf16 v[100:103], v[112:115], a[160:163], v[100:103]
    ds_read_b128 v[132:135], v217 offset:45056
    v_cvt_pk_bf16_f32 v81, v82, v83
    v_mfma_f32_16x16x32_bf16 v[104:107], v[112:115], a[176:179], v[184:187]
    ds_read_b128 v[136:139], v218 offset:45056
    v_mfma_f32_16x16x32_bf16 v[104:107], v[116:119], a[180:183], v[104:107]
    s_add_u32 s55, s55, 16384
    v_exp_f32 v64, v64
    v_mfma_f32_16x16x32_bf16 v[104:107], v[120:123], a[184:187], v[104:107]
    s_add_u32 m0, s53, 49152
    v_exp_f32 v65, v65
    v_mfma_f32_16x16x32_bf16 v[104:107], v[124:127], a[188:191], v[104:107]
    buffer_load_dwordx4 v240, s[16:19], s55 offen offset:0 lds
    v_mfma_f32_16x16x32_bf16 v[108:111], v[124:127], a[204:207], v[188:191]
    ds_read_b128 v[140:143], v219 offset:45056
    v_cvt_pk_bf16_f32 v82, v64, v65
    v_mfma_f32_16x16x32_bf16 v[108:111], v[120:123], a[200:203], v[108:111]
    v_exp_f32 v66, v66
    v_mfma_f32_16x16x32_bf16 v[108:111], v[116:119], a[196:199], v[108:111]
    v_exp_f32 v67, v67
    v_mfma_f32_16x16x32_bf16 v[108:111], v[112:115], a[192:195], v[108:111]
    s_waitcnt lgkmcnt(1)
    ds_read_b64_tr_b16 v[156:157], v229 offset:57344
    v_cvt_pk_bf16_f32 v83, v66, v67
    v_mfma_f32_16x16x32_bf16 v[48:51], v[128:131], a[144:147], v[176:179]
    ds_read_b64_tr_b16 v[158:159], v229 offset:61440
    v_mfma_f32_16x16x32_bf16 v[48:51], v[132:135], a[148:151], v[48:51]
    v_mfma_f32_16x16x32_bf16 v[48:51], v[136:139], a[152:155], v[48:51]
    s_waitcnt lgkmcnt(2)
    v_mfma_f32_16x16x32_bf16 v[48:51], v[140:143], a[156:159], v[48:51]
    v_exp_f32 v84, v84
    v_mfma_f32_16x16x32_bf16 v[52:55], v[140:143], a[172:175], v[180:183]
    v_exp_f32 v85, v85
    v_mfma_f32_16x16x32_bf16 v[52:55], v[136:139], a[168:171], v[52:55]
    ds_read_b64_tr_b16 v[160:161], v230 offset:49152
    v_cvt_pk_bf16_f32 v84, v84, v85
    v_mfma_f32_16x16x32_bf16 v[52:55], v[132:135], a[164:167], v[52:55]
    v_exp_f32 v86, v86
    v_mfma_f32_16x16x32_bf16 v[52:55], v[128:131], a[160:163], v[52:55]
    v_exp_f32 v87, v87
    v_mfma_f32_16x16x32_bf16 v[56:59], v[128:131], a[176:179], v[184:187]
    ds_read_b64_tr_b16 v[162:163], v230 offset:53248
    v_cvt_pk_bf16_f32 v85, v86, v87
    v_mfma_f32_16x16x32_bf16 v[56:59], v[132:135], a[180:183], v[56:59]
    ds_read_b64_tr_b16 v[164:165], v230 offset:57344
    v_mfma_f32_16x16x32_bf16 v[56:59], v[136:139], a[184:187], v[56:59]
    v_exp_f32 v68, v68
    v_mfma_f32_16x16x32_bf16 v[56:59], v[140:143], a[188:191], v[56:59]
    v_exp_f32 v69, v69
    v_mfma_f32_16x16x32_bf16 v[60:63], v[140:143], a[204:207], v[188:191]
    buffer_load_dwordx4 v241, s[16:19], s55 offen offset:1024 lds
    v_mfma_f32_16x16x32_bf16 v[60:63], v[136:139], a[200:203], v[60:63]
    ds_read_b64_tr_b16 v[166:167], v230 offset:61440
    v_cvt_pk_bf16_f32 v86, v68, v69
    v_mfma_f32_16x16x32_bf16 v[60:63], v[132:135], a[196:199], v[60:63]
    v_exp_f32 v70, v70
    v_mfma_f32_16x16x32_bf16 v[60:63], v[128:131], a[192:195], v[60:63]
    v_exp_f32 v71, v71
    v_mfma_f32_16x16x32_bf16 a[0:3], v[144:147], v[16:19], a[0:3]
    ds_read_b64_tr_b16 v[168:169], v231 offset:49152
    v_cvt_pk_bf16_f32 v87, v70, v71
    v_mfma_f32_16x16x32_bf16 a[0:3], v[148:151], v[32:35], a[0:3]
    ds_read_b64_tr_b16 v[170:171], v231 offset:53248
    v_mfma_f32_16x16x32_bf16 a[4:7], v[148:151], v[36:39], a[4:7]
    v_mfma_f32_16x16x32_bf16 a[4:7], v[144:147], v[20:23], a[4:7]
    v_mfma_f32_16x16x32_bf16 a[8:11], v[144:147], v[24:27], a[8:11]
    v_exp_f32 v88, v88
    v_mfma_f32_16x16x32_bf16 a[8:11], v[148:151], v[40:43], a[8:11]
    v_exp_f32 v89, v89
    v_mfma_f32_16x16x32_bf16 a[12:15], v[148:151], v[44:47], a[12:15]
    ds_read_b64_tr_b16 v[172:173], v231 offset:57344
    v_cvt_pk_bf16_f32 v88, v88, v89
    v_mfma_f32_16x16x32_bf16 a[12:15], v[144:147], v[28:31], a[12:15]
    s_waitcnt lgkmcnt(7)
    v_exp_f32 v90, v90
    v_mfma_f32_16x16x32_bf16 a[28:31], v[152:155], v[28:31], a[28:31]
    v_exp_f32 v91, v91
    v_mfma_f32_16x16x32_bf16 a[28:31], v[156:159], v[44:47], a[28:31]
    ds_read_b64_tr_b16 v[174:175], v231 offset:61440
    v_cvt_pk_bf16_f32 v89, v90, v91
    v_mfma_f32_16x16x32_bf16 a[24:27], v[156:159], v[40:43], a[24:27]
    ds_read_b64_tr_b16 v[144:145], v232 offset:49152
    v_mfma_f32_16x16x32_bf16 a[24:27], v[152:155], v[24:27], a[24:27]
    v_exp_f32 v72, v72
    v_mfma_f32_16x16x32_bf16 a[20:23], v[152:155], v[20:23], a[20:23]
    v_exp_f32 v73, v73
    v_mfma_f32_16x16x32_bf16 a[20:23], v[156:159], v[36:39], a[20:23]
    buffer_load_dwordx4 v240, s[16:19], s55 offen offset:2048 lds
    v_mfma_f32_16x16x32_bf16 a[16:19], v[156:159], v[32:35], a[16:19]
    ds_read_b64_tr_b16 v[146:147], v232 offset:53248
    v_cvt_pk_bf16_f32 v90, v72, v73
    v_mfma_f32_16x16x32_bf16 a[16:19], v[152:155], v[16:19], a[16:19]
    s_waitcnt lgkmcnt(6)
    v_exp_f32 v74, v74
    v_mfma_f32_16x16x32_bf16 a[32:35], v[160:163], v[16:19], a[32:35]
    v_exp_f32 v75, v75
    v_mfma_f32_16x16x32_bf16 a[32:35], v[164:167], v[32:35], a[32:35]
    ds_read_b64_tr_b16 v[148:149], v232 offset:57344
    v_cvt_pk_bf16_f32 v91, v74, v75
    v_mfma_f32_16x16x32_bf16 a[36:39], v[164:167], v[36:39], a[36:39]
    ds_read_b64_tr_b16 v[150:151], v232 offset:61440
    v_mfma_f32_16x16x32_bf16 a[36:39], v[160:163], v[20:23], a[36:39]
    ds_read_b64_tr_b16 v[152:153], v233 offset:49152
    v_mfma_f32_16x16x32_bf16 a[40:43], v[160:163], v[24:27], a[40:43]
    ds_read_b64_tr_b16 v[154:155], v233 offset:53248
    v_mfma_f32_16x16x32_bf16 a[40:43], v[164:167], v[40:43], a[40:43]
    v_exp_f32 v92, v92
    v_mfma_f32_16x16x32_bf16 a[44:47], v[164:167], v[44:47], a[44:47]
    v_exp_f32 v93, v93
    v_mfma_f32_16x16x32_bf16 a[44:47], v[160:163], v[28:31], a[44:47]
    s_waitcnt lgkmcnt(6)
    ds_read_b64_tr_b16 v[156:157], v233 offset:57344
    v_cvt_pk_bf16_f32 v92, v92, v93
    v_mfma_f32_16x16x32_bf16 a[60:63], v[168:171], v[28:31], a[60:63]
    v_exp_f32 v94, v94
    v_mfma_f32_16x16x32_bf16 a[60:63], v[172:175], v[44:47], a[60:63]
    v_exp_f32 v95, v95
    v_mfma_f32_16x16x32_bf16 a[56:59], v[172:175], v[40:43], a[56:59]
    ds_read_b64_tr_b16 v[158:159], v233 offset:61440
    v_cvt_pk_bf16_f32 v93, v94, v95
    v_mfma_f32_16x16x32_bf16 a[56:59], v[168:171], v[24:27], a[56:59]
    ds_read_b64_tr_b16 v[160:161], v234 offset:49152
    v_mfma_f32_16x16x32_bf16 a[52:55], v[168:171], v[20:23], a[52:55]
    v_exp_f32 v76, v76
    v_mfma_f32_16x16x32_bf16 a[52:55], v[172:175], v[36:39], a[52:55]
    v_exp_f32 v77, v77
    v_mfma_f32_16x16x32_bf16 a[48:51], v[172:175], v[32:35], a[48:51]
    buffer_load_dwordx4 v241, s[16:19], s55 offen offset:3072 lds
    v_mfma_f32_16x16x32_bf16 a[48:51], v[168:171], v[16:19], a[48:51]
    s_waitcnt lgkmcnt(5)
    ds_read_b64_tr_b16 v[162:163], v234 offset:53248
    v_cvt_pk_bf16_f32 v94, v76, v77
    v_mfma_f32_16x16x32_bf16 a[64:67], v[144:147], v[16:19], a[64:67]
    v_exp_f32 v78, v78
    v_mfma_f32_16x16x32_bf16 a[64:67], v[148:151], v[32:35], a[64:67]
    v_exp_f32 v79, v79
    v_mfma_f32_16x16x32_bf16 a[68:71], v[148:151], v[36:39], a[68:71]
    ds_read_b64_tr_b16 v[164:165], v234 offset:57344
    v_cvt_pk_bf16_f32 v95, v78, v79
    v_mfma_f32_16x16x32_bf16 a[68:71], v[144:147], v[20:23], a[68:71]
    ds_read_b64_tr_b16 v[166:167], v234 offset:61440
    v_mfma_f32_16x16x32_bf16 a[72:75], v[144:147], v[24:27], a[72:75]
    v_mfma_f32_16x16x32_bf16 a[72:75], v[148:151], v[40:43], a[72:75]
    s_waitcnt vmcnt(8)
    v_mfma_f32_16x16x32_bf16 a[76:79], v[148:151], v[44:47], a[76:79]
    s_barrier
    v_exp_f32 v96, v96
    v_mfma_f32_16x16x32_bf16 a[76:79], v[144:147], v[28:31], a[76:79]
    s_waitcnt lgkmcnt(4)
    v_exp_f32 v97, v97
    v_mfma_f32_16x16x32_bf16 a[92:95], v[152:155], v[28:31], a[92:95]
    ds_read_b64_tr_b16 v[168:169], v235 offset:49152
    v_cvt_pk_bf16_f32 v96, v96, v97
    v_mfma_f32_16x16x32_bf16 a[92:95], v[156:159], v[44:47], a[92:95]
    v_exp_f32 v98, v98
    v_mfma_f32_16x16x32_bf16 a[88:91], v[156:159], v[40:43], a[88:91]
    v_exp_f32 v99, v99
    v_mfma_f32_16x16x32_bf16 a[88:91], v[152:155], v[24:27], a[88:91]
    ds_read_b64_tr_b16 v[170:171], v235 offset:53248
    v_cvt_pk_bf16_f32 v97, v98, v99
    v_mfma_f32_16x16x32_bf16 a[84:87], v[152:155], v[20:23], a[84:87]
    s_add_u32 s54, s54, 16384
    ds_read_b64_tr_b16 v[172:173], v235 offset:57344
    v_mfma_f32_16x16x32_bf16 a[84:87], v[156:159], v[36:39], a[84:87]
    s_add_u32 m0, s53, 65536
    v_exp_f32 v48, v48
    v_mfma_f32_16x16x32_bf16 a[80:83], v[156:159], v[32:35], a[80:83]
    s_waitcnt lgkmcnt(3)
    v_exp_f32 v49, v49
    v_mfma_f32_16x16x32_bf16 a[80:83], v[152:155], v[16:19], a[80:83]
    buffer_load_dwordx4 v236, s[12:15], s54 offen offset:0 lds
    v_mfma_f32_16x16x32_bf16 a[96:99], v[160:163], v[16:19], a[96:99]
    ds_read_b64_tr_b16 v[174:175], v235 offset:61440
    v_cvt_pk_bf16_f32 v98, v48, v49
    v_mfma_f32_16x16x32_bf16 a[96:99], v[164:167], v[32:35], a[96:99]
    v_exp_f32 v50, v50
    v_mfma_f32_16x16x32_bf16 a[100:103], v[164:167], v[36:39], a[100:103]
    v_exp_f32 v51, v51
    v_mfma_f32_16x16x32_bf16 a[100:103], v[160:163], v[20:23], a[100:103]
    ds_read_b128 v[112:115], v212 offset:0
    v_cvt_pk_bf16_f32 v99, v50, v51
    v_mfma_f32_16x16x32_bf16 a[104:107], v[160:163], v[24:27], a[104:107]
    ds_read_b128 v[116:119], v213 offset:0
    v_mfma_f32_16x16x32_bf16 a[104:107], v[164:167], v[40:43], a[104:107]
    v_mfma_f32_16x16x32_bf16 a[108:111], v[164:167], v[44:47], a[108:111]
    v_mfma_f32_16x16x32_bf16 a[108:111], v[160:163], v[28:31], a[108:111]
    s_waitcnt lgkmcnt(2)
    v_exp_f32 v100, v100
    v_mfma_f32_16x16x32_bf16 a[124:127], v[168:171], v[28:31], a[124:127]
    v_exp_f32 v101, v101
    v_mfma_f32_16x16x32_bf16 a[124:127], v[172:175], v[44:47], a[124:127]
    ds_read_b128 v[120:123], v214 offset:0
    v_cvt_pk_bf16_f32 v100, v100, v101
    v_mfma_f32_16x16x32_bf16 a[120:123], v[172:175], v[40:43], a[120:123]
    v_exp_f32 v102, v102
    v_mfma_f32_16x16x32_bf16 a[120:123], v[168:171], v[24:27], a[120:123]
    v_exp_f32 v103, v103
    v_mfma_f32_16x16x32_bf16 a[116:119], v[168:171], v[20:23], a[116:119]
    ds_read_b128 v[124:127], v215 offset:0
    v_cvt_pk_bf16_f32 v101, v102, v103
    v_mfma_f32_16x16x32_bf16 a[116:119], v[172:175], v[36:39], a[116:119]
    ds_read_b128 v[128:131], v212 offset:4096
    v_mfma_f32_16x16x32_bf16 a[112:115], v[172:175], v[32:35], a[112:115]
    v_exp_f32 v52, v52
    v_mfma_f32_16x16x32_bf16 a[112:115], v[168:171], v[16:19], a[112:115]
    v_exp_f32 v53, v53
    v_mfma_f32_16x16x32_bf16 a[128:131], v[208:211], v[16:19], a[128:131]
    buffer_load_dwordx4 v237, s[12:15], s54 offen offset:1024 lds
    v_mfma_f32_16x16x32_bf16 a[128:131], v[208:211], v[32:35], a[128:131]
    ds_read_b128 v[132:135], v213 offset:4096
    v_cvt_pk_bf16_f32 v102, v52, v53
    v_mfma_f32_16x16x32_bf16 a[132:135], v[208:211], v[36:39], a[132:135]
    v_exp_f32 v54, v54
    v_mfma_f32_16x16x32_bf16 a[132:135], v[208:211], v[20:23], a[132:135]
    v_exp_f32 v55, v55
    v_mfma_f32_16x16x32_bf16 a[136:139], v[208:211], v[24:27], a[136:139]
    v_cvt_pk_bf16_f32 v103, v54, v55
    v_mfma_f32_16x16x32_bf16 a[136:139], v[208:211], v[40:43], a[136:139]
    v_mfma_f32_16x16x32_bf16 a[140:143], v[208:211], v[44:47], a[140:143]
    v_mfma_f32_16x16x32_bf16 a[140:143], v[208:211], v[28:31], a[140:143]
    s_waitcnt lgkmcnt(2)
    s_sub_u32 s32, s32, 1
    s_cmp_eq_u32 s32, s95
    s_cbranch_scc1 f_publish
f_pub_ret:
    s_cmp_eq_u32 s32, s94
    s_cbranch_scc1 f_mid
f_mid_ret:
    s_cmp_lg_u32 s32, 0
    s_cbranch_scc1 f_att_loop
    s_waitcnt lgkmcnt(0)
    s_add_u32 s40, s10, 29360128
    s_addc_u32 s41, s11, 0
    s_mov_b32 s42, 16777216
    s_mov_b32 s43, 0x20000
    s_add_u32 s20, s10, 75497472
    s_addc_u32 s21, s11, 0
    s_mov_b32 s22, 16384
    s_mov_b32 s23, 0x20000
    v_lshlrev_b32 v143, 5, v1
    v_add_u32 v143, 8192, v143
    s_cmp_eq_u32 s3, 0
    s_cselect_b32 s28, 0, 0x4000
    buffer_load_dwordx4 v[168:171], v143, s[20:23], s28 offen sc1
    buffer_load_dwordx4 v[172:175], v143, s[20:23], s28 offen offset:16 sc1
    s_lshl_b32 s28, s5, 5
    s_add_u32 s28, s28, s4
    s_lshl_b32 s28, s28, 3
    s_add_u32 s101, s28, 12288
    v_mov_b32 v12, 0
    v_mov_b32 v13, 0
    v_mov_b32 v14, 0
    v_mov_b32 v15, 0
    v_accvgpr_read_b32 v2, a128
    v_accvgpr_read_b32 v3, a132
    v_accvgpr_read_b32 v4, a136
    v_accvgpr_read_b32 v5, a140
    v_rcp_f32 v176, v2
    v_rcp_f32 v178, v3
    v_rcp_f32 v180, v4
    v_rcp_f32 v182, v5
    v_mov_b32 v177, v176
    v_mov_b32 v179, v178
    v_mov_b32 v181, v180
    v_mov_b32 v183, v182
    s_lshl_b32 s28, s5, 4
    s_lshl_b32 s29, s3, 2
    s_add_u32 s28, s28, s29
    s_lshl_b32 s28, s28, 17
    s_bfe_u32 s29, s4, 0x10003
    s_lshl_b32 s29, s29, 4
    s_lshr_b32 s30, s4, 4
    s_lshl_b32 s30, s30, 3
    s_add_u32 s29, s29, s30
    s_and_b32 s30, s4, 7
    s_add_u32 s29, s29, s30
    s_lshl_b32 s29, s29, 12
    s_add_u32 s28, s28, s29
    v_accvgpr_read_b32 v16, a0
    v_accvgpr_read_b32 v17, a1
    v_accvgpr_read_b32 v18, a2
    v_accvgpr_read_b32 v19, a3
    v_accvgpr_read_b32 v20, a16
    v_accvgpr_read_b32 v21, a17
    v_accvgpr_read_b32 v22, a18
    v_accvgpr_read_b32 v23, a19
    v_pk_mul_f32 v[16:17], v[16:17], v[176:177]
    v_pk_mul_f32 v[18:19], v[18:19], v[176:177]
    v_pk_mul_f32 v[20:21], v[20:21], v[176:177]
    v_pk_mul_f32 v[22:23], v[22:23], v[176:177]
    v_cvt_pk_bf16_f32 v64, v16, v17
    v_cvt_pk_bf16_f32 v65, v18, v19
    v_cvt_pk_bf16_f32 v66, v20, v21
    v_cvt_pk_bf16_f32 v67, v22, v23
    buffer_store_dwordx4 v[64:67], v254, s[40:43], s28 offen offset:0 sc1
    v_accvgpr_read_b32 v24, a32
    v_accvgpr_read_b32 v25, a33
    v_accvgpr_read_b32 v26, a34
    v_accvgpr_read_b32 v27, a35
    v_accvgpr_read_b32 v28, a48
    v_accvgpr_read_b32 v29, a49
    v_accvgpr_read_b32 v30, a50
    v_accvgpr_read_b32 v31, a51
    v_pk_mul_f32 v[24:25], v[24:25], v[176:177]
    v_pk_mul_f32 v[26:27], v[26:27], v[176:177]
    v_pk_mul_f32 v[28:29], v[28:29], v[176:177]
    v_pk_mul_f32 v[30:31], v[30:31], v[176:177]
    v_cvt_pk_bf16_f32 v68, v24, v25
    v_cvt_pk_bf16_f32 v69, v26, v27
    v_cvt_pk_bf16_f32 v70, v28, v29
    v_cvt_pk_bf16_f32 v71, v30, v31
    buffer_store_dwordx4 v[68:71], v254, s[40:43], s28 offen offset:1024 sc1
    v_mfma_f32_16x16x32_bf16 v[184:187], v[12:15], v[64:67], 0
    v_accvgpr_read_b32 v32, a64
    v_accvgpr_read_b32 v33, a65
    v_accvgpr_read_b32 v34, a66
    v_accvgpr_read_b32 v35, a67
    v_accvgpr_read_b32 v36, a80
    v_accvgpr_read_b32 v37, a81
    v_accvgpr_read_b32 v38, a82
    v_accvgpr_read_b32 v39, a83
    v_pk_mul_f32 v[32:33], v[32:33], v[176:177]
    v_pk_mul_f32 v[34:35], v[34:35], v[176:177]
    v_pk_mul_f32 v[36:37], v[36:37], v[176:177]
    v_pk_mul_f32 v[38:39], v[38:39], v[176:177]
    v_cvt_pk_bf16_f32 v72, v32, v33
    v_cvt_pk_bf16_f32 v73, v34, v35
    v_cvt_pk_bf16_f32 v74, v36, v37
    v_cvt_pk_bf16_f32 v75, v38, v39
    buffer_store_dwordx4 v[72:75], v254, s[40:43], s28 offen offset:2048 sc1
    v_mfma_f32_16x16x32_bf16 v[184:187], v[12:15], v[68:71], v[184:187]
    v_accvgpr_read_b32 v40, a96
    v_accvgpr_read_b32 v41, a97
    v_accvgpr_read_b32 v42, a98
    v_accvgpr_read_b32 v43, a99
    v_accvgpr_read_b32 v44, a112
    v_accvgpr_read_b32 v45, a113
    v_accvgpr_read_b32 v46, a114
    v_accvgpr_read_b32 v47, a115
    v_pk_mul_f32 v[40:41], v[40:41], v[176:177]
    v_pk_mul_f32 v[42:43], v[42:43], v[176:177]
    v_pk_mul_f32 v[44:45], v[44:45], v[176:177]
    v_pk_mul_f32 v[46:47], v[46:47], v[176:177]
    v_cvt_pk_bf16_f32 v76, v40, v41
    v_cvt_pk_bf16_f32 v77, v42, v43
    v_cvt_pk_bf16_f32 v78, v44, v45
    v_cvt_pk_bf16_f32 v79, v46, v47
    buffer_store_dwordx4 v[76:79], v254, s[40:43], s28 offen offset:3072 sc1
    v_mfma_f32_16x16x32_bf16 v[184:187], v[12:15], v[72:75], v[184:187]
    s_add_u32 s28, s28, 0x20000
    v_accvgpr_read_b32 v16, a4
    v_accvgpr_read_b32 v17, a5
    v_accvgpr_read_b32 v18, a6
    v_accvgpr_read_b32 v19, a7
    v_accvgpr_read_b32 v20, a20
    v_accvgpr_read_b32 v21, a21
    v_accvgpr_read_b32 v22, a22
    v_accvgpr_read_b32 v23, a23
    v_pk_mul_f32 v[16:17], v[16:17], v[178:179]
    v_pk_mul_f32 v[18:19], v[18:19], v[178:179]
    v_pk_mul_f32 v[20:21], v[20:21], v[178:179]
    v_pk_mul_f32 v[22:23], v[22:23], v[178:179]
    v_cvt_pk_bf16_f32 v80, v16, v17
    v_cvt_pk_bf16_f32 v81, v18, v19
    v_cvt_pk_bf16_f32 v82, v20, v21
    v_cvt_pk_bf16_f32 v83, v22, v23
    buffer_store_dwordx4 v[80:83], v254, s[40:43], s28 offen offset:0 sc1
    v_mfma_f32_16x16x32_bf16 v[184:187], v[12:15], v[76:79], v[184:187]
    v_accvgpr_read_b32 v24, a36
    v_accvgpr_read_b32 v25, a37
    v_accvgpr_read_b32 v26, a38
    v_accvgpr_read_b32 v27, a39
    v_accvgpr_read_b32 v28, a52
    v_accvgpr_read_b32 v29, a53
    v_accvgpr_read_b32 v30, a54
    v_accvgpr_read_b32 v31, a55
    v_pk_mul_f32 v[24:25], v[24:25], v[178:179]
    v_pk_mul_f32 v[26:27], v[26:27], v[178:179]
    v_pk_mul_f32 v[28:29], v[28:29], v[178:179]
    v_pk_mul_f32 v[30:31], v[30:31], v[178:179]
    v_cvt_pk_bf16_f32 v84, v24, v25
    v_cvt_pk_bf16_f32 v85, v26, v27
    v_cvt_pk_bf16_f32 v86, v28, v29
    v_cvt_pk_bf16_f32 v87, v30, v31
    buffer_store_dwordx4 v[84:87], v254, s[40:43], s28 offen offset:1024 sc1
    v_mfma_f32_16x16x32_bf16 v[184:187], v[12:15], v[80:83], v[184:187]
    v_accvgpr_read_b32 v32, a68
    v_accvgpr_read_b32 v33, a69
    v_accvgpr_read_b32 v34, a70
    v_accvgpr_read_b32 v35, a71
    v_accvgpr_read_b32 v36, a84
    v_accvgpr_read_b32 v37, a85
    v_accvgpr_read_b32 v38, a86
    v_accvgpr_read_b32 v39, a87
    v_pk_mul_f32 v[32:33], v[32:33], v[178:179]
    v_pk_mul_f32 v[34:35], v[34:35], v[178:179]
    v_pk_mul_f32 v[36:37], v[36:37], v[178:179]
    v_pk_mul_f32 v[38:39], v[38:39], v[178:179]
    v_cvt_pk_bf16_f32 v88, v32, v33
    v_cvt_pk_bf16_f32 v89, v34, v35
    v_cvt_pk_bf16_f32 v90, v36, v37
    v_cvt_pk_bf16_f32 v91, v38, v39
    buffer_store_dwordx4 v[88:91], v254, s[40:43], s28 offen offset:2048 sc1
    v_mfma_f32_16x16x32_bf16 v[184:187], v[12:15], v[84:87], v[184:187]
    v_accvgpr_read_b32 v40, a100
    v_accvgpr_read_b32 v41, a101
    v_accvgpr_read_b32 v42, a102
    v_accvgpr_read_b32 v43, a103
    v_accvgpr_read_b32 v44, a116
    v_accvgpr_read_b32 v45, a117
    v_accvgpr_read_b32 v46, a118
    v_accvgpr_read_b32 v47, a119
    v_pk_mul_f32 v[40:41], v[40:41], v[178:179]
    v_pk_mul_f32 v[42:43], v[42:43], v[178:179]
    v_pk_mul_f32 v[44:45], v[44:45], v[178:179]
    v_pk_mul_f32 v[46:47], v[46:47], v[178:179]
    v_cvt_pk_bf16_f32 v92, v40, v41
    v_cvt_pk_bf16_f32 v93, v42, v43
    v_cvt_pk_bf16_f32 v94, v44, v45
    v_cvt_pk_bf16_f32 v95, v46, v47
    buffer_store_dwordx4 v[92:95], v254, s[40:43], s28 offen offset:3072 sc1
    v_mfma_f32_16x16x32_bf16 v[184:187], v[12:15], v[88:91], v[184:187]
    s_add_u32 s28, s28, 0x20000
    v_accvgpr_read_b32 v16, a8
    v_accvgpr_read_b32 v17, a9
    v_accvgpr_read_b32 v18, a10
    v_accvgpr_read_b32 v19, a11
    v_accvgpr_read_b32 v20, a24
    v_accvgpr_read_b32 v21, a25
    v_accvgpr_read_b32 v22, a26
    v_accvgpr_read_b32 v23, a27
    v_pk_mul_f32 v[16:17], v[16:17], v[180:181]
    v_pk_mul_f32 v[18:19], v[18:19], v[180:181]
    v_pk_mul_f32 v[20:21], v[20:21], v[180:181]
    v_pk_mul_f32 v[22:23], v[22:23], v[180:181]
    v_cvt_pk_bf16_f32 v96, v16, v17
    v_cvt_pk_bf16_f32 v97, v18, v19
    v_cvt_pk_bf16_f32 v98, v20, v21
    v_cvt_pk_bf16_f32 v99, v22, v23
    buffer_store_dwordx4 v[96:99], v254, s[40:43], s28 offen offset:0 sc1
    v_mfma_f32_16x16x32_bf16 v[184:187], v[12:15], v[92:95], v[184:187]
    v_accvgpr_read_b32 v24, a40
    v_accvgpr_read_b32 v25, a41
    v_accvgpr_read_b32 v26, a42
    v_accvgpr_read_b32 v27, a43
    v_accvgpr_read_b32 v28, a56
    v_accvgpr_read_b32 v29, a57
    v_accvgpr_read_b32 v30, a58
    v_accvgpr_read_b32 v31, a59
    v_pk_mul_f32 v[24:25], v[24:25], v[180:181]
    v_pk_mul_f32 v[26:27], v[26:27], v[180:181]
    v_pk_mul_f32 v[28:29], v[28:29], v[180:181]
    v_pk_mul_f32 v[30:31], v[30:31], v[180:181]
    v_cvt_pk_bf16_f32 v100, v24, v25
    v_cvt_pk_bf16_f32 v101, v26, v27
    v_cvt_pk_bf16_f32 v102, v28, v29
    v_cvt_pk_bf16_f32 v103, v30, v31
    buffer_store_dwordx4 v[100:103], v254, s[40:43], s28 offen offset:1024 sc1
    v_mfma_f32_16x16x32_bf16 v[184:187], v[12:15], v[96:99], v[184:187]
    v_accvgpr_read_b32 v32, a72
    v_accvgpr_read_b32 v33, a73
    v_accvgpr_read_b32 v34, a74
    v_accvgpr_read_b32 v35, a75
    v_accvgpr_read_b32 v36, a88
    v_accvgpr_read_b32 v37, a89
    v_accvgpr_read_b32 v38, a90
    v_accvgpr_read_b32 v39, a91
    v_pk_mul_f32 v[32:33], v[32:33], v[180:181]
    v_pk_mul_f32 v[34:35], v[34:35], v[180:181]
    v_pk_mul_f32 v[36:37], v[36:37], v[180:181]
    v_pk_mul_f32 v[38:39], v[38:39], v[180:181]
    v_cvt_pk_bf16_f32 v104, v32, v33
    v_cvt_pk_bf16_f32 v105, v34, v35
    v_cvt_pk_bf16_f32 v106, v36, v37
    v_cvt_pk_bf16_f32 v107, v38, v39
    buffer_store_dwordx4 v[104:107], v254, s[40:43], s28 offen offset:2048 sc1
    v_mfma_f32_16x16x32_bf16 v[184:187], v[12:15], v[100:103], v[184:187]
    v_accvgpr_read_b32 v40, a104
    v_accvgpr_read_b32 v41, a105
    v_accvgpr_read_b32 v42, a106
    v_accvgpr_read_b32 v43, a107
    v_accvgpr_read_b32 v44, a120
    v_accvgpr_read_b32 v45, a121
    v_accvgpr_read_b32 v46, a122
    v_accvgpr_read_b32 v47, a123
    v_pk_mul_f32 v[40:41], v[40:41], v[180:181]
    v_pk_mul_f32 v[42:43], v[42:43], v[180:181]
    v_pk_mul_f32 v[44:45], v[44:45], v[180:181]
    v_pk_mul_f32 v[46:47], v[46:47], v[180:181]
    v_cvt_pk_bf16_f32 v108, v40, v41
    v_cvt_pk_bf16_f32 v109, v42, v43
    v_cvt_pk_bf16_f32 v110, v44, v45
    v_cvt_pk_bf16_f32 v111, v46, v47
    buffer_store_dwordx4 v[108:111], v254, s[40:43], s28 offen offset:3072 sc1
    v_mfma_f32_16x16x32_bf16 v[184:187], v[12:15], v[104:107], v[184:187]
    s_add_u32 s28, s28, 0x20000
    v_accvgpr_read_b32 v16, a12
    v_accvgpr_read_b32 v17, a13
    v_accvgpr_read_b32 v18, a14
    v_accvgpr_read_b32 v19, a15
    v_accvgpr_read_b32 v20, a28
    v_accvgpr_read_b32 v21, a29
    v_accvgpr_read_b32 v22, a30
    v_accvgpr_read_b32 v23, a31
    v_pk_mul_f32 v[16:17], v[16:17], v[182:183]
    v_pk_mul_f32 v[18:19], v[18:19], v[182:183]
    v_pk_mul_f32 v[20:21], v[20:21], v[182:183]
    v_pk_mul_f32 v[22:23], v[22:23], v[182:183]
    v_cvt_pk_bf16_f32 v112, v16, v17
    v_cvt_pk_bf16_f32 v113, v18, v19
    v_cvt_pk_bf16_f32 v114, v20, v21
    v_cvt_pk_bf16_f32 v115, v22, v23
    buffer_store_dwordx4 v[112:115], v254, s[40:43], s28 offen offset:0 sc1
    v_mfma_f32_16x16x32_bf16 v[184:187], v[12:15], v[108:111], v[184:187]
    v_accvgpr_read_b32 v24, a44
    v_accvgpr_read_b32 v25, a45
    v_accvgpr_read_b32 v26, a46
    v_accvgpr_read_b32 v27, a47
    v_accvgpr_read_b32 v28, a60
    v_accvgpr_read_b32 v29, a61
    v_accvgpr_read_b32 v30, a62
    v_accvgpr_read_b32 v31, a63
    v_pk_mul_f32 v[24:25], v[24:25], v[182:183]
    v_pk_mul_f32 v[26:27], v[26:27], v[182:183]
    v_pk_mul_f32 v[28:29], v[28:29], v[182:183]
    v_pk_mul_f32 v[30:31], v[30:31], v[182:183]
    v_cvt_pk_bf16_f32 v116, v24, v25
    v_cvt_pk_bf16_f32 v117, v26, v27
    v_cvt_pk_bf16_f32 v118, v28, v29
    v_cvt_pk_bf16_f32 v119, v30, v31
    buffer_store_dwordx4 v[116:119], v254, s[40:43], s28 offen offset:1024 sc1
    v_mfma_f32_16x16x32_bf16 v[184:187], v[12:15], v[112:115], v[184:187]
    v_accvgpr_read_b32 v32, a76
    v_accvgpr_read_b32 v33, a77
    v_accvgpr_read_b32 v34, a78
    v_accvgpr_read_b32 v35, a79
    v_accvgpr_read_b32 v36, a92
    v_accvgpr_read_b32 v37, a93
    v_accvgpr_read_b32 v38, a94
    v_accvgpr_read_b32 v39, a95
    v_pk_mul_f32 v[32:33], v[32:33], v[182:183]
    v_pk_mul_f32 v[34:35], v[34:35], v[182:183]
    v_pk_mul_f32 v[36:37], v[36:37], v[182:183]
    v_pk_mul_f32 v[38:39], v[38:39], v[182:183]
    v_cvt_pk_bf16_f32 v120, v32, v33
    v_cvt_pk_bf16_f32 v121, v34, v35
    v_cvt_pk_bf16_f32 v122, v36, v37
    v_cvt_pk_bf16_f32 v123, v38, v39
    buffer_store_dwordx4 v[120:123], v254, s[40:43], s28 offen offset:2048 sc1
    v_mfma_f32_16x16x32_bf16 v[184:187], v[12:15], v[116:119], v[184:187]
    v_accvgpr_read_b32 v40, a108
    v_accvgpr_read_b32 v41, a109
    v_accvgpr_read_b32 v42, a110
    v_accvgpr_read_b32 v43, a111
    v_accvgpr_read_b32 v44, a124
    v_accvgpr_read_b32 v45, a125
    v_accvgpr_read_b32 v46, a126
    v_accvgpr_read_b32 v47, a127
    v_pk_mul_f32 v[40:41], v[40:41], v[182:183]
    v_pk_mul_f32 v[42:43], v[42:43], v[182:183]
    v_pk_mul_f32 v[44:45], v[44:45], v[182:183]
    v_pk_mul_f32 v[46:47], v[46:47], v[182:183]
    v_cvt_pk_bf16_f32 v124, v40, v41
    v_cvt_pk_bf16_f32 v125, v42, v43
    v_cvt_pk_bf16_f32 v126, v44, v45
    v_cvt_pk_bf16_f32 v127, v46, v47
    buffer_store_dwordx4 v[124:127], v254, s[40:43], s28 offen offset:3072 sc1
    v_mfma_f32_16x16x32_bf16 v[184:187], v[12:15], v[120:123], v[184:187]
    v_mfma_f32_16x16x32_bf16 v[184:187], v[12:15], v[124:127], v[184:187]
    v_mov_b32 v10, 0x5f800000
    v_cmp_nle_f32 vcc, v2, v10
    v_cmp_nle_f32 s[28:29], v3, v10
    s_or_b64 vcc, vcc, s[28:29]
    v_cmp_nle_f32 s[28:29], v4, v10
    s_or_b64 vcc, vcc, s[28:29]
    v_cmp_nle_f32 s[28:29], v5, v10
    s_or_b64 vcc, vcc, s[28:29]
    v_cmp_u_f32 s[28:29], v184, v184
    s_or_b64 vcc, vcc, s[28:29]
    s_cmp_eq_u64 vcc, 0
    s_cbranch_scc1 f_chk_ok
    v_mov_b32 v10, 1
    v_mov_b32 v11, 131328
    ds_write_b32 v11, v10
f_chk_ok:
    s_waitcnt vmcnt(16)
    s_waitcnt lgkmcnt(0)
    s_barrier
    v_mov_b32 v11, 131328
    ds_read_b32 v10, v11
    s_waitcnt lgkmcnt(0)
    v_readfirstlane_b32 s35, v10
    s_xor_b32 s28, s33, 1
    s_and_b32 s35, s35, s28
    s_cmp_lg_u32 s35, 0
    s_cbranch_scc0 f_done
    s_mov_b32 s33, 1
    s_waitcnt vmcnt(0)
    s_barrier
    s_mov_b32 s54, 4294950912
    v_mov_b32 v2, 0xff800000
    v_mov_b32 v3, 0xff800000
    v_mov_b32 v4, 0xff800000
    v_mov_b32 v5, 0xff800000
    s_mov_b32 s32, 32
f_fb_loop:
    s_add_u32 s54, s54, 16384
    s_add_u32 m0, s53, 0
    s_nop 0
    buffer_load_dwordx4 v236, s[12:15], s54 offen offset:0 lds
    buffer_load_dwordx4 v237, s[12:15], s54 offen offset:1024 lds
    buffer_load_dwordx4 v238, s[12:15], s54 offen offset:2048 lds
    buffer_load_dwordx4 v239, s[12:15], s54 offen offset:3072 lds
    s_waitcnt vmcnt(0)
    s_barrier
    ds_read_b128 v[112:115], v212 offset:0
    ds_read_b128 v[116:119], v213 offset:0
    ds_read_b128 v[120:123], v214 offset:0
    ds_read_b128 v[124:127], v215 offset:0
    ds_read_b128 v[128:131], v212 offset:4096
    ds_read_b128 v[132:135], v213 offset:4096
    ds_read_b128 v[136:139], v214 offset:4096
    ds_read_b128 v[140:143], v215 offset:4096
    s_waitcnt lgkmcnt(0)
    v_mfma_f32_16x16x32_bf16 v[80:83], v[112:115], a[144:147], 0
    v_mfma_f32_16x16x32_bf16 v[84:87], v[112:115], a[160:163], 0
    v_mfma_f32_16x16x32_bf16 v[88:91], v[112:115], a[176:179], 0
    v_mfma_f32_16x16x32_bf16 v[92:95], v[112:115], a[192:195], 0
    v_mfma_f32_16x16x32_bf16 v[80:83], v[116:119], a[148:151], v[80:83]
    v_mfma_f32_16x16x32_bf16 v[84:87], v[116:119], a[164:167], v[84:87]
    v_mfma_f32_16x16x32_bf16 v[88:91], v[116:119], a[180:183], v[88:91]
    v_mfma_f32_16x16x32_bf16 v[92:95], v[116:119], a[196:199], v[92:95]
    v_mfma_f32_16x16x32_bf16 v[80:83], v[120:123], a[152:155], v[80:83]
    v_mfma_f32_16x16x32_bf16 v[84:87], v[120:123], a[168:171], v[84:87]
    v_mfma_f32_16x16x32_bf16 v[88:91], v[120:123], a[184:187], v[88:91]
    v_mfma_f32_16x16x32_bf16 v[92:95], v[120:123], a[200:203], v[92:95]
    v_mfma_f32_16x16x32_bf16 v[80:83], v[124:127], a[156:159], v[80:83]
    v_mfma_f32_16x16x32_bf16 v[84:87], v[124:127], a[172:175], v[84:87]
    v_mfma_f32_16x16x32_bf16 v[88:91], v[124:127], a[188:191], v[88:91]
    v_mfma_f32_16x16x32_bf16 v[92:95], v[124:127], a[204:207], v[92:95]
    v_mfma_f32_16x16x32_bf16 v[64:67], v[128:131], a[144:147], 0
    v_mfma_f32_16x16x32_bf16 v[68:71], v[128:131], a[160:163], 0
    v_mfma_f32_16x16x32_bf16 v[72:75], v[128:131], a[176:179], 0
    v_mfma_f32_16x16x32_bf16 v[76:79], v[128:131], a[192:195], 0
    v_mfma_f32_16x16x32_bf16 v[64:67], v[132:135], a[148:151], v[64:67]
    v_mfma_f32_16x16x32_bf16 v[68:71], v[132:135], a[164:167], v[68:71]
    v_mfma_f32_16x16x32_bf16 v[72:75], v[132:135], a[180:183], v[72:75]
    v_mfma_f32_16x16x32_bf16 v[76:79], v[132:135], a[196:199], v[76:79]
    v_mfma_f32_16x16x32_bf16 v[64:67], v[136:139], a[152:155], v[64:67]
    v_mfma_f32_16x16x32_bf16 v[68:71], v[136:139], a[168:171], v[68:71]
    v_mfma_f32_16x16x32_bf16 v[72:75], v[136:139], a[184:187], v[72:75]
    v_mfma_f32_16x16x32_bf16 v[76:79], v[136:139], a[200:203], v[76:79]
    v_mfma_f32_16x16x32_bf16 v[64:67], v[140:143], a[156:159], v[64:67]
    v_mfma_f32_16x16x32_bf16 v[68:71], v[140:143], a[172:175], v[68:71]
    v_mfma_f32_16x16x32_bf16 v[72:75], v[140:143], a[188:191], v[72:75]
    v_mfma_f32_16x16x32_bf16 v[76:79], v[140:143], a[204:207], v[76:79]
    ds_read_b128 v[112:115], v212 offset:8192
    ds_read_b128 v[116:119], v213 offset:8192
    ds_read_b128 v[120:123], v214 offset:8192
    ds_read_b128 v[124:127], v215 offset:8192
    ds_read_b128 v[128:131], v212 offset:12288
    ds_read_b128 v[132:135], v213 offset:12288
    ds_read_b128 v[136:139], v214 offset:12288
    ds_read_b128 v[140:143], v215 offset:12288
    s_waitcnt lgkmcnt(0)
    v_mfma_f32_16x16x32_bf16 v[96:99], v[112:115], a[144:147], 0
    v_mfma_f32_16x16x32_bf16 v[100:103], v[112:115], a[160:163], 0
    v_mfma_f32_16x16x32_bf16 v[104:107], v[112:115], a[176:179], 0
    v_mfma_f32_16x16x32_bf16 v[108:111], v[112:115], a[192:195], 0
    v_mfma_f32_16x16x32_bf16 v[96:99], v[116:119], a[148:151], v[96:99]
    v_mfma_f32_16x16x32_bf16 v[100:103], v[116:119], a[164:167], v[100:103]
    v_mfma_f32_16x16x32_bf16 v[104:107], v[116:119], a[180:183], v[104:107]
    v_mfma_f32_16x16x32_bf16 v[108:111], v[116:119], a[196:199], v[108:111]
    v_mfma_f32_16x16x32_bf16 v[96:99], v[120:123], a[152:155], v[96:99]
    v_mfma_f32_16x16x32_bf16 v[100:103], v[120:123], a[168:171], v[100:103]
    v_mfma_f32_16x16x32_bf16 v[104:107], v[120:123], a[184:187], v[104:107]
    v_mfma_f32_16x16x32_bf16 v[108:111], v[120:123], a[200:203], v[108:111]
    v_mfma_f32_16x16x32_bf16 v[96:99], v[124:127], a[156:159], v[96:99]
    v_mfma_f32_16x16x32_bf16 v[100:103], v[124:127], a[172:175], v[100:103]
    v_mfma_f32_16x16x32_bf16 v[104:107], v[124:127], a[188:191], v[104:107]
    v_mfma_f32_16x16x32_bf16 v[108:111], v[124:127], a[204:207], v[108:111]
    v_mfma_f32_16x16x32_bf16 v[48:51], v[128:131], a[144:147], 0
    v_mfma_f32_16x16x32_bf16 v[52:55], v[128:131], a[160:163], 0
    v_mfma_f32_16x16x32_bf16 v[56:59], v[128:131], a[176:179], 0
    v_mfma_f32_16x16x32_bf16 v[60:63], v[128:131], a[192:195], 0
    v_mfma_f32_16x16x32_bf16 v[48:51], v[132:135], a[148:151], v[48:51]
    v_mfma_f32_16x16x32_bf16 v[52:55], v[132:135], a[164:167], v[52:55]
    v_mfma_f32_16x16x32_bf16 v[56:59], v[132:135], a[180:183], v[56:59]
    v_mfma_f32_16x16x32_bf16 v[60:63], v[132:135], a[196:199], v[60:63]
    v_mfma_f32_16x16x32_bf16 v[48:51], v[136:139], a[152:155], v[48:51]
    v_mfma_f32_16x16x32_bf16 v[52:55], v[136:139], a[168:171], v[52:55]
    v_mfma_f32_16x16x32_bf16 v[56:59], v[136:139], a[184:187], v[56:59]
    v_mfma_f32_16x16x32_bf16 v[60:63], v[136:139], a[200:203], v[60:63]
    v_mfma_f32_16x16x32_bf16 v[48:51], v[140:143], a[156:159], v[48:51]
    v_mfma_f32_16x16x32_bf16 v[52:55], v[140:143], a[172:175], v[52:55]
    v_mfma_f32_16x16x32_bf16 v[56:59], v[140:143], a[188:191], v[56:59]
    v_mfma_f32_16x16x32_bf16 v[60:63], v[140:143], a[204:207], v[60:63]
    v_max3_f32 v2, v2, v80, v81
    v_max3_f32 v2, v2, v82, v83
    v_max3_f32 v2, v2, v64, v65
    v_max3_f32 v2, v2, v66, v67
    v_max3_f32 v2, v2, v96, v97
    v_max3_f32 v2, v2, v98, v99
    v_max3_f32 v2, v2, v48, v49
    v_max3_f32 v2, v2, v50, v51
    v_max3_f32 v3, v3, v84, v85
    v_max3_f32 v3, v3, v86, v87
    v_max3_f32 v3, v3, v68, v69
    v_max3_f32 v3, v3, v70, v71
    v_max3_f32 v3, v3, v100, v101
    v_max3_f32 v3, v3, v102, v103
    v_max3_f32 v3, v3, v52, v53
    v_max3_f32 v3, v3, v54, v55
    v_max3_f32 v4, v4, v88, v89
    v_max3_f32 v4, v4, v90, v91
    v_max3_f32 v4, v4, v72, v73
    v_max3_f32 v4, v4, v74, v75
    v_max3_f32 v4, v4, v104, v105
    v_max3_f32 v4, v4, v106, v107
    v_max3_f32 v4, v4, v56, v57
    v_max3_f32 v4, v4, v58, v59
    v_max3_f32 v5, v5, v92, v93
    v_max3_f32 v5, v5, v94, v95
    v_max3_f32 v5, v5, v76, v77
    v_max3_f32 v5, v5, v78, v79
    v_max3_f32 v5, v5, v108, v109
    v_max3_f32 v5, v5, v110, v111
    v_max3_f32 v5, v5, v60, v61
    v_max3_f32 v5, v5, v62, v63
    s_barrier
    s_sub_u32 s32, s32, 1
    s_cmp_lg_u32 s32, 0
    s_cbranch_scc1 f_fb_loop
    v_mov_b32 v6, v2
    v_mov_b32 v7, v3
    v_mov_b32 v8, v4
    v_mov_b32 v9, v5
    v_permlane32_swap_b32 v2, v6
    v_permlane32_swap_b32 v3, v7
    v_permlane32_swap_b32 v4, v8
    v_permlane32_swap_b32 v5, v9
    v_max_f32 v2, v2, v6
    v_max_f32 v3, v3, v7
    v_max_f32 v4, v4, v8
    v_max_f32 v5, v5, v9
    v_mov_b32 v6, v2
    v_mov_b32 v7, v3
    v_mov_b32 v8, v4
    v_mov_b32 v9, v5
    v_permlane16_swap_b32 v2, v6
    v_permlane16_swap_b32 v3, v7
    v_permlane16_swap_b32 v4, v8
    v_permlane16_swap_b32 v5, v9
    v_max_f32 v2, v2, v6
    v_max_f32 v3, v3, v7
    v_max_f32 v4, v4, v8
    v_max_f32 v5, v5, v9
    v_sub_f32 v176, 0, v2
    v_sub_f32 v177, 0, v2
    v_sub_f32 v178, 0, v2
    v_sub_f32 v179, 0, v2
    v_sub_f32 v180, 0, v3
    v_sub_f32 v181, 0, v3
    v_sub_f32 v182, 0, v3
    v_sub_f32 v183, 0, v3
    v_sub_f32 v184, 0, v4
    v_sub_f32 v185, 0, v4
    v_sub_f32 v186, 0, v4
    v_sub_f32 v187, 0, v4
    v_sub_f32 v188, 0, v5
    v_sub_f32 v189, 0, v5
    v_sub_f32 v190, 0, v5
    v_sub_f32 v191, 0, v5
    v_mov_b32 v12, 0
    v_mov_b32 v13, 0
    v_mov_b32 v14, 0
    v_mov_b32 v15, 0
    s_nop 0
    s_nop 0
    v_mfma_f32_16x16x32_bf16 a[0:3], v[12:15], v[12:15], 0
    v_mfma_f32_16x16x32_bf16 a[4:7], v[12:15], v[12:15], 0
    v_mfma_f32_16x16x32_bf16 a[8:11], v[12:15], v[12:15], 0
    v_mfma_f32_16x16x32_bf16 a[12:15], v[12:15], v[12:15], 0
    v_mfma_f32_16x16x32_bf16 a[16:19], v[12:15], v[12:15], 0
    v_mfma_f32_16x16x32_bf16 a[20:23], v[12:15], v[12:15], 0
    v_mfma_f32_16x16x32_bf16 a[24:27], v[12:15], v[12:15], 0
    v_mfma_f32_16x16x32_bf16 a[28:31], v[12:15], v[12:15], 0
    v_mfma_f32_16x16x32_bf16 a[32:35], v[12:15], v[12:15], 0
    v_mfma_f32_16x16x32_bf16 a[36:39], v[12:15], v[12:15], 0
    v_mfma_f32_16x16x32_bf16 a[40:43], v[12:15], v[12:15], 0
    v_mfma_f32_16x16x32_bf16 a[44:47], v[12:15], v[12:15], 0
    v_mfma_f32_16x16x32_bf16 a[48:51], v[12:15], v[12:15], 0
    v_mfma_f32_16x16x32_bf16 a[52:55], v[12:15], v[12:15], 0
    v_mfma_f32_16x16x32_bf16 a[56:59], v[12:15], v[12:15], 0
    v_mfma_f32_16x16x32_bf16 a[60:63], v[12:15], v[12:15], 0
    v_mfma_f32_16x16x32_bf16 a[64:67], v[12:15], v[12:15], 0
    v_mfma_f32_16x16x32_bf16 a[68:71], v[12:15], v[12:15], 0
    v_mfma_f32_16x16x32_bf16 a[72:75], v[12:15], v[12:15], 0
    v_mfma_f32_16x16x32_bf16 a[76:79], v[12:15], v[12:15], 0
    v_mfma_f32_16x16x32_bf16 a[80:83], v[12:15], v[12:15], 0
    v_mfma_f32_16x16x32_bf16 a[84:87], v[12:15], v[12:15], 0
    v_mfma_f32_16x16x32_bf16 a[88:91], v[12:15], v[12:15], 0
    v_mfma_f32_16x16x32_bf16 a[92:95], v[12:15], v[12:15], 0
    v_mfma_f32_16x16x32_bf16 a[96:99], v[12:15], v[12:15], 0
    v_mfma_f32_16x16x32_bf16 a[100:103], v[12:15], v[12:15], 0
    v_mfma_f32_16x16x32_bf16 a[104:107], v[12:15], v[12:15], 0
    v_mfma_f32_16x16x32_bf16 a[108:111], v[12:15], v[12:15], 0
    v_mfma_f32_16x16x32_bf16 a[112:115], v[12:15], v[12:15], 0
    v_mfma_f32_16x16x32_bf16 a[116:119], v[12:15], v[12:15], 0
    v_mfma_f32_16x16x32_bf16 a[120:123], v[12:15], v[12:15], 0
    v_mfma_f32_16x16x32_bf16 a[124:127], v[12:15], v[12:15], 0
    v_mfma_f32_16x16x32_bf16 a[128:131], v[12:15], v[12:15], 0
    v_mfma_f32_16x16x32_bf16 a[132:135], v[12:15], v[12:15], 0
    v_mfma_f32_16x16x32_bf16 a[136:139], v[12:15], v[12:15], 0
    v_mfma_f32_16x16x32_bf16 a[140:143], v[12:15], v[12:15], 0
    s_mov_b32 s54, 4294950912
    s_mov_b32 s55, 4294950912
    s_add_u32 s54, s54, 16384
    s_add_u32 m0, s53, 98304
    s_nop 0
    buffer_load_dwordx4 v236, s[12:15], s54 offen offset:0 lds
    buffer_load_dwordx4 v237, s[12:15], s54 offen offset:1024 lds
    buffer_load_dwordx4 v238, s[12:15], s54 offen offset:2048 lds
    buffer_load_dwordx4 v239, s[12:15], s54 offen offset:3072 lds
    s_add_u32 s54, s54, 16384
    s_add_u32 m0, s53, 0
    s_nop 0
    buffer_load_dwordx4 v236, s[12:15], s54 offen offset:0 lds
    buffer_load_dwordx4 v237, s[12:15], s54 offen offset:1024 lds
    buffer_load_dwordx4 v238, s[12:15], s54 offen offset:2048 lds
    buffer_load_dwordx4 v239, s[12:15], s54 offen offset:3072 lds
    s_add_u32 s55, s55, 16384
    s_add_u32 m0, s53, 16384
    s_nop 0
    buffer_load_dwordx4 v240, s[16:19], s55 offen offset:0 lds
    buffer_load_dwordx4 v241, s[16:19], s55 offen offset:1024 lds
    buffer_load_dwordx4 v240, s[16:19], s55 offen offset:2048 lds
    buffer_load_dwordx4 v241, s[16:19], s55 offen offset:3072 lds
    s_add_u32 s54, s54, 16384
    s_add_u32 m0, s53, 32768
    s_nop 0
    buffer_load_dwordx4 v236, s[12:15], s54 offen offset:0 lds
    buffer_load_dwordx4 v237, s[12:15], s54 offen offset:1024 lds
    buffer_load_dwordx4 v238, s[12:15], s54 offen offset:2048 lds
    buffer_load_dwordx4 v239, s[12:15], s54 offen offset:3072 lds
    s_add_u32 s55, s55, 16384
    s_add_u32 m0, s53, 49152
    s_nop 0
    buffer_load_dwordx4 v240, s[16:19], s55 offen offset:0 lds
    buffer_load_dwordx4 v241, s[16:19], s55 offen offset:1024 lds
    buffer_load_dwordx4 v240, s[16:19], s55 offen offset:2048 lds
    buffer_load_dwordx4 v241, s[16:19], s55 offen offset:3072 lds
    s_add_u32 s54, s54, 16384
    s_add_u32 m0, s53, 65536
    s_nop 0
    buffer_load_dwordx4 v236, s[12:15], s54 offen offset:0 lds
    buffer_load_dwordx4 v237, s[12:15], s54 offen offset:1024 lds
    s_waitcnt vmcnt(0)
    s_barrier
    s_branch f_att_go
f_publish:
    s_cmp_eq_u32 s32, 3
    s_cbranch_scc1 f_pub_f1
    v_mov_b32 v8, 1
    s_mov_b64 exec, 1
    buffer_atomic_add v8, off, s[96:99], s61 sc1
    s_mov_b64 exec, -1
    s_mov_b32 s95, 3
    s_branch f_pub_ret
f_pub_f1:
    v_mov_b32 v8, s92
    v_mov_b32 v9, s93
    s_lshl_b32 s28, s2, 3
    s_add_u32 s28, s28, 12591104
    s_mov_b64 exec, 1
    buffer_store_dwordx2 v[8:9], off, s[40:43], s28 sc1
    s_mov_b64 exec, -1
    s_mov_b32 s95, -1
    s_branch f_pub_ret
f_mid:
    s_mov_b32 s94, -1
    s_cmp_lt_u32 s4, 16
    s_cbranch_scc1 f_mid_skip
    v_readfirstlane_b32 s35, v199
    s_cmp_ge_u32 s35, 16
    s_cbranch_scc1 f_ready
f_spin:
    buffer_load_dword v198, off, s[96:99], s61 sc1
    s_waitcnt vmcnt(0)
    v_readfirstlane_b32 s35, v198
    s_cmp_lt_u32 s35, 16
    s_cbranch_scc1 f_spin
    buffer_load_dwordx2 v[196:197], v200, s[24:27], s62 offen sc1
    s_waitcnt vmcnt(0)
f_ready:
    v_mul_f32 v12, 0x3a124925, v196
    v_mul_f32 v13, 0x3a124925, v197
    v_fma_f32 v13, -v12, v12, v13
    v_max_f32 v13, 0, v13
    v_cvt_pk_bf16_f32 v14, v12, v13
    v_lshlrev_b32 v12, 16, v14
    v_and_b32 v13, 0xffff0000, v14
    v_add_f32 v13, 0x3727c5ac, v13
    v_cvt_pk_bf16_f32 v13, v13, v13
    v_and_b32 v13, 0xffff0000, v13
    v_sqrt_f32 v13, v13
    s_nop 0
    v_cvt_pk_bf16_f32 v13, v13, v13
    v_and_b32 v13, 0xffff0000, v13
    v_rcp_f32 v13, v13
    v_and_b32 v11, 15, v1
    v_lshlrev_b32 v11, 3, v11
    v_mul_f32 v12, v12, v13
    v_sub_f32 v12, 0, v12
    v_lshrrev_b32 v10, 5, v1
    v_lshl_add_u32 v11, v10, 5, v11
    v_and_b32 v11, 127, v11
    v_lshrrev_b32 v10, 4, v1
    v_lshl_add_u32 v11, v10, 7, v11
    s_lshl_b32 s28, s5, 4
    s_lshl_b32 s29, s3, 2
    s_add_u32 s28, s28, s29
    s_lshl_b32 s28, s28, 12
    s_and_b32 s29, s4, 15
    s_lshl_b32 s29, s29, 19
    s_add_u32 s29, s29, s28
    s_add_u32 s29, s29, 16777216
    v_mov_b32 v2, v13
    v_mov_b32 v6, v13
    s_nop 1
    v_permlane32_swap_b32 v2, v6
    v_mov_b32 v4, v2
    v_mov_b32 v8, v6
    s_nop 0
    v_permlane16_swap_b32 v2, v4
    v_permlane16_swap_b32 v6, v8
    v_mov_b32 v3, v12
    v_mov_b32 v7, v12
    s_nop 0
    s_nop 0
    v_permlane32_swap_b32 v3, v7
    v_mov_b32 v5, v3
    v_mov_b32 v9, v7
    s_nop 0
    v_permlane16_swap_b32 v3, v5
    v_permlane16_swap_b32 v7, v9
    v_accvgpr_read_b32 v12, a208
    v_accvgpr_read_b32 v13, a209
    v_lshlrev_b32 v196, 16, v12
    v_and_b32 v197, 0xffff0000, v12
    v_lshlrev_b32 v198, 16, v13
    v_and_b32 v199, 0xffff0000, v13
    v_pk_fma_f32 v[196:197], v[196:197], v[2:3], v[2:3] op_sel:[0,0,1] op_sel_hi:[1,0,1]
    v_pk_fma_f32 v[198:199], v[198:199], v[2:3], v[2:3] op_sel:[0,0,1] op_sel_hi:[1,0,1]
    v_cvt_pk_bf16_f32 v12, v196, v197
    v_cvt_pk_bf16_f32 v13, v198, v199
    buffer_store_dwordx2 v[12:13], v11, s[24:27], s29 offen offset:0 sc1
    v_accvgpr_read_b32 v14, a210
    v_accvgpr_read_b32 v15, a211
    v_lshlrev_b32 v196, 16, v14
    v_and_b32 v197, 0xffff0000, v14
    v_lshlrev_b32 v198, 16, v15
    v_and_b32 v199, 0xffff0000, v15
    v_pk_fma_f32 v[196:197], v[196:197], v[2:3], v[2:3] op_sel:[0,0,1] op_sel_hi:[1,0,1]
    v_pk_fma_f32 v[198:199], v[198:199], v[2:3], v[2:3] op_sel:[0,0,1] op_sel_hi:[1,0,1]
    v_cvt_pk_bf16_f32 v14, v196, v197
    v_cvt_pk_bf16_f32 v15, v198, v199
    buffer_store_dwordx2 v[14:15], v11, s[24:27], s29 offen offset:512 sc1
    v_accvgpr_read_b32 v12, a212
    v_accvgpr_read_b32 v13, a213
    v_lshlrev_b32 v196, 16, v12
    v_and_b32 v197, 0xffff0000, v12
    v_lshlrev_b32 v198, 16, v13
    v_and_b32 v199, 0xffff0000, v13
    v_pk_fma_f32 v[196:197], v[196:197], v[2:3], v[2:3] op_sel:[0,0,1] op_sel_hi:[1,0,1]
    v_pk_fma_f32 v[198:199], v[198:199], v[2:3], v[2:3] op_sel:[0,0,1] op_sel_hi:[1,0,1]
    v_cvt_pk_bf16_f32 v12, v196, v197
    v_cvt_pk_bf16_f32 v13, v198, v199
    buffer_store_dwordx2 v[12:13], v11, s[24:27], s29 offen offset:1024 sc1
    v_accvgpr_read_b32 v14, a214
    v_accvgpr_read_b32 v15, a215
    v_lshlrev_b32 v196, 16, v14
    v_and_b32 v197, 0xffff0000, v14
    v_lshlrev_b32 v198, 16, v15
    v_and_b32 v199, 0xffff0000, v15
    v_pk_fma_f32 v[196:197], v[196:197], v[2:3], v[2:3] op_sel:[0,0,1] op_sel_hi:[1,0,1]
    v_pk_fma_f32 v[198:199], v[198:199], v[2:3], v[2:3] op_sel:[0,0,1] op_sel_hi:[1,0,1]
    v_cvt_pk_bf16_f32 v14, v196, v197
    v_cvt_pk_bf16_f32 v15, v198, v199
    buffer_store_dwordx2 v[14:15], v11, s[24:27], s29 offen offset:1536 sc1
    v_accvgpr_read_b32 v12, a216
    v_accvgpr_read_b32 v13, a217
    v_lshlrev_b32 v196, 16, v12
    v_and_b32 v197, 0xffff0000, v12
    v_lshlrev_b32 v198, 16, v13
    v_and_b32 v199, 0xffff0000, v13
    v_pk_fma_f32 v[196:197], v[196:197], v[2:3], v[2:3] op_sel:[0,0,1] op_sel_hi:[1,0,1]
    v_pk_fma_f32 v[198:199], v[198:199], v[2:3], v[2:3] op_sel:[0,0,1] op_sel_hi:[1,0,1]
    v_cvt_pk_bf16_f32 v12, v196, v197
    v_cvt_pk_bf16_f32 v13, v198, v199
    buffer_store_dwordx2 v[12:13], v11, s[24:27], s29 offen offset:2048 sc1
    v_accvgpr_read_b32 v14, a218
    v_accvgpr_read_b32 v15, a219
    v_lshlrev_b32 v196, 16, v14
    v_and_b32 v197, 0xffff0000, v14
    v_lshlrev_b32 v198, 16, v15
    v_and_b32 v199, 0xffff0000, v15
    v_pk_fma_f32 v[196:197], v[196:197], v[2:3], v[2:3] op_sel:[0,0,1] op_sel_hi:[1,0,1]
    v_pk_fma_f32 v[198:199], v[198:199], v[2:3], v[2:3] op_sel:[0,0,1] op_sel_hi:[1,0,1]
    v_cvt_pk_bf16_f32 v14, v196, v197
    v_cvt_pk_bf16_f32 v15, v198, v199
    buffer_store_dwordx2 v[14:15], v11, s[24:27], s29 offen offset:2560 sc1
    v_accvgpr_read_b32 v12, a220
    v_accvgpr_read_b32 v13, a221
    v_lshlrev_b32 v196, 16, v12
    v_and_b32 v197, 0xffff0000, v12
    v_lshlrev_b32 v198, 16, v13
    v_and_b32 v199, 0xffff0000, v13
    v_pk_fma_f32 v[196:197], v[196:197], v[2:3], v[2:3] op_sel:[0,0,1] op_sel_hi:[1,0,1]
    v_pk_fma_f32 v[198:199], v[198:199], v[2:3], v[2:3] op_sel:[0,0,1] op_sel_hi:[1,0,1]
    v_cvt_pk_bf16_f32 v12, v196, v197
    v_cvt_pk_bf16_f32 v13, v198, v199
    buffer_store_dwordx2 v[12:13], v11, s[24:27], s29 offen offset:3072 sc1
    s_add_u32 s29, s29, 4096
    v_accvgpr_read_b32 v14, a222
    v_accvgpr_read_b32 v15, a223
    v_lshlrev_b32 v196, 16, v14
    v_and_b32 v197, 0xffff0000, v14
    v_lshlrev_b32 v198, 16, v15
    v_and_b32 v199, 0xffff0000, v15
    v_pk_fma_f32 v[196:197], v[196:197], v[4:5], v[4:5] op_sel:[0,0,1] op_sel_hi:[1,0,1]
    v_pk_fma_f32 v[198:199], v[198:199], v[4:5], v[4:5] op_sel:[0,0,1] op_sel_hi:[1,0,1]
    v_cvt_pk_bf16_f32 v14, v196, v197
    v_cvt_pk_bf16_f32 v15, v198, v199
    buffer_store_dwordx2 v[14:15], v11, s[24:27], s29 offen offset:0 sc1
    v_accvgpr_read_b32 v12, a224
    v_accvgpr_read_b32 v13, a225
    v_lshlrev_b32 v196, 16, v12
    v_and_b32 v197, 0xffff0000, v12
    v_lshlrev_b32 v198, 16, v13
    v_and_b32 v199, 0xffff0000, v13
    v_pk_fma_f32 v[196:197], v[196:197], v[4:5], v[4:5] op_sel:[0,0,1] op_sel_hi:[1,0,1]
    v_pk_fma_f32 v[198:199], v[198:199], v[4:5], v[4:5] op_sel:[0,0,1] op_sel_hi:[1,0,1]
    v_cvt_pk_bf16_f32 v12, v196, v197
    v_cvt_pk_bf16_f32 v13, v198, v199
    buffer_store_dwordx2 v[12:13], v11, s[24:27], s29 offen offset:512 sc1
    v_accvgpr_read_b32 v14, a226
    v_accvgpr_read_b32 v15, a227
    v_lshlrev_b32 v196, 16, v14
    v_and_b32 v197, 0xffff0000, v14
    v_lshlrev_b32 v198, 16, v15
    v_and_b32 v199, 0xffff0000, v15
    v_pk_fma_f32 v[196:197], v[196:197], v[4:5], v[4:5] op_sel:[0,0,1] op_sel_hi:[1,0,1]
    v_pk_fma_f32 v[198:199], v[198:199], v[4:5], v[4:5] op_sel:[0,0,1] op_sel_hi:[1,0,1]
    v_cvt_pk_bf16_f32 v14, v196, v197
    v_cvt_pk_bf16_f32 v15, v198, v199
    buffer_store_dwordx2 v[14:15], v11, s[24:27], s29 offen offset:1024 sc1
    v_accvgpr_read_b32 v12, a228
    v_accvgpr_read_b32 v13, a229
    v_lshlrev_b32 v196, 16, v12
    v_and_b32 v197, 0xffff0000, v12
    v_lshlrev_b32 v198, 16, v13
    v_and_b32 v199, 0xffff0000, v13
    v_pk_fma_f32 v[196:197], v[196:197], v[4:5], v[4:5] op_sel:[0,0,1] op_sel_hi:[1,0,1]
    v_pk_fma_f32 v[198:199], v[198:199], v[4:5], v[4:5] op_sel:[0,0,1] op_sel_hi:[1,0,1]
    v_cvt_pk_bf16_f32 v12, v196, v197
    v_cvt_pk_bf16_f32 v13, v198, v199
    buffer_store_dwordx2 v[12:13], v11, s[24:27], s29 offen offset:1536 sc1
    v_accvgpr_read_b32 v14, a230
    v_accvgpr_read_b32 v15, a231
    v_lshlrev_b32 v196, 16, v14
    v_and_b32 v197, 0xffff0000, v14
    v_lshlrev_b32 v198, 16, v15
    v_and_b32 v199, 0xffff0000, v15
    v_pk_fma_f32 v[196:197], v[196:197], v[4:5], v[4:5] op_sel:[0,0,1] op_sel_hi:[1,0,1]
    v_pk_fma_f32 v[198:199], v[198:199], v[4:5], v[4:5] op_sel:[0,0,1] op_sel_hi:[1,0,1]
    v_cvt_pk_bf16_f32 v14, v196, v197
    v_cvt_pk_bf16_f32 v15, v198, v199
    buffer_store_dwordx2 v[14:15], v11, s[24:27], s29 offen offset:2048 sc1
    v_accvgpr_read_b32 v12, a232
    v_accvgpr_read_b32 v13, a233
    v_lshlrev_b32 v196, 16, v12
    v_and_b32 v197, 0xffff0000, v12
    v_lshlrev_b32 v198, 16, v13
    v_and_b32 v199, 0xffff0000, v13
    v_pk_fma_f32 v[196:197], v[196:197], v[4:5], v[4:5] op_sel:[0,0,1] op_sel_hi:[1,0,1]
    v_pk_fma_f32 v[198:199], v[198:199], v[4:5], v[4:5] op_sel:[0,0,1] op_sel_hi:[1,0,1]
    v_cvt_pk_bf16_f32 v12, v196, v197
    v_cvt_pk_bf16_f32 v13, v198, v199
    buffer_store_dwordx2 v[12:13], v11, s[24:27], s29 offen offset:2560 sc1
    v_accvgpr_read_b32 v14, a234
    v_accvgpr_read_b32 v15, a235
    v_lshlrev_b32 v196, 16, v14
    v_and_b32 v197, 0xffff0000, v14
    v_lshlrev_b32 v198, 16, v15
    v_and_b32 v199, 0xffff0000, v15
    v_pk_fma_f32 v[196:197], v[196:197], v[4:5], v[4:5] op_sel:[0,0,1] op_sel_hi:[1,0,1]
    v_pk_fma_f32 v[198:199], v[198:199], v[4:5], v[4:5] op_sel:[0,0,1] op_sel_hi:[1,0,1]
    v_cvt_pk_bf16_f32 v14, v196, v197
    v_cvt_pk_bf16_f32 v15, v198, v199
    buffer_store_dwordx2 v[14:15], v11, s[24:27], s29 offen offset:3072 sc1
    s_add_u32 s29, s29, 4096
    v_accvgpr_read_b32 v12, a236
    v_accvgpr_read_b32 v13, a237
    v_lshlrev_b32 v196, 16, v12
    v_and_b32 v197, 0xffff0000, v12
    v_lshlrev_b32 v198, 16, v13
    v_and_b32 v199, 0xffff0000, v13
    v_pk_fma_f32 v[196:197], v[196:197], v[6:7], v[6:7] op_sel:[0,0,1] op_sel_hi:[1,0,1]
    v_pk_fma_f32 v[198:199], v[198:199], v[6:7], v[6:7] op_sel:[0,0,1] op_sel_hi:[1,0,1]
    v_cvt_pk_bf16_f32 v12, v196, v197
    v_cvt_pk_bf16_f32 v13, v198, v199
    buffer_store_dwordx2 v[12:13], v11, s[24:27], s29 offen offset:0 sc1
    v_accvgpr_read_b32 v14, a238
    v_accvgpr_read_b32 v15, a239
    v_lshlrev_b32 v196, 16, v14
    v_and_b32 v197, 0xffff0000, v14
    v_lshlrev_b32 v198, 16, v15
    v_and_b32 v199, 0xffff0000, v15
    v_pk_fma_f32 v[196:197], v[196:197], v[6:7], v[6:7] op_sel:[0,0,1] op_sel_hi:[1,0,1]
    v_pk_fma_f32 v[198:199], v[198:199], v[6:7], v[6:7] op_sel:[0,0,1] op_sel_hi:[1,0,1]
    v_cvt_pk_bf16_f32 v14, v196, v197
    v_cvt_pk_bf16_f32 v15, v198, v199
    buffer_store_dwordx2 v[14:15], v11, s[24:27], s29 offen offset:512 sc1
    v_accvgpr_read_b32 v12, a240
    v_accvgpr_read_b32 v13, a241
    v_lshlrev_b32 v196, 16, v12
    v_and_b32 v197, 0xffff0000, v12
    v_lshlrev_b32 v198, 16, v13
    v_and_b32 v199, 0xffff0000, v13
    v_pk_fma_f32 v[196:197], v[196:197], v[6:7], v[6:7] op_sel:[0,0,1] op_sel_hi:[1,0,1]
    v_pk_fma_f32 v[198:199], v[198:199], v[6:7], v[6:7] op_sel:[0,0,1] op_sel_hi:[1,0,1]
    v_cvt_pk_bf16_f32 v12, v196, v197
    v_cvt_pk_bf16_f32 v13, v198, v199
    buffer_store_dwordx2 v[12:13], v11, s[24:27], s29 offen offset:1024 sc1
    v_accvgpr_read_b32 v14, a242
    v_accvgpr_read_b32 v15, a243
    v_lshlrev_b32 v196, 16, v14
    v_and_b32 v197, 0xffff0000, v14
    v_lshlrev_b32 v198, 16, v15
    v_and_b32 v199, 0xffff0000, v15
    v_pk_fma_f32 v[196:197], v[196:197], v[6:7], v[6:7] op_sel:[0,0,1] op_sel_hi:[1,0,1]
    v_pk_fma_f32 v[198:199], v[198:199], v[6:7], v[6:7] op_sel:[0,0,1] op_sel_hi:[1,0,1]
    v_cvt_pk_bf16_f32 v14, v196, v197
    v_cvt_pk_bf16_f32 v15, v198, v199
    buffer_store_dwordx2 v[14:15], v11, s[24:27], s29 offen offset:1536 sc1
    v_accvgpr_read_b32 v12, a244
    v_accvgpr_read_b32 v13, a245
    v_lshlrev_b32 v196, 16, v12
    v_and_b32 v197, 0xffff0000, v12
    v_lshlrev_b32 v198, 16, v13
    v_and_b32 v199, 0xffff0000, v13
    v_pk_fma_f32 v[196:197], v[196:197], v[6:7], v[6:7] op_sel:[0,0,1] op_sel_hi:[1,0,1]
    v_pk_fma_f32 v[198:199], v[198:199], v[6:7], v[6:7] op_sel:[0,0,1] op_sel_hi:[1,0,1]
    v_cvt_pk_bf16_f32 v12, v196, v197
    v_cvt_pk_bf16_f32 v13, v198, v199
    buffer_store_dwordx2 v[12:13], v11, s[24:27], s29 offen offset:2048 sc1
    v_accvgpr_read_b32 v14, a246
    v_accvgpr_read_b32 v15, a247
    v_lshlrev_b32 v196, 16, v14
    v_and_b32 v197, 0xffff0000, v14
    v_lshlrev_b32 v198, 16, v15
    v_and_b32 v199, 0xffff0000, v15
    v_pk_fma_f32 v[196:197], v[196:197], v[6:7], v[6:7] op_sel:[0,0,1] op_sel_hi:[1,0,1]
    v_pk_fma_f32 v[198:199], v[198:199], v[6:7], v[6:7] op_sel:[0,0,1] op_sel_hi:[1,0,1]
    v_cvt_pk_bf16_f32 v14, v196, v197
    v_cvt_pk_bf16_f32 v15, v198, v199
    buffer_store_dwordx2 v[14:15], v11, s[24:27], s29 offen offset:2560 sc1
    v_accvgpr_read_b32 v12, a248
    v_accvgpr_read_b32 v13, a249
    v_lshlrev_b32 v196, 16, v12
    v_and_b32 v197, 0xffff0000, v12
    v_lshlrev_b32 v198, 16, v13
    v_and_b32 v199, 0xffff0000, v13
    v_pk_fma_f32 v[196:197], v[196:197], v[6:7], v[6:7] op_sel:[0,0,1] op_sel_hi:[1,0,1]
    v_pk_fma_f32 v[198:199], v[198:199], v[6:7], v[6:7] op_sel:[0,0,1] op_sel_hi:[1,0,1]
    v_cvt_pk_bf16_f32 v12, v196, v197
    v_cvt_pk_bf16_f32 v13, v198, v199
    buffer_store_dwordx2 v[12:13], v11, s[24:27], s29 offen offset:3072 sc1
    s_add_u32 s29, s29, 4096
    v_accvgpr_read_b32 v14, a250
    v_accvgpr_read_b32 v15, a251
    v_lshlrev_b32 v196, 16, v14
    v_and_b32 v197, 0xffff0000, v14
    v_lshlrev_b32 v198, 16, v15
    v_and_b32 v199, 0xffff0000, v15
    v_pk_fma_f32 v[196:197], v[196:197], v[8:9], v[8:9] op_sel:[0,0,1] op_sel_hi:[1,0,1]
    v_pk_fma_f32 v[198:199], v[198:199], v[8:9], v[8:9] op_sel:[0,0,1] op_sel_hi:[1,0,1]
    v_cvt_pk_bf16_f32 v14, v196, v197
    v_cvt_pk_bf16_f32 v15, v198, v199
    buffer_store_dwordx2 v[14:15], v11, s[24:27], s29 offen offset:0 sc1
    v_accvgpr_read_b32 v12, a252
    v_accvgpr_read_b32 v13, a253
    v_lshlrev_b32 v196, 16, v12
    v_and_b32 v197, 0xffff0000, v12
    v_lshlrev_b32 v198, 16, v13
    v_and_b32 v199, 0xffff0000, v13
    v_pk_fma_f32 v[196:197], v[196:197], v[8:9], v[8:9] op_sel:[0,0,1] op_sel_hi:[1,0,1]
    v_pk_fma_f32 v[198:199], v[198:199], v[8:9], v[8:9] op_sel:[0,0,1] op_sel_hi:[1,0,1]
    v_cvt_pk_bf16_f32 v12, v196, v197
    v_cvt_pk_bf16_f32 v13, v198, v199
    buffer_store_dwordx2 v[12:13], v11, s[24:27], s29 offen offset:512 sc1
    v_accvgpr_read_b32 v14, a254
    v_accvgpr_read_b32 v15, a255
    v_lshlrev_b32 v196, 16, v14
    v_and_b32 v197, 0xffff0000, v14
    v_lshlrev_b32 v198, 16, v15
    v_and_b32 v199, 0xffff0000, v15
    v_pk_fma_f32 v[196:197], v[196:197], v[8:9], v[8:9] op_sel:[0,0,1] op_sel_hi:[1,0,1]
    v_pk_fma_f32 v[198:199], v[198:199], v[8:9], v[8:9] op_sel:[0,0,1] op_sel_hi:[1,0,1]
    v_cvt_pk_bf16_f32 v14, v196, v197
    v_cvt_pk_bf16_f32 v15, v198, v199
    buffer_store_dwordx2 v[14:15], v11, s[24:27], s29 offen offset:1024 sc1
    v_lshlrev_b32 v196, 16, v242
    v_and_b32 v197, 0xffff0000, v242
    v_lshlrev_b32 v198, 16, v243
    v_and_b32 v199, 0xffff0000, v243
    v_pk_fma_f32 v[196:197], v[196:197], v[8:9], v[8:9] op_sel:[0,0,1] op_sel_hi:[1,0,1]
    v_pk_fma_f32 v[198:199], v[198:199], v[8:9], v[8:9] op_sel:[0,0,1] op_sel_hi:[1,0,1]
    v_cvt_pk_bf16_f32 v12, v196, v197
    v_cvt_pk_bf16_f32 v13, v198, v199
    buffer_store_dwordx2 v[12:13], v11, s[24:27], s29 offen offset:1536 sc1
    v_lshlrev_b32 v196, 16, v244
    v_and_b32 v197, 0xffff0000, v244
    v_lshlrev_b32 v198, 16, v245
    v_and_b32 v199, 0xffff0000, v245
    v_pk_fma_f32 v[196:197], v[196:197], v[8:9], v[8:9] op_sel:[0,0,1] op_sel_hi:[1,0,1]
    v_pk_fma_f32 v[198:199], v[198:199], v[8:9], v[8:9] op_sel:[0,0,1] op_sel_hi:[1,0,1]
    v_cvt_pk_bf16_f32 v14, v196, v197
    v_cvt_pk_bf16_f32 v15, v198, v199
    buffer_store_dwordx2 v[14:15], v11, s[24:27], s29 offen offset:2048 sc1
    v_lshlrev_b32 v196, 16, v246
    v_and_b32 v197, 0xffff0000, v246
    v_lshlrev_b32 v198, 16, v247
    v_and_b32 v199, 0xffff0000, v247
    v_pk_fma_f32 v[196:197], v[196:197], v[8:9], v[8:9] op_sel:[0,0,1] op_sel_hi:[1,0,1]
    v_pk_fma_f32 v[198:199], v[198:199], v[8:9], v[8:9] op_sel:[0,0,1] op_sel_hi:[1,0,1]
    v_cvt_pk_bf16_f32 v12, v196, v197
    v_cvt_pk_bf16_f32 v13, v198, v199
    buffer_store_dwordx2 v[12:13], v11, s[24:27], s29 offen offset:2560 sc1
    v_lshlrev_b32 v196, 16, v248
    v_and_b32 v197, 0xffff0000, v248
    v_lshlrev_b32 v198, 16, v249
    v_and_b32 v199, 0xffff0000, v249
    v_pk_fma_f32 v[196:197], v[196:197], v[8:9], v[8:9] op_sel:[0,0,1] op_sel_hi:[1,0,1]
    v_pk_fma_f32 v[198:199], v[198:199], v[8:9], v[8:9] op_sel:[0,0,1] op_sel_hi:[1,0,1]
    v_cvt_pk_bf16_f32 v14, v196, v197
    v_cvt_pk_bf16_f32 v15, v198, v199
    buffer_store_dwordx2 v[14:15], v11, s[24:27], s29 offen offset:3072 sc1
f_mid_skip:
    s_lshr_b32 s28, s2, 3
    s_lshl_b32 s28, s28, 2
    s_add_u32 s28, s28, s3
    s_getpc_b64 s[30:31]
f_pc3:
    s_add_u32 s30, s30, f_l23-f_pc3
    s_addc_u32 s31, s31, 0
    v_lshl_add_u32 v14, s28, 6, v1
    v_lshlrev_b32 v14, 3, v14
    v_min_u32 v14, f_code_end-f_l23-4, v14
    v_mov_b32 v15, s31
    v_add_co_u32 v14, vcc, s30, v14
    s_nop 1
    v_addc_co_u32 v15, vcc, 0, v15, vcc
    s_branch f_mid_ret
f_done:
f_l23:
    s_load_dwordx2 s[6:7], s[0:1], 32
    s_load_dwordx2 s[8:9], s[0:1], 96
    s_load_dwordx2 s[10:11], s[0:1], 64
    s_load_dwordx2 s[46:47], s[0:1], 0
    s_load_dwordx2 s[48:49], s[0:1], 80
    s_mov_b64 s[50:51], s[92:93]
    s_waitcnt lgkmcnt(0)
    s_add_u32 s52, s8, 71303168
    s_addc_u32 s53, s9, 0
    s_mov_b32 s54, 3670016
    s_mov_b32 s55, 0x20000
    s_mov_b32 s56, s46
    s_mov_b32 s57, s47
    s_mov_b32 s58, 4194304
    s_mov_b32 s59, 0x20000
    s_mov_b32 s92, s48
    s_mov_b32 s93, s49
    s_mov_b32 s94, 4194304
    s_mov_b32 s95, 0x20000
    s_add_u32 s96, s8, 75497472
    s_addc_u32 s97, s9, 0
    s_mov_b32 s98, 16384
    s_mov_b32 s99, 0x20000
    s_add_u32 s88, s8, 46137344
    s_addc_u32 s89, s9, 0
    s_mov_b32 s90, 7340032
    s_mov_b32 s91, 0x20000
    s_and_b32 s31, s2, 7
    s_lshr_b32 s32, s2, 3
    s_lshr_b32 s60, s31, 1
    s_lshl_b32 s60, s60, 2
    s_and_b32 s33, s32, 3
    s_add_u32 s60, s60, s33
    s_and_b32 s61, s31, 1
    s_lshl_b32 s61, s61, 3
    s_lshr_b32 s33, s32, 2
    s_add_u32 s61, s61, s33
    s_lshl_b32 s60, s60, 3
    s_lshl_b32 s33, s3, 1
    s_add_u32 s60, s60, s33
    v_lshlrev_b32 v12, 4, v1
    s_lshl_b32 s28, s3, 11
    v_add_u32 v12, s28, v12
    s_mul_i32 s46, s3, 24576
    s_add_u32 s46, s46, 65536
    s_lshl_b32 s47, s3, 14
    s_sub_u32 s44, s46, 4096
    s_mul_i32 s45, s61, 229376
    s_sub_u32 s45, s45, 0x2000
    s_mul_i32 s28, s60, 57344
    v_lshlrev_b32 v15, 4, v1
    v_add_u32 v2, s28, v15
    v_add_u32 v3, 57344, v2
    s_lshr_b32 s63, s60, 4
    s_lshl_b32 s63, s63, 7
    v_and_b32 v9, 15, v1
    v_lshlrev_b32 v9, 11, v9
    v_lshrrev_b32 v10, 4, v1
    v_lshl_add_u32 v4, v10, 4, v9
    s_lshl_b32 s48, s60, 15
    s_lshl_b32 s35, s61, 7
    s_add_u32 s48, s48, s35
    s_add_u32 s49, s48, 0x8000
    s_lshr_b32 s28, s2, 3
    s_lshl_b32 s28, s28, 2
    s_add_u32 s28, s28, s3
    s_getpc_b64 s[30:31]
f_pc4:
    s_sub_u32 s30, s30, f_pc4-f_l23
    s_subb_u32 s31, s31, 0
    v_lshl_add_u32 v6, s28, 6, v1
    v_lshlrev_b32 v6, 3, v6
    v_min_u32 v6, f_code_end-f_l23-4, v6
    v_mov_b32 v7, s31
    v_add_co_u32 v6, vcc, s30, v6
    s_nop 1
    v_addc_co_u32 v7, vcc, 0, v7, vcc
    s_waitcnt lgkmcnt(0)
    s_and_b32 s31, s2, 7
    s_lshr_b32 s32, s2, 3
    s_cmp_ge_u32 s31, 4
    s_cbranch_scc1 f_g3
    s_and_b32 s33, s31, 1
    s_bfe_u32 s4, s31, 0x10001
    s_lshl_b32 s4, s4, 2
    s_and_b32 s34, s32, 3
    s_add_u32 s4, s4, s34
    s_lshr_b32 s5, s32, 2
    s_mov_b32 s12, s6
    s_mov_b32 s13, s7
    s_mov_b32 s14, 8388608
    s_mov_b32 s15, 0x20000
    s_add_u32 s16, s8, 29360128
    s_addc_u32 s17, s9, 0
    s_mov_b32 s18, 16777216
    s_mov_b32 s19, 0x20000
    s_add_u32 s20, s8, 54525952
    s_addc_u32 s21, s9, 0
    s_mov_b32 s22, 8388608
    s_mov_b32 s23, 0x20000
    v_lshrrev_b32 v8, 2, v1
    v_and_b32 v9, 7, v8
    v_lshlrev_b32 v9, 1, v9
    v_bfe_u32 v10, v1, 1, 1
    v_xor_b32 v9, v9, v10
    v_lshlrev_b32 v8, 8, v8
    v_and_b32 v10, 1, v1
    v_lshl_add_u32 v8, v10, 3, v8
    v_xor_b32 v10, 0, v9
    v_lshl_add_u32 v144, v10, 4, v8
    v_xor_b32 v10, 2, v9
    v_lshl_add_u32 v145, v10, 4, v8
    v_xor_b32 v10, 4, v9
    v_lshl_add_u32 v146, v10, 4, v8
    v_xor_b32 v10, 6, v9
    v_lshl_add_u32 v147, v10, 4, v8
    v_xor_b32 v10, 8, v9
    v_lshl_add_u32 v148, v10, 4, v8
    v_xor_b32 v10, 10, v9
    v_lshl_add_u32 v149, v10, 4, v8
    v_xor_b32 v10, 12, v9
    v_lshl_add_u32 v150, v10, 4, v8
    v_xor_b32 v10, 14, v9
    v_lshl_add_u32 v151, v10, 4, v8
    v_lshrrev_b32 v8, 4, v1
    v_and_b32 v9, 15, v1
    s_lshl_b32 s24, s3, 15
    s_lshl_b32 s25, s5, 8
    s_add_u32 s24, s24, s25
    v_add_u32 v10, 0, v8
    v_lshlrev_b32 v10, 1, v10
    v_xor_b32 v10, v10, v9
    v_lshlrev_b32 v10, 4, v10
    v_add_u32 v11, 0, v8
    v_lshl_add_u32 v10, v11, 11, v10
    v_add_u32 v160, s24, v10
    v_add_u32 v10, 4, v8
    v_lshlrev_b32 v10, 1, v10
    v_xor_b32 v10, v10, v9
    v_lshlrev_b32 v10, 4, v10
    v_add_u32 v11, 4, v8
    v_lshl_add_u32 v10, v11, 11, v10
    v_add_u32 v161, s24, v10
    v_add_u32 v10, 0, v8
    v_lshlrev_b32 v10, 1, v10
    v_xor_b32 v10, v10, v9
    v_lshlrev_b32 v10, 4, v10
    v_add_u32 v11, 8, v8
    v_lshl_add_u32 v10, v11, 11, v10
    v_add_u32 v162, s24, v10
    v_add_u32 v10, 4, v8
    v_lshlrev_b32 v10, 1, v10
    v_xor_b32 v10, v10, v9
    v_lshlrev_b32 v10, 4, v10
    v_add_u32 v11, 12, v8
    v_lshl_add_u32 v10, v11, 11, v10
    v_add_u32 v163, s24, v10
    s_lshl_b32 s24, s4, 4
    s_lshl_b32 s25, s3, 2
    s_add_u32 s24, s24, s25
    s_lshl_b32 s26, s24, 17
    v_lshlrev_b32 v8, 4, v1
    v_add_u32 v164, s26, v8
    v_add_u32 v165, 0x20000, v164
    v_add_u32 v166, 0x20000, v165
    v_add_u32 v167, 0x20000, v166
    s_lshl_b32 s27, s3, 12
    s_lshl_b32 s28, s33, 21
    s_mov_b32 s41, 0x20000
    s_mov_b32 s38, 0x20000
    s_mov_b32 s40, 0x220000
    s_sub_u32 s28, s28, 0x20000
    s_lshl_b32 s29, s33, 16
    s_lshl_b32 s43, s4, 5
    s_lshl_b32 s25, s33, 3
    s_add_u32 s43, s43, s25
    s_lshl_b32 s43, s43, 3
    s_add_u32 s43, s43, 12288
    s_add_u32 s42, s43, 128
    v_and_b32 v10, 7, v1
    v_lshlrev_b32 v10, 3, v10
    s_sub_u32 s29, s29, 4096
    s_add_u32 s28, s28, s41
    s_add_u32 m0, s27, 0
    s_nop 0
    buffer_load_dwordx4 v160, s[12:15], s28 offen lds
    s_add_u32 m0, s27, 1024
    s_nop 0
    buffer_load_dwordx4 v161, s[12:15], s28 offen lds
    s_add_u32 m0, s27, 2048
    s_nop 0
    buffer_load_dwordx4 v162, s[12:15], s28 offen lds
    s_add_u32 m0, s27, 3072
    s_nop 0
    buffer_load_dwordx4 v163, s[12:15], s28 offen lds
    s_add_u32 s28, s28, 0x20000
    s_add_u32 m0, s27, 16384
    s_nop 0
    buffer_load_dwordx4 v160, s[12:15], s28 offen lds
    s_add_u32 m0, s27, 17408
    s_nop 0
    buffer_load_dwordx4 v161, s[12:15], s28 offen lds
    s_add_u32 m0, s27, 18432
    s_nop 0
    buffer_load_dwordx4 v162, s[12:15], s28 offen lds
    s_add_u32 m0, s27, 19456
    s_nop 0
    buffer_load_dwordx4 v163, s[12:15], s28 offen lds
    s_add_u32 s28, s28, 0x20000
    s_add_u32 m0, s27, 32768
    s_nop 0
    buffer_load_dwordx4 v160, s[12:15], s28 offen lds
    v_mov_b32 v16, 0
    v_mov_b32 v17, 0
    v_mov_b32 v18, 0
    v_mov_b32 v19, 0
    v_mov_b32 v20, 0
    v_mov_b32 v21, 0
    v_mov_b32 v22, 0
    v_mov_b32 v23, 0
    v_mov_b32 v24, 0
    v_mov_b32 v25, 0
    v_mov_b32 v26, 0
    v_mov_b32 v27, 0
    v_mov_b32 v28, 0
    v_mov_b32 v29, 0
    v_mov_b32 v30, 0
    v_mov_b32 v31, 0
    v_mov_b32 v32, 0
    v_mov_b32 v33, 0
    v_mov_b32 v34, 0
    v_mov_b32 v35, 0
    v_mov_b32 v36, 0
    v_mov_b32 v37, 0
    v_mov_b32 v38, 0
    v_mov_b32 v39, 0
    v_mov_b32 v40, 0
    v_mov_b32 v41, 0
    v_mov_b32 v42, 0
    v_mov_b32 v43, 0
    v_mov_b32 v44, 0
    v_mov_b32 v45, 0
    v_mov_b32 v46, 0
    v_mov_b32 v47, 0
    v_mov_b32 v48, 0
    v_mov_b32 v49, 0
    v_mov_b32 v50, 0
    v_mov_b32 v51, 0
    v_mov_b32 v52, 0
    v_mov_b32 v53, 0
    v_mov_b32 v54, 0
    v_mov_b32 v55, 0
    v_mov_b32 v56, 0
    v_mov_b32 v57, 0
    v_mov_b32 v58, 0
    v_mov_b32 v59, 0
    v_mov_b32 v60, 0
    v_mov_b32 v61, 0
    v_mov_b32 v62, 0
    v_mov_b32 v63, 0
    v_mov_b32 v64, 0
    v_mov_b32 v65, 0
    v_mov_b32 v66, 0
    v_mov_b32 v67, 0
    v_mov_b32 v68, 0
    v_mov_b32 v69, 0
    v_mov_b32 v70, 0
    v_mov_b32 v71, 0
    v_mov_b32 v72, 0
    v_mov_b32 v73, 0
    v_mov_b32 v74, 0
    v_mov_b32 v75, 0
    v_mov_b32 v76, 0
    v_mov_b32 v77, 0
    v_mov_b32 v78, 0
    v_mov_b32 v79, 0
    v_mov_b32 v80, 0
    v_mov_b32 v81, 0
    v_mov_b32 v82, 0
    v_mov_b32 v83, 0
    v_mov_b32 v84, 0
    v_mov_b32 v85, 0
    v_mov_b32 v86, 0
    v_mov_b32 v87, 0
    v_mov_b32 v88, 0
    v_mov_b32 v89, 0
    v_mov_b32 v90, 0
    v_mov_b32 v91, 0
    v_mov_b32 v92, 0
    v_mov_b32 v93, 0
    v_mov_b32 v94, 0
    v_mov_b32 v95, 0
    v_mov_b32 v96, 0
    v_mov_b32 v97, 0
    v_mov_b32 v98, 0
    v_mov_b32 v99, 0
    v_mov_b32 v100, 0
    v_mov_b32 v101, 0
    v_mov_b32 v102, 0
    v_mov_b32 v103, 0
    v_mov_b32 v104, 0
    v_mov_b32 v105, 0
    v_mov_b32 v106, 0
    v_mov_b32 v107, 0
    v_mov_b32 v108, 0
    v_mov_b32 v109, 0
    v_mov_b32 v110, 0
    v_mov_b32 v111, 0
    v_mov_b32 v112, 0
    v_mov_b32 v113, 0
    v_mov_b32 v114, 0
    v_mov_b32 v115, 0
    v_mov_b32 v116, 0
    v_mov_b32 v117, 0
    v_mov_b32 v118, 0
    v_mov_b32 v119, 0
    v_mov_b32 v120, 0
    v_mov_b32 v121, 0
    v_mov_b32 v122, 0
    v_mov_b32 v123, 0
    v_mov_b32 v124, 0
    v_mov_b32 v125, 0
    v_mov_b32 v126, 0
    v_mov_b32 v127, 0
    v_mov_b32 v128, 0
    v_mov_b32 v129, 0
    v_mov_b32 v130, 0
    v_mov_b32 v131, 0
    v_mov_b32 v132, 0
    v_mov_b32 v133, 0
    v_mov_b32 v134, 0
    v_mov_b32 v135, 0
    v_mov_b32 v136, 0
    v_mov_b32 v137, 0
    v_mov_b32 v138, 0
    v_mov_b32 v139, 0
    v_mov_b32 v140, 0
    v_mov_b32 v141, 0
    v_mov_b32 v142, 0
    v_mov_b32 v143, 0
    s_waitcnt vmcnt(9)
    s_barrier
    s_cmp_lg_u32 s3, 0
    s_cbranch_scc1 f_f2_skipA
    v_mov_b32 v8, s50
    v_mov_b32 v9, s51
    s_mov_b64 exec, 1
    buffer_store_dwordx2 v[8:9], off, s[96:99], s101 sc1
    s_mov_b64 exec, -1
f_f2_skipA:
    s_cmp_lg_u32 s3, 0
    s_cbranch_scc1 f_fl_rdyA
    v_cmp_ne_u64 vcc, s[50:51], v[168:169]
    v_cmp_ne_u64 s[30:31], s[50:51], v[170:171]
    s_nop 1
    s_or_b64 vcc, vcc, s[30:31]
    v_cmp_ne_u64 s[30:31], s[50:51], v[172:173]
    s_nop 1
    s_or_b64 vcc, vcc, s[30:31]
    v_cmp_ne_u64 s[30:31], s[50:51], v[174:175]
    s_nop 1
    s_or_b64 vcc, vcc, s[30:31]
    s_cmp_eq_u64 vcc, 0
    s_cbranch_scc1 f_f1_okA
    v_lshlrev_b32 v176, 5, v1
    v_add_u32 v176, 8192, v176
f_fl_spinA:
    buffer_load_dwordx4 v[168:171], v176, s[96:99], 0 offen sc1
    buffer_load_dwordx4 v[172:175], v176, s[96:99], 0 offen offset:16 sc1
    s_waitcnt vmcnt(0)
    v_cmp_ne_u64 vcc, s[50:51], v[168:169]
    v_cmp_ne_u64 s[30:31], s[50:51], v[170:171]
    s_nop 1
    s_or_b64 vcc, vcc, s[30:31]
    v_cmp_ne_u64 s[30:31], s[50:51], v[172:173]
    s_nop 1
    s_or_b64 vcc, vcc, s[30:31]
    v_cmp_ne_u64 s[30:31], s[50:51], v[174:175]
    s_nop 1
    s_or_b64 vcc, vcc, s[30:31]
    s_cmp_lg_u64 vcc, 0
    s_cbranch_scc1 f_fl_spinA
f_f1_okA:
    v_and_b32 v177, 7, v1
    v_lshlrev_b32 v177, 3, v177
f_f2_spin:
    buffer_load_dwordx2 v[178:179], v177, s[96:99], s43 offen sc1
    s_waitcnt vmcnt(0)
    v_cmp_ne_u64 vcc, s[50:51], v[178:179]
    s_nop 1
    s_cmp_lg_u64 vcc, 0
    s_cbranch_scc1 f_f2_spin
f_fl_rdyA:
    s_waitcnt vmcnt(5)
    s_barrier
    s_add_u32 s29, s29, 4096
    buffer_load_dwordx4 a[0:3], v164, s[16:19], s29 offen offset:0
    buffer_load_dwordx4 a[4:7], v165, s[16:19], s29 offen offset:0
    buffer_load_dwordx4 a[8:11], v166, s[16:19], s29 offen offset:0
    buffer_load_dwordx4 a[12:15], v167, s[16:19], s29 offen offset:0
    buffer_load_dwordx4 a[16:19], v164, s[16:19], s29 offen offset:1024
    buffer_load_dwordx4 a[20:23], v165, s[16:19], s29 offen offset:1024
    buffer_load_dwordx4 a[24:27], v166, s[16:19], s29 offen offset:1024
    buffer_load_dwordx4 a[28:31], v167, s[16:19], s29 offen offset:1024
    buffer_load_dwordx4 a[32:35], v164, s[16:19], s29 offen offset:2048
    buffer_load_dwordx4 a[36:39], v165, s[16:19], s29 offen offset:2048
    buffer_load_dwordx4 a[40:43], v166, s[16:19], s29 offen offset:2048
    buffer_load_dwordx4 a[44:47], v167, s[16:19], s29 offen offset:2048
    buffer_load_dwordx4 a[48:51], v164, s[16:19], s29 offen offset:3072
    buffer_load_dwordx4 a[52:55], v165, s[16:19], s29 offen offset:3072
    buffer_load_dwordx4 a[56:59], v166, s[16:19], s29 offen offset:3072
    buffer_load_dwordx4 a[60:63], v167, s[16:19], s29 offen offset:3072
    ds_read_b64_tr_b16 v[168:169], v144 offset:0
    ds_read_b64_tr_b16 v[170:171], v144 offset:4096
    ds_read_b64_tr_b16 v[172:173], v144 offset:8192
    ds_read_b64_tr_b16 v[174:175], v144 offset:12288
    ds_read_b64_tr_b16 v[176:177], v145 offset:0
    ds_read_b64_tr_b16 v[178:179], v145 offset:4096
    ds_read_b64_tr_b16 v[180:181], v145 offset:8192
    ds_read_b64_tr_b16 v[182:183], v145 offset:12288
    s_waitcnt vmcnt(8)
    s_waitcnt lgkmcnt(4)
    s_mov_b32 s30, 6
f_g5_loop:
    v_mfma_f32_16x16x32_bf16 v[16:19], v[168:171], a[0:3], v[16:19]
    s_add_u32 s29, s29, 4096
    ds_read_b64_tr_b16 v[184:185], v146 offset:0
    v_mfma_f32_16x16x32_bf16 v[16:19], v[172:175], a[16:19], v[16:19]
    buffer_load_dwordx4 a[64:67], v164, s[16:19], s29 offen offset:0
    v_mfma_f32_16x16x32_bf16 v[20:23], v[172:175], a[20:23], v[20:23]
    ds_read_b64_tr_b16 v[186:187], v146 offset:4096
    v_mfma_f32_16x16x32_bf16 v[20:23], v[168:171], a[4:7], v[20:23]
    ds_read_b64_tr_b16 v[188:189], v146 offset:8192
    v_mfma_f32_16x16x32_bf16 v[24:27], v[168:171], a[8:11], v[24:27]
    s_add_u32 m0, s27, 33792
    v_mfma_f32_16x16x32_bf16 v[24:27], v[172:175], a[24:27], v[24:27]
    buffer_load_dwordx4 v161, s[12:15], s28 offen lds
    v_mfma_f32_16x16x32_bf16 v[28:31], v[172:175], a[28:31], v[28:31]
    ds_read_b64_tr_b16 v[190:191], v146 offset:12288
    v_mfma_f32_16x16x32_bf16 v[28:31], v[168:171], a[12:15], v[28:31]
    s_waitcnt lgkmcnt(4)
    ds_read_b64_tr_b16 v[192:193], v147 offset:0
    v_mfma_f32_16x16x32_bf16 v[44:47], v[176:179], a[12:15], v[44:47]
    v_mfma_f32_16x16x32_bf16 v[44:47], v[180:183], a[28:31], v[44:47]
    buffer_load_dwordx4 a[68:71], v165, s[16:19], s29 offen offset:0
    v_mfma_f32_16x16x32_bf16 v[40:43], v[180:183], a[24:27], v[40:43]
    ds_read_b64_tr_b16 v[194:195], v147 offset:4096
    v_mfma_f32_16x16x32_bf16 v[40:43], v[176:179], a[8:11], v[40:43]
    ds_read_b64_tr_b16 v[196:197], v147 offset:8192
    v_mfma_f32_16x16x32_bf16 v[36:39], v[176:179], a[4:7], v[36:39]
    v_mfma_f32_16x16x32_bf16 v[36:39], v[180:183], a[20:23], v[36:39]
    ds_read_b64_tr_b16 v[198:199], v147 offset:12288
    v_mfma_f32_16x16x32_bf16 v[32:35], v[180:183], a[16:19], v[32:35]
    ds_read_b64_tr_b16 v[168:169], v148 offset:0
    v_mfma_f32_16x16x32_bf16 v[32:35], v[176:179], a[0:3], v[32:35]
    s_waitcnt lgkmcnt(5)
    v_mfma_f32_16x16x32_bf16 v[48:51], v[184:187], a[0:3], v[48:51]
    ds_read_b64_tr_b16 v[170:171], v148 offset:4096
    v_mfma_f32_16x16x32_bf16 v[48:51], v[188:191], a[16:19], v[48:51]
    buffer_load_dwordx4 a[72:75], v166, s[16:19], s29 offen offset:0
    v_mfma_f32_16x16x32_bf16 v[52:55], v[188:191], a[20:23], v[52:55]
    ds_read_b64_tr_b16 v[172:173], v148 offset:8192
    v_mfma_f32_16x16x32_bf16 v[52:55], v[184:187], a[4:7], v[52:55]
    v_mfma_f32_16x16x32_bf16 v[56:59], v[184:187], a[8:11], v[56:59]
    s_add_u32 m0, s27, 34816
    ds_read_b64_tr_b16 v[174:175], v148 offset:12288
    v_mfma_f32_16x16x32_bf16 v[56:59], v[188:191], a[24:27], v[56:59]
    buffer_load_dwordx4 v162, s[12:15], s28 offen lds
    v_mfma_f32_16x16x32_bf16 v[60:63], v[188:191], a[28:31], v[60:63]
    ds_read_b64_tr_b16 v[176:177], v149 offset:0
    v_mfma_f32_16x16x32_bf16 v[60:63], v[184:187], a[12:15], v[60:63]
    s_waitcnt lgkmcnt(5)
    ds_read_b64_tr_b16 v[178:179], v149 offset:4096
    v_mfma_f32_16x16x32_bf16 v[76:79], v[192:195], a[12:15], v[76:79]
    v_mfma_f32_16x16x32_bf16 v[76:79], v[196:199], a[28:31], v[76:79]
    buffer_load_dwordx4 a[76:79], v167, s[16:19], s29 offen offset:0
    v_mfma_f32_16x16x32_bf16 v[72:75], v[196:199], a[24:27], v[72:75]
    ds_read_b64_tr_b16 v[180:181], v149 offset:8192
    v_mfma_f32_16x16x32_bf16 v[72:75], v[192:195], a[8:11], v[72:75]
    ds_read_b64_tr_b16 v[182:183], v149 offset:12288
    v_mfma_f32_16x16x32_bf16 v[68:71], v[192:195], a[4:7], v[68:71]
    v_mfma_f32_16x16x32_bf16 v[68:71], v[196:199], a[20:23], v[68:71]
    ds_read_b64_tr_b16 v[184:185], v150 offset:0
    v_mfma_f32_16x16x32_bf16 v[64:67], v[196:199], a[16:19], v[64:67]
    s_add_u32 s44, s44, 4096
    ds_read_b64_tr_b16 v[186:187], v150 offset:4096
    v_mfma_f32_16x16x32_bf16 v[64:67], v[192:195], a[0:3], v[64:67]
    s_waitcnt lgkmcnt(6)
    v_mfma_f32_16x16x32_bf16 v[80:83], v[168:171], a[0:3], v[80:83]
    s_add_u32 s45, s45, 0x2000
    ds_read_b64_tr_b16 v[188:189], v150 offset:8192
    v_mfma_f32_16x16x32_bf16 v[80:83], v[172:175], a[16:19], v[80:83]
    buffer_load_dwordx4 a[80:83], v164, s[16:19], s29 offen offset:1024
    v_mfma_f32_16x16x32_bf16 v[84:87], v[172:175], a[20:23], v[84:87]
    s_add_u32 m0, s44, 0
    ds_read_b64_tr_b16 v[190:191], v150 offset:12288
    v_mfma_f32_16x16x32_bf16 v[84:87], v[168:171], a[4:7], v[84:87]
    buffer_load_dwordx4 v12, s[52:55], s45 offen offset:0 lds
    v_mfma_f32_16x16x32_bf16 v[88:91], v[168:171], a[8:11], v[88:91]
    s_add_u32 m0, s27, 35840
    v_mfma_f32_16x16x32_bf16 v[88:91], v[172:175], a[24:27], v[88:91]
    buffer_load_dwordx4 v163, s[12:15], s28 offen lds
    v_mfma_f32_16x16x32_bf16 v[92:95], v[172:175], a[28:31], v[92:95]
    ds_read_b64_tr_b16 v[192:193], v151 offset:0
    v_mfma_f32_16x16x32_bf16 v[92:95], v[168:171], a[12:15], v[92:95]
    s_waitcnt lgkmcnt(5)
    ds_read_b64_tr_b16 v[194:195], v151 offset:4096
    v_mfma_f32_16x16x32_bf16 v[108:111], v[176:179], a[12:15], v[108:111]
    global_load_dword v5, v[6:7], off
    v_mfma_f32_16x16x32_bf16 v[108:111], v[180:183], a[28:31], v[108:111]
    buffer_load_dwordx4 a[84:87], v165, s[16:19], s29 offen offset:1024
    v_mfma_f32_16x16x32_bf16 v[104:107], v[180:183], a[24:27], v[104:107]
    v_mfma_f32_16x16x32_bf16 v[104:107], v[176:179], a[8:11], v[104:107]
    ds_read_b64_tr_b16 v[196:197], v151 offset:8192
    v_mfma_f32_16x16x32_bf16 v[100:103], v[176:179], a[4:7], v[100:103]
    ds_read_b64_tr_b16 v[198:199], v151 offset:12288
    v_mfma_f32_16x16x32_bf16 v[100:103], v[180:183], a[20:23], v[100:103]
    s_waitcnt vmcnt(15)
    v_mfma_f32_16x16x32_bf16 v[96:99], v[180:183], a[16:19], v[96:99]
    s_barrier
    v_mfma_f32_16x16x32_bf16 v[96:99], v[176:179], a[0:3], v[96:99]
    s_waitcnt lgkmcnt(4)
    ds_read_b64_tr_b16 v[168:169], v144 offset:16384
    v_mfma_f32_16x16x32_bf16 v[112:115], v[184:187], a[0:3], v[112:115]
    ds_read_b64_tr_b16 v[170:171], v144 offset:20480
    v_mfma_f32_16x16x32_bf16 v[112:115], v[188:191], a[16:19], v[112:115]
    buffer_load_dwordx4 a[88:91], v166, s[16:19], s29 offen offset:1024
    v_mfma_f32_16x16x32_bf16 v[116:119], v[188:191], a[20:23], v[116:119]
    v_mfma_f32_16x16x32_bf16 v[116:119], v[184:187], a[4:7], v[116:119]
    s_add_u32 s28, s28, 0x20000
    ds_read_b64_tr_b16 v[172:173], v144 offset:24576
    v_mfma_f32_16x16x32_bf16 v[120:123], v[184:187], a[8:11], v[120:123]
    s_add_u32 m0, s27, 49152
    ds_read_b64_tr_b16 v[174:175], v144 offset:28672
    v_mfma_f32_16x16x32_bf16 v[120:123], v[188:191], a[24:27], v[120:123]
    buffer_load_dwordx4 v160, s[12:15], s28 offen lds
    v_mfma_f32_16x16x32_bf16 v[124:127], v[188:191], a[28:31], v[124:127]
    v_mfma_f32_16x16x32_bf16 v[124:127], v[184:187], a[12:15], v[124:127]
    s_waitcnt lgkmcnt(4)
    ds_read_b64_tr_b16 v[176:177], v145 offset:16384
    v_mfma_f32_16x16x32_bf16 v[140:143], v[192:195], a[12:15], v[140:143]
    ds_read_b64_tr_b16 v[178:179], v145 offset:20480
    v_mfma_f32_16x16x32_bf16 v[140:143], v[196:199], a[28:31], v[140:143]
    buffer_load_dwordx4 a[92:95], v167, s[16:19], s29 offen offset:1024
    v_mfma_f32_16x16x32_bf16 v[136:139], v[196:199], a[24:27], v[136:139]
    v_mfma_f32_16x16x32_bf16 v[136:139], v[192:195], a[8:11], v[136:139]
    ds_read_b64_tr_b16 v[180:181], v145 offset:24576
    v_mfma_f32_16x16x32_bf16 v[132:135], v[192:195], a[4:7], v[132:135]
    ds_read_b64_tr_b16 v[182:183], v145 offset:28672
    v_mfma_f32_16x16x32_bf16 v[132:135], v[196:199], a[20:23], v[132:135]
    v_mfma_f32_16x16x32_bf16 v[128:131], v[196:199], a[16:19], v[128:131]
    s_waitcnt vmcnt(14)
    ds_read_b64_tr_b16 v[184:185], v146 offset:16384
    v_mfma_f32_16x16x32_bf16 v[128:131], v[192:195], a[0:3], v[128:131]
    s_waitcnt lgkmcnt(5)
    ds_read_b64_tr_b16 v[186:187], v146 offset:20480
    v_mfma_f32_16x16x32_bf16 v[16:19], v[168:171], a[32:35], v[16:19]
    v_mfma_f32_16x16x32_bf16 v[16:19], v[172:175], a[48:51], v[16:19]
    buffer_load_dwordx4 a[96:99], v164, s[16:19], s29 offen offset:2048
    v_mfma_f32_16x16x32_bf16 v[20:23], v[172:175], a[52:55], v[20:23]
    ds_read_b64_tr_b16 v[188:189], v146 offset:24576
    v_mfma_f32_16x16x32_bf16 v[20:23], v[168:171], a[36:39], v[20:23]
    ds_read_b64_tr_b16 v[190:191], v146 offset:28672
    v_mfma_f32_16x16x32_bf16 v[24:27], v[168:171], a[40:43], v[24:27]
    s_add_u32 m0, s27, 50176
    v_mfma_f32_16x16x32_bf16 v[24:27], v[172:175], a[56:59], v[24:27]
    buffer_load_dwordx4 v161, s[12:15], s28 offen lds
    v_mfma_f32_16x16x32_bf16 v[28:31], v[172:175], a[60:63], v[28:31]
    ds_read_b64_tr_b16 v[192:193], v147 offset:16384
    v_mfma_f32_16x16x32_bf16 v[28:31], v[168:171], a[44:47], v[28:31]
    s_waitcnt lgkmcnt(5)
    ds_read_b64_tr_b16 v[194:195], v147 offset:20480
    v_mfma_f32_16x16x32_bf16 v[44:47], v[176:179], a[44:47], v[44:47]
    v_mfma_f32_16x16x32_bf16 v[44:47], v[180:183], a[60:63], v[44:47]
    buffer_load_dwordx4 a[100:103], v165, s[16:19], s29 offen offset:2048
    v_mfma_f32_16x16x32_bf16 v[40:43], v[180:183], a[56:59], v[40:43]
    ds_read_b64_tr_b16 v[196:197], v147 offset:24576
    v_mfma_f32_16x16x32_bf16 v[40:43], v[176:179], a[40:43], v[40:43]
    ds_read_b64_tr_b16 v[198:199], v147 offset:28672
    v_mfma_f32_16x16x32_bf16 v[36:39], v[176:179], a[36:39], v[36:39]
    v_mfma_f32_16x16x32_bf16 v[36:39], v[180:183], a[52:55], v[36:39]
    ds_read_b64_tr_b16 v[168:169], v148 offset:16384
    v_mfma_f32_16x16x32_bf16 v[32:35], v[180:183], a[48:51], v[32:35]
    v_mfma_f32_16x16x32_bf16 v[32:35], v[176:179], a[32:35], v[32:35]
    s_waitcnt lgkmcnt(5)
    ds_read_b64_tr_b16 v[170:171], v148 offset:20480
    v_mfma_f32_16x16x32_bf16 v[48:51], v[184:187], a[32:35], v[48:51]
    ds_read_b64_tr_b16 v[172:173], v148 offset:24576
    v_mfma_f32_16x16x32_bf16 v[48:51], v[188:191], a[48:51], v[48:51]
    buffer_load_dwordx4 a[104:107], v166, s[16:19], s29 offen offset:2048
    v_mfma_f32_16x16x32_bf16 v[52:55], v[188:191], a[52:55], v[52:55]
    v_mfma_f32_16x16x32_bf16 v[52:55], v[184:187], a[36:39], v[52:55]
    ds_read_b64_tr_b16 v[174:175], v148 offset:28672
    v_mfma_f32_16x16x32_bf16 v[56:59], v[184:187], a[40:43], v[56:59]
    s_add_u32 m0, s27, 51200
    ds_read_b64_tr_b16 v[176:177], v149 offset:16384
    v_mfma_f32_16x16x32_bf16 v[56:59], v[188:191], a[56:59], v[56:59]
    buffer_load_dwordx4 v162, s[12:15], s28 offen lds
    v_mfma_f32_16x16x32_bf16 v[60:63], v[188:191], a[60:63], v[60:63]
    v_mfma_f32_16x16x32_bf16 v[60:63], v[184:187], a[44:47], v[60:63]
    s_waitcnt lgkmcnt(5)
    ds_read_b64_tr_b16 v[178:179], v149 offset:20480
    v_mfma_f32_16x16x32_bf16 v[76:79], v[192:195], a[44:47], v[76:79]
    ds_read_b64_tr_b16 v[180:181], v149 offset:24576
    v_mfma_f32_16x16x32_bf16 v[76:79], v[196:199], a[60:63], v[76:79]
    buffer_load_dwordx4 a[108:111], v167, s[16:19], s29 offen offset:2048
    v_mfma_f32_16x16x32_bf16 v[72:75], v[196:199], a[56:59], v[72:75]
    v_mfma_f32_16x16x32_bf16 v[72:75], v[192:195], a[40:43], v[72:75]
    ds_read_b64_tr_b16 v[182:183], v149 offset:28672
    v_mfma_f32_16x16x32_bf16 v[68:71], v[192:195], a[36:39], v[68:71]
    ds_read_b64_tr_b16 v[184:185], v150 offset:16384
    v_mfma_f32_16x16x32_bf16 v[68:71], v[196:199], a[52:55], v[68:71]
    v_mfma_f32_16x16x32_bf16 v[64:67], v[196:199], a[48:51], v[64:67]
    ds_read_b64_tr_b16 v[186:187], v150 offset:20480
    v_mfma_f32_16x16x32_bf16 v[64:67], v[192:195], a[32:35], v[64:67]
    s_waitcnt lgkmcnt(6)
    ds_read_b64_tr_b16 v[188:189], v150 offset:24576
    v_mfma_f32_16x16x32_bf16 v[80:83], v[168:171], a[32:35], v[80:83]
    v_mfma_f32_16x16x32_bf16 v[80:83], v[172:175], a[48:51], v[80:83]
    buffer_load_dwordx4 a[112:115], v164, s[16:19], s29 offen offset:3072
    v_mfma_f32_16x16x32_bf16 v[84:87], v[172:175], a[52:55], v[84:87]
    s_add_u32 m0, s44, 0
    ds_read_b64_tr_b16 v[190:191], v150 offset:28672
    v_mfma_f32_16x16x32_bf16 v[84:87], v[168:171], a[36:39], v[84:87]
    buffer_load_dwordx4 v12, s[52:55], s45 offen offset:1024 lds
    v_mfma_f32_16x16x32_bf16 v[88:91], v[168:171], a[40:43], v[88:91]
    buffer_load_dwordx2 v[8:9], v10, s[96:99], s42 offen sc1
    v_mfma_f32_16x16x32_bf16 v[88:91], v[172:175], a[56:59], v[88:91]
    s_add_u32 m0, s27, 52224
    s_nop 0
    buffer_load_dwordx4 v163, s[12:15], s28 offen lds
    v_mfma_f32_16x16x32_bf16 v[92:95], v[172:175], a[60:63], v[92:95]
    ds_read_b64_tr_b16 v[192:193], v151 offset:16384
    v_mfma_f32_16x16x32_bf16 v[92:95], v[168:171], a[44:47], v[92:95]
    s_waitcnt lgkmcnt(5)
    v_mfma_f32_16x16x32_bf16 v[108:111], v[176:179], a[44:47], v[108:111]
    ds_read_b64_tr_b16 v[194:195], v151 offset:20480
    v_mfma_f32_16x16x32_bf16 v[108:111], v[180:183], a[60:63], v[108:111]
    buffer_load_dwordx4 a[116:119], v165, s[16:19], s29 offen offset:3072
    v_mfma_f32_16x16x32_bf16 v[104:107], v[180:183], a[56:59], v[104:107]
    ds_read_b64_tr_b16 v[196:197], v151 offset:24576
    v_mfma_f32_16x16x32_bf16 v[104:107], v[176:179], a[40:43], v[104:107]
    v_mfma_f32_16x16x32_bf16 v[100:103], v[176:179], a[36:39], v[100:103]
    ds_read_b64_tr_b16 v[198:199], v151 offset:28672
    v_mfma_f32_16x16x32_bf16 v[100:103], v[180:183], a[52:55], v[100:103]
    s_waitcnt vmcnt(16)
    v_mfma_f32_16x16x32_bf16 v[96:99], v[180:183], a[48:51], v[96:99]
    s_barrier
    v_mfma_f32_16x16x32_bf16 v[96:99], v[176:179], a[32:35], v[96:99]
    s_waitcnt lgkmcnt(4)
    ds_read_b64_tr_b16 v[168:169], v144 offset:32768
    v_mfma_f32_16x16x32_bf16 v[112:115], v[184:187], a[32:35], v[112:115]
    ds_read_b64_tr_b16 v[170:171], v144 offset:36864
    v_mfma_f32_16x16x32_bf16 v[112:115], v[188:191], a[48:51], v[112:115]
    buffer_load_dwordx4 a[120:123], v166, s[16:19], s29 offen offset:3072
    v_mfma_f32_16x16x32_bf16 v[116:119], v[188:191], a[52:55], v[116:119]
    v_mfma_f32_16x16x32_bf16 v[116:119], v[184:187], a[36:39], v[116:119]
    s_add_u32 s28, s28, s41
    ds_read_b64_tr_b16 v[172:173], v144 offset:40960
    v_mfma_f32_16x16x32_bf16 v[120:123], v[184:187], a[40:43], v[120:123]
    s_add_u32 m0, s27, 0
    ds_read_b64_tr_b16 v[174:175], v144 offset:45056
    v_mfma_f32_16x16x32_bf16 v[120:123], v[188:191], a[56:59], v[120:123]
    buffer_load_dwordx4 v160, s[12:15], s28 offen lds
    v_mfma_f32_16x16x32_bf16 v[124:127], v[188:191], a[60:63], v[124:127]
    v_mfma_f32_16x16x32_bf16 v[124:127], v[184:187], a[44:47], v[124:127]
    s_waitcnt lgkmcnt(4)
    ds_read_b64_tr_b16 v[176:177], v145 offset:32768
    v_mfma_f32_16x16x32_bf16 v[140:143], v[192:195], a[44:47], v[140:143]
    ds_read_b64_tr_b16 v[178:179], v145 offset:36864
    v_mfma_f32_16x16x32_bf16 v[140:143], v[196:199], a[60:63], v[140:143]
    buffer_load_dwordx4 a[124:127], v167, s[16:19], s29 offen offset:3072
    v_mfma_f32_16x16x32_bf16 v[136:139], v[196:199], a[56:59], v[136:139]
    v_mfma_f32_16x16x32_bf16 v[136:139], v[192:195], a[40:43], v[136:139]
    ds_read_b64_tr_b16 v[180:181], v145 offset:40960
    v_mfma_f32_16x16x32_bf16 v[132:135], v[192:195], a[36:39], v[132:135]
    ds_read_b64_tr_b16 v[182:183], v145 offset:45056
    v_mfma_f32_16x16x32_bf16 v[132:135], v[196:199], a[52:55], v[132:135]
    v_mfma_f32_16x16x32_bf16 v[128:131], v[196:199], a[48:51], v[128:131]
    s_waitcnt vmcnt(14)
    ds_read_b64_tr_b16 v[184:185], v146 offset:32768
    v_mfma_f32_16x16x32_bf16 v[128:131], v[192:195], a[32:35], v[128:131]
    s_waitcnt lgkmcnt(5)
    v_mfma_f32_16x16x32_bf16 v[16:19], v[168:171], a[64:67], v[16:19]
    s_add_u32 s29, s29, 4096
    ds_read_b64_tr_b16 v[186:187], v146 offset:36864
    v_mfma_f32_16x16x32_bf16 v[16:19], v[172:175], a[80:83], v[16:19]
    buffer_load_dwordx4 a[0:3], v164, s[16:19], s29 offen offset:0
    v_mfma_f32_16x16x32_bf16 v[20:23], v[172:175], a[84:87], v[20:23]
    ds_read_b64_tr_b16 v[188:189], v146 offset:40960
    v_mfma_f32_16x16x32_bf16 v[20:23], v[168:171], a[68:71], v[20:23]
    v_mfma_f32_16x16x32_bf16 v[24:27], v[168:171], a[72:75], v[24:27]
    s_add_u32 m0, s27, 1024
    ds_read_b64_tr_b16 v[190:191], v146 offset:45056
    v_mfma_f32_16x16x32_bf16 v[24:27], v[172:175], a[88:91], v[24:27]
    buffer_load_dwordx4 v161, s[12:15], s28 offen lds
    v_mfma_f32_16x16x32_bf16 v[28:31], v[172:175], a[92:95], v[28:31]
    ds_read_b64_tr_b16 v[192:193], v147 offset:32768
    v_mfma_f32_16x16x32_bf16 v[28:31], v[168:171], a[76:79], v[28:31]
    s_waitcnt lgkmcnt(5)
    v_mfma_f32_16x16x32_bf16 v[44:47], v[176:179], a[76:79], v[44:47]
    ds_read_b64_tr_b16 v[194:195], v147 offset:36864
    v_mfma_f32_16x16x32_bf16 v[44:47], v[180:183], a[92:95], v[44:47]
    buffer_load_dwordx4 a[4:7], v165, s[16:19], s29 offen offset:0
    v_mfma_f32_16x16x32_bf16 v[40:43], v[180:183], a[88:91], v[40:43]
    ds_read_b64_tr_b16 v[196:197], v147 offset:40960
    v_mfma_f32_16x16x32_bf16 v[40:43], v[176:179], a[72:75], v[40:43]
    v_mfma_f32_16x16x32_bf16 v[36:39], v[176:179], a[68:71], v[36:39]
    ds_read_b64_tr_b16 v[198:199], v147 offset:45056
    v_mfma_f32_16x16x32_bf16 v[36:39], v[180:183], a[84:87], v[36:39]
    v_mfma_f32_16x16x32_bf16 v[32:35], v[180:183], a[80:83], v[32:35]
    ds_read_b64_tr_b16 v[168:169], v148 offset:32768
    v_mfma_f32_16x16x32_bf16 v[32:35], v[176:179], a[64:67], v[32:35]
    s_waitcnt lgkmcnt(5)
    ds_read_b64_tr_b16 v[170:171], v148 offset:36864
    v_mfma_f32_16x16x32_bf16 v[48:51], v[184:187], a[64:67], v[48:51]
    v_mfma_f32_16x16x32_bf16 v[48:51], v[188:191], a[80:83], v[48:51]
    buffer_load_dwordx4 a[8:11], v166, s[16:19], s29 offen offset:0
    v_mfma_f32_16x16x32_bf16 v[52:55], v[188:191], a[84:87], v[52:55]
    ds_read_b64_tr_b16 v[172:173], v148 offset:40960
    v_mfma_f32_16x16x32_bf16 v[52:55], v[184:187], a[68:71], v[52:55]
    ds_read_b64_tr_b16 v[174:175], v148 offset:45056
    v_mfma_f32_16x16x32_bf16 v[56:59], v[184:187], a[72:75], v[56:59]
    s_add_u32 m0, s27, 2048
    v_mfma_f32_16x16x32_bf16 v[56:59], v[188:191], a[88:91], v[56:59]
    buffer_load_dwordx4 v162, s[12:15], s28 offen lds
    v_mfma_f32_16x16x32_bf16 v[60:63], v[188:191], a[92:95], v[60:63]
    ds_read_b64_tr_b16 v[176:177], v149 offset:32768
    v_mfma_f32_16x16x32_bf16 v[60:63], v[184:187], a[76:79], v[60:63]
    s_waitcnt lgkmcnt(5)
    ds_read_b64_tr_b16 v[178:179], v149 offset:36864
    v_mfma_f32_16x16x32_bf16 v[76:79], v[192:195], a[76:79], v[76:79]
    v_mfma_f32_16x16x32_bf16 v[76:79], v[196:199], a[92:95], v[76:79]
    buffer_load_dwordx4 a[12:15], v167, s[16:19], s29 offen offset:0
    v_mfma_f32_16x16x32_bf16 v[72:75], v[196:199], a[88:91], v[72:75]
    ds_read_b64_tr_b16 v[180:181], v149 offset:40960
    v_mfma_f32_16x16x32_bf16 v[72:75], v[192:195], a[72:75], v[72:75]
    ds_read_b64_tr_b16 v[182:183], v149 offset:45056
    v_mfma_f32_16x16x32_bf16 v[68:71], v[192:195], a[68:71], v[68:71]
    v_mfma_f32_16x16x32_bf16 v[68:71], v[196:199], a[84:87], v[68:71]
    ds_read_b64_tr_b16 v[184:185], v150 offset:32768
    v_mfma_f32_16x16x32_bf16 v[64:67], v[196:199], a[80:83], v[64:67]
    v_mfma_f32_16x16x32_bf16 v[64:67], v[192:195], a[64:67], v[64:67]
    s_waitcnt lgkmcnt(5)
    ds_read_b64_tr_b16 v[186:187], v150 offset:36864
    v_mfma_f32_16x16x32_bf16 v[80:83], v[168:171], a[64:67], v[80:83]
    s_add_u32 s45, s45, 0x2000
    ds_read_b64_tr_b16 v[188:189], v150 offset:40960
    v_mfma_f32_16x16x32_bf16 v[80:83], v[172:175], a[80:83], v[80:83]
    buffer_load_dwordx4 a[16:19], v164, s[16:19], s29 offen offset:1024
    v_mfma_f32_16x16x32_bf16 v[84:87], v[172:175], a[84:87], v[84:87]
    s_add_u32 m0, s44, 2048
    v_mfma_f32_16x16x32_bf16 v[84:87], v[168:171], a[68:71], v[84:87]
    buffer_load_dwordx4 v12, s[52:55], s45 offen offset:0 lds
    v_mfma_f32_16x16x32_bf16 v[88:91], v[168:171], a[72:75], v[88:91]
    s_add_u32 m0, s27, 3072
    ds_read_b64_tr_b16 v[190:191], v150 offset:45056
    v_mfma_f32_16x16x32_bf16 v[88:91], v[172:175], a[88:91], v[88:91]
    buffer_load_dwordx4 v163, s[12:15], s28 offen lds
    v_mfma_f32_16x16x32_bf16 v[92:95], v[172:175], a[92:95], v[92:95]
    ds_read_b64_tr_b16 v[192:193], v151 offset:32768
    v_mfma_f32_16x16x32_bf16 v[92:95], v[168:171], a[76:79], v[92:95]
    s_waitcnt lgkmcnt(5)
    v_mfma_f32_16x16x32_bf16 v[108:111], v[176:179], a[76:79], v[108:111]
    ds_read_b64_tr_b16 v[194:195], v151 offset:36864
    v_mfma_f32_16x16x32_bf16 v[108:111], v[180:183], a[92:95], v[108:111]
    buffer_load_dwordx4 a[20:23], v165, s[16:19], s29 offen offset:1024
    v_mfma_f32_16x16x32_bf16 v[104:107], v[180:183], a[88:91], v[104:107]
    ds_read_b64_tr_b16 v[196:197], v151 offset:40960
    v_mfma_f32_16x16x32_bf16 v[104:107], v[176:179], a[72:75], v[104:107]
    v_mfma_f32_16x16x32_bf16 v[100:103], v[176:179], a[68:71], v[100:103]
    ds_read_b64_tr_b16 v[198:199], v151 offset:45056
    v_mfma_f32_16x16x32_bf16 v[100:103], v[180:183], a[84:87], v[100:103]
    s_waitcnt vmcnt(14)
    v_mfma_f32_16x16x32_bf16 v[96:99], v[180:183], a[80:83], v[96:99]
    s_barrier
    v_mfma_f32_16x16x32_bf16 v[96:99], v[176:179], a[64:67], v[96:99]
    s_waitcnt lgkmcnt(4)
    ds_read_b64_tr_b16 v[168:169], v144 offset:49152
    v_mfma_f32_16x16x32_bf16 v[112:115], v[184:187], a[64:67], v[112:115]
    ds_read_b64_tr_b16 v[170:171], v144 offset:53248
    v_mfma_f32_16x16x32_bf16 v[112:115], v[188:191], a[80:83], v[112:115]
    buffer_load_dwordx4 a[24:27], v166, s[16:19], s29 offen offset:1024
    v_mfma_f32_16x16x32_bf16 v[116:119], v[188:191], a[84:87], v[116:119]
    v_mfma_f32_16x16x32_bf16 v[116:119], v[184:187], a[68:71], v[116:119]
    s_add_u32 s28, s28, 0x20000
    ds_read_b64_tr_b16 v[172:173], v144 offset:57344
    v_mfma_f32_16x16x32_bf16 v[120:123], v[184:187], a[72:75], v[120:123]
    s_add_u32 m0, s27, 16384
    ds_read_b64_tr_b16 v[174:175], v144 offset:61440
    v_mfma_f32_16x16x32_bf16 v[120:123], v[188:191], a[88:91], v[120:123]
    buffer_load_dwordx4 v160, s[12:15], s28 offen lds
    v_mfma_f32_16x16x32_bf16 v[124:127], v[188:191], a[92:95], v[124:127]
    v_mfma_f32_16x16x32_bf16 v[124:127], v[184:187], a[76:79], v[124:127]
    s_waitcnt lgkmcnt(4)
    ds_read_b64_tr_b16 v[176:177], v145 offset:49152
    v_mfma_f32_16x16x32_bf16 v[140:143], v[192:195], a[76:79], v[140:143]
    ds_read_b64_tr_b16 v[178:179], v145 offset:53248
    v_mfma_f32_16x16x32_bf16 v[140:143], v[196:199], a[92:95], v[140:143]
    buffer_load_dwordx4 a[28:31], v167, s[16:19], s29 offen offset:1024
    v_mfma_f32_16x16x32_bf16 v[136:139], v[196:199], a[88:91], v[136:139]
    v_mfma_f32_16x16x32_bf16 v[136:139], v[192:195], a[72:75], v[136:139]
    ds_read_b64_tr_b16 v[180:181], v145 offset:57344
    v_mfma_f32_16x16x32_bf16 v[132:135], v[192:195], a[68:71], v[132:135]
    ds_read_b64_tr_b16 v[182:183], v145 offset:61440
    v_mfma_f32_16x16x32_bf16 v[132:135], v[196:199], a[84:87], v[132:135]
    v_mfma_f32_16x16x32_bf16 v[128:131], v[196:199], a[80:83], v[128:131]
    s_waitcnt vmcnt(13)
    ds_read_b64_tr_b16 v[184:185], v146 offset:49152
    v_mfma_f32_16x16x32_bf16 v[128:131], v[192:195], a[64:67], v[128:131]
    s_waitcnt lgkmcnt(5)
    v_mfma_f32_16x16x32_bf16 v[16:19], v[168:171], a[96:99], v[16:19]
    ds_read_b64_tr_b16 v[186:187], v146 offset:53248
    v_mfma_f32_16x16x32_bf16 v[16:19], v[172:175], a[112:115], v[16:19]
    buffer_load_dwordx4 a[32:35], v164, s[16:19], s29 offen offset:2048
    v_mfma_f32_16x16x32_bf16 v[20:23], v[172:175], a[116:119], v[20:23]
    ds_read_b64_tr_b16 v[188:189], v146 offset:57344
    v_mfma_f32_16x16x32_bf16 v[20:23], v[168:171], a[100:103], v[20:23]
    v_mfma_f32_16x16x32_bf16 v[24:27], v[168:171], a[104:107], v[24:27]
    s_add_u32 m0, s27, 17408
    ds_read_b64_tr_b16 v[190:191], v146 offset:61440
    v_mfma_f32_16x16x32_bf16 v[24:27], v[172:175], a[120:123], v[24:27]
    buffer_load_dwordx4 v161, s[12:15], s28 offen lds
    v_mfma_f32_16x16x32_bf16 v[28:31], v[172:175], a[124:127], v[28:31]
    ds_read_b64_tr_b16 v[192:193], v147 offset:49152
    v_mfma_f32_16x16x32_bf16 v[28:31], v[168:171], a[108:111], v[28:31]
    s_waitcnt lgkmcnt(5)
    v_mfma_f32_16x16x32_bf16 v[44:47], v[176:179], a[108:111], v[44:47]
    ds_read_b64_tr_b16 v[194:195], v147 offset:53248
    v_mfma_f32_16x16x32_bf16 v[44:47], v[180:183], a[124:127], v[44:47]
    buffer_load_dwordx4 a[36:39], v165, s[16:19], s29 offen offset:2048
    v_mfma_f32_16x16x32_bf16 v[40:43], v[180:183], a[120:123], v[40:43]
    ds_read_b64_tr_b16 v[196:197], v147 offset:57344
    v_mfma_f32_16x16x32_bf16 v[40:43], v[176:179], a[104:107], v[40:43]
    v_mfma_f32_16x16x32_bf16 v[36:39], v[176:179], a[100:103], v[36:39]
    ds_read_b64_tr_b16 v[198:199], v147 offset:61440
    v_mfma_f32_16x16x32_bf16 v[36:39], v[180:183], a[116:119], v[36:39]
    v_mfma_f32_16x16x32_bf16 v[32:35], v[180:183], a[112:115], v[32:35]
    ds_read_b64_tr_b16 v[168:169], v148 offset:49152
    v_mfma_f32_16x16x32_bf16 v[32:35], v[176:179], a[96:99], v[32:35]
    s_waitcnt lgkmcnt(5)
    ds_read_b64_tr_b16 v[170:171], v148 offset:53248
    v_mfma_f32_16x16x32_bf16 v[48:51], v[184:187], a[96:99], v[48:51]
    v_mfma_f32_16x16x32_bf16 v[48:51], v[188:191], a[112:115], v[48:51]
    buffer_load_dwordx4 a[40:43], v166, s[16:19], s29 offen offset:2048
    v_mfma_f32_16x16x32_bf16 v[52:55], v[188:191], a[116:119], v[52:55]
    ds_read_b64_tr_b16 v[172:173], v148 offset:57344
    v_mfma_f32_16x16x32_bf16 v[52:55], v[184:187], a[100:103], v[52:55]
    ds_read_b64_tr_b16 v[174:175], v148 offset:61440
    v_mfma_f32_16x16x32_bf16 v[56:59], v[184:187], a[104:107], v[56:59]
    s_add_u32 m0, s27, 18432
    v_mfma_f32_16x16x32_bf16 v[56:59], v[188:191], a[120:123], v[56:59]
    buffer_load_dwordx4 v162, s[12:15], s28 offen lds
    v_mfma_f32_16x16x32_bf16 v[60:63], v[188:191], a[124:127], v[60:63]
    ds_read_b64_tr_b16 v[176:177], v149 offset:49152
    v_mfma_f32_16x16x32_bf16 v[60:63], v[184:187], a[108:111], v[60:63]
    s_waitcnt lgkmcnt(5)
    ds_read_b64_tr_b16 v[178:179], v149 offset:53248
    v_mfma_f32_16x16x32_bf16 v[76:79], v[192:195], a[108:111], v[76:79]
    v_mfma_f32_16x16x32_bf16 v[76:79], v[196:199], a[124:127], v[76:79]
    buffer_load_dwordx4 a[44:47], v167, s[16:19], s29 offen offset:2048
    v_mfma_f32_16x16x32_bf16 v[72:75], v[196:199], a[120:123], v[72:75]
    ds_read_b64_tr_b16 v[180:181], v149 offset:57344
    v_mfma_f32_16x16x32_bf16 v[72:75], v[192:195], a[104:107], v[72:75]
    ds_read_b64_tr_b16 v[182:183], v149 offset:61440
    v_mfma_f32_16x16x32_bf16 v[68:71], v[192:195], a[100:103], v[68:71]
    v_mfma_f32_16x16x32_bf16 v[68:71], v[196:199], a[116:119], v[68:71]
    ds_read_b64_tr_b16 v[184:185], v150 offset:49152
    v_mfma_f32_16x16x32_bf16 v[64:67], v[196:199], a[112:115], v[64:67]
    v_mfma_f32_16x16x32_bf16 v[64:67], v[192:195], a[96:99], v[64:67]
    s_waitcnt lgkmcnt(5)
    ds_read_b64_tr_b16 v[186:187], v150 offset:53248
    v_mfma_f32_16x16x32_bf16 v[80:83], v[168:171], a[96:99], v[80:83]
    ds_read_b64_tr_b16 v[188:189], v150 offset:57344
    v_mfma_f32_16x16x32_bf16 v[80:83], v[172:175], a[112:115], v[80:83]
    buffer_load_dwordx4 a[48:51], v164, s[16:19], s29 offen offset:3072
    v_mfma_f32_16x16x32_bf16 v[84:87], v[172:175], a[116:119], v[84:87]
    s_add_u32 m0, s44, 2048
    v_mfma_f32_16x16x32_bf16 v[84:87], v[168:171], a[100:103], v[84:87]
    buffer_load_dwordx4 v12, s[52:55], s45 offen offset:1024 lds
    v_mfma_f32_16x16x32_bf16 v[88:91], v[168:171], a[104:107], v[88:91]
    s_add_u32 m0, s27, 19456
    ds_read_b64_tr_b16 v[190:191], v150 offset:61440
    v_mfma_f32_16x16x32_bf16 v[88:91], v[172:175], a[120:123], v[88:91]
    buffer_load_dwordx4 v163, s[12:15], s28 offen lds
    v_mfma_f32_16x16x32_bf16 v[92:95], v[172:175], a[124:127], v[92:95]
    ds_read_b64_tr_b16 v[192:193], v151 offset:49152
    v_mfma_f32_16x16x32_bf16 v[92:95], v[168:171], a[108:111], v[92:95]
    s_waitcnt lgkmcnt(5)
    v_mfma_f32_16x16x32_bf16 v[108:111], v[176:179], a[108:111], v[108:111]
    ds_read_b64_tr_b16 v[194:195], v151 offset:53248
    v_mfma_f32_16x16x32_bf16 v[108:111], v[180:183], a[124:127], v[108:111]
    buffer_load_dwordx4 a[52:55], v165, s[16:19], s29 offen offset:3072
    v_mfma_f32_16x16x32_bf16 v[104:107], v[180:183], a[120:123], v[104:107]
    ds_read_b64_tr_b16 v[196:197], v151 offset:57344
    v_mfma_f32_16x16x32_bf16 v[104:107], v[176:179], a[104:107], v[104:107]
    v_mfma_f32_16x16x32_bf16 v[100:103], v[176:179], a[100:103], v[100:103]
    ds_read_b64_tr_b16 v[198:199], v151 offset:61440
    v_mfma_f32_16x16x32_bf16 v[100:103], v[180:183], a[116:119], v[100:103]
    s_waitcnt vmcnt(14)
    v_mfma_f32_16x16x32_bf16 v[96:99], v[180:183], a[112:115], v[96:99]
    s_barrier
    v_mfma_f32_16x16x32_bf16 v[96:99], v[176:179], a[96:99], v[96:99]
    s_waitcnt lgkmcnt(4)
    ds_read_b64_tr_b16 v[168:169], v144 offset:0
    v_mfma_f32_16x16x32_bf16 v[112:115], v[184:187], a[96:99], v[112:115]
    ds_read_b64_tr_b16 v[170:171], v144 offset:4096
    v_mfma_f32_16x16x32_bf16 v[112:115], v[188:191], a[112:115], v[112:115]
    buffer_load_dwordx4 a[56:59], v166, s[16:19], s29 offen offset:3072
    v_mfma_f32_16x16x32_bf16 v[116:119], v[188:191], a[116:119], v[116:119]
    v_mfma_f32_16x16x32_bf16 v[116:119], v[184:187], a[100:103], v[116:119]
    s_add_u32 s28, s28, 0x20000
    ds_read_b64_tr_b16 v[172:173], v144 offset:8192
    v_mfma_f32_16x16x32_bf16 v[120:123], v[184:187], a[104:107], v[120:123]
    s_add_u32 m0, s27, 32768
    v_mfma_f32_16x16x32_bf16 v[120:123], v[188:191], a[120:123], v[120:123]
    buffer_load_dwordx4 v160, s[12:15], s28 offen lds
    v_mfma_f32_16x16x32_bf16 v[124:127], v[188:191], a[124:127], v[124:127]
    ds_read_b64_tr_b16 v[174:175], v144 offset:12288
    v_mfma_f32_16x16x32_bf16 v[124:127], v[184:187], a[108:111], v[124:127]
    s_waitcnt lgkmcnt(4)
    v_mfma_f32_16x16x32_bf16 v[140:143], v[192:195], a[108:111], v[140:143]
    ds_read_b64_tr_b16 v[176:177], v145 offset:0
    v_mfma_f32_16x16x32_bf16 v[140:143], v[196:199], a[124:127], v[140:143]
    buffer_load_dwordx4 a[60:63], v167, s[16:19], s29 offen offset:3072
    v_mfma_f32_16x16x32_bf16 v[136:139], v[196:199], a[120:123], v[136:139]
    ds_read_b64_tr_b16 v[178:179], v145 offset:4096
    v_mfma_f32_16x16x32_bf16 v[136:139], v[192:195], a[104:107], v[136:139]
    v_mfma_f32_16x16x32_bf16 v[132:135], v[192:195], a[100:103], v[132:135]
    ds_read_b64_tr_b16 v[180:181], v145 offset:8192
    v_mfma_f32_16x16x32_bf16 v[132:135], v[196:199], a[116:119], v[132:135]
    v_mfma_f32_16x16x32_bf16 v[128:131], v[196:199], a[112:115], v[128:131]
    s_waitcnt vmcnt(13)
    ds_read_b64_tr_b16 v[182:183], v145 offset:12288
    v_mfma_f32_16x16x32_bf16 v[128:131], v[192:195], a[96:99], v[128:131]
    s_waitcnt lgkmcnt(4)
    s_sub_u32 s30, s30, 1
    s_cmp_eq_u32 s30, 3
    s_cselect_b32 s41, s40, s38
    s_cbranch_scc1 f_late_chk
f_late_ret:
    s_cmp_lg_u32 s30, 0
    s_cbranch_scc1 f_g5_loop
    v_mfma_f32_16x16x32_bf16 v[16:19], v[168:171], a[0:3], v[16:19]
    s_add_u32 s29, s29, 4096
    ds_read_b64_tr_b16 v[184:185], v146 offset:0
    v_mfma_f32_16x16x32_bf16 v[16:19], v[172:175], a[16:19], v[16:19]
    buffer_load_dwordx4 a[64:67], v164, s[16:19], s29 offen offset:0
    v_mfma_f32_16x16x32_bf16 v[20:23], v[172:175], a[20:23], v[20:23]
    ds_read_b64_tr_b16 v[186:187], v146 offset:4096
    v_mfma_f32_16x16x32_bf16 v[20:23], v[168:171], a[4:7], v[20:23]
    ds_read_b64_tr_b16 v[188:189], v146 offset:8192
    v_mfma_f32_16x16x32_bf16 v[24:27], v[168:171], a[8:11], v[24:27]
    s_add_u32 m0, s27, 33792
    v_mfma_f32_16x16x32_bf16 v[24:27], v[172:175], a[24:27], v[24:27]
    buffer_load_dwordx4 v161, s[12:15], s28 offen lds
    v_mfma_f32_16x16x32_bf16 v[28:31], v[172:175], a[28:31], v[28:31]
    ds_read_b64_tr_b16 v[190:191], v146 offset:12288
    v_mfma_f32_16x16x32_bf16 v[28:31], v[168:171], a[12:15], v[28:31]
    s_waitcnt lgkmcnt(4)
    ds_read_b64_tr_b16 v[192:193], v147 offset:0
    v_mfma_f32_16x16x32_bf16 v[44:47], v[176:179], a[12:15], v[44:47]
    v_mfma_f32_16x16x32_bf16 v[44:47], v[180:183], a[28:31], v[44:47]
    buffer_load_dwordx4 a[68:71], v165, s[16:19], s29 offen offset:0
    v_mfma_f32_16x16x32_bf16 v[40:43], v[180:183], a[24:27], v[40:43]
    ds_read_b64_tr_b16 v[194:195], v147 offset:4096
    v_mfma_f32_16x16x32_bf16 v[40:43], v[176:179], a[8:11], v[40:43]
    ds_read_b64_tr_b16 v[196:197], v147 offset:8192
    v_mfma_f32_16x16x32_bf16 v[36:39], v[176:179], a[4:7], v[36:39]
    v_mfma_f32_16x16x32_bf16 v[36:39], v[180:183], a[20:23], v[36:39]
    ds_read_b64_tr_b16 v[198:199], v147 offset:12288
    v_mfma_f32_16x16x32_bf16 v[32:35], v[180:183], a[16:19], v[32:35]
    ds_read_b64_tr_b16 v[168:169], v148 offset:0
    v_mfma_f32_16x16x32_bf16 v[32:35], v[176:179], a[0:3], v[32:35]
    s_waitcnt lgkmcnt(5)
    v_mfma_f32_16x16x32_bf16 v[48:51], v[184:187], a[0:3], v[48:51]
    ds_read_b64_tr_b16 v[170:171], v148 offset:4096
    v_mfma_f32_16x16x32_bf16 v[48:51], v[188:191], a[16:19], v[48:51]
    buffer_load_dwordx4 a[72:75], v166, s[16:19], s29 offen offset:0
    v_mfma_f32_16x16x32_bf16 v[52:55], v[188:191], a[20:23], v[52:55]
    ds_read_b64_tr_b16 v[172:173], v148 offset:8192
    v_mfma_f32_16x16x32_bf16 v[52:55], v[184:187], a[4:7], v[52:55]
    s_add_u32 m0, s27, 34816
    v_mfma_f32_16x16x32_bf16 v[56:59], v[184:187], a[8:11], v[56:59]
    buffer_load_dwordx4 a[240:243], v4, s[56:59], s48 offen offset:0
    v_mfma_f32_16x16x32_bf16 v[56:59], v[188:191], a[24:27], v[56:59]
    buffer_load_dwordx4 v162, s[12:15], s28 offen lds
    v_mfma_f32_16x16x32_bf16 v[60:63], v[188:191], a[28:31], v[60:63]
    ds_read_b64_tr_b16 v[174:175], v148 offset:12288
    v_mfma_f32_16x16x32_bf16 v[60:63], v[184:187], a[12:15], v[60:63]
    s_waitcnt lgkmcnt(4)
    ds_read_b64_tr_b16 v[176:177], v149 offset:0
    v_mfma_f32_16x16x32_bf16 v[76:79], v[192:195], a[12:15], v[76:79]
    ds_read_b64_tr_b16 v[178:179], v149 offset:4096
    v_mfma_f32_16x16x32_bf16 v[76:79], v[196:199], a[28:31], v[76:79]
    buffer_load_dwordx4 a[76:79], v167, s[16:19], s29 offen offset:0
    v_mfma_f32_16x16x32_bf16 v[72:75], v[196:199], a[24:27], v[72:75]
    v_mfma_f32_16x16x32_bf16 v[72:75], v[192:195], a[8:11], v[72:75]
    ds_read_b64_tr_b16 v[180:181], v149 offset:8192
    v_mfma_f32_16x16x32_bf16 v[68:71], v[192:195], a[4:7], v[68:71]
    ds_read_b64_tr_b16 v[182:183], v149 offset:12288
    v_mfma_f32_16x16x32_bf16 v[68:71], v[196:199], a[20:23], v[68:71]
    v_mfma_f32_16x16x32_bf16 v[64:67], v[196:199], a[16:19], v[64:67]
    ds_read_b64_tr_b16 v[184:185], v150 offset:0
    v_mfma_f32_16x16x32_bf16 v[64:67], v[192:195], a[0:3], v[64:67]
    s_waitcnt lgkmcnt(5)
    ds_read_b64_tr_b16 v[186:187], v150 offset:4096
    v_mfma_f32_16x16x32_bf16 v[80:83], v[168:171], a[0:3], v[80:83]
    v_mfma_f32_16x16x32_bf16 v[80:83], v[172:175], a[16:19], v[80:83]
    buffer_load_dwordx4 a[80:83], v164, s[16:19], s29 offen offset:1024
    v_mfma_f32_16x16x32_bf16 v[84:87], v[172:175], a[20:23], v[84:87]
    ds_read_b64_tr_b16 v[188:189], v150 offset:8192
    v_mfma_f32_16x16x32_bf16 v[84:87], v[168:171], a[4:7], v[84:87]
    ds_read_b64_tr_b16 v[190:191], v150 offset:12288
    v_mfma_f32_16x16x32_bf16 v[88:91], v[168:171], a[8:11], v[88:91]
    s_add_u32 m0, s27, 35840
    v_mfma_f32_16x16x32_bf16 v[88:91], v[172:175], a[24:27], v[88:91]
    buffer_load_dwordx4 v163, s[12:15], s28 offen lds
    v_mfma_f32_16x16x32_bf16 v[92:95], v[172:175], a[28:31], v[92:95]
    ds_read_b64_tr_b16 v[192:193], v151 offset:0
    v_mfma_f32_16x16x32_bf16 v[92:95], v[168:171], a[12:15], v[92:95]
    s_waitcnt lgkmcnt(5)
    ds_read_b64_tr_b16 v[194:195], v151 offset:4096
    v_mfma_f32_16x16x32_bf16 v[108:111], v[176:179], a[12:15], v[108:111]
    v_mfma_f32_16x16x32_bf16 v[108:111], v[180:183], a[28:31], v[108:111]
    buffer_load_dwordx4 a[84:87], v165, s[16:19], s29 offen offset:1024
    v_mfma_f32_16x16x32_bf16 v[104:107], v[180:183], a[24:27], v[104:107]
    ds_read_b64_tr_b16 v[196:197], v151 offset:8192
    v_mfma_f32_16x16x32_bf16 v[104:107], v[176:179], a[8:11], v[104:107]
    ds_read_b64_tr_b16 v[198:199], v151 offset:12288
    v_mfma_f32_16x16x32_bf16 v[100:103], v[176:179], a[4:7], v[100:103]
    buffer_load_dwordx4 a[244:247], v4, s[56:59], s48 offen offset:64
    v_mfma_f32_16x16x32_bf16 v[100:103], v[180:183], a[20:23], v[100:103]
    s_waitcnt vmcnt(15)
    v_mfma_f32_16x16x32_bf16 v[96:99], v[180:183], a[16:19], v[96:99]
    s_barrier
    v_mfma_f32_16x16x32_bf16 v[96:99], v[176:179], a[0:3], v[96:99]
    s_waitcnt lgkmcnt(4)
    ds_read_b64_tr_b16 v[168:169], v144 offset:16384
    v_mfma_f32_16x16x32_bf16 v[112:115], v[184:187], a[0:3], v[112:115]
    ds_read_b64_tr_b16 v[170:171], v144 offset:20480
    v_mfma_f32_16x16x32_bf16 v[112:115], v[188:191], a[16:19], v[112:115]
    buffer_load_dwordx4 a[88:91], v166, s[16:19], s29 offen offset:1024
    v_mfma_f32_16x16x32_bf16 v[116:119], v[188:191], a[20:23], v[116:119]
    v_mfma_f32_16x16x32_bf16 v[116:119], v[184:187], a[4:7], v[116:119]
    s_add_u32 s28, s28, 0x20000
    ds_read_b64_tr_b16 v[172:173], v144 offset:24576
    v_mfma_f32_16x16x32_bf16 v[120:123], v[184:187], a[8:11], v[120:123]
    s_add_u32 m0, s27, 49152
    ds_read_b64_tr_b16 v[174:175], v144 offset:28672
    v_mfma_f32_16x16x32_bf16 v[120:123], v[188:191], a[24:27], v[120:123]
    buffer_load_dwordx4 v160, s[12:15], s28 offen lds
    v_mfma_f32_16x16x32_bf16 v[124:127], v[188:191], a[28:31], v[124:127]
    v_mfma_f32_16x16x32_bf16 v[124:127], v[184:187], a[12:15], v[124:127]
    s_waitcnt lgkmcnt(4)
    ds_read_b64_tr_b16 v[176:177], v145 offset:16384
    v_mfma_f32_16x16x32_bf16 v[140:143], v[192:195], a[12:15], v[140:143]
    ds_read_b64_tr_b16 v[178:179], v145 offset:20480
    v_mfma_f32_16x16x32_bf16 v[140:143], v[196:199], a[28:31], v[140:143]
    buffer_load_dwordx4 a[92:95], v167, s[16:19], s29 offen offset:1024
    v_mfma_f32_16x16x32_bf16 v[136:139], v[196:199], a[24:27], v[136:139]
    v_mfma_f32_16x16x32_bf16 v[136:139], v[192:195], a[8:11], v[136:139]
    ds_read_b64_tr_b16 v[180:181], v145 offset:24576
    v_mfma_f32_16x16x32_bf16 v[132:135], v[192:195], a[4:7], v[132:135]
    ds_read_b64_tr_b16 v[182:183], v145 offset:28672
    v_mfma_f32_16x16x32_bf16 v[132:135], v[196:199], a[20:23], v[132:135]
    v_mfma_f32_16x16x32_bf16 v[128:131], v[196:199], a[16:19], v[128:131]
    s_waitcnt vmcnt(14)
    ds_read_b64_tr_b16 v[184:185], v146 offset:16384
    v_mfma_f32_16x16x32_bf16 v[128:131], v[192:195], a[0:3], v[128:131]
    s_waitcnt lgkmcnt(5)
    ds_read_b64_tr_b16 v[186:187], v146 offset:20480
    v_mfma_f32_16x16x32_bf16 v[16:19], v[168:171], a[32:35], v[16:19]
    v_mfma_f32_16x16x32_bf16 v[16:19], v[172:175], a[48:51], v[16:19]
    buffer_load_dwordx4 a[96:99], v164, s[16:19], s29 offen offset:2048
    v_mfma_f32_16x16x32_bf16 v[20:23], v[172:175], a[52:55], v[20:23]
    ds_read_b64_tr_b16 v[188:189], v146 offset:24576
    v_mfma_f32_16x16x32_bf16 v[20:23], v[168:171], a[36:39], v[20:23]
    s_add_u32 m0, s27, 50176
    ds_read_b64_tr_b16 v[190:191], v146 offset:28672
    v_mfma_f32_16x16x32_bf16 v[24:27], v[168:171], a[40:43], v[24:27]
    buffer_load_dwordx4 a[248:251], v4, s[56:59], s49 offen offset:0
    v_mfma_f32_16x16x32_bf16 v[24:27], v[172:175], a[56:59], v[24:27]
    buffer_load_dwordx4 v161, s[12:15], s28 offen lds
    v_mfma_f32_16x16x32_bf16 v[28:31], v[172:175], a[60:63], v[28:31]
    v_mfma_f32_16x16x32_bf16 v[28:31], v[168:171], a[44:47], v[28:31]
    s_waitcnt lgkmcnt(4)
    ds_read_b64_tr_b16 v[192:193], v147 offset:16384
    v_mfma_f32_16x16x32_bf16 v[44:47], v[176:179], a[44:47], v[44:47]
    ds_read_b64_tr_b16 v[194:195], v147 offset:20480
    v_mfma_f32_16x16x32_bf16 v[44:47], v[180:183], a[60:63], v[44:47]
    buffer_load_dwordx4 a[100:103], v165, s[16:19], s29 offen offset:2048
    v_mfma_f32_16x16x32_bf16 v[40:43], v[180:183], a[56:59], v[40:43]
    v_mfma_f32_16x16x32_bf16 v[40:43], v[176:179], a[40:43], v[40:43]
    ds_read_b64_tr_b16 v[196:197], v147 offset:24576
    v_mfma_f32_16x16x32_bf16 v[36:39], v[176:179], a[36:39], v[36:39]
    ds_read_b64_tr_b16 v[198:199], v147 offset:28672
    v_mfma_f32_16x16x32_bf16 v[36:39], v[180:183], a[52:55], v[36:39]
    v_mfma_f32_16x16x32_bf16 v[32:35], v[180:183], a[48:51], v[32:35]
    ds_read_b64_tr_b16 v[168:169], v148 offset:16384
    v_mfma_f32_16x16x32_bf16 v[32:35], v[176:179], a[32:35], v[32:35]
    s_waitcnt lgkmcnt(5)
    v_mfma_f32_16x16x32_bf16 v[48:51], v[184:187], a[32:35], v[48:51]
    ds_read_b64_tr_b16 v[170:171], v148 offset:20480
    v_mfma_f32_16x16x32_bf16 v[48:51], v[188:191], a[48:51], v[48:51]
    buffer_load_dwordx4 a[104:107], v166, s[16:19], s29 offen offset:2048
    v_mfma_f32_16x16x32_bf16 v[52:55], v[188:191], a[52:55], v[52:55]
    ds_read_b64_tr_b16 v[172:173], v148 offset:24576
    v_mfma_f32_16x16x32_bf16 v[52:55], v[184:187], a[36:39], v[52:55]
    v_mfma_f32_16x16x32_bf16 v[56:59], v[184:187], a[40:43], v[56:59]
    s_add_u32 m0, s27, 51200
    ds_read_b64_tr_b16 v[174:175], v148 offset:28672
    v_mfma_f32_16x16x32_bf16 v[56:59], v[188:191], a[56:59], v[56:59]
    buffer_load_dwordx4 v162, s[12:15], s28 offen lds
    v_mfma_f32_16x16x32_bf16 v[60:63], v[188:191], a[60:63], v[60:63]
    ds_read_b64_tr_b16 v[176:177], v149 offset:16384
    v_mfma_f32_16x16x32_bf16 v[60:63], v[184:187], a[44:47], v[60:63]
    s_waitcnt lgkmcnt(5)
    v_mfma_f32_16x16x32_bf16 v[76:79], v[192:195], a[44:47], v[76:79]
    ds_read_b64_tr_b16 v[178:179], v149 offset:20480
    v_mfma_f32_16x16x32_bf16 v[76:79], v[196:199], a[60:63], v[76:79]
    buffer_load_dwordx4 a[108:111], v167, s[16:19], s29 offen offset:2048
    v_mfma_f32_16x16x32_bf16 v[72:75], v[196:199], a[56:59], v[72:75]
    ds_read_b64_tr_b16 v[180:181], v149 offset:24576
    v_mfma_f32_16x16x32_bf16 v[72:75], v[192:195], a[40:43], v[72:75]
    v_mfma_f32_16x16x32_bf16 v[68:71], v[192:195], a[36:39], v[68:71]
    buffer_load_dwordx4 a[252:255], v4, s[56:59], s49 offen offset:64
    v_mfma_f32_16x16x32_bf16 v[68:71], v[196:199], a[52:55], v[68:71]
    ds_read_b64_tr_b16 v[182:183], v149 offset:28672
    v_mfma_f32_16x16x32_bf16 v[64:67], v[196:199], a[48:51], v[64:67]
    ds_read_b64_tr_b16 v[184:185], v150 offset:16384
    v_mfma_f32_16x16x32_bf16 v[64:67], v[192:195], a[32:35], v[64:67]
    s_waitcnt lgkmcnt(5)
    v_mfma_f32_16x16x32_bf16 v[80:83], v[168:171], a[32:35], v[80:83]
    ds_read_b64_tr_b16 v[186:187], v150 offset:20480
    v_mfma_f32_16x16x32_bf16 v[80:83], v[172:175], a[48:51], v[80:83]
    buffer_load_dwordx4 a[112:115], v164, s[16:19], s29 offen offset:3072
    v_mfma_f32_16x16x32_bf16 v[84:87], v[172:175], a[52:55], v[84:87]
    ds_read_b64_tr_b16 v[188:189], v150 offset:24576
    v_mfma_f32_16x16x32_bf16 v[84:87], v[168:171], a[36:39], v[84:87]
    v_mfma_f32_16x16x32_bf16 v[88:91], v[168:171], a[40:43], v[88:91]
    s_add_u32 m0, s27, 52224
    ds_read_b64_tr_b16 v[190:191], v150 offset:28672
    v_mfma_f32_16x16x32_bf16 v[88:91], v[172:175], a[56:59], v[88:91]
    buffer_load_dwordx4 v163, s[12:15], s28 offen lds
    v_mfma_f32_16x16x32_bf16 v[92:95], v[172:175], a[60:63], v[92:95]
    ds_read_b64_tr_b16 v[192:193], v151 offset:16384
    v_mfma_f32_16x16x32_bf16 v[92:95], v[168:171], a[44:47], v[92:95]
    s_waitcnt lgkmcnt(5)
    v_mfma_f32_16x16x32_bf16 v[108:111], v[176:179], a[44:47], v[108:111]
    ds_read_b64_tr_b16 v[194:195], v151 offset:20480
    v_mfma_f32_16x16x32_bf16 v[108:111], v[180:183], a[60:63], v[108:111]
    buffer_load_dwordx4 a[116:119], v165, s[16:19], s29 offen offset:3072
    v_mfma_f32_16x16x32_bf16 v[104:107], v[180:183], a[56:59], v[104:107]
    ds_read_b64_tr_b16 v[196:197], v151 offset:24576
    v_mfma_f32_16x16x32_bf16 v[104:107], v[176:179], a[40:43], v[104:107]
    v_mfma_f32_16x16x32_bf16 v[100:103], v[176:179], a[36:39], v[100:103]
    ds_read_b64_tr_b16 v[198:199], v151 offset:28672
    v_mfma_f32_16x16x32_bf16 v[100:103], v[180:183], a[52:55], v[100:103]
    s_waitcnt vmcnt(16)
    v_mfma_f32_16x16x32_bf16 v[96:99], v[180:183], a[48:51], v[96:99]
    s_barrier
    v_mfma_f32_16x16x32_bf16 v[96:99], v[176:179], a[32:35], v[96:99]
    s_waitcnt lgkmcnt(4)
    ds_read_b64_tr_b16 v[168:169], v144 offset:32768
    v_mfma_f32_16x16x32_bf16 v[112:115], v[184:187], a[32:35], v[112:115]
    ds_read_b64_tr_b16 v[170:171], v144 offset:36864
    v_mfma_f32_16x16x32_bf16 v[112:115], v[188:191], a[48:51], v[112:115]
    buffer_load_dwordx4 a[120:123], v166, s[16:19], s29 offen offset:3072
    v_mfma_f32_16x16x32_bf16 v[116:119], v[188:191], a[52:55], v[116:119]
    v_mfma_f32_16x16x32_bf16 v[116:119], v[184:187], a[36:39], v[116:119]
    s_add_u32 s28, s28, s41
    ds_read_b64_tr_b16 v[172:173], v144 offset:40960
    v_mfma_f32_16x16x32_bf16 v[120:123], v[184:187], a[40:43], v[120:123]
    s_add_u32 m0, s27, 0
    ds_read_b64_tr_b16 v[174:175], v144 offset:45056
    v_mfma_f32_16x16x32_bf16 v[120:123], v[188:191], a[56:59], v[120:123]
    buffer_load_dwordx4 v160, s[12:15], s28 offen lds
    v_mfma_f32_16x16x32_bf16 v[124:127], v[188:191], a[60:63], v[124:127]
    v_mfma_f32_16x16x32_bf16 v[124:127], v[184:187], a[44:47], v[124:127]
    s_waitcnt lgkmcnt(4)
    ds_read_b64_tr_b16 v[176:177], v145 offset:32768
    v_mfma_f32_16x16x32_bf16 v[140:143], v[192:195], a[44:47], v[140:143]
    ds_read_b64_tr_b16 v[178:179], v145 offset:36864
    v_mfma_f32_16x16x32_bf16 v[140:143], v[196:199], a[60:63], v[140:143]
    buffer_load_dwordx4 a[124:127], v167, s[16:19], s29 offen offset:3072
    v_mfma_f32_16x16x32_bf16 v[136:139], v[196:199], a[56:59], v[136:139]
    v_mfma_f32_16x16x32_bf16 v[136:139], v[192:195], a[40:43], v[136:139]
    ds_read_b64_tr_b16 v[180:181], v145 offset:40960
    v_mfma_f32_16x16x32_bf16 v[132:135], v[192:195], a[36:39], v[132:135]
    v_mfma_f32_16x16x32_bf16 v[132:135], v[196:199], a[52:55], v[132:135]
    ds_read_b64_tr_b16 v[182:183], v145 offset:45056
    v_mfma_f32_16x16x32_bf16 v[128:131], v[196:199], a[48:51], v[128:131]
    s_waitcnt vmcnt(14)
    ds_read_b64_tr_b16 v[184:185], v146 offset:32768
    v_mfma_f32_16x16x32_bf16 v[128:131], v[192:195], a[32:35], v[128:131]
    s_waitcnt lgkmcnt(5)
    v_mfma_f32_16x16x32_bf16 v[16:19], v[168:171], a[64:67], v[16:19]
    s_add_u32 s29, s29, 4096
    ds_read_b64_tr_b16 v[186:187], v146 offset:36864
    v_mfma_f32_16x16x32_bf16 v[16:19], v[172:175], a[80:83], v[16:19]
    buffer_load_dwordx4 a[0:3], v164, s[16:19], s29 offen offset:0
    v_mfma_f32_16x16x32_bf16 v[20:23], v[172:175], a[84:87], v[20:23]
    ds_read_b64_tr_b16 v[188:189], v146 offset:40960
    v_mfma_f32_16x16x32_bf16 v[20:23], v[168:171], a[68:71], v[20:23]
    v_mfma_f32_16x16x32_bf16 v[24:27], v[168:171], a[72:75], v[24:27]
    s_add_u32 m0, s27, 1024
    ds_read_b64_tr_b16 v[190:191], v146 offset:45056
    v_mfma_f32_16x16x32_bf16 v[24:27], v[172:175], a[88:91], v[24:27]
    buffer_load_dwordx4 v161, s[12:15], s28 offen lds
    v_mfma_f32_16x16x32_bf16 v[28:31], v[172:175], a[92:95], v[28:31]
    v_mfma_f32_16x16x32_bf16 v[28:31], v[168:171], a[76:79], v[28:31]
    s_waitcnt lgkmcnt(4)
    ds_read_b64_tr_b16 v[192:193], v147 offset:32768
    v_mfma_f32_16x16x32_bf16 v[44:47], v[176:179], a[76:79], v[44:47]
    ds_read_b64_tr_b16 v[194:195], v147 offset:36864
    v_mfma_f32_16x16x32_bf16 v[44:47], v[180:183], a[92:95], v[44:47]
    buffer_load_dwordx4 a[4:7], v165, s[16:19], s29 offen offset:0
    v_mfma_f32_16x16x32_bf16 v[40:43], v[180:183], a[88:91], v[40:43]
    v_mfma_f32_16x16x32_bf16 v[40:43], v[176:179], a[72:75], v[40:43]
    ds_read_b64_tr_b16 v[196:197], v147 offset:40960
    v_mfma_f32_16x16x32_bf16 v[36:39], v[176:179], a[68:71], v[36:39]
    ds_read_b64_tr_b16 v[198:199], v147 offset:45056
    v_mfma_f32_16x16x32_bf16 v[36:39], v[180:183], a[84:87], v[36:39]
    v_mfma_f32_16x16x32_bf16 v[32:35], v[180:183], a[80:83], v[32:35]
    ds_read_b64_tr_b16 v[168:169], v148 offset:32768
    v_mfma_f32_16x16x32_bf16 v[32:35], v[176:179], a[64:67], v[32:35]
    s_waitcnt lgkmcnt(5)
    v_mfma_f32_16x16x32_bf16 v[48:51], v[184:187], a[64:67], v[48:51]
    ds_read_b64_tr_b16 v[170:171], v148 offset:36864
    v_mfma_f32_16x16x32_bf16 v[48:51], v[188:191], a[80:83], v[48:51]
    buffer_load_dwordx4 a[8:11], v166, s[16:19], s29 offen offset:0
    v_mfma_f32_16x16x32_bf16 v[52:55], v[188:191], a[84:87], v[52:55]
    ds_read_b64_tr_b16 v[172:173], v148 offset:40960
    v_mfma_f32_16x16x32_bf16 v[52:55], v[184:187], a[68:71], v[52:55]
    v_mfma_f32_16x16x32_bf16 v[56:59], v[184:187], a[72:75], v[56:59]
    s_add_u32 m0, s27, 2048
    ds_read_b64_tr_b16 v[174:175], v148 offset:45056
    v_mfma_f32_16x16x32_bf16 v[56:59], v[188:191], a[88:91], v[56:59]
    buffer_load_dwordx4 v162, s[12:15], s28 offen lds
    v_mfma_f32_16x16x32_bf16 v[60:63], v[188:191], a[92:95], v[60:63]
    ds_read_b64_tr_b16 v[176:177], v149 offset:32768
    v_mfma_f32_16x16x32_bf16 v[60:63], v[184:187], a[76:79], v[60:63]
    s_waitcnt lgkmcnt(5)
    v_mfma_f32_16x16x32_bf16 v[76:79], v[192:195], a[76:79], v[76:79]
    ds_read_b64_tr_b16 v[178:179], v149 offset:36864
    v_mfma_f32_16x16x32_bf16 v[76:79], v[196:199], a[92:95], v[76:79]
    buffer_load_dwordx4 a[12:15], v167, s[16:19], s29 offen offset:0
    v_mfma_f32_16x16x32_bf16 v[72:75], v[196:199], a[88:91], v[72:75]
    v_mfma_f32_16x16x32_bf16 v[72:75], v[192:195], a[72:75], v[72:75]
    ds_read_b64_tr_b16 v[180:181], v149 offset:40960
    v_mfma_f32_16x16x32_bf16 v[68:71], v[192:195], a[68:71], v[68:71]
    ds_read_b64_tr_b16 v[182:183], v149 offset:45056
    v_mfma_f32_16x16x32_bf16 v[68:71], v[196:199], a[84:87], v[68:71]
    v_mfma_f32_16x16x32_bf16 v[64:67], v[196:199], a[80:83], v[64:67]
    ds_read_b64_tr_b16 v[184:185], v150 offset:32768
    v_mfma_f32_16x16x32_bf16 v[64:67], v[192:195], a[64:67], v[64:67]
    s_waitcnt lgkmcnt(5)
    ds_read_b64_tr_b16 v[186:187], v150 offset:36864
    v_mfma_f32_16x16x32_bf16 v[80:83], v[168:171], a[64:67], v[80:83]
    v_mfma_f32_16x16x32_bf16 v[80:83], v[172:175], a[80:83], v[80:83]
    buffer_load_dwordx4 a[16:19], v164, s[16:19], s29 offen offset:1024
    v_mfma_f32_16x16x32_bf16 v[84:87], v[172:175], a[84:87], v[84:87]
    ds_read_b64_tr_b16 v[188:189], v150 offset:40960
    v_mfma_f32_16x16x32_bf16 v[84:87], v[168:171], a[68:71], v[84:87]
    v_mfma_f32_16x16x32_bf16 v[88:91], v[168:171], a[72:75], v[88:91]
    s_add_u32 m0, s27, 3072
    ds_read_b64_tr_b16 v[190:191], v150 offset:45056
    v_mfma_f32_16x16x32_bf16 v[88:91], v[172:175], a[88:91], v[88:91]
    buffer_load_dwordx4 v163, s[12:15], s28 offen lds
    v_mfma_f32_16x16x32_bf16 v[92:95], v[172:175], a[92:95], v[92:95]
    ds_read_b64_tr_b16 v[192:193], v151 offset:32768
    v_mfma_f32_16x16x32_bf16 v[92:95], v[168:171], a[76:79], v[92:95]
    s_waitcnt lgkmcnt(5)
    v_mfma_f32_16x16x32_bf16 v[108:111], v[176:179], a[76:79], v[108:111]
    ds_read_b64_tr_b16 v[194:195], v151 offset:36864
    v_mfma_f32_16x16x32_bf16 v[108:111], v[180:183], a[92:95], v[108:111]
    buffer_load_dwordx4 a[20:23], v165, s[16:19], s29 offen offset:1024
    v_mfma_f32_16x16x32_bf16 v[104:107], v[180:183], a[88:91], v[104:107]
    ds_read_b64_tr_b16 v[196:197], v151 offset:40960
    v_mfma_f32_16x16x32_bf16 v[104:107], v[176:179], a[72:75], v[104:107]
    v_mfma_f32_16x16x32_bf16 v[100:103], v[176:179], a[68:71], v[100:103]
    ds_read_b64_tr_b16 v[198:199], v151 offset:45056
    v_mfma_f32_16x16x32_bf16 v[100:103], v[180:183], a[84:87], v[100:103]
    s_waitcnt vmcnt(13)
    v_mfma_f32_16x16x32_bf16 v[96:99], v[180:183], a[80:83], v[96:99]
    s_barrier
    v_mfma_f32_16x16x32_bf16 v[96:99], v[176:179], a[64:67], v[96:99]
    s_waitcnt lgkmcnt(4)
    ds_read_b64_tr_b16 v[168:169], v144 offset:49152
    v_mfma_f32_16x16x32_bf16 v[112:115], v[184:187], a[64:67], v[112:115]
    ds_read_b64_tr_b16 v[170:171], v144 offset:53248
    v_mfma_f32_16x16x32_bf16 v[112:115], v[188:191], a[80:83], v[112:115]
    buffer_load_dwordx4 a[24:27], v166, s[16:19], s29 offen offset:1024
    v_mfma_f32_16x16x32_bf16 v[116:119], v[188:191], a[84:87], v[116:119]
    v_mfma_f32_16x16x32_bf16 v[116:119], v[184:187], a[68:71], v[116:119]
    s_add_u32 s28, s28, 0x20000
    ds_read_b64_tr_b16 v[172:173], v144 offset:57344
    v_mfma_f32_16x16x32_bf16 v[120:123], v[184:187], a[72:75], v[120:123]
    s_add_u32 m0, s27, 16384
    ds_read_b64_tr_b16 v[174:175], v144 offset:61440
    v_mfma_f32_16x16x32_bf16 v[120:123], v[188:191], a[88:91], v[120:123]
    buffer_load_dwordx4 v160, s[12:15], s28 offen lds
    v_mfma_f32_16x16x32_bf16 v[124:127], v[188:191], a[92:95], v[124:127]
    v_mfma_f32_16x16x32_bf16 v[124:127], v[184:187], a[76:79], v[124:127]
    s_waitcnt lgkmcnt(4)
    ds_read_b64_tr_b16 v[176:177], v145 offset:49152
    v_mfma_f32_16x16x32_bf16 v[140:143], v[192:195], a[76:79], v[140:143]
    ds_read_b64_tr_b16 v[178:179], v145 offset:53248
    v_mfma_f32_16x16x32_bf16 v[140:143], v[196:199], a[92:95], v[140:143]
    buffer_load_dwordx4 a[28:31], v167, s[16:19], s29 offen offset:1024
    v_mfma_f32_16x16x32_bf16 v[136:139], v[196:199], a[88:91], v[136:139]
    v_mfma_f32_16x16x32_bf16 v[136:139], v[192:195], a[72:75], v[136:139]
    ds_read_b64_tr_b16 v[180:181], v145 offset:57344
    v_mfma_f32_16x16x32_bf16 v[132:135], v[192:195], a[68:71], v[132:135]
    v_mfma_f32_16x16x32_bf16 v[132:135], v[196:199], a[84:87], v[132:135]
    ds_read_b64_tr_b16 v[182:183], v145 offset:61440
    v_mfma_f32_16x16x32_bf16 v[128:131], v[196:199], a[80:83], v[128:131]
    s_waitcnt vmcnt(12)
    ds_read_b64_tr_b16 v[184:185], v146 offset:49152
    v_mfma_f32_16x16x32_bf16 v[128:131], v[192:195], a[64:67], v[128:131]
    s_waitcnt lgkmcnt(5)
    v_mfma_f32_16x16x32_bf16 v[16:19], v[168:171], a[96:99], v[16:19]
    ds_read_b64_tr_b16 v[186:187], v146 offset:53248
    v_mfma_f32_16x16x32_bf16 v[16:19], v[172:175], a[112:115], v[16:19]
    buffer_load_dwordx4 a[32:35], v164, s[16:19], s29 offen offset:2048
    v_mfma_f32_16x16x32_bf16 v[20:23], v[172:175], a[116:119], v[20:23]
    ds_read_b64_tr_b16 v[188:189], v146 offset:57344
    v_mfma_f32_16x16x32_bf16 v[20:23], v[168:171], a[100:103], v[20:23]
    v_mfma_f32_16x16x32_bf16 v[24:27], v[168:171], a[104:107], v[24:27]
    s_add_u32 m0, s27, 17408
    ds_read_b64_tr_b16 v[190:191], v146 offset:61440
    v_mfma_f32_16x16x32_bf16 v[24:27], v[172:175], a[120:123], v[24:27]
    buffer_load_dwordx4 v161, s[12:15], s28 offen lds
    v_mfma_f32_16x16x32_bf16 v[28:31], v[172:175], a[124:127], v[28:31]
    v_mfma_f32_16x16x32_bf16 v[28:31], v[168:171], a[108:111], v[28:31]
    s_waitcnt lgkmcnt(4)
    ds_read_b64_tr_b16 v[192:193], v147 offset:49152
    v_mfma_f32_16x16x32_bf16 v[44:47], v[176:179], a[108:111], v[44:47]
    ds_read_b64_tr_b16 v[194:195], v147 offset:53248
    v_mfma_f32_16x16x32_bf16 v[44:47], v[180:183], a[124:127], v[44:47]
    buffer_load_dwordx4 a[36:39], v165, s[16:19], s29 offen offset:2048
    v_mfma_f32_16x16x32_bf16 v[40:43], v[180:183], a[120:123], v[40:43]
    v_mfma_f32_16x16x32_bf16 v[40:43], v[176:179], a[104:107], v[40:43]
    ds_read_b64_tr_b16 v[196:197], v147 offset:57344
    v_mfma_f32_16x16x32_bf16 v[36:39], v[176:179], a[100:103], v[36:39]
    ds_read_b64_tr_b16 v[198:199], v147 offset:61440
    v_mfma_f32_16x16x32_bf16 v[36:39], v[180:183], a[116:119], v[36:39]
    v_mfma_f32_16x16x32_bf16 v[32:35], v[180:183], a[112:115], v[32:35]
    ds_read_b64_tr_b16 v[168:169], v148 offset:49152
    v_mfma_f32_16x16x32_bf16 v[32:35], v[176:179], a[96:99], v[32:35]
    s_waitcnt lgkmcnt(5)
    v_mfma_f32_16x16x32_bf16 v[48:51], v[184:187], a[96:99], v[48:51]
    ds_read_b64_tr_b16 v[170:171], v148 offset:53248
    v_mfma_f32_16x16x32_bf16 v[48:51], v[188:191], a[112:115], v[48:51]
    buffer_load_dwordx4 a[40:43], v166, s[16:19], s29 offen offset:2048
    v_mfma_f32_16x16x32_bf16 v[52:55], v[188:191], a[116:119], v[52:55]
    ds_read_b64_tr_b16 v[172:173], v148 offset:57344
    v_mfma_f32_16x16x32_bf16 v[52:55], v[184:187], a[100:103], v[52:55]
    v_mfma_f32_16x16x32_bf16 v[56:59], v[184:187], a[104:107], v[56:59]
    s_add_u32 m0, s27, 18432
    ds_read_b64_tr_b16 v[174:175], v148 offset:61440
    v_mfma_f32_16x16x32_bf16 v[56:59], v[188:191], a[120:123], v[56:59]
    buffer_load_dwordx4 v162, s[12:15], s28 offen lds
    v_mfma_f32_16x16x32_bf16 v[60:63], v[188:191], a[124:127], v[60:63]
    ds_read_b64_tr_b16 v[176:177], v149 offset:49152
    v_mfma_f32_16x16x32_bf16 v[60:63], v[184:187], a[108:111], v[60:63]
    s_waitcnt lgkmcnt(5)
    v_mfma_f32_16x16x32_bf16 v[76:79], v[192:195], a[108:111], v[76:79]
    ds_read_b64_tr_b16 v[178:179], v149 offset:53248
    v_mfma_f32_16x16x32_bf16 v[76:79], v[196:199], a[124:127], v[76:79]
    buffer_load_dwordx4 a[44:47], v167, s[16:19], s29 offen offset:2048
    v_mfma_f32_16x16x32_bf16 v[72:75], v[196:199], a[120:123], v[72:75]
    v_mfma_f32_16x16x32_bf16 v[72:75], v[192:195], a[104:107], v[72:75]
    ds_read_b64_tr_b16 v[180:181], v149 offset:57344
    v_mfma_f32_16x16x32_bf16 v[68:71], v[192:195], a[100:103], v[68:71]
    ds_read_b64_tr_b16 v[182:183], v149 offset:61440
    v_mfma_f32_16x16x32_bf16 v[68:71], v[196:199], a[116:119], v[68:71]
    v_mfma_f32_16x16x32_bf16 v[64:67], v[196:199], a[112:115], v[64:67]
    ds_read_b64_tr_b16 v[184:185], v150 offset:49152
    v_mfma_f32_16x16x32_bf16 v[64:67], v[192:195], a[96:99], v[64:67]
    s_waitcnt lgkmcnt(5)
    ds_read_b64_tr_b16 v[186:187], v150 offset:53248
    v_mfma_f32_16x16x32_bf16 v[80:83], v[168:171], a[96:99], v[80:83]
    v_mfma_f32_16x16x32_bf16 v[80:83], v[172:175], a[112:115], v[80:83]
    buffer_load_dwordx4 a[48:51], v164, s[16:19], s29 offen offset:3072
    v_mfma_f32_16x16x32_bf16 v[84:87], v[172:175], a[116:119], v[84:87]
    ds_read_b64_tr_b16 v[188:189], v150 offset:57344
    v_mfma_f32_16x16x32_bf16 v[84:87], v[168:171], a[100:103], v[84:87]
    v_mfma_f32_16x16x32_bf16 v[88:91], v[168:171], a[104:107], v[88:91]
    s_add_u32 m0, s27, 19456
    ds_read_b64_tr_b16 v[190:191], v150 offset:61440
    v_mfma_f32_16x16x32_bf16 v[88:91], v[172:175], a[120:123], v[88:91]
    buffer_load_dwordx4 v163, s[12:15], s28 offen lds
    v_mfma_f32_16x16x32_bf16 v[92:95], v[172:175], a[124:127], v[92:95]
    ds_read_b64_tr_b16 v[192:193], v151 offset:49152
    v_mfma_f32_16x16x32_bf16 v[92:95], v[168:171], a[108:111], v[92:95]
    s_waitcnt lgkmcnt(5)
    v_mfma_f32_16x16x32_bf16 v[108:111], v[176:179], a[108:111], v[108:111]
    ds_read_b64_tr_b16 v[194:195], v151 offset:53248
    v_mfma_f32_16x16x32_bf16 v[108:111], v[180:183], a[124:127], v[108:111]
    buffer_load_dwordx4 a[52:55], v165, s[16:19], s29 offen offset:3072
    v_mfma_f32_16x16x32_bf16 v[104:107], v[180:183], a[120:123], v[104:107]
    ds_read_b64_tr_b16 v[196:197], v151 offset:57344
    v_mfma_f32_16x16x32_bf16 v[104:107], v[176:179], a[104:107], v[104:107]
    v_mfma_f32_16x16x32_bf16 v[100:103], v[176:179], a[100:103], v[100:103]
    ds_read_b64_tr_b16 v[198:199], v151 offset:61440
    v_mfma_f32_16x16x32_bf16 v[100:103], v[180:183], a[116:119], v[100:103]
    s_waitcnt vmcnt(13)
    v_mfma_f32_16x16x32_bf16 v[96:99], v[180:183], a[112:115], v[96:99]
    s_barrier
    v_mfma_f32_16x16x32_bf16 v[96:99], v[176:179], a[96:99], v[96:99]
    s_waitcnt lgkmcnt(4)
    ds_read_b64_tr_b16 v[168:169], v144 offset:0
    v_mfma_f32_16x16x32_bf16 v[112:115], v[184:187], a[96:99], v[112:115]
    ds_read_b64_tr_b16 v[170:171], v144 offset:4096
    v_mfma_f32_16x16x32_bf16 v[112:115], v[188:191], a[112:115], v[112:115]
    buffer_load_dwordx4 a[56:59], v166, s[16:19], s29 offen offset:3072
    v_mfma_f32_16x16x32_bf16 v[116:119], v[188:191], a[116:119], v[116:119]
    v_mfma_f32_16x16x32_bf16 v[116:119], v[184:187], a[100:103], v[116:119]
    s_add_u32 s28, s28, 0x20000
    ds_read_b64_tr_b16 v[172:173], v144 offset:8192
    v_mfma_f32_16x16x32_bf16 v[120:123], v[184:187], a[104:107], v[120:123]
    s_add_u32 m0, s27, 32768
    v_mfma_f32_16x16x32_bf16 v[120:123], v[188:191], a[120:123], v[120:123]
    buffer_load_dwordx4 v160, s[12:15], s28 offen lds
    v_mfma_f32_16x16x32_bf16 v[124:127], v[188:191], a[124:127], v[124:127]
    ds_read_b64_tr_b16 v[174:175], v144 offset:12288
    v_mfma_f32_16x16x32_bf16 v[124:127], v[184:187], a[108:111], v[124:127]
    s_waitcnt lgkmcnt(4)
    v_mfma_f32_16x16x32_bf16 v[140:143], v[192:195], a[108:111], v[140:143]
    ds_read_b64_tr_b16 v[176:177], v145 offset:0
    v_mfma_f32_16x16x32_bf16 v[140:143], v[196:199], a[124:127], v[140:143]
    buffer_load_dwordx4 a[60:63], v167, s[16:19], s29 offen offset:3072
    v_mfma_f32_16x16x32_bf16 v[136:139], v[196:199], a[120:123], v[136:139]
    ds_read_b64_tr_b16 v[178:179], v145 offset:4096
    v_mfma_f32_16x16x32_bf16 v[136:139], v[192:195], a[104:107], v[136:139]
    v_mfma_f32_16x16x32_bf16 v[132:135], v[192:195], a[100:103], v[132:135]
    ds_read_b64_tr_b16 v[180:181], v145 offset:8192
    v_mfma_f32_16x16x32_bf16 v[132:135], v[196:199], a[116:119], v[132:135]
    v_mfma_f32_16x16x32_bf16 v[128:131], v[196:199], a[112:115], v[128:131]
    s_waitcnt vmcnt(12)
    ds_read_b64_tr_b16 v[182:183], v145 offset:12288
    v_mfma_f32_16x16x32_bf16 v[128:131], v[192:195], a[96:99], v[128:131]
    s_waitcnt lgkmcnt(4)
    v_mfma_f32_16x16x32_bf16 v[16:19], v[168:171], a[0:3], v[16:19]
    s_add_u32 s29, s29, 4096
    ds_read_b64_tr_b16 v[184:185], v146 offset:0
    v_mfma_f32_16x16x32_bf16 v[16:19], v[172:175], a[16:19], v[16:19]
    buffer_load_dwordx4 a[64:67], v164, s[16:19], s29 offen offset:0
    v_mfma_f32_16x16x32_bf16 v[20:23], v[172:175], a[20:23], v[20:23]
    ds_read_b64_tr_b16 v[186:187], v146 offset:4096
    v_mfma_f32_16x16x32_bf16 v[20:23], v[168:171], a[4:7], v[20:23]
    v_mfma_f32_16x16x32_bf16 v[24:27], v[168:171], a[8:11], v[24:27]
    s_add_u32 m0, s27, 33792
    ds_read_b64_tr_b16 v[188:189], v146 offset:8192
    v_mfma_f32_16x16x32_bf16 v[24:27], v[172:175], a[24:27], v[24:27]
    buffer_load_dwordx4 v161, s[12:15], s28 offen lds
    v_mfma_f32_16x16x32_bf16 v[28:31], v[172:175], a[28:31], v[28:31]
    ds_read_b64_tr_b16 v[190:191], v146 offset:12288
    v_mfma_f32_16x16x32_bf16 v[28:31], v[168:171], a[12:15], v[28:31]
    s_waitcnt lgkmcnt(4)
    v_mfma_f32_16x16x32_bf16 v[44:47], v[176:179], a[12:15], v[44:47]
    ds_read_b64_tr_b16 v[192:193], v147 offset:0
    v_mfma_f32_16x16x32_bf16 v[44:47], v[180:183], a[28:31], v[44:47]
    buffer_load_dwordx4 a[68:71], v165, s[16:19], s29 offen offset:0
    v_mfma_f32_16x16x32_bf16 v[40:43], v[180:183], a[24:27], v[40:43]
    ds_read_b64_tr_b16 v[194:195], v147 offset:4096
    v_mfma_f32_16x16x32_bf16 v[40:43], v[176:179], a[8:11], v[40:43]
    v_mfma_f32_16x16x32_bf16 v[36:39], v[176:179], a[4:7], v[36:39]
    ds_read_b64_tr_b16 v[196:197], v147 offset:8192
    v_mfma_f32_16x16x32_bf16 v[36:39], v[180:183], a[20:23], v[36:39]
    ds_read_b64_tr_b16 v[198:199], v147 offset:12288
    v_mfma_f32_16x16x32_bf16 v[32:35], v[180:183], a[16:19], v[32:35]
    v_mfma_f32_16x16x32_bf16 v[32:35], v[176:179], a[0:3], v[32:35]
    s_waitcnt lgkmcnt(4)
    ds_read_b64_tr_b16 v[168:169], v148 offset:0
    v_mfma_f32_16x16x32_bf16 v[48:51], v[184:187], a[0:3], v[48:51]
    ds_read_b64_tr_b16 v[170:171], v148 offset:4096
    v_mfma_f32_16x16x32_bf16 v[48:51], v[188:191], a[16:19], v[48:51]
    buffer_load_dwordx4 a[72:75], v166, s[16:19], s29 offen offset:0
    v_mfma_f32_16x16x32_bf16 v[52:55], v[188:191], a[20:23], v[52:55]
    v_mfma_f32_16x16x32_bf16 v[52:55], v[184:187], a[4:7], v[52:55]
    ds_read_b64_tr_b16 v[172:173], v148 offset:8192
    v_mfma_f32_16x16x32_bf16 v[56:59], v[184:187], a[8:11], v[56:59]
    s_add_u32 m0, s27, 34816
    ds_read_b64_tr_b16 v[174:175], v148 offset:12288
    v_mfma_f32_16x16x32_bf16 v[56:59], v[188:191], a[24:27], v[56:59]
    buffer_load_dwordx4 v162, s[12:15], s28 offen lds
    v_mfma_f32_16x16x32_bf16 v[60:63], v[188:191], a[28:31], v[60:63]
    v_mfma_f32_16x16x32_bf16 v[60:63], v[184:187], a[12:15], v[60:63]
    s_waitcnt lgkmcnt(4)
    ds_read_b64_tr_b16 v[176:177], v149 offset:0
    v_mfma_f32_16x16x32_bf16 v[76:79], v[192:195], a[12:15], v[76:79]
    v_mfma_f32_16x16x32_bf16 v[76:79], v[196:199], a[28:31], v[76:79]
    buffer_load_dwordx4 a[76:79], v167, s[16:19], s29 offen offset:0
    v_mfma_f32_16x16x32_bf16 v[72:75], v[196:199], a[24:27], v[72:75]
    ds_read_b64_tr_b16 v[178:179], v149 offset:4096
    v_mfma_f32_16x16x32_bf16 v[72:75], v[192:195], a[8:11], v[72:75]
    ds_read_b64_tr_b16 v[180:181], v149 offset:8192
    v_mfma_f32_16x16x32_bf16 v[68:71], v[192:195], a[4:7], v[68:71]
    v_mfma_f32_16x16x32_bf16 v[68:71], v[196:199], a[20:23], v[68:71]
    ds_read_b64_tr_b16 v[182:183], v149 offset:12288
    v_mfma_f32_16x16x32_bf16 v[64:67], v[196:199], a[16:19], v[64:67]
    ds_read_b64_tr_b16 v[184:185], v150 offset:0
    v_mfma_f32_16x16x32_bf16 v[64:67], v[192:195], a[0:3], v[64:67]
    s_waitcnt lgkmcnt(5)
    v_mfma_f32_16x16x32_bf16 v[80:83], v[168:171], a[0:3], v[80:83]
    ds_read_b64_tr_b16 v[186:187], v150 offset:4096
    v_mfma_f32_16x16x32_bf16 v[80:83], v[172:175], a[16:19], v[80:83]
    buffer_load_dwordx4 a[80:83], v164, s[16:19], s29 offen offset:1024
    v_mfma_f32_16x16x32_bf16 v[84:87], v[172:175], a[20:23], v[84:87]
    ds_read_b64_tr_b16 v[188:189], v150 offset:8192
    v_mfma_f32_16x16x32_bf16 v[84:87], v[168:171], a[4:7], v[84:87]
    v_mfma_f32_16x16x32_bf16 v[88:91], v[168:171], a[8:11], v[88:91]
    s_add_u32 m0, s27, 35840
    ds_read_b64_tr_b16 v[190:191], v150 offset:12288
    v_mfma_f32_16x16x32_bf16 v[88:91], v[172:175], a[24:27], v[88:91]
    buffer_load_dwordx4 v163, s[12:15], s28 offen lds
    v_mfma_f32_16x16x32_bf16 v[92:95], v[172:175], a[28:31], v[92:95]
    ds_read_b64_tr_b16 v[192:193], v151 offset:0
    v_mfma_f32_16x16x32_bf16 v[92:95], v[168:171], a[12:15], v[92:95]
    s_waitcnt lgkmcnt(5)
    v_mfma_f32_16x16x32_bf16 v[108:111], v[176:179], a[12:15], v[108:111]
    ds_read_b64_tr_b16 v[194:195], v151 offset:4096
    v_mfma_f32_16x16x32_bf16 v[108:111], v[180:183], a[28:31], v[108:111]
    buffer_load_dwordx4 a[84:87], v165, s[16:19], s29 offen offset:1024
    v_mfma_f32_16x16x32_bf16 v[104:107], v[180:183], a[24:27], v[104:107]
    ds_read_b64_tr_b16 v[196:197], v151 offset:8192
    v_mfma_f32_16x16x32_bf16 v[104:107], v[176:179], a[8:11], v[104:107]
    v_mfma_f32_16x16x32_bf16 v[100:103], v[176:179], a[4:7], v[100:103]
    ds_read_b64_tr_b16 v[198:199], v151 offset:12288
    v_mfma_f32_16x16x32_bf16 v[100:103], v[180:183], a[20:23], v[100:103]
    s_waitcnt vmcnt(13)
    v_mfma_f32_16x16x32_bf16 v[96:99], v[180:183], a[16:19], v[96:99]
    s_barrier
    v_mfma_f32_16x16x32_bf16 v[96:99], v[176:179], a[0:3], v[96:99]
    s_waitcnt lgkmcnt(4)
    ds_read_b64_tr_b16 v[168:169], v144 offset:16384
    v_mfma_f32_16x16x32_bf16 v[112:115], v[184:187], a[0:3], v[112:115]
    ds_read_b64_tr_b16 v[170:171], v144 offset:20480
    v_mfma_f32_16x16x32_bf16 v[112:115], v[188:191], a[16:19], v[112:115]
    buffer_load_dwordx4 a[88:91], v166, s[16:19], s29 offen offset:1024
    v_mfma_f32_16x16x32_bf16 v[116:119], v[188:191], a[20:23], v[116:119]
    v_mfma_f32_16x16x32_bf16 v[116:119], v[184:187], a[4:7], v[116:119]
    s_add_u32 s28, s28, 0x20000
    ds_read_b64_tr_b16 v[172:173], v144 offset:24576
    v_mfma_f32_16x16x32_bf16 v[120:123], v[184:187], a[8:11], v[120:123]
    s_add_u32 m0, s27, 49152
    ds_read_b64_tr_b16 v[174:175], v144 offset:28672
    v_mfma_f32_16x16x32_bf16 v[120:123], v[188:191], a[24:27], v[120:123]
    buffer_load_dwordx4 v160, s[12:15], s28 offen lds
    v_mfma_f32_16x16x32_bf16 v[124:127], v[188:191], a[28:31], v[124:127]
    v_mfma_f32_16x16x32_bf16 v[124:127], v[184:187], a[12:15], v[124:127]
    s_waitcnt lgkmcnt(4)
    ds_read_b64_tr_b16 v[176:177], v145 offset:16384
    v_mfma_f32_16x16x32_bf16 v[140:143], v[192:195], a[12:15], v[140:143]
    ds_read_b64_tr_b16 v[178:179], v145 offset:20480
    v_mfma_f32_16x16x32_bf16 v[140:143], v[196:199], a[28:31], v[140:143]
    buffer_load_dwordx4 a[92:95], v167, s[16:19], s29 offen offset:1024
    v_mfma_f32_16x16x32_bf16 v[136:139], v[196:199], a[24:27], v[136:139]
    v_mfma_f32_16x16x32_bf16 v[136:139], v[192:195], a[8:11], v[136:139]
    ds_read_b64_tr_b16 v[180:181], v145 offset:24576
    v_mfma_f32_16x16x32_bf16 v[132:135], v[192:195], a[4:7], v[132:135]
    v_mfma_f32_16x16x32_bf16 v[132:135], v[196:199], a[20:23], v[132:135]
    ds_read_b64_tr_b16 v[182:183], v145 offset:28672
    v_mfma_f32_16x16x32_bf16 v[128:131], v[196:199], a[16:19], v[128:131]
    s_waitcnt vmcnt(12)
    ds_read_b64_tr_b16 v[184:185], v146 offset:16384
    v_mfma_f32_16x16x32_bf16 v[128:131], v[192:195], a[0:3], v[128:131]
    s_waitcnt lgkmcnt(5)
    v_mfma_f32_16x16x32_bf16 v[16:19], v[168:171], a[32:35], v[16:19]
    ds_read_b64_tr_b16 v[186:187], v146 offset:20480
    v_mfma_f32_16x16x32_bf16 v[16:19], v[172:175], a[48:51], v[16:19]
    buffer_load_dwordx4 a[96:99], v164, s[16:19], s29 offen offset:2048
    v_mfma_f32_16x16x32_bf16 v[20:23], v[172:175], a[52:55], v[20:23]
    ds_read_b64_tr_b16 v[188:189], v146 offset:24576
    v_mfma_f32_16x16x32_bf16 v[20:23], v[168:171], a[36:39], v[20:23]
    v_mfma_f32_16x16x32_bf16 v[24:27], v[168:171], a[40:43], v[24:27]
    s_add_u32 m0, s27, 50176
    ds_read_b64_tr_b16 v[190:191], v146 offset:28672
    v_mfma_f32_16x16x32_bf16 v[24:27], v[172:175], a[56:59], v[24:27]
    buffer_load_dwordx4 v161, s[12:15], s28 offen lds
    v_mfma_f32_16x16x32_bf16 v[28:31], v[172:175], a[60:63], v[28:31]
    v_mfma_f32_16x16x32_bf16 v[28:31], v[168:171], a[44:47], v[28:31]
    s_waitcnt lgkmcnt(4)
    ds_read_b64_tr_b16 v[192:193], v147 offset:16384
    v_mfma_f32_16x16x32_bf16 v[44:47], v[176:179], a[44:47], v[44:47]
    ds_read_b64_tr_b16 v[194:195], v147 offset:20480
    v_mfma_f32_16x16x32_bf16 v[44:47], v[180:183], a[60:63], v[44:47]
    buffer_load_dwordx4 a[100:103], v165, s[16:19], s29 offen offset:2048
    v_mfma_f32_16x16x32_bf16 v[40:43], v[180:183], a[56:59], v[40:43]
    v_mfma_f32_16x16x32_bf16 v[40:43], v[176:179], a[40:43], v[40:43]
    ds_read_b64_tr_b16 v[196:197], v147 offset:24576
    v_mfma_f32_16x16x32_bf16 v[36:39], v[176:179], a[36:39], v[36:39]
    ds_read_b64_tr_b16 v[198:199], v147 offset:28672
    v_mfma_f32_16x16x32_bf16 v[36:39], v[180:183], a[52:55], v[36:39]
    v_mfma_f32_16x16x32_bf16 v[32:35], v[180:183], a[48:51], v[32:35]
    ds_read_b64_tr_b16 v[168:169], v148 offset:16384
    v_mfma_f32_16x16x32_bf16 v[32:35], v[176:179], a[32:35], v[32:35]
    s_waitcnt lgkmcnt(5)
    v_mfma_f32_16x16x32_bf16 v[48:51], v[184:187], a[32:35], v[48:51]
    ds_read_b64_tr_b16 v[170:171], v148 offset:20480
    v_mfma_f32_16x16x32_bf16 v[48:51], v[188:191], a[48:51], v[48:51]
    buffer_load_dwordx4 a[104:107], v166, s[16:19], s29 offen offset:2048
    v_mfma_f32_16x16x32_bf16 v[52:55], v[188:191], a[52:55], v[52:55]
    ds_read_b64_tr_b16 v[172:173], v148 offset:24576
    v_mfma_f32_16x16x32_bf16 v[52:55], v[184:187], a[36:39], v[52:55]
    v_mfma_f32_16x16x32_bf16 v[56:59], v[184:187], a[40:43], v[56:59]
    s_add_u32 m0, s27, 51200
    ds_read_b64_tr_b16 v[174:175], v148 offset:28672
    v_mfma_f32_16x16x32_bf16 v[56:59], v[188:191], a[56:59], v[56:59]
    buffer_load_dwordx4 v162, s[12:15], s28 offen lds
    v_mfma_f32_16x16x32_bf16 v[60:63], v[188:191], a[60:63], v[60:63]
    ds_read_b64_tr_b16 v[176:177], v149 offset:16384
    v_mfma_f32_16x16x32_bf16 v[60:63], v[184:187], a[44:47], v[60:63]
    s_waitcnt lgkmcnt(5)
    v_mfma_f32_16x16x32_bf16 v[76:79], v[192:195], a[44:47], v[76:79]
    ds_read_b64_tr_b16 v[178:179], v149 offset:20480
    v_mfma_f32_16x16x32_bf16 v[76:79], v[196:199], a[60:63], v[76:79]
    buffer_load_dwordx4 a[108:111], v167, s[16:19], s29 offen offset:2048
    v_mfma_f32_16x16x32_bf16 v[72:75], v[196:199], a[56:59], v[72:75]
    v_mfma_f32_16x16x32_bf16 v[72:75], v[192:195], a[40:43], v[72:75]
    ds_read_b64_tr_b16 v[180:181], v149 offset:24576
    v_mfma_f32_16x16x32_bf16 v[68:71], v[192:195], a[36:39], v[68:71]
    ds_read_b64_tr_b16 v[182:183], v149 offset:28672
    v_mfma_f32_16x16x32_bf16 v[68:71], v[196:199], a[52:55], v[68:71]
    v_mfma_f32_16x16x32_bf16 v[64:67], v[196:199], a[48:51], v[64:67]
    ds_read_b64_tr_b16 v[184:185], v150 offset:16384
    v_mfma_f32_16x16x32_bf16 v[64:67], v[192:195], a[32:35], v[64:67]
    s_waitcnt lgkmcnt(5)
    ds_read_b64_tr_b16 v[186:187], v150 offset:20480
    v_mfma_f32_16x16x32_bf16 v[80:83], v[168:171], a[32:35], v[80:83]
    v_mfma_f32_16x16x32_bf16 v[80:83], v[172:175], a[48:51], v[80:83]
    buffer_load_dwordx4 a[112:115], v164, s[16:19], s29 offen offset:3072
    v_mfma_f32_16x16x32_bf16 v[84:87], v[172:175], a[52:55], v[84:87]
    ds_read_b64_tr_b16 v[188:189], v150 offset:24576
    v_mfma_f32_16x16x32_bf16 v[84:87], v[168:171], a[36:39], v[84:87]
    v_mfma_f32_16x16x32_bf16 v[88:91], v[168:171], a[40:43], v[88:91]
    s_add_u32 m0, s27, 52224
    ds_read_b64_tr_b16 v[190:191], v150 offset:28672
    v_mfma_f32_16x16x32_bf16 v[88:91], v[172:175], a[56:59], v[88:91]
    buffer_load_dwordx4 v163, s[12:15], s28 offen lds
    v_mfma_f32_16x16x32_bf16 v[92:95], v[172:175], a[60:63], v[92:95]
    ds_read_b64_tr_b16 v[192:193], v151 offset:16384
    v_mfma_f32_16x16x32_bf16 v[92:95], v[168:171], a[44:47], v[92:95]
    s_waitcnt lgkmcnt(5)
    v_mfma_f32_16x16x32_bf16 v[108:111], v[176:179], a[44:47], v[108:111]
    ds_read_b64_tr_b16 v[194:195], v151 offset:20480
    v_mfma_f32_16x16x32_bf16 v[108:111], v[180:183], a[60:63], v[108:111]
    buffer_load_dwordx4 a[116:119], v165, s[16:19], s29 offen offset:3072
    v_mfma_f32_16x16x32_bf16 v[104:107], v[180:183], a[56:59], v[104:107]
    ds_read_b64_tr_b16 v[196:197], v151 offset:24576
    v_mfma_f32_16x16x32_bf16 v[104:107], v[176:179], a[40:43], v[104:107]
    v_mfma_f32_16x16x32_bf16 v[100:103], v[176:179], a[36:39], v[100:103]
    ds_read_b64_tr_b16 v[198:199], v151 offset:28672
    v_mfma_f32_16x16x32_bf16 v[100:103], v[180:183], a[52:55], v[100:103]
    s_waitcnt vmcnt(13)
    v_mfma_f32_16x16x32_bf16 v[96:99], v[180:183], a[48:51], v[96:99]
    s_barrier
    v_mfma_f32_16x16x32_bf16 v[96:99], v[176:179], a[32:35], v[96:99]
    s_waitcnt lgkmcnt(4)
    ds_read_b64_tr_b16 v[168:169], v144 offset:32768
    v_mfma_f32_16x16x32_bf16 v[112:115], v[184:187], a[32:35], v[112:115]
    ds_read_b64_tr_b16 v[170:171], v144 offset:36864
    v_mfma_f32_16x16x32_bf16 v[112:115], v[188:191], a[48:51], v[112:115]
    buffer_load_dwordx4 a[120:123], v166, s[16:19], s29 offen offset:3072
    v_mfma_f32_16x16x32_bf16 v[116:119], v[188:191], a[52:55], v[116:119]
    v_mfma_f32_16x16x32_bf16 v[116:119], v[184:187], a[36:39], v[116:119]
    ds_read_b64_tr_b16 v[172:173], v144 offset:40960
    v_mfma_f32_16x16x32_bf16 v[120:123], v[184:187], a[40:43], v[120:123]
    v_mfma_f32_16x16x32_bf16 v[120:123], v[188:191], a[56:59], v[120:123]
    ds_read_b64_tr_b16 v[174:175], v144 offset:45056
    v_mfma_f32_16x16x32_bf16 v[124:127], v[188:191], a[60:63], v[124:127]
    v_mfma_f32_16x16x32_bf16 v[124:127], v[184:187], a[44:47], v[124:127]
    s_waitcnt lgkmcnt(4)
    ds_read_b64_tr_b16 v[176:177], v145 offset:32768
    v_mfma_f32_16x16x32_bf16 v[140:143], v[192:195], a[44:47], v[140:143]
    v_mfma_f32_16x16x32_bf16 v[140:143], v[196:199], a[60:63], v[140:143]
    buffer_load_dwordx4 a[124:127], v167, s[16:19], s29 offen offset:3072
    v_mfma_f32_16x16x32_bf16 v[136:139], v[196:199], a[56:59], v[136:139]
    ds_read_b64_tr_b16 v[178:179], v145 offset:36864
    v_mfma_f32_16x16x32_bf16 v[136:139], v[192:195], a[40:43], v[136:139]
    v_mfma_f32_16x16x32_bf16 v[132:135], v[192:195], a[36:39], v[132:135]
    ds_read_b64_tr_b16 v[180:181], v145 offset:40960
    v_mfma_f32_16x16x32_bf16 v[132:135], v[196:199], a[52:55], v[132:135]
    v_mfma_f32_16x16x32_bf16 v[128:131], v[196:199], a[48:51], v[128:131]
    s_waitcnt vmcnt(11)
    ds_read_b64_tr_b16 v[182:183], v145 offset:45056
    v_mfma_f32_16x16x32_bf16 v[128:131], v[192:195], a[32:35], v[128:131]
    s_waitcnt lgkmcnt(4)
    v_mfma_f32_16x16x32_bf16 v[16:19], v[168:171], a[64:67], v[16:19]
    ds_read_b64_tr_b16 v[184:185], v146 offset:32768
    v_mfma_f32_16x16x32_bf16 v[16:19], v[172:175], a[80:83], v[16:19]
    v_mfma_f32_16x16x32_bf16 v[20:23], v[172:175], a[84:87], v[20:23]
    ds_read_b64_tr_b16 v[186:187], v146 offset:36864
    v_mfma_f32_16x16x32_bf16 v[20:23], v[168:171], a[68:71], v[20:23]
    v_mfma_f32_16x16x32_bf16 v[24:27], v[168:171], a[72:75], v[24:27]
    ds_read_b64_tr_b16 v[188:189], v146 offset:40960
    v_mfma_f32_16x16x32_bf16 v[24:27], v[172:175], a[88:91], v[24:27]
    ds_read_b64_tr_b16 v[190:191], v146 offset:45056
    v_mfma_f32_16x16x32_bf16 v[28:31], v[172:175], a[92:95], v[28:31]
    v_mfma_f32_16x16x32_bf16 v[28:31], v[168:171], a[76:79], v[28:31]
    s_waitcnt lgkmcnt(4)
    ds_read_b64_tr_b16 v[192:193], v147 offset:32768
    v_mfma_f32_16x16x32_bf16 v[44:47], v[176:179], a[76:79], v[44:47]
    v_mfma_f32_16x16x32_bf16 v[44:47], v[180:183], a[92:95], v[44:47]
    ds_read_b64_tr_b16 v[194:195], v147 offset:36864
    v_mfma_f32_16x16x32_bf16 v[40:43], v[180:183], a[88:91], v[40:43]
    v_mfma_f32_16x16x32_bf16 v[40:43], v[176:179], a[72:75], v[40:43]
    ds_read_b64_tr_b16 v[196:197], v147 offset:40960
    v_mfma_f32_16x16x32_bf16 v[36:39], v[176:179], a[68:71], v[36:39]
    v_mfma_f32_16x16x32_bf16 v[36:39], v[180:183], a[84:87], v[36:39]
    ds_read_b64_tr_b16 v[198:199], v147 offset:45056
    v_mfma_f32_16x16x32_bf16 v[32:35], v[180:183], a[80:83], v[32:35]
    v_mfma_f32_16x16x32_bf16 v[32:35], v[176:179], a[64:67], v[32:35]
    s_waitcnt lgkmcnt(4)
    ds_read_b64_tr_b16 v[168:169], v148 offset:32768
    v_mfma_f32_16x16x32_bf16 v[48:51], v[184:187], a[64:67], v[48:51]
    v_mfma_f32_16x16x32_bf16 v[48:51], v[188:191], a[80:83], v[48:51]
    ds_read_b64_tr_b16 v[170:171], v148 offset:36864
    v_mfma_f32_16x16x32_bf16 v[52:55], v[188:191], a[84:87], v[52:55]
    v_mfma_f32_16x16x32_bf16 v[52:55], v[184:187], a[68:71], v[52:55]
    ds_read_b64_tr_b16 v[172:173], v148 offset:40960
    v_mfma_f32_16x16x32_bf16 v[56:59], v[184:187], a[72:75], v[56:59]
    v_mfma_f32_16x16x32_bf16 v[56:59], v[188:191], a[88:91], v[56:59]
    ds_read_b64_tr_b16 v[174:175], v148 offset:45056
    v_mfma_f32_16x16x32_bf16 v[60:63], v[188:191], a[92:95], v[60:63]
    v_mfma_f32_16x16x32_bf16 v[60:63], v[184:187], a[76:79], v[60:63]
    s_waitcnt lgkmcnt(4)
    ds_read_b64_tr_b16 v[176:177], v149 offset:32768
    v_mfma_f32_16x16x32_bf16 v[76:79], v[192:195], a[76:79], v[76:79]
    v_mfma_f32_16x16x32_bf16 v[76:79], v[196:199], a[92:95], v[76:79]
    ds_read_b64_tr_b16 v[178:179], v149 offset:36864
    v_mfma_f32_16x16x32_bf16 v[72:75], v[196:199], a[88:91], v[72:75]
    ds_read_b64_tr_b16 v[180:181], v149 offset:40960
    v_mfma_f32_16x16x32_bf16 v[72:75], v[192:195], a[72:75], v[72:75]
    v_mfma_f32_16x16x32_bf16 v[68:71], v[192:195], a[68:71], v[68:71]
    ds_read_b64_tr_b16 v[182:183], v149 offset:45056
    v_mfma_f32_16x16x32_bf16 v[68:71], v[196:199], a[84:87], v[68:71]
    v_mfma_f32_16x16x32_bf16 v[64:67], v[196:199], a[80:83], v[64:67]
    ds_read_b64_tr_b16 v[184:185], v150 offset:32768
    v_mfma_f32_16x16x32_bf16 v[64:67], v[192:195], a[64:67], v[64:67]
    s_waitcnt lgkmcnt(5)
    v_mfma_f32_16x16x32_bf16 v[80:83], v[168:171], a[64:67], v[80:83]
    ds_read_b64_tr_b16 v[186:187], v150 offset:36864
    v_mfma_f32_16x16x32_bf16 v[80:83], v[172:175], a[80:83], v[80:83]
    v_mfma_f32_16x16x32_bf16 v[84:87], v[172:175], a[84:87], v[84:87]
    ds_read_b64_tr_b16 v[188:189], v150 offset:40960
    v_mfma_f32_16x16x32_bf16 v[84:87], v[168:171], a[68:71], v[84:87]
    v_mfma_f32_16x16x32_bf16 v[88:91], v[168:171], a[72:75], v[88:91]
    ds_read_b64_tr_b16 v[190:191], v150 offset:45056
    v_mfma_f32_16x16x32_bf16 v[88:91], v[172:175], a[88:91], v[88:91]
    v_mfma_f32_16x16x32_bf16 v[92:95], v[172:175], a[92:95], v[92:95]
    ds_read_b64_tr_b16 v[192:193], v151 offset:32768
    v_mfma_f32_16x16x32_bf16 v[92:95], v[168:171], a[76:79], v[92:95]
    s_waitcnt lgkmcnt(5)
    v_mfma_f32_16x16x32_bf16 v[108:111], v[176:179], a[76:79], v[108:111]
    ds_read_b64_tr_b16 v[194:195], v151 offset:36864
    v_mfma_f32_16x16x32_bf16 v[108:111], v[180:183], a[92:95], v[108:111]
    v_mfma_f32_16x16x32_bf16 v[104:107], v[180:183], a[88:91], v[104:107]
    ds_read_b64_tr_b16 v[196:197], v151 offset:40960
    v_mfma_f32_16x16x32_bf16 v[104:107], v[176:179], a[72:75], v[104:107]
    v_mfma_f32_16x16x32_bf16 v[100:103], v[176:179], a[68:71], v[100:103]
    ds_read_b64_tr_b16 v[198:199], v151 offset:45056
    v_mfma_f32_16x16x32_bf16 v[100:103], v[180:183], a[84:87], v[100:103]
    s_waitcnt vmcnt(3)
    v_mfma_f32_16x16x32_bf16 v[96:99], v[180:183], a[80:83], v[96:99]
    s_barrier
    v_mfma_f32_16x16x32_bf16 v[96:99], v[176:179], a[64:67], v[96:99]
    s_waitcnt lgkmcnt(4)
    ds_read_b64_tr_b16 v[168:169], v144 offset:49152
    v_mfma_f32_16x16x32_bf16 v[112:115], v[184:187], a[64:67], v[112:115]
    v_mfma_f32_16x16x32_bf16 v[112:115], v[188:191], a[80:83], v[112:115]
    ds_read_b64_tr_b16 v[170:171], v144 offset:53248
    v_mfma_f32_16x16x32_bf16 v[116:119], v[188:191], a[84:87], v[116:119]
    v_mfma_f32_16x16x32_bf16 v[116:119], v[184:187], a[68:71], v[116:119]
    ds_read_b64_tr_b16 v[172:173], v144 offset:57344
    v_mfma_f32_16x16x32_bf16 v[120:123], v[184:187], a[72:75], v[120:123]
    v_mfma_f32_16x16x32_bf16 v[120:123], v[188:191], a[88:91], v[120:123]
    ds_read_b64_tr_b16 v[174:175], v144 offset:61440
    v_mfma_f32_16x16x32_bf16 v[124:127], v[188:191], a[92:95], v[124:127]
    v_mfma_f32_16x16x32_bf16 v[124:127], v[184:187], a[76:79], v[124:127]
    s_waitcnt lgkmcnt(4)
    ds_read_b64_tr_b16 v[176:177], v145 offset:49152
    v_mfma_f32_16x16x32_bf16 v[140:143], v[192:195], a[76:79], v[140:143]
    v_mfma_f32_16x16x32_bf16 v[140:143], v[196:199], a[92:95], v[140:143]
    ds_read_b64_tr_b16 v[178:179], v145 offset:53248
    v_mfma_f32_16x16x32_bf16 v[136:139], v[196:199], a[88:91], v[136:139]
    v_mfma_f32_16x16x32_bf16 v[136:139], v[192:195], a[72:75], v[136:139]
    ds_read_b64_tr_b16 v[180:181], v145 offset:57344
    v_mfma_f32_16x16x32_bf16 v[132:135], v[192:195], a[68:71], v[132:135]
    v_mfma_f32_16x16x32_bf16 v[132:135], v[196:199], a[84:87], v[132:135]
    ds_read_b64_tr_b16 v[182:183], v145 offset:61440
    v_mfma_f32_16x16x32_bf16 v[128:131], v[196:199], a[80:83], v[128:131]
    s_waitcnt vmcnt(0)
    v_mfma_f32_16x16x32_bf16 v[128:131], v[192:195], a[64:67], v[128:131]
    s_waitcnt lgkmcnt(4)
    ds_read_b64_tr_b16 v[184:185], v146 offset:49152
    v_mfma_f32_16x16x32_bf16 v[16:19], v[168:171], a[96:99], v[16:19]
    v_mfma_f32_16x16x32_bf16 v[16:19], v[172:175], a[112:115], v[16:19]
    ds_read_b64_tr_b16 v[186:187], v146 offset:53248
    v_mfma_f32_16x16x32_bf16 v[20:23], v[172:175], a[116:119], v[20:23]
    v_mfma_f32_16x16x32_bf16 v[20:23], v[168:171], a[100:103], v[20:23]
    ds_read_b64_tr_b16 v[188:189], v146 offset:57344
    v_mfma_f32_16x16x32_bf16 v[24:27], v[168:171], a[104:107], v[24:27]
    v_mfma_f32_16x16x32_bf16 v[24:27], v[172:175], a[120:123], v[24:27]
    ds_read_b64_tr_b16 v[190:191], v146 offset:61440
    v_mfma_f32_16x16x32_bf16 v[28:31], v[172:175], a[124:127], v[28:31]
    v_mfma_f32_16x16x32_bf16 v[28:31], v[168:171], a[108:111], v[28:31]
    s_waitcnt lgkmcnt(4)
    ds_read_b64_tr_b16 v[192:193], v147 offset:49152
    v_mfma_f32_16x16x32_bf16 v[44:47], v[176:179], a[108:111], v[44:47]
    v_mfma_f32_16x16x32_bf16 v[44:47], v[180:183], a[124:127], v[44:47]
    ds_read_b64_tr_b16 v[194:195], v147 offset:53248
    v_mfma_f32_16x16x32_bf16 v[40:43], v[180:183], a[120:123], v[40:43]
    v_mfma_f32_16x16x32_bf16 v[40:43], v[176:179], a[104:107], v[40:43]
    ds_read_b64_tr_b16 v[196:197], v147 offset:57344
    v_mfma_f32_16x16x32_bf16 v[36:39], v[176:179], a[100:103], v[36:39]
    v_mfma_f32_16x16x32_bf16 v[36:39], v[180:183], a[116:119], v[36:39]
    ds_read_b64_tr_b16 v[198:199], v147 offset:61440
    v_mfma_f32_16x16x32_bf16 v[32:35], v[180:183], a[112:115], v[32:35]
    v_mfma_f32_16x16x32_bf16 v[32:35], v[176:179], a[96:99], v[32:35]
    s_waitcnt lgkmcnt(4)
    ds_read_b64_tr_b16 v[168:169], v148 offset:49152
    v_mfma_f32_16x16x32_bf16 v[48:51], v[184:187], a[96:99], v[48:51]
    v_mfma_f32_16x16x32_bf16 v[48:51], v[188:191], a[112:115], v[48:51]
    ds_read_b64_tr_b16 v[170:171], v148 offset:53248
    v_mfma_f32_16x16x32_bf16 v[52:55], v[188:191], a[116:119], v[52:55]
    v_mfma_f32_16x16x32_bf16 v[52:55], v[184:187], a[100:103], v[52:55]
    ds_read_b64_tr_b16 v[172:173], v148 offset:57344
    v_mfma_f32_16x16x32_bf16 v[56:59], v[184:187], a[104:107], v[56:59]
    v_mfma_f32_16x16x32_bf16 v[56:59], v[188:191], a[120:123], v[56:59]
    ds_read_b64_tr_b16 v[174:175], v148 offset:61440
    v_mfma_f32_16x16x32_bf16 v[60:63], v[188:191], a[124:127], v[60:63]
    v_mfma_f32_16x16x32_bf16 v[60:63], v[184:187], a[108:111], v[60:63]
    s_waitcnt lgkmcnt(4)
    ds_read_b64_tr_b16 v[176:177], v149 offset:49152
    v_mfma_f32_16x16x32_bf16 v[76:79], v[192:195], a[108:111], v[76:79]
    v_mfma_f32_16x16x32_bf16 v[76:79], v[196:199], a[124:127], v[76:79]
    ds_read_b64_tr_b16 v[178:179], v149 offset:53248
    v_mfma_f32_16x16x32_bf16 v[72:75], v[196:199], a[120:123], v[72:75]
    v_mfma_f32_16x16x32_bf16 v[72:75], v[192:195], a[104:107], v[72:75]
    ds_read_b64_tr_b16 v[180:181], v149 offset:57344
    v_mfma_f32_16x16x32_bf16 v[68:71], v[192:195], a[100:103], v[68:71]
    v_mfma_f32_16x16x32_bf16 v[68:71], v[196:199], a[116:119], v[68:71]
    ds_read_b64_tr_b16 v[182:183], v149 offset:61440
    v_mfma_f32_16x16x32_bf16 v[64:67], v[196:199], a[112:115], v[64:67]
    v_mfma_f32_16x16x32_bf16 v[64:67], v[192:195], a[96:99], v[64:67]
    s_waitcnt lgkmcnt(4)
    ds_read_b64_tr_b16 v[184:185], v150 offset:49152
    v_mfma_f32_16x16x32_bf16 v[80:83], v[168:171], a[96:99], v[80:83]
    v_mfma_f32_16x16x32_bf16 v[80:83], v[172:175], a[112:115], v[80:83]
    ds_read_b64_tr_b16 v[186:187], v150 offset:53248
    v_mfma_f32_16x16x32_bf16 v[84:87], v[172:175], a[116:119], v[84:87]
    v_mfma_f32_16x16x32_bf16 v[84:87], v[168:171], a[100:103], v[84:87]
    ds_read_b64_tr_b16 v[188:189], v150 offset:57344
    v_mfma_f32_16x16x32_bf16 v[88:91], v[168:171], a[104:107], v[88:91]
    v_mfma_f32_16x16x32_bf16 v[88:91], v[172:175], a[120:123], v[88:91]
    ds_read_b64_tr_b16 v[190:191], v150 offset:61440
    v_mfma_f32_16x16x32_bf16 v[92:95], v[172:175], a[124:127], v[92:95]
    v_mfma_f32_16x16x32_bf16 v[92:95], v[168:171], a[108:111], v[92:95]
    s_waitcnt lgkmcnt(4)
    ds_read_b64_tr_b16 v[192:193], v151 offset:49152
    v_mfma_f32_16x16x32_bf16 v[108:111], v[176:179], a[108:111], v[108:111]
    v_mfma_f32_16x16x32_bf16 v[108:111], v[180:183], a[124:127], v[108:111]
    ds_read_b64_tr_b16 v[194:195], v151 offset:53248
    v_mfma_f32_16x16x32_bf16 v[104:107], v[180:183], a[120:123], v[104:107]
    v_mfma_f32_16x16x32_bf16 v[104:107], v[176:179], a[104:107], v[104:107]
    ds_read_b64_tr_b16 v[196:197], v151 offset:57344
    v_mfma_f32_16x16x32_bf16 v[100:103], v[176:179], a[100:103], v[100:103]
    v_mfma_f32_16x16x32_bf16 v[100:103], v[180:183], a[116:119], v[100:103]
    ds_read_b64_tr_b16 v[198:199], v151 offset:61440
    v_mfma_f32_16x16x32_bf16 v[96:99], v[180:183], a[112:115], v[96:99]
    v_mfma_f32_16x16x32_bf16 v[96:99], v[176:179], a[96:99], v[96:99]
    s_waitcnt lgkmcnt(4)
    v_mfma_f32_16x16x32_bf16 v[112:115], v[184:187], a[96:99], v[112:115]
    v_mfma_f32_16x16x32_bf16 v[112:115], v[188:191], a[112:115], v[112:115]
    v_mfma_f32_16x16x32_bf16 v[116:119], v[188:191], a[116:119], v[116:119]
    v_mfma_f32_16x16x32_bf16 v[116:119], v[184:187], a[100:103], v[116:119]
    v_mfma_f32_16x16x32_bf16 v[120:123], v[184:187], a[104:107], v[120:123]
    v_mfma_f32_16x16x32_bf16 v[120:123], v[188:191], a[120:123], v[120:123]
    v_mfma_f32_16x16x32_bf16 v[124:127], v[188:191], a[124:127], v[124:127]
    v_mfma_f32_16x16x32_bf16 v[124:127], v[184:187], a[108:111], v[124:127]
    s_waitcnt lgkmcnt(0)
    v_mfma_f32_16x16x32_bf16 v[140:143], v[192:195], a[108:111], v[140:143]
    v_mfma_f32_16x16x32_bf16 v[140:143], v[196:199], a[124:127], v[140:143]
    v_mfma_f32_16x16x32_bf16 v[136:139], v[196:199], a[120:123], v[136:139]
    v_mfma_f32_16x16x32_bf16 v[136:139], v[192:195], a[104:107], v[136:139]
    v_mfma_f32_16x16x32_bf16 v[132:135], v[192:195], a[100:103], v[132:135]
    v_mfma_f32_16x16x32_bf16 v[132:135], v[196:199], a[116:119], v[132:135]
    v_mfma_f32_16x16x32_bf16 v[128:131], v[196:199], a[112:115], v[128:131]
    v_mfma_f32_16x16x32_bf16 v[128:131], v[192:195], a[96:99], v[128:131]
    s_barrier
    v_lshlrev_b32 v10, 3, v1
    s_cmp_eq_u32 s3, 0
    s_cselect_b32 s35, s63, 0x4000
    buffer_load_dwordx2 v[8:9], v10, s[96:99], s35 offen sc1
    s_lshl_b32 s24, s24, 15
    s_lshl_b32 s25, s5, 12
    s_add_u32 s24, s24, s25
    s_lshl_b32 s25, s33, 22
    s_add_u32 s24, s24, s25
    v_cvt_pk_bf16_f32 v168, v16, v17
    v_cvt_pk_bf16_f32 v169, v18, v19
    v_cvt_pk_bf16_f32 v170, v32, v33
    v_cvt_pk_bf16_f32 v171, v34, v35
    buffer_store_dwordx4 v[168:171], v15, s[20:23], s24 offen offset:0 sc1
    v_cvt_pk_bf16_f32 v172, v48, v49
    v_cvt_pk_bf16_f32 v173, v50, v51
    v_cvt_pk_bf16_f32 v174, v64, v65
    v_cvt_pk_bf16_f32 v175, v66, v67
    buffer_store_dwordx4 v[172:175], v15, s[20:23], s24 offen offset:1024 sc1
    v_cvt_pk_bf16_f32 v176, v80, v81
    v_cvt_pk_bf16_f32 v177, v82, v83
    v_cvt_pk_bf16_f32 v178, v96, v97
    v_cvt_pk_bf16_f32 v179, v98, v99
    buffer_store_dwordx4 v[176:179], v15, s[20:23], s24 offen offset:2048 sc1
    v_cvt_pk_bf16_f32 v180, v112, v113
    v_cvt_pk_bf16_f32 v181, v114, v115
    v_cvt_pk_bf16_f32 v182, v128, v129
    v_cvt_pk_bf16_f32 v183, v130, v131
    buffer_store_dwordx4 v[180:183], v15, s[20:23], s24 offen offset:3072 sc1
    s_add_u32 s24, s24, 0x8000
    v_cvt_pk_bf16_f32 v184, v20, v21
    v_cvt_pk_bf16_f32 v185, v22, v23
    v_cvt_pk_bf16_f32 v186, v36, v37
    v_cvt_pk_bf16_f32 v187, v38, v39
    buffer_store_dwordx4 v[184:187], v15, s[20:23], s24 offen offset:0 sc1
    v_cvt_pk_bf16_f32 v188, v52, v53
    v_cvt_pk_bf16_f32 v189, v54, v55
    v_cvt_pk_bf16_f32 v190, v68, v69
    v_cvt_pk_bf16_f32 v191, v70, v71
    buffer_store_dwordx4 v[188:191], v15, s[20:23], s24 offen offset:1024 sc1
    v_cvt_pk_bf16_f32 v192, v84, v85
    v_cvt_pk_bf16_f32 v193, v86, v87
    v_cvt_pk_bf16_f32 v194, v100, v101
    v_cvt_pk_bf16_f32 v195, v102, v103
    buffer_store_dwordx4 v[192:195], v15, s[20:23], s24 offen offset:2048 sc1
    v_cvt_pk_bf16_f32 v196, v116, v117
    v_cvt_pk_bf16_f32 v197, v118, v119
    v_cvt_pk_bf16_f32 v198, v132, v133
    v_cvt_pk_bf16_f32 v199, v134, v135
    buffer_store_dwordx4 v[196:199], v15, s[20:23], s24 offen offset:3072 sc1
    s_add_u32 s24, s24, 0x8000
    v_cvt_pk_bf16_f32 v200, v24, v25
    v_cvt_pk_bf16_f32 v201, v26, v27
    v_cvt_pk_bf16_f32 v202, v40, v41
    v_cvt_pk_bf16_f32 v203, v42, v43
    buffer_store_dwordx4 v[200:203], v15, s[20:23], s24 offen offset:0 sc1
    v_cvt_pk_bf16_f32 v204, v56, v57
    v_cvt_pk_bf16_f32 v205, v58, v59
    v_cvt_pk_bf16_f32 v206, v72, v73
    v_cvt_pk_bf16_f32 v207, v74, v75
    buffer_store_dwordx4 v[204:207], v15, s[20:23], s24 offen offset:1024 sc1
    v_cvt_pk_bf16_f32 v208, v88, v89
    v_cvt_pk_bf16_f32 v209, v90, v91
    v_cvt_pk_bf16_f32 v210, v104, v105
    v_cvt_pk_bf16_f32 v211, v106, v107
    buffer_store_dwordx4 v[208:211], v15, s[20:23], s24 offen offset:2048 sc1
    v_cvt_pk_bf16_f32 v212, v120, v121
    v_cvt_pk_bf16_f32 v213, v122, v123
    v_cvt_pk_bf16_f32 v214, v136, v137
    v_cvt_pk_bf16_f32 v215, v138, v139
    buffer_store_dwordx4 v[212:215], v15, s[20:23], s24 offen offset:3072 sc1
    s_add_u32 s24, s24, 0x8000
    v_cvt_pk_bf16_f32 v216, v28, v29
    v_cvt_pk_bf16_f32 v217, v30, v31
    v_cvt_pk_bf16_f32 v218, v44, v45
    v_cvt_pk_bf16_f32 v219, v46, v47
    buffer_store_dwordx4 v[216:219], v15, s[20:23], s24 offen offset:0 sc1
    v_cvt_pk_bf16_f32 v220, v60, v61
    v_cvt_pk_bf16_f32 v221, v62, v63
    v_cvt_pk_bf16_f32 v222, v76, v77
    v_cvt_pk_bf16_f32 v223, v78, v79
    buffer_store_dwordx4 v[220:223], v15, s[20:23], s24 offen offset:1024 sc1
    v_cvt_pk_bf16_f32 v224, v92, v93
    v_cvt_pk_bf16_f32 v225, v94, v95
    v_cvt_pk_bf16_f32 v226, v108, v109
    v_cvt_pk_bf16_f32 v227, v110, v111
    buffer_store_dwordx4 v[224:227], v15, s[20:23], s24 offen offset:2048 sc1
    v_cvt_pk_bf16_f32 v228, v124, v125
    v_cvt_pk_bf16_f32 v229, v126, v127
    v_cvt_pk_bf16_f32 v230, v140, v141
    v_cvt_pk_bf16_f32 v231, v142, v143
    buffer_store_dwordx4 v[228:231], v15, s[20:23], s24 offen offset:3072 sc1
    s_lshl_b32 s43, s4, 7
    s_lshl_b32 s25, s5, 4
    s_add_u32 s43, s43, s25
    s_lshl_b32 s25, s33, 3
    s_add_u32 s43, s43, s25
    s_add_u32 s43, s43, 1024
    s_add_u32 s45, s45, 0x2000
    s_add_u32 m0, s47, 0
    s_nop 0
    buffer_load_dwordx4 v12, s[52:55], s45 offen offset:0 lds
    s_add_u32 m0, s47, 0
    s_nop 0
    buffer_load_dwordx4 v12, s[52:55], s45 offen offset:1024 lds
    s_add_u32 s45, s45, 0x2000
    s_add_u32 m0, s47, 2048
    s_nop 0
    buffer_load_dwordx4 v12, s[52:55], s45 offen offset:0 lds
    s_add_u32 m0, s47, 2048
    s_nop 0
    buffer_load_dwordx4 v12, s[52:55], s45 offen offset:1024 lds
    s_add_u32 s45, s45, 0x2000
    s_add_u32 m0, s47, 4096
    s_nop 0
    buffer_load_dwordx4 v12, s[52:55], s45 offen offset:0 lds
    s_add_u32 m0, s47, 4096
    s_nop 0
    buffer_load_dwordx4 v12, s[52:55], s45 offen offset:1024 lds
    s_add_u32 s45, s45, 0x2000
    s_add_u32 m0, s47, 6144
    s_nop 0
    buffer_load_dwordx4 v12, s[52:55], s45 offen offset:0 lds
    s_add_u32 m0, s47, 6144
    s_nop 0
    buffer_load_dwordx4 v12, s[52:55], s45 offen offset:1024 lds
    s_add_u32 s45, s45, 0x2000
    s_add_u32 m0, s47, 8192
    s_nop 0
    buffer_load_dwordx4 v12, s[52:55], s45 offen offset:0 lds
    s_add_u32 m0, s47, 8192
    s_nop 0
    buffer_load_dwordx4 v12, s[52:55], s45 offen offset:1024 lds
    s_add_u32 s45, s45, 0x2000
    s_add_u32 m0, s47, 10240
    s_nop 0
    buffer_load_dwordx4 v12, s[52:55], s45 offen offset:0 lds
    s_add_u32 m0, s47, 10240
    s_nop 0
    buffer_load_dwordx4 v12, s[52:55], s45 offen offset:1024 lds
    s_add_u32 s45, s45, 0x2000
    s_add_u32 m0, s47, 12288
    s_nop 0
    buffer_load_dwordx4 v12, s[52:55], s45 offen offset:0 lds
    s_add_u32 m0, s47, 12288
    s_nop 0
    buffer_load_dwordx4 v12, s[52:55], s45 offen offset:1024 lds
    s_add_u32 s45, s45, 0x2000
    s_add_u32 m0, s47, 14336
    s_nop 0
    buffer_load_dwordx4 v12, s[52:55], s45 offen offset:0 lds
    s_add_u32 m0, s47, 14336
    s_nop 0
    buffer_load_dwordx4 v12, s[52:55], s45 offen offset:1024 lds
    s_waitcnt vmcnt(16)
    s_barrier
    s_cmp_lg_u32 s3, 0
    s_cbranch_scc1 f_s_nopub
    v_mov_b32 v6, s50
    v_mov_b32 v7, s51
    s_mov_b64 exec, 1
    buffer_store_dwordx2 v[6:7], off, s[96:99], s43 sc1
    s_mov_b64 exec, -1
f_s_nopub:
    s_cmp_lg_u32 s3, 0
    s_cbranch_scc1 f_y_rdy1
    v_lshlrev_b32 v10, 3, v1
    s_mov_b64 exec, 0xffff
    v_cmp_ne_u64 vcc, s[50:51], v[8:9]
    s_nop 1
    s_cmp_eq_u64 vcc, 0
    s_cbranch_scc1 f_y_got1
f_y_spin1:
    buffer_load_dwordx2 v[8:9], v10, s[96:99], s63 offen sc1
    s_waitcnt vmcnt(0)
    v_cmp_ne_u64 vcc, s[50:51], v[8:9]
    s_nop 1
    s_cmp_lg_u64 vcc, 0
    s_cbranch_scc1 f_y_spin1
f_y_got1:
    s_mov_b64 exec, -1
f_y_rdy1:
    s_barrier
    s_mov_b32 s37, 4294966272
    s_add_u32 s37, s37, 1024
    buffer_load_dwordx4 a[0:3], v2, s[88:91], s37 offen
    buffer_load_dwordx4 a[4:7], v3, s[88:91], s37 offen
    s_add_u32 s37, s37, 1024
    buffer_load_dwordx4 a[8:11], v2, s[88:91], s37 offen
    buffer_load_dwordx4 a[12:15], v3, s[88:91], s37 offen
    s_add_u32 s37, s37, 1024
    buffer_load_dwordx4 a[16:19], v2, s[88:91], s37 offen
    buffer_load_dwordx4 a[20:23], v3, s[88:91], s37 offen
    s_add_u32 s37, s37, 1024
    buffer_load_dwordx4 a[24:27], v2, s[88:91], s37 offen sc1
    buffer_load_dwordx4 a[28:31], v3, s[88:91], s37 offen sc1
    s_add_u32 s37, s37, 1024
    buffer_load_dwordx4 a[32:35], v2, s[88:91], s37 offen
    buffer_load_dwordx4 a[36:39], v3, s[88:91], s37 offen
    s_add_u32 s37, s37, 1024
    buffer_load_dwordx4 a[40:43], v2, s[88:91], s37 offen
    buffer_load_dwordx4 a[44:47], v3, s[88:91], s37 offen
    s_add_u32 s37, s37, 1024
    buffer_load_dwordx4 a[48:51], v2, s[88:91], s37 offen
    buffer_load_dwordx4 a[52:55], v3, s[88:91], s37 offen
    s_add_u32 s37, s37, 1024
    buffer_load_dwordx4 a[56:59], v2, s[88:91], s37 offen
    buffer_load_dwordx4 a[60:63], v3, s[88:91], s37 offen
    s_add_u32 s37, s37, 1024
    buffer_load_dwordx4 a[64:67], v2, s[88:91], s37 offen
    buffer_load_dwordx4 a[68:71], v3, s[88:91], s37 offen
    s_add_u32 s37, s37, 1024
    buffer_load_dwordx4 a[72:75], v2, s[88:91], s37 offen
    buffer_load_dwordx4 a[76:79], v3, s[88:91], s37 offen
    s_add_u32 s37, s37, 1024
    buffer_load_dwordx4 a[80:83], v2, s[88:91], s37 offen sc1
    buffer_load_dwordx4 a[84:87], v3, s[88:91], s37 offen sc1
    v_lshrrev_b32 v8, 2, v1
    v_bfe_u32 v9, v8, 1, 2
    v_lshlrev_b32 v9, 1, v9
    v_bfe_u32 v10, v1, 1, 1
    v_xor_b32 v9, v9, v10
    v_lshlrev_b32 v8, 7, v8
    v_and_b32 v10, 1, v1
    v_lshl_add_u32 v8, v10, 3, v8
    v_xor_b32 v10, 0, v9
    v_lshl_add_u32 v48, v10, 4, v8
    v_add_u32 v52, 0x10000, v48
    v_add_u32 v56, 0x20000, v48
    v_xor_b32 v10, 2, v9
    v_lshl_add_u32 v49, v10, 4, v8
    v_add_u32 v53, 0x10000, v49
    v_add_u32 v57, 0x20000, v49
    v_xor_b32 v10, 4, v9
    v_lshl_add_u32 v50, v10, 4, v8
    v_add_u32 v54, 0x10000, v50
    v_add_u32 v58, 0x20000, v50
    v_xor_b32 v10, 6, v9
    v_lshl_add_u32 v51, v10, 4, v8
    v_add_u32 v55, 0x10000, v51
    v_add_u32 v59, 0x20000, v51
    ds_read_b64_tr_b16 v[60:61], v52 offset:0
    ds_read_b64_tr_b16 v[62:63], v52 offset:24576
    ds_read_b64_tr_b16 v[64:65], v52 offset:49152
    ds_read_b64_tr_b16 v[66:67], v56 offset:8192
    ds_read_b64_tr_b16 v[68:69], v53 offset:0
    ds_read_b64_tr_b16 v[70:71], v53 offset:24576
    ds_read_b64_tr_b16 v[72:73], v53 offset:49152
    ds_read_b64_tr_b16 v[74:75], v57 offset:8192
    ds_read_b64_tr_b16 v[76:77], v54 offset:0
    ds_read_b64_tr_b16 v[78:79], v54 offset:24576
    ds_read_b64_tr_b16 v[80:81], v54 offset:49152
    ds_read_b64_tr_b16 v[82:83], v58 offset:8192
    v_mov_b32 v16, 0
    v_mov_b32 v17, 0
    v_mov_b32 v18, 0
    v_mov_b32 v19, 0
    v_mov_b32 v20, 0
    v_mov_b32 v21, 0
    v_mov_b32 v22, 0
    v_mov_b32 v23, 0
    v_mov_b32 v24, 0
    v_mov_b32 v25, 0
    v_mov_b32 v26, 0
    v_mov_b32 v27, 0
    v_mov_b32 v28, 0
    v_mov_b32 v29, 0
    v_mov_b32 v30, 0
    v_mov_b32 v31, 0
    v_mov_b32 v32, 0
    v_mov_b32 v33, 0
    v_mov_b32 v34, 0
    v_mov_b32 v35, 0
    v_mov_b32 v36, 0
    v_mov_b32 v37, 0
    v_mov_b32 v38, 0
    v_mov_b32 v39, 0
    v_mov_b32 v40, 0
    v_mov_b32 v41, 0
    v_mov_b32 v42, 0
    v_mov_b32 v43, 0
    v_mov_b32 v44, 0
    v_mov_b32 v45, 0
    v_mov_b32 v46, 0
    v_mov_b32 v47, 0
    s_lshl_b32 s34, s60, 15
    s_lshl_b32 s35, s61, 11
    s_add_u32 s34, s34, s35
    v_and_b32 v9, 15, v1
    v_lshlrev_b32 v9, 11, v9
    v_lshrrev_b32 v10, 4, v1
    v_lshl_add_u32 v4, v10, 4, v9
    s_add_u32 s20, s8, 54525952
    s_addc_u32 s21, s9, 0
    s_mov_b32 s22, 8388608
    s_mov_b32 s23, 0x20000
    s_lshr_b32 s39, s61, 1
    s_lshl_b32 s39, s39, 4
    s_add_u32 s39, s39, s63
    s_add_u32 s39, s39, 1024
    s_cmp_eq_u32 s3, 0
    s_cselect_b32 s43, s43, 0x4000
    v_mov_b32 v8, s50
    v_mov_b32 v9, s51
    v_mov_b32 v10, 0x4000
    v_cmp_eq_u32 vcc, 0, v1
    s_nop 1
    v_cndmask_b32 v10, v10, 0, vcc
    v_and_b32 v11, 1, v1
    v_lshlrev_b32 v11, 3, v11
    s_waitcnt vmcnt(18)
    s_waitcnt lgkmcnt(8)
    v_mfma_f32_16x16x32_bf16 v[16:19], v[60:63], a[0:3], v[16:19]
    s_add_u32 s37, s37, 1024
    ds_read_b64_tr_b16 v[84:85], v55 offset:0
    v_mfma_f32_16x16x32_bf16 v[16:19], v[64:67], a[8:11], v[16:19]
    buffer_load_dwordx4 a[88:91], v2, s[88:91], s37 offen
    v_mfma_f32_16x16x32_bf16 v[20:23], v[64:67], a[12:15], v[20:23]
    ds_read_b64_tr_b16 v[86:87], v55 offset:24576
    v_mfma_f32_16x16x32_bf16 v[20:23], v[60:63], a[4:7], v[20:23]
    s_waitcnt lgkmcnt(6)
    ds_read_b64_tr_b16 v[88:89], v55 offset:49152
    v_mfma_f32_16x16x32_bf16 v[28:31], v[68:71], a[4:7], v[28:31]
    ds_read_b64_tr_b16 v[90:91], v59 offset:8192
    v_mfma_f32_16x16x32_bf16 v[28:31], v[72:75], a[12:15], v[28:31]
    buffer_load_dwordx4 a[92:95], v3, s[88:91], s37 offen
    v_mfma_f32_16x16x32_bf16 v[24:27], v[72:75], a[8:11], v[24:27]
    ds_read_b64_tr_b16 v[60:61], v52 offset:2048
    ds_read_b64_tr_b16 v[62:63], v52 offset:26624
    v_mfma_f32_16x16x32_bf16 v[24:27], v[68:71], a[0:3], v[24:27]
    s_waitcnt lgkmcnt(6)
    ds_read_b64_tr_b16 v[64:65], v52 offset:51200
    v_mfma_f32_16x16x32_bf16 v[32:35], v[76:79], a[0:3], v[32:35]
    s_add_u32 s37, s37, 1024
    ds_read_b64_tr_b16 v[66:67], v56 offset:10240
    v_mfma_f32_16x16x32_bf16 v[32:35], v[80:83], a[8:11], v[32:35]
    buffer_load_dwordx4 a[96:99], v2, s[88:91], s37 offen
    v_mfma_f32_16x16x32_bf16 v[36:39], v[80:83], a[12:15], v[36:39]
    ds_read_b64_tr_b16 v[68:69], v53 offset:2048
    ds_read_b64_tr_b16 v[70:71], v53 offset:26624
    v_mfma_f32_16x16x32_bf16 v[36:39], v[76:79], a[4:7], v[36:39]
    s_waitcnt lgkmcnt(6)
    ds_read_b64_tr_b16 v[72:73], v53 offset:51200
    v_mfma_f32_16x16x32_bf16 v[44:47], v[84:87], a[4:7], v[44:47]
    ds_read_b64_tr_b16 v[74:75], v57 offset:10240
    v_mfma_f32_16x16x32_bf16 v[44:47], v[88:91], a[12:15], v[44:47]
    buffer_load_dwordx4 a[100:103], v3, s[88:91], s37 offen
    v_mfma_f32_16x16x32_bf16 v[40:43], v[88:91], a[8:11], v[40:43]
    s_waitcnt vmcnt(18)
    ds_read_b64_tr_b16 v[76:77], v54 offset:2048
    ds_read_b64_tr_b16 v[78:79], v54 offset:26624
    v_mfma_f32_16x16x32_bf16 v[40:43], v[84:87], a[0:3], v[40:43]
    s_waitcnt lgkmcnt(6)
    ds_read_b64_tr_b16 v[80:81], v54 offset:51200
    v_mfma_f32_16x16x32_bf16 v[16:19], v[60:63], a[16:19], v[16:19]
    s_add_u32 s37, s37, 1024
    ds_read_b64_tr_b16 v[82:83], v58 offset:10240
    v_mfma_f32_16x16x32_bf16 v[16:19], v[64:67], a[24:27], v[16:19]
    buffer_load_dwordx4 a[0:3], v2, s[88:91], s37 offen
    v_mfma_f32_16x16x32_bf16 v[20:23], v[64:67], a[28:31], v[20:23]
    ds_read_b64_tr_b16 v[84:85], v55 offset:2048
    ds_read_b64_tr_b16 v[86:87], v55 offset:26624
    v_mfma_f32_16x16x32_bf16 v[20:23], v[60:63], a[20:23], v[20:23]
    s_waitcnt lgkmcnt(6)
    ds_read_b64_tr_b16 v[88:89], v55 offset:51200
    v_mfma_f32_16x16x32_bf16 v[28:31], v[68:71], a[20:23], v[28:31]
    ds_read_b64_tr_b16 v[90:91], v59 offset:10240
    v_mfma_f32_16x16x32_bf16 v[28:31], v[72:75], a[28:31], v[28:31]
    buffer_load_dwordx4 a[4:7], v3, s[88:91], s37 offen
    v_mfma_f32_16x16x32_bf16 v[24:27], v[72:75], a[24:27], v[24:27]
    ds_read_b64_tr_b16 v[60:61], v52 offset:4096
    ds_read_b64_tr_b16 v[62:63], v52 offset:28672
    v_mfma_f32_16x16x32_bf16 v[24:27], v[68:71], a[16:19], v[24:27]
    s_waitcnt lgkmcnt(6)
    ds_read_b64_tr_b16 v[64:65], v52 offset:53248
    v_mfma_f32_16x16x32_bf16 v[32:35], v[76:79], a[16:19], v[32:35]
    s_add_u32 s37, s37, 1024
    ds_read_b64_tr_b16 v[66:67], v56 offset:12288
    v_mfma_f32_16x16x32_bf16 v[32:35], v[80:83], a[24:27], v[32:35]
    buffer_load_dwordx4 a[8:11], v2, s[88:91], s37 offen
    v_mfma_f32_16x16x32_bf16 v[36:39], v[80:83], a[28:31], v[36:39]
    ds_read_b64_tr_b16 v[68:69], v53 offset:4096
    ds_read_b64_tr_b16 v[70:71], v53 offset:28672
    v_mfma_f32_16x16x32_bf16 v[36:39], v[76:79], a[20:23], v[36:39]
    s_waitcnt lgkmcnt(6)
    ds_read_b64_tr_b16 v[72:73], v53 offset:53248
    v_mfma_f32_16x16x32_bf16 v[44:47], v[84:87], a[20:23], v[44:47]
    ds_read_b64_tr_b16 v[74:75], v57 offset:12288
    v_mfma_f32_16x16x32_bf16 v[44:47], v[88:91], a[28:31], v[44:47]
    buffer_load_dwordx4 a[12:15], v3, s[88:91], s37 offen
    v_mfma_f32_16x16x32_bf16 v[40:43], v[88:91], a[24:27], v[40:43]
    s_waitcnt vmcnt(18)
    ds_read_b64_tr_b16 v[76:77], v54 offset:4096
    ds_read_b64_tr_b16 v[78:79], v54 offset:28672
    v_mfma_f32_16x16x32_bf16 v[40:43], v[84:87], a[16:19], v[40:43]
    s_waitcnt lgkmcnt(6)
    ds_read_b64_tr_b16 v[80:81], v54 offset:53248
    v_mfma_f32_16x16x32_bf16 v[16:19], v[60:63], a[32:35], v[16:19]
    s_add_u32 s37, s37, 1024
    ds_read_b64_tr_b16 v[82:83], v58 offset:12288
    v_mfma_f32_16x16x32_bf16 v[16:19], v[64:67], a[40:43], v[16:19]
    buffer_load_dwordx4 a[16:19], v2, s[88:91], s37 offen
    v_mfma_f32_16x16x32_bf16 v[20:23], v[64:67], a[44:47], v[20:23]
    ds_read_b64_tr_b16 v[84:85], v55 offset:4096
    ds_read_b64_tr_b16 v[86:87], v55 offset:28672
    v_mfma_f32_16x16x32_bf16 v[20:23], v[60:63], a[36:39], v[20:23]
    s_waitcnt lgkmcnt(6)
    ds_read_b64_tr_b16 v[88:89], v55 offset:53248
    v_mfma_f32_16x16x32_bf16 v[28:31], v[68:71], a[36:39], v[28:31]
    ds_read_b64_tr_b16 v[90:91], v59 offset:12288
    v_mfma_f32_16x16x32_bf16 v[28:31], v[72:75], a[44:47], v[28:31]
    buffer_load_dwordx4 a[20:23], v3, s[88:91], s37 offen
    v_mfma_f32_16x16x32_bf16 v[24:27], v[72:75], a[40:43], v[24:27]
    ds_read_b64_tr_b16 v[60:61], v52 offset:6144
    ds_read_b64_tr_b16 v[62:63], v52 offset:30720
    v_mfma_f32_16x16x32_bf16 v[24:27], v[68:71], a[32:35], v[24:27]
    s_waitcnt lgkmcnt(6)
    ds_read_b64_tr_b16 v[64:65], v52 offset:55296
    v_mfma_f32_16x16x32_bf16 v[32:35], v[76:79], a[32:35], v[32:35]
    s_add_u32 s37, s37, 1024
    ds_read_b64_tr_b16 v[66:67], v56 offset:14336
    v_mfma_f32_16x16x32_bf16 v[32:35], v[80:83], a[40:43], v[32:35]
    buffer_load_dwordx4 a[24:27], v2, s[88:91], s37 offen
    v_mfma_f32_16x16x32_bf16 v[36:39], v[80:83], a[44:47], v[36:39]
    ds_read_b64_tr_b16 v[68:69], v53 offset:6144
    ds_read_b64_tr_b16 v[70:71], v53 offset:30720
    v_mfma_f32_16x16x32_bf16 v[36:39], v[76:79], a[36:39], v[36:39]
    s_waitcnt lgkmcnt(6)
    ds_read_b64_tr_b16 v[72:73], v53 offset:55296
    v_mfma_f32_16x16x32_bf16 v[44:47], v[84:87], a[36:39], v[44:47]
    ds_read_b64_tr_b16 v[74:75], v57 offset:14336
    v_mfma_f32_16x16x32_bf16 v[44:47], v[88:91], a[44:47], v[44:47]
    buffer_load_dwordx4 a[28:31], v3, s[88:91], s37 offen
    v_mfma_f32_16x16x32_bf16 v[40:43], v[88:91], a[40:43], v[40:43]
    s_waitcnt vmcnt(18)
    ds_read_b64_tr_b16 v[76:77], v54 offset:6144
    ds_read_b64_tr_b16 v[78:79], v54 offset:30720
    v_mfma_f32_16x16x32_bf16 v[40:43], v[84:87], a[32:35], v[40:43]
    s_waitcnt lgkmcnt(6)
    ds_read_b64_tr_b16 v[80:81], v54 offset:55296
    v_mfma_f32_16x16x32_bf16 v[16:19], v[60:63], a[48:51], v[16:19]
    s_add_u32 s37, s37, 1024
    ds_read_b64_tr_b16 v[82:83], v58 offset:14336
    v_mfma_f32_16x16x32_bf16 v[16:19], v[64:67], a[56:59], v[16:19]
    buffer_load_dwordx4 a[32:35], v2, s[88:91], s37 offen sc1
    v_mfma_f32_16x16x32_bf16 v[20:23], v[64:67], a[60:63], v[20:23]
    ds_read_b64_tr_b16 v[84:85], v55 offset:6144
    ds_read_b64_tr_b16 v[86:87], v55 offset:30720
    v_mfma_f32_16x16x32_bf16 v[20:23], v[60:63], a[52:55], v[20:23]
    s_waitcnt lgkmcnt(6)
    ds_read_b64_tr_b16 v[88:89], v55 offset:55296
    v_mfma_f32_16x16x32_bf16 v[28:31], v[68:71], a[52:55], v[28:31]
    ds_read_b64_tr_b16 v[90:91], v59 offset:14336
    v_mfma_f32_16x16x32_bf16 v[28:31], v[72:75], a[60:63], v[28:31]
    buffer_load_dwordx4 a[36:39], v3, s[88:91], s37 offen sc1
    v_mfma_f32_16x16x32_bf16 v[24:27], v[72:75], a[56:59], v[24:27]
    ds_read_b64_tr_b16 v[60:61], v52 offset:8192
    ds_read_b64_tr_b16 v[62:63], v52 offset:32768
    v_mfma_f32_16x16x32_bf16 v[24:27], v[68:71], a[48:51], v[24:27]
    s_waitcnt lgkmcnt(6)
    ds_read_b64_tr_b16 v[64:65], v52 offset:57344
    v_mfma_f32_16x16x32_bf16 v[32:35], v[76:79], a[48:51], v[32:35]
    s_add_u32 s37, s37, 1024
    ds_read_b64_tr_b16 v[66:67], v56 offset:16384
    v_mfma_f32_16x16x32_bf16 v[32:35], v[80:83], a[56:59], v[32:35]
    buffer_load_dwordx4 a[40:43], v2, s[88:91], s37 offen
    v_mfma_f32_16x16x32_bf16 v[36:39], v[80:83], a[60:63], v[36:39]
    s_add_u32 s45, s45, 0x2000
    ds_read_b64_tr_b16 v[68:69], v53 offset:8192
    ds_read_b64_tr_b16 v[70:71], v53 offset:32768
    v_mfma_f32_16x16x32_bf16 v[36:39], v[76:79], a[52:55], v[36:39]
    s_waitcnt lgkmcnt(6)
    ds_read_b64_tr_b16 v[72:73], v53 offset:57344
    v_mfma_f32_16x16x32_bf16 v[44:47], v[84:87], a[52:55], v[44:47]
    s_add_u32 m0, s46, 0
    ds_read_b64_tr_b16 v[74:75], v57 offset:16384
    v_mfma_f32_16x16x32_bf16 v[44:47], v[88:91], a[60:63], v[44:47]
    buffer_load_dwordx4 a[44:47], v3, s[88:91], s37 offen
    v_mfma_f32_16x16x32_bf16 v[40:43], v[88:91], a[56:59], v[40:43]
    s_waitcnt vmcnt(18)
    ds_read_b64_tr_b16 v[76:77], v54 offset:8192
    ds_read_b64_tr_b16 v[78:79], v54 offset:32768
    v_mfma_f32_16x16x32_bf16 v[40:43], v[84:87], a[48:51], v[40:43]
    s_waitcnt lgkmcnt(6)
    ds_read_b64_tr_b16 v[80:81], v54 offset:57344
    v_mfma_f32_16x16x32_bf16 v[16:19], v[60:63], a[64:67], v[16:19]
    s_add_u32 s37, s37, 1024
    ds_read_b64_tr_b16 v[82:83], v58 offset:16384
    v_mfma_f32_16x16x32_bf16 v[16:19], v[64:67], a[72:75], v[16:19]
    s_barrier
    ds_read_b64_tr_b16 v[84:85], v55 offset:8192
    v_mfma_f32_16x16x32_bf16 v[20:23], v[64:67], a[76:79], v[20:23]
    buffer_load_dwordx4 a[48:51], v2, s[88:91], s37 offen
    v_mfma_f32_16x16x32_bf16 v[20:23], v[60:63], a[68:71], v[20:23]
    s_waitcnt lgkmcnt(5)
    ds_read_b64_tr_b16 v[86:87], v55 offset:32768
    ds_read_b64_tr_b16 v[88:89], v55 offset:57344
    v_mfma_f32_16x16x32_bf16 v[28:31], v[68:71], a[68:71], v[28:31]
    buffer_load_dwordx4 v12, s[52:55], s45 offen offset:0 lds
    v_mfma_f32_16x16x32_bf16 v[28:31], v[72:75], a[76:79], v[28:31]
    buffer_load_dwordx4 a[52:55], v3, s[88:91], s37 offen
    v_mfma_f32_16x16x32_bf16 v[24:27], v[72:75], a[72:75], v[24:27]
    ds_read_b64_tr_b16 v[90:91], v59 offset:16384
    ds_read_b64_tr_b16 v[60:61], v52 offset:10240
    v_mfma_f32_16x16x32_bf16 v[24:27], v[68:71], a[64:67], v[24:27]
    s_waitcnt lgkmcnt(5)
    ds_read_b64_tr_b16 v[62:63], v52 offset:34816
    ds_read_b64_tr_b16 v[64:65], v52 offset:59392
    v_mfma_f32_16x16x32_bf16 v[32:35], v[76:79], a[64:67], v[32:35]
    s_add_u32 s37, s37, 1024
    ds_read_b64_tr_b16 v[66:67], v56 offset:18432
    v_mfma_f32_16x16x32_bf16 v[32:35], v[80:83], a[72:75], v[32:35]
    buffer_load_dwordx4 a[56:59], v2, s[88:91], s37 offen
    v_mfma_f32_16x16x32_bf16 v[36:39], v[80:83], a[76:79], v[36:39]
    s_add_u32 m0, s46, 0
    ds_read_b64_tr_b16 v[68:69], v53 offset:10240
    ds_read_b64_tr_b16 v[70:71], v53 offset:34816
    v_mfma_f32_16x16x32_bf16 v[36:39], v[76:79], a[68:71], v[36:39]
    s_waitcnt lgkmcnt(6)
    ds_read_b64_tr_b16 v[72:73], v53 offset:59392
    v_mfma_f32_16x16x32_bf16 v[44:47], v[84:87], a[68:71], v[44:47]
    buffer_load_dwordx4 v12, s[52:55], s45 offen offset:1024 lds
    v_mfma_f32_16x16x32_bf16 v[44:47], v[88:91], a[76:79], v[44:47]
    buffer_load_dwordx4 a[60:63], v3, s[88:91], s37 offen
    v_mfma_f32_16x16x32_bf16 v[40:43], v[88:91], a[72:75], v[40:43]
    s_waitcnt vmcnt(20)
    ds_read_b64_tr_b16 v[74:75], v57 offset:18432
    ds_read_b64_tr_b16 v[76:77], v54 offset:10240
    v_mfma_f32_16x16x32_bf16 v[40:43], v[84:87], a[64:67], v[40:43]
    s_waitcnt lgkmcnt(5)
    ds_read_b64_tr_b16 v[78:79], v54 offset:34816
    ds_read_b64_tr_b16 v[80:81], v54 offset:59392
    v_mfma_f32_16x16x32_bf16 v[16:19], v[60:63], a[80:83], v[16:19]
    s_add_u32 s37, s37, 1024
    s_add_u32 s45, s45, 0x2000
    ds_read_b64_tr_b16 v[82:83], v58 offset:18432
    v_mfma_f32_16x16x32_bf16 v[16:19], v[64:67], a[88:91], v[16:19]
    buffer_load_dwordx4 a[64:67], v2, s[88:91], s37 offen
    v_mfma_f32_16x16x32_bf16 v[20:23], v[64:67], a[92:95], v[20:23]
    s_add_u32 m0, s46, 2048
    ds_read_b64_tr_b16 v[84:85], v55 offset:10240
    ds_read_b64_tr_b16 v[86:87], v55 offset:34816
    v_mfma_f32_16x16x32_bf16 v[20:23], v[60:63], a[84:87], v[20:23]
    s_waitcnt lgkmcnt(6)
    ds_read_b64_tr_b16 v[88:89], v55 offset:59392
    v_mfma_f32_16x16x32_bf16 v[28:31], v[68:71], a[84:87], v[28:31]
    buffer_load_dwordx4 v12, s[52:55], s45 offen offset:0 lds
    v_mfma_f32_16x16x32_bf16 v[28:31], v[72:75], a[92:95], v[28:31]
    buffer_load_dwordx4 a[68:71], v3, s[88:91], s37 offen
    v_mfma_f32_16x16x32_bf16 v[24:27], v[72:75], a[88:91], v[24:27]
    ds_read_b64_tr_b16 v[90:91], v59 offset:18432
    ds_read_b64_tr_b16 v[60:61], v52 offset:12288
    v_mfma_f32_16x16x32_bf16 v[24:27], v[68:71], a[80:83], v[24:27]
    s_waitcnt lgkmcnt(5)
    ds_read_b64_tr_b16 v[62:63], v52 offset:36864
    ds_read_b64_tr_b16 v[64:65], v52 offset:61440
    v_mfma_f32_16x16x32_bf16 v[32:35], v[76:79], a[80:83], v[32:35]
    s_add_u32 s37, s37, 1024
    ds_read_b64_tr_b16 v[66:67], v56 offset:20480
    v_mfma_f32_16x16x32_bf16 v[32:35], v[80:83], a[88:91], v[32:35]
    buffer_load_dwordx4 a[72:75], v2, s[88:91], s37 offen
    v_mfma_f32_16x16x32_bf16 v[36:39], v[80:83], a[92:95], v[36:39]
    s_add_u32 m0, s46, 2048
    ds_read_b64_tr_b16 v[68:69], v53 offset:12288
    ds_read_b64_tr_b16 v[70:71], v53 offset:36864
    v_mfma_f32_16x16x32_bf16 v[36:39], v[76:79], a[84:87], v[36:39]
    s_waitcnt lgkmcnt(6)
    ds_read_b64_tr_b16 v[72:73], v53 offset:61440
    v_mfma_f32_16x16x32_bf16 v[44:47], v[84:87], a[84:87], v[44:47]
    buffer_load_dwordx4 v12, s[52:55], s45 offen offset:1024 lds
    v_mfma_f32_16x16x32_bf16 v[44:47], v[88:91], a[92:95], v[44:47]
    buffer_load_dwordx4 a[76:79], v3, s[88:91], s37 offen
    v_mfma_f32_16x16x32_bf16 v[40:43], v[88:91], a[88:91], v[40:43]
    s_waitcnt vmcnt(22)
    ds_read_b64_tr_b16 v[74:75], v57 offset:20480
    ds_read_b64_tr_b16 v[76:77], v54 offset:12288
    v_mfma_f32_16x16x32_bf16 v[40:43], v[84:87], a[80:83], v[40:43]
    s_waitcnt lgkmcnt(5)
    ds_read_b64_tr_b16 v[78:79], v54 offset:36864
    ds_read_b64_tr_b16 v[80:81], v54 offset:61440
    v_mfma_f32_16x16x32_bf16 v[16:19], v[60:63], a[96:99], v[16:19]
    s_add_u32 s37, s37, 1024
    s_add_u32 s45, s45, 0x2000
    ds_read_b64_tr_b16 v[82:83], v58 offset:20480
    v_mfma_f32_16x16x32_bf16 v[16:19], v[64:67], a[0:3], v[16:19]
    buffer_load_dwordx4 a[80:83], v2, s[88:91], s37 offen
    v_mfma_f32_16x16x32_bf16 v[20:23], v[64:67], a[4:7], v[20:23]
    s_add_u32 m0, s46, 4096
    ds_read_b64_tr_b16 v[84:85], v55 offset:12288
    ds_read_b64_tr_b16 v[86:87], v55 offset:36864
    v_mfma_f32_16x16x32_bf16 v[20:23], v[60:63], a[100:103], v[20:23]
    s_waitcnt lgkmcnt(6)
    ds_read_b64_tr_b16 v[88:89], v55 offset:61440
    v_mfma_f32_16x16x32_bf16 v[28:31], v[68:71], a[100:103], v[28:31]
    buffer_load_dwordx4 v12, s[52:55], s45 offen offset:0 lds
    v_mfma_f32_16x16x32_bf16 v[28:31], v[72:75], a[4:7], v[28:31]
    buffer_load_dwordx4 a[84:87], v3, s[88:91], s37 offen
    v_mfma_f32_16x16x32_bf16 v[24:27], v[72:75], a[0:3], v[24:27]
    ds_read_b64_tr_b16 v[90:91], v59 offset:20480
    ds_read_b64_tr_b16 v[60:61], v52 offset:14336
    v_mfma_f32_16x16x32_bf16 v[24:27], v[68:71], a[96:99], v[24:27]
    s_waitcnt lgkmcnt(5)
    ds_read_b64_tr_b16 v[62:63], v52 offset:38912
    ds_read_b64_tr_b16 v[64:65], v52 offset:63488
    v_mfma_f32_16x16x32_bf16 v[32:35], v[76:79], a[96:99], v[32:35]
    s_add_u32 s37, s37, 1024
    ds_read_b64_tr_b16 v[66:67], v56 offset:22528
    v_mfma_f32_16x16x32_bf16 v[32:35], v[80:83], a[0:3], v[32:35]
    buffer_load_dwordx4 a[88:91], v2, s[88:91], s37 offen sc1
    v_mfma_f32_16x16x32_bf16 v[36:39], v[80:83], a[4:7], v[36:39]
    s_add_u32 m0, s46, 4096
    ds_read_b64_tr_b16 v[68:69], v53 offset:14336
    ds_read_b64_tr_b16 v[70:71], v53 offset:38912
    v_mfma_f32_16x16x32_bf16 v[36:39], v[76:79], a[100:103], v[36:39]
    s_waitcnt lgkmcnt(6)
    ds_read_b64_tr_b16 v[72:73], v53 offset:63488
    v_mfma_f32_16x16x32_bf16 v[44:47], v[84:87], a[100:103], v[44:47]
    buffer_load_dwordx4 v12, s[52:55], s45 offen offset:1024 lds
    v_mfma_f32_16x16x32_bf16 v[44:47], v[88:91], a[4:7], v[44:47]
    buffer_load_dwordx4 a[92:95], v3, s[88:91], s37 offen sc1
    v_mfma_f32_16x16x32_bf16 v[40:43], v[88:91], a[0:3], v[40:43]
    s_waitcnt vmcnt(24)
    ds_read_b64_tr_b16 v[74:75], v57 offset:22528
    ds_read_b64_tr_b16 v[76:77], v54 offset:14336
    v_mfma_f32_16x16x32_bf16 v[40:43], v[84:87], a[96:99], v[40:43]
    s_waitcnt lgkmcnt(5)
    ds_read_b64_tr_b16 v[78:79], v54 offset:38912
    ds_read_b64_tr_b16 v[80:81], v54 offset:63488
    v_mfma_f32_16x16x32_bf16 v[16:19], v[60:63], a[8:11], v[16:19]
    s_add_u32 s37, s37, 1024
    ds_read_b64_tr_b16 v[82:83], v58 offset:22528
    v_mfma_f32_16x16x32_bf16 v[16:19], v[64:67], a[16:19], v[16:19]
    ds_read_b64_tr_b16 v[84:85], v55 offset:14336
    v_mfma_f32_16x16x32_bf16 v[20:23], v[64:67], a[20:23], v[20:23]
    s_barrier
    ds_read_b64_tr_b16 v[86:87], v55 offset:38912
    v_mfma_f32_16x16x32_bf16 v[20:23], v[60:63], a[12:15], v[20:23]
    s_waitcnt lgkmcnt(6)
    s_add_u32 m0, s46, 6144
    s_add_u32 s45, s45, 0x2000
    ds_read_b64_tr_b16 v[88:89], v55 offset:63488
    v_mfma_f32_16x16x32_bf16 v[28:31], v[68:71], a[12:15], v[28:31]
    buffer_load_dwordx4 a[96:99], v2, s[88:91], s37 offen
    v_mfma_f32_16x16x32_bf16 v[28:31], v[72:75], a[20:23], v[28:31]
    buffer_load_dwordx4 v12, s[52:55], s45 offen offset:0 lds
    v_mfma_f32_16x16x32_bf16 v[24:27], v[72:75], a[16:19], v[24:27]
    buffer_load_dwordx4 a[100:103], v3, s[88:91], s37 offen
    v_mfma_f32_16x16x32_bf16 v[24:27], v[68:71], a[8:11], v[24:27]
    s_waitcnt lgkmcnt(3)
    ds_read_b64_tr_b16 v[90:91], v59 offset:22528
    ds_read_b64_tr_b16 v[60:61], v52 offset:16384
    v_mfma_f32_16x16x32_bf16 v[32:35], v[76:79], a[8:11], v[32:35]
    s_add_u32 s37, s37, 1024
    ds_read_b64_tr_b16 v[62:63], v52 offset:40960
    ds_read_b64_tr_b16 v[64:65], v56 offset:0
    v_mfma_f32_16x16x32_bf16 v[32:35], v[80:83], a[16:19], v[32:35]
    buffer_load_dwordx4 a[0:3], v2, s[88:91], s37 offen
    v_mfma_f32_16x16x32_bf16 v[36:39], v[80:83], a[20:23], v[36:39]
    s_add_u32 m0, s46, 6144
    ds_read_b64_tr_b16 v[66:67], v56 offset:24576
    ds_read_b64_tr_b16 v[68:69], v53 offset:16384
    v_mfma_f32_16x16x32_bf16 v[36:39], v[76:79], a[12:15], v[36:39]
    s_waitcnt lgkmcnt(5)
    ds_read_b64_tr_b16 v[70:71], v53 offset:40960
    ds_read_b64_tr_b16 v[72:73], v57 offset:0
    v_mfma_f32_16x16x32_bf16 v[44:47], v[84:87], a[12:15], v[44:47]
    buffer_load_dwordx4 v12, s[52:55], s45 offen offset:1024 lds
    v_mfma_f32_16x16x32_bf16 v[44:47], v[88:91], a[20:23], v[44:47]
    buffer_load_dwordx4 a[4:7], v3, s[88:91], s37 offen
    v_mfma_f32_16x16x32_bf16 v[40:43], v[88:91], a[16:19], v[40:43]
    s_waitcnt vmcnt(26)
    ds_read_b64_tr_b16 v[74:75], v57 offset:24576
    ds_read_b64_tr_b16 v[76:77], v54 offset:16384
    v_mfma_f32_16x16x32_bf16 v[40:43], v[84:87], a[8:11], v[40:43]
    s_waitcnt lgkmcnt(5)
    ds_read_b64_tr_b16 v[78:79], v54 offset:40960
    ds_read_b64_tr_b16 v[80:81], v58 offset:0
    v_mfma_f32_16x16x32_bf16 v[16:19], v[60:63], a[24:27], v[16:19]
    s_add_u32 s37, s37, 1024
    s_add_u32 s45, s45, 0x2000
    ds_read_b64_tr_b16 v[82:83], v58 offset:24576
    v_mfma_f32_16x16x32_bf16 v[16:19], v[64:67], a[32:35], v[16:19]
    buffer_load_dwordx4 a[8:11], v2, s[88:91], s37 offen
    v_mfma_f32_16x16x32_bf16 v[20:23], v[64:67], a[36:39], v[20:23]
    s_add_u32 m0, s46, 8192
    ds_read_b64_tr_b16 v[84:85], v55 offset:16384
    ds_read_b64_tr_b16 v[86:87], v55 offset:40960
    v_mfma_f32_16x16x32_bf16 v[20:23], v[60:63], a[28:31], v[20:23]
    s_waitcnt lgkmcnt(6)
    ds_read_b64_tr_b16 v[88:89], v59 offset:0
    v_mfma_f32_16x16x32_bf16 v[28:31], v[68:71], a[28:31], v[28:31]
    buffer_load_dwordx4 v12, s[52:55], s45 offen offset:0 lds
    v_mfma_f32_16x16x32_bf16 v[28:31], v[72:75], a[36:39], v[28:31]
    buffer_load_dwordx4 a[12:15], v3, s[88:91], s37 offen
    v_mfma_f32_16x16x32_bf16 v[24:27], v[72:75], a[32:35], v[24:27]
    ds_read_b64_tr_b16 v[90:91], v59 offset:24576
    ds_read_b64_tr_b16 v[60:61], v52 offset:18432
    v_mfma_f32_16x16x32_bf16 v[24:27], v[68:71], a[24:27], v[24:27]
    s_waitcnt lgkmcnt(5)
    ds_read_b64_tr_b16 v[62:63], v52 offset:43008
    ds_read_b64_tr_b16 v[64:65], v56 offset:2048
    v_mfma_f32_16x16x32_bf16 v[32:35], v[76:79], a[24:27], v[32:35]
    s_add_u32 s37, s37, 1024
    ds_read_b64_tr_b16 v[66:67], v56 offset:26624
    v_mfma_f32_16x16x32_bf16 v[32:35], v[80:83], a[32:35], v[32:35]
    buffer_load_dwordx4 a[16:19], v2, s[88:91], s37 offen
    v_mfma_f32_16x16x32_bf16 v[36:39], v[80:83], a[36:39], v[36:39]
    s_add_u32 m0, s46, 8192
    ds_read_b64_tr_b16 v[68:69], v53 offset:18432
    ds_read_b64_tr_b16 v[70:71], v53 offset:43008
    v_mfma_f32_16x16x32_bf16 v[36:39], v[76:79], a[28:31], v[36:39]
    s_waitcnt lgkmcnt(6)
    ds_read_b64_tr_b16 v[72:73], v57 offset:2048
    v_mfma_f32_16x16x32_bf16 v[44:47], v[84:87], a[28:31], v[44:47]
    buffer_load_dwordx4 v12, s[52:55], s45 offen offset:1024 lds
    v_mfma_f32_16x16x32_bf16 v[44:47], v[88:91], a[36:39], v[44:47]
    buffer_load_dwordx4 a[20:23], v3, s[88:91], s37 offen
    v_mfma_f32_16x16x32_bf16 v[40:43], v[88:91], a[32:35], v[40:43]
    s_waitcnt vmcnt(27)
    ds_read_b64_tr_b16 v[74:75], v57 offset:26624
    ds_read_b64_tr_b16 v[76:77], v54 offset:18432
    v_mfma_f32_16x16x32_bf16 v[40:43], v[84:87], a[24:27], v[40:43]
    s_waitcnt lgkmcnt(5)
    ds_read_b64_tr_b16 v[78:79], v54 offset:43008
    ds_read_b64_tr_b16 v[80:81], v58 offset:2048
    v_mfma_f32_16x16x32_bf16 v[16:19], v[60:63], a[40:43], v[16:19]
    s_add_u32 s37, s37, 1024
    s_add_u32 s45, s45, 0x2000
    ds_read_b64_tr_b16 v[82:83], v58 offset:26624
    v_mfma_f32_16x16x32_bf16 v[16:19], v[64:67], a[48:51], v[16:19]
    buffer_load_dwordx4 a[24:27], v2, s[88:91], s37 offen
    v_mfma_f32_16x16x32_bf16 v[20:23], v[64:67], a[52:55], v[20:23]
    s_add_u32 m0, s46, 10240
    ds_read_b64_tr_b16 v[84:85], v55 offset:18432
    ds_read_b64_tr_b16 v[86:87], v55 offset:43008
    v_mfma_f32_16x16x32_bf16 v[20:23], v[60:63], a[44:47], v[20:23]
    s_waitcnt lgkmcnt(6)
    ds_read_b64_tr_b16 v[88:89], v59 offset:2048
    v_mfma_f32_16x16x32_bf16 v[28:31], v[68:71], a[44:47], v[28:31]
    buffer_load_dwordx4 v12, s[52:55], s45 offen offset:0 lds
    v_mfma_f32_16x16x32_bf16 v[28:31], v[72:75], a[52:55], v[28:31]
    buffer_load_dwordx4 a[28:31], v3, s[88:91], s37 offen
    v_mfma_f32_16x16x32_bf16 v[24:27], v[72:75], a[48:51], v[24:27]
    ds_read_b64_tr_b16 v[90:91], v59 offset:26624
    ds_read_b64_tr_b16 v[60:61], v52 offset:20480
    v_mfma_f32_16x16x32_bf16 v[24:27], v[68:71], a[40:43], v[24:27]
    s_waitcnt lgkmcnt(5)
    ds_read_b64_tr_b16 v[62:63], v52 offset:45056
    ds_read_b64_tr_b16 v[64:65], v56 offset:4096
    v_mfma_f32_16x16x32_bf16 v[32:35], v[76:79], a[40:43], v[32:35]
    s_add_u32 s37, s37, 1024
    ds_read_b64_tr_b16 v[66:67], v56 offset:28672
    v_mfma_f32_16x16x32_bf16 v[32:35], v[80:83], a[48:51], v[32:35]
    buffer_load_dwordx4 a[32:35], v2, s[88:91], s37 offen
    v_mfma_f32_16x16x32_bf16 v[36:39], v[80:83], a[52:55], v[36:39]
    s_add_u32 m0, s46, 10240
    ds_read_b64_tr_b16 v[68:69], v53 offset:20480
    ds_read_b64_tr_b16 v[70:71], v53 offset:45056
    v_mfma_f32_16x16x32_bf16 v[36:39], v[76:79], a[44:47], v[36:39]
    s_waitcnt lgkmcnt(6)
    ds_read_b64_tr_b16 v[72:73], v57 offset:4096
    v_mfma_f32_16x16x32_bf16 v[44:47], v[84:87], a[44:47], v[44:47]
    buffer_load_dwordx4 v12, s[52:55], s45 offen offset:1024 lds
    v_mfma_f32_16x16x32_bf16 v[44:47], v[88:91], a[52:55], v[44:47]
    buffer_load_dwordx4 a[36:39], v3, s[88:91], s37 offen
    v_mfma_f32_16x16x32_bf16 v[40:43], v[88:91], a[48:51], v[40:43]
    s_waitcnt vmcnt(27)
    ds_read_b64_tr_b16 v[74:75], v57 offset:28672
    ds_read_b64_tr_b16 v[76:77], v54 offset:20480
    v_mfma_f32_16x16x32_bf16 v[40:43], v[84:87], a[40:43], v[40:43]
    s_waitcnt lgkmcnt(5)
    ds_read_b64_tr_b16 v[78:79], v54 offset:45056
    ds_read_b64_tr_b16 v[80:81], v58 offset:4096
    v_mfma_f32_16x16x32_bf16 v[16:19], v[60:63], a[56:59], v[16:19]
    s_add_u32 s37, s37, 1024
    s_add_u32 s45, s45, 0x2000
    ds_read_b64_tr_b16 v[82:83], v58 offset:28672
    v_mfma_f32_16x16x32_bf16 v[16:19], v[64:67], a[64:67], v[16:19]
    buffer_load_dwordx4 a[40:43], v2, s[88:91], s37 offen sc1
    v_mfma_f32_16x16x32_bf16 v[20:23], v[64:67], a[68:71], v[20:23]
    s_add_u32 m0, s46, 12288
    ds_read_b64_tr_b16 v[84:85], v55 offset:20480
    ds_read_b64_tr_b16 v[86:87], v55 offset:45056
    v_mfma_f32_16x16x32_bf16 v[20:23], v[60:63], a[60:63], v[20:23]
    s_waitcnt lgkmcnt(6)
    ds_read_b64_tr_b16 v[88:89], v59 offset:4096
    v_mfma_f32_16x16x32_bf16 v[28:31], v[68:71], a[60:63], v[28:31]
    buffer_load_dwordx4 v12, s[52:55], s45 offen offset:0 lds
    v_mfma_f32_16x16x32_bf16 v[28:31], v[72:75], a[68:71], v[28:31]
    buffer_load_dwordx4 a[44:47], v3, s[88:91], s37 offen sc1
    v_mfma_f32_16x16x32_bf16 v[24:27], v[72:75], a[64:67], v[24:27]
    ds_read_b64_tr_b16 v[90:91], v59 offset:28672
    ds_read_b64_tr_b16 v[60:61], v52 offset:22528
    v_mfma_f32_16x16x32_bf16 v[24:27], v[68:71], a[56:59], v[24:27]
    s_waitcnt lgkmcnt(5)
    ds_read_b64_tr_b16 v[62:63], v52 offset:47104
    ds_read_b64_tr_b16 v[64:65], v56 offset:6144
    v_mfma_f32_16x16x32_bf16 v[32:35], v[76:79], a[56:59], v[32:35]
    s_add_u32 s37, s37, 1024
    ds_read_b64_tr_b16 v[66:67], v56 offset:30720
    v_mfma_f32_16x16x32_bf16 v[32:35], v[80:83], a[64:67], v[32:35]
    buffer_load_dwordx4 a[48:51], v2, s[88:91], s37 offen
    v_mfma_f32_16x16x32_bf16 v[36:39], v[80:83], a[68:71], v[36:39]
    s_add_u32 m0, s46, 12288
    ds_read_b64_tr_b16 v[68:69], v53 offset:22528
    ds_read_b64_tr_b16 v[70:71], v53 offset:47104
    v_mfma_f32_16x16x32_bf16 v[36:39], v[76:79], a[60:63], v[36:39]
    s_waitcnt lgkmcnt(6)
    ds_read_b64_tr_b16 v[72:73], v57 offset:6144
    v_mfma_f32_16x16x32_bf16 v[44:47], v[84:87], a[60:63], v[44:47]
    buffer_load_dwordx4 v12, s[52:55], s45 offen offset:1024 lds
    v_mfma_f32_16x16x32_bf16 v[44:47], v[88:91], a[68:71], v[44:47]
    buffer_load_dwordx4 a[52:55], v3, s[88:91], s37 offen
    v_mfma_f32_16x16x32_bf16 v[40:43], v[88:91], a[64:67], v[40:43]
    s_waitcnt vmcnt(27)
    ds_read_b64_tr_b16 v[74:75], v57 offset:30720
    ds_read_b64_tr_b16 v[76:77], v54 offset:22528
    v_mfma_f32_16x16x32_bf16 v[40:43], v[84:87], a[56:59], v[40:43]
    s_waitcnt lgkmcnt(5)
    ds_read_b64_tr_b16 v[78:79], v54 offset:47104
    ds_read_b64_tr_b16 v[80:81], v58 offset:6144
    v_mfma_f32_16x16x32_bf16 v[16:19], v[60:63], a[72:75], v[16:19]
    s_add_u32 s37, s37, 1024
    ds_read_b64_tr_b16 v[82:83], v58 offset:30720
    v_mfma_f32_16x16x32_bf16 v[16:19], v[64:67], a[80:83], v[16:19]
    buffer_load_dwordx4 a[56:59], v2, s[88:91], s37 offen
    v_mfma_f32_16x16x32_bf16 v[20:23], v[64:67], a[84:87], v[20:23]
    ds_read_b64_tr_b16 v[84:85], v55 offset:22528
    ds_read_b64_tr_b16 v[86:87], v55 offset:47104
    v_mfma_f32_16x16x32_bf16 v[20:23], v[60:63], a[76:79], v[20:23]
    s_waitcnt lgkmcnt(6)
    ds_read_b64_tr_b16 v[88:89], v59 offset:6144
    v_mfma_f32_16x16x32_bf16 v[28:31], v[68:71], a[76:79], v[28:31]
    ds_read_b64_tr_b16 v[90:91], v59 offset:30720
    v_mfma_f32_16x16x32_bf16 v[28:31], v[72:75], a[84:87], v[28:31]
    buffer_load_dwordx4 a[60:63], v3, s[88:91], s37 offen
    v_mfma_f32_16x16x32_bf16 v[24:27], v[72:75], a[80:83], v[24:27]
    ds_read_b64_tr_b16 v[60:61], v48 offset:0
    ds_read_b64_tr_b16 v[62:63], v48 offset:16384
    v_mfma_f32_16x16x32_bf16 v[24:27], v[68:71], a[72:75], v[24:27]
    s_waitcnt lgkmcnt(6)
    ds_read_b64_tr_b16 v[64:65], v48 offset:32768
    v_mfma_f32_16x16x32_bf16 v[32:35], v[76:79], a[72:75], v[32:35]
    s_add_u32 s37, s37, 1024
    ds_read_b64_tr_b16 v[66:67], v48 offset:49152
    v_mfma_f32_16x16x32_bf16 v[32:35], v[80:83], a[80:83], v[32:35]
    buffer_load_dwordx4 a[64:67], v2, s[88:91], s37 offen
    v_mfma_f32_16x16x32_bf16 v[36:39], v[80:83], a[84:87], v[36:39]
    s_add_u32 s45, s45, 0x2000
    ds_read_b64_tr_b16 v[68:69], v49 offset:0
    ds_read_b64_tr_b16 v[70:71], v49 offset:16384
    v_mfma_f32_16x16x32_bf16 v[36:39], v[76:79], a[76:79], v[36:39]
    s_waitcnt lgkmcnt(6)
    ds_read_b64_tr_b16 v[72:73], v49 offset:32768
    v_mfma_f32_16x16x32_bf16 v[44:47], v[84:87], a[76:79], v[44:47]
    s_add_u32 m0, s46, 14336
    ds_read_b64_tr_b16 v[74:75], v49 offset:49152
    v_mfma_f32_16x16x32_bf16 v[44:47], v[88:91], a[84:87], v[44:47]
    buffer_load_dwordx4 a[68:71], v3, s[88:91], s37 offen
    v_mfma_f32_16x16x32_bf16 v[40:43], v[88:91], a[80:83], v[40:43]
    s_waitcnt vmcnt(25)
    ds_read_b64_tr_b16 v[76:77], v50 offset:0
    ds_read_b64_tr_b16 v[78:79], v50 offset:16384
    v_mfma_f32_16x16x32_bf16 v[40:43], v[84:87], a[72:75], v[40:43]
    s_waitcnt lgkmcnt(6)
    ds_read_b64_tr_b16 v[80:81], v50 offset:32768
    v_mfma_f32_16x16x32_bf16 v[16:19], v[60:63], a[88:91], v[16:19]
    s_add_u32 s37, s37, 1024
    ds_read_b64_tr_b16 v[82:83], v50 offset:49152
    v_mfma_f32_16x16x32_bf16 v[16:19], v[64:67], a[96:99], v[16:19]
    s_barrier
    ds_read_b64_tr_b16 v[84:85], v51 offset:0
    v_mfma_f32_16x16x32_bf16 v[20:23], v[64:67], a[100:103], v[20:23]
    buffer_load_dwordx4 a[72:75], v2, s[88:91], s37 offen
    v_mfma_f32_16x16x32_bf16 v[20:23], v[60:63], a[92:95], v[20:23]
    s_waitcnt lgkmcnt(5)
    ds_read_b64_tr_b16 v[86:87], v51 offset:16384
    ds_read_b64_tr_b16 v[88:89], v51 offset:32768
    v_mfma_f32_16x16x32_bf16 v[28:31], v[68:71], a[92:95], v[28:31]
    buffer_load_dwordx4 v12, s[52:55], s45 offen offset:0 lds
    v_mfma_f32_16x16x32_bf16 v[28:31], v[72:75], a[100:103], v[28:31]
    buffer_load_dwordx4 a[76:79], v3, s[88:91], s37 offen
    v_mfma_f32_16x16x32_bf16 v[24:27], v[72:75], a[96:99], v[24:27]
    ds_read_b64_tr_b16 v[90:91], v51 offset:49152
    ds_read_b64_tr_b16 v[60:61], v48 offset:2048
    v_mfma_f32_16x16x32_bf16 v[24:27], v[68:71], a[88:91], v[24:27]
    s_waitcnt lgkmcnt(5)
    ds_read_b64_tr_b16 v[62:63], v48 offset:18432
    ds_read_b64_tr_b16 v[64:65], v48 offset:34816
    v_mfma_f32_16x16x32_bf16 v[32:35], v[76:79], a[88:91], v[32:35]
    s_add_u32 s37, s37, 1024
    ds_read_b64_tr_b16 v[66:67], v48 offset:51200
    v_mfma_f32_16x16x32_bf16 v[32:35], v[80:83], a[96:99], v[32:35]
    buffer_load_dwordx4 a[80:83], v2, s[88:91], s37 offen
    v_mfma_f32_16x16x32_bf16 v[36:39], v[80:83], a[100:103], v[36:39]
    s_add_u32 m0, s46, 14336
    ds_read_b64_tr_b16 v[68:69], v49 offset:2048
    ds_read_b64_tr_b16 v[70:71], v49 offset:18432
    v_mfma_f32_16x16x32_bf16 v[36:39], v[76:79], a[92:95], v[36:39]
    s_waitcnt lgkmcnt(6)
    ds_read_b64_tr_b16 v[72:73], v49 offset:34816
    v_mfma_f32_16x16x32_bf16 v[44:47], v[84:87], a[92:95], v[44:47]
    buffer_load_dwordx4 v12, s[52:55], s45 offen offset:1024 lds
    v_mfma_f32_16x16x32_bf16 v[44:47], v[88:91], a[100:103], v[44:47]
    buffer_load_dwordx4 a[84:87], v3, s[88:91], s37 offen
    v_mfma_f32_16x16x32_bf16 v[40:43], v[88:91], a[96:99], v[40:43]
    s_waitcnt vmcnt(25)
    ds_read_b64_tr_b16 v[74:75], v49 offset:51200
    ds_read_b64_tr_b16 v[76:77], v50 offset:2048
    v_mfma_f32_16x16x32_bf16 v[40:43], v[84:87], a[88:91], v[40:43]
    s_waitcnt lgkmcnt(5)
    ds_read_b64_tr_b16 v[78:79], v50 offset:18432
    ds_read_b64_tr_b16 v[80:81], v50 offset:34816
    v_mfma_f32_16x16x32_bf16 v[16:19], v[60:63], a[0:3], v[16:19]
    s_add_u32 s37, s37, 1024
    ds_read_b64_tr_b16 v[82:83], v50 offset:51200
    v_mfma_f32_16x16x32_bf16 v[16:19], v[64:67], a[8:11], v[16:19]
    buffer_load_dwordx4 a[88:91], v2, s[88:91], s37 offen
    v_mfma_f32_16x16x32_bf16 v[20:23], v[64:67], a[12:15], v[20:23]
    ds_read_b64_tr_b16 v[84:85], v51 offset:2048
    ds_read_b64_tr_b16 v[86:87], v51 offset:18432
    v_mfma_f32_16x16x32_bf16 v[20:23], v[60:63], a[4:7], v[20:23]
    s_waitcnt lgkmcnt(6)
    ds_read_b64_tr_b16 v[88:89], v51 offset:34816
    v_mfma_f32_16x16x32_bf16 v[28:31], v[68:71], a[4:7], v[28:31]
    ds_read_b64_tr_b16 v[90:91], v51 offset:51200
    v_mfma_f32_16x16x32_bf16 v[28:31], v[72:75], a[12:15], v[28:31]
    buffer_load_dwordx4 a[92:95], v3, s[88:91], s37 offen
    v_mfma_f32_16x16x32_bf16 v[24:27], v[72:75], a[8:11], v[24:27]
    ds_read_b64_tr_b16 v[60:61], v48 offset:4096
    ds_read_b64_tr_b16 v[62:63], v48 offset:20480
    v_mfma_f32_16x16x32_bf16 v[24:27], v[68:71], a[0:3], v[24:27]
    s_waitcnt lgkmcnt(6)
    ds_read_b64_tr_b16 v[64:65], v48 offset:36864
    v_mfma_f32_16x16x32_bf16 v[32:35], v[76:79], a[0:3], v[32:35]
    s_add_u32 s37, s37, 1024
    ds_read_b64_tr_b16 v[66:67], v48 offset:53248
    v_mfma_f32_16x16x32_bf16 v[32:35], v[80:83], a[8:11], v[32:35]
    buffer_load_dwordx4 a[96:99], v2, s[88:91], s37 offen sc1
    v_mfma_f32_16x16x32_bf16 v[36:39], v[80:83], a[12:15], v[36:39]
    ds_read_b64_tr_b16 v[68:69], v49 offset:4096
    ds_read_b64_tr_b16 v[70:71], v49 offset:20480
    v_mfma_f32_16x16x32_bf16 v[36:39], v[76:79], a[4:7], v[36:39]
    s_waitcnt lgkmcnt(6)
    ds_read_b64_tr_b16 v[72:73], v49 offset:36864
    v_mfma_f32_16x16x32_bf16 v[44:47], v[84:87], a[4:7], v[44:47]
    ds_read_b64_tr_b16 v[74:75], v49 offset:53248
    v_mfma_f32_16x16x32_bf16 v[44:47], v[88:91], a[12:15], v[44:47]
    buffer_load_dwordx4 a[100:103], v3, s[88:91], s37 offen sc1
    v_mfma_f32_16x16x32_bf16 v[40:43], v[88:91], a[8:11], v[40:43]
    s_waitcnt vmcnt(23)
    ds_read_b64_tr_b16 v[76:77], v50 offset:4096
    ds_read_b64_tr_b16 v[78:79], v50 offset:20480
    v_mfma_f32_16x16x32_bf16 v[40:43], v[84:87], a[0:3], v[40:43]
    s_waitcnt lgkmcnt(6)
    ds_read_b64_tr_b16 v[80:81], v50 offset:36864
    v_mfma_f32_16x16x32_bf16 v[16:19], v[60:63], a[16:19], v[16:19]
    s_add_u32 s37, s37, 1024
    ds_read_b64_tr_b16 v[82:83], v50 offset:53248
    v_mfma_f32_16x16x32_bf16 v[16:19], v[64:67], a[24:27], v[16:19]
    buffer_load_dwordx4 a[0:3], v2, s[88:91], s37 offen
    v_mfma_f32_16x16x32_bf16 v[20:23], v[64:67], a[28:31], v[20:23]
    ds_read_b64_tr_b16 v[84:85], v51 offset:4096
    ds_read_b64_tr_b16 v[86:87], v51 offset:20480
    v_mfma_f32_16x16x32_bf16 v[20:23], v[60:63], a[20:23], v[20:23]
    s_waitcnt lgkmcnt(6)
    ds_read_b64_tr_b16 v[88:89], v51 offset:36864
    v_mfma_f32_16x16x32_bf16 v[28:31], v[68:71], a[20:23], v[28:31]
    ds_read_b64_tr_b16 v[90:91], v51 offset:53248
    v_mfma_f32_16x16x32_bf16 v[28:31], v[72:75], a[28:31], v[28:31]
    buffer_load_dwordx4 a[4:7], v3, s[88:91], s37 offen
    v_mfma_f32_16x16x32_bf16 v[24:27], v[72:75], a[24:27], v[24:27]
    ds_read_b64_tr_b16 v[60:61], v48 offset:6144
    ds_read_b64_tr_b16 v[62:63], v48 offset:22528
    v_mfma_f32_16x16x32_bf16 v[24:27], v[68:71], a[16:19], v[24:27]
    s_waitcnt lgkmcnt(6)
    ds_read_b64_tr_b16 v[64:65], v48 offset:38912
    v_mfma_f32_16x16x32_bf16 v[32:35], v[76:79], a[16:19], v[32:35]
    s_add_u32 s37, s37, 1024
    ds_read_b64_tr_b16 v[66:67], v48 offset:55296
    v_mfma_f32_16x16x32_bf16 v[32:35], v[80:83], a[24:27], v[32:35]
    buffer_load_dwordx4 a[8:11], v2, s[88:91], s37 offen
    v_mfma_f32_16x16x32_bf16 v[36:39], v[80:83], a[28:31], v[36:39]
    ds_read_b64_tr_b16 v[68:69], v49 offset:6144
    ds_read_b64_tr_b16 v[70:71], v49 offset:22528
    v_mfma_f32_16x16x32_bf16 v[36:39], v[76:79], a[20:23], v[36:39]
    s_waitcnt lgkmcnt(6)
    ds_read_b64_tr_b16 v[72:73], v49 offset:38912
    v_mfma_f32_16x16x32_bf16 v[44:47], v[84:87], a[20:23], v[44:47]
    ds_read_b64_tr_b16 v[74:75], v49 offset:55296
    v_mfma_f32_16x16x32_bf16 v[44:47], v[88:91], a[28:31], v[44:47]
    buffer_load_dwordx4 a[12:15], v3, s[88:91], s37 offen
    v_mfma_f32_16x16x32_bf16 v[40:43], v[88:91], a[24:27], v[40:43]
    s_waitcnt vmcnt(21)
    ds_read_b64_tr_b16 v[76:77], v50 offset:6144
    ds_read_b64_tr_b16 v[78:79], v50 offset:22528
    v_mfma_f32_16x16x32_bf16 v[40:43], v[84:87], a[16:19], v[40:43]
    s_waitcnt lgkmcnt(6)
    ds_read_b64_tr_b16 v[80:81], v50 offset:38912
    v_mfma_f32_16x16x32_bf16 v[16:19], v[60:63], a[32:35], v[16:19]
    s_add_u32 s37, s37, 1024
    ds_read_b64_tr_b16 v[82:83], v50 offset:55296
    v_mfma_f32_16x16x32_bf16 v[16:19], v[64:67], a[40:43], v[16:19]
    buffer_load_dwordx4 a[16:19], v2, s[88:91], s37 offen
    v_mfma_f32_16x16x32_bf16 v[20:23], v[64:67], a[44:47], v[20:23]
    ds_read_b64_tr_b16 v[84:85], v51 offset:6144
    ds_read_b64_tr_b16 v[86:87], v51 offset:22528
    v_mfma_f32_16x16x32_bf16 v[20:23], v[60:63], a[36:39], v[20:23]
    s_waitcnt lgkmcnt(6)
    ds_read_b64_tr_b16 v[88:89], v51 offset:38912
    v_mfma_f32_16x16x32_bf16 v[28:31], v[68:71], a[36:39], v[28:31]
    ds_read_b64_tr_b16 v[90:91], v51 offset:55296
    v_mfma_f32_16x16x32_bf16 v[28:31], v[72:75], a[44:47], v[28:31]
    buffer_load_dwordx4 a[20:23], v3, s[88:91], s37 offen
    v_mfma_f32_16x16x32_bf16 v[24:27], v[72:75], a[40:43], v[24:27]
    ds_read_b64_tr_b16 v[60:61], v48 offset:8192
    ds_read_b64_tr_b16 v[62:63], v48 offset:24576
    v_mfma_f32_16x16x32_bf16 v[24:27], v[68:71], a[32:35], v[24:27]
    s_waitcnt lgkmcnt(6)
    ds_read_b64_tr_b16 v[64:65], v48 offset:40960
    v_mfma_f32_16x16x32_bf16 v[32:35], v[76:79], a[32:35], v[32:35]
    s_add_u32 s37, s37, 1024
    ds_read_b64_tr_b16 v[66:67], v48 offset:57344
    v_mfma_f32_16x16x32_bf16 v[32:35], v[80:83], a[40:43], v[32:35]
    buffer_load_dwordx4 a[24:27], v2, s[88:91], s37 offen
    v_mfma_f32_16x16x32_bf16 v[36:39], v[80:83], a[44:47], v[36:39]
    ds_read_b64_tr_b16 v[68:69], v49 offset:8192
    ds_read_b64_tr_b16 v[70:71], v49 offset:24576
    v_mfma_f32_16x16x32_bf16 v[36:39], v[76:79], a[36:39], v[36:39]
    s_waitcnt lgkmcnt(6)
    ds_read_b64_tr_b16 v[72:73], v49 offset:40960
    v_mfma_f32_16x16x32_bf16 v[44:47], v[84:87], a[36:39], v[44:47]
    ds_read_b64_tr_b16 v[74:75], v49 offset:57344
    v_mfma_f32_16x16x32_bf16 v[44:47], v[88:91], a[44:47], v[44:47]
    buffer_load_dwordx4 a[28:31], v3, s[88:91], s37 offen
    v_mfma_f32_16x16x32_bf16 v[40:43], v[88:91], a[40:43], v[40:43]
    s_waitcnt vmcnt(20)
    ds_read_b64_tr_b16 v[76:77], v50 offset:8192
    ds_read_b64_tr_b16 v[78:79], v50 offset:24576
    v_mfma_f32_16x16x32_bf16 v[40:43], v[84:87], a[32:35], v[40:43]
    s_waitcnt lgkmcnt(6)
    ds_read_b64_tr_b16 v[80:81], v50 offset:40960
    v_mfma_f32_16x16x32_bf16 v[16:19], v[60:63], a[48:51], v[16:19]
    s_add_u32 s37, s37, 1024
    ds_read_b64_tr_b16 v[82:83], v50 offset:57344
    v_mfma_f32_16x16x32_bf16 v[16:19], v[64:67], a[56:59], v[16:19]
    buffer_load_dwordx4 a[32:35], v2, s[88:91], s37 offen
    v_mfma_f32_16x16x32_bf16 v[20:23], v[64:67], a[60:63], v[20:23]
    ds_read_b64_tr_b16 v[84:85], v51 offset:8192
    ds_read_b64_tr_b16 v[86:87], v51 offset:24576
    v_mfma_f32_16x16x32_bf16 v[20:23], v[60:63], a[52:55], v[20:23]
    s_waitcnt lgkmcnt(6)
    ds_read_b64_tr_b16 v[88:89], v51 offset:40960
    v_mfma_f32_16x16x32_bf16 v[28:31], v[68:71], a[52:55], v[28:31]
    ds_read_b64_tr_b16 v[90:91], v51 offset:57344
    v_mfma_f32_16x16x32_bf16 v[28:31], v[72:75], a[60:63], v[28:31]
    buffer_load_dwordx4 a[36:39], v3, s[88:91], s37 offen
    v_mfma_f32_16x16x32_bf16 v[24:27], v[72:75], a[56:59], v[24:27]
    ds_read_b64_tr_b16 v[60:61], v48 offset:10240
    ds_read_b64_tr_b16 v[62:63], v48 offset:26624
    v_mfma_f32_16x16x32_bf16 v[24:27], v[68:71], a[48:51], v[24:27]
    s_waitcnt lgkmcnt(6)
    ds_read_b64_tr_b16 v[64:65], v48 offset:43008
    v_mfma_f32_16x16x32_bf16 v[32:35], v[76:79], a[48:51], v[32:35]
    s_add_u32 s37, s37, 1024
    ds_read_b64_tr_b16 v[66:67], v48 offset:59392
    v_mfma_f32_16x16x32_bf16 v[32:35], v[80:83], a[56:59], v[32:35]
    buffer_load_dwordx4 a[40:43], v2, s[88:91], s37 offen
    v_mfma_f32_16x16x32_bf16 v[36:39], v[80:83], a[60:63], v[36:39]
    ds_read_b64_tr_b16 v[68:69], v49 offset:10240
    ds_read_b64_tr_b16 v[70:71], v49 offset:26624
    v_mfma_f32_16x16x32_bf16 v[36:39], v[76:79], a[52:55], v[36:39]
    s_waitcnt lgkmcnt(6)
    ds_read_b64_tr_b16 v[72:73], v49 offset:43008
    v_mfma_f32_16x16x32_bf16 v[44:47], v[84:87], a[52:55], v[44:47]
    ds_read_b64_tr_b16 v[74:75], v49 offset:59392
    v_mfma_f32_16x16x32_bf16 v[44:47], v[88:91], a[60:63], v[44:47]
    buffer_load_dwordx4 a[44:47], v3, s[88:91], s37 offen
    v_mfma_f32_16x16x32_bf16 v[40:43], v[88:91], a[56:59], v[40:43]
    s_waitcnt vmcnt(19)
    ds_read_b64_tr_b16 v[76:77], v50 offset:10240
    ds_read_b64_tr_b16 v[78:79], v50 offset:26624
    v_mfma_f32_16x16x32_bf16 v[40:43], v[84:87], a[48:51], v[40:43]
    s_waitcnt lgkmcnt(6)
    ds_read_b64_tr_b16 v[80:81], v50 offset:43008
    v_mfma_f32_16x16x32_bf16 v[16:19], v[60:63], a[64:67], v[16:19]
    s_add_u32 s37, s37, 1024
    ds_read_b64_tr_b16 v[82:83], v50 offset:59392
    v_mfma_f32_16x16x32_bf16 v[16:19], v[64:67], a[72:75], v[16:19]
    buffer_load_dwordx4 a[48:51], v2, s[88:91], s37 offen sc1
    v_mfma_f32_16x16x32_bf16 v[20:23], v[64:67], a[76:79], v[20:23]
    ds_read_b64_tr_b16 v[84:85], v51 offset:10240
    ds_read_b64_tr_b16 v[86:87], v51 offset:26624
    v_mfma_f32_16x16x32_bf16 v[20:23], v[60:63], a[68:71], v[20:23]
    s_waitcnt lgkmcnt(6)
    ds_read_b64_tr_b16 v[88:89], v51 offset:43008
    v_mfma_f32_16x16x32_bf16 v[28:31], v[68:71], a[68:71], v[28:31]
    ds_read_b64_tr_b16 v[90:91], v51 offset:59392
    v_mfma_f32_16x16x32_bf16 v[28:31], v[72:75], a[76:79], v[28:31]
    buffer_load_dwordx4 a[52:55], v3, s[88:91], s37 offen sc1
    v_mfma_f32_16x16x32_bf16 v[24:27], v[72:75], a[72:75], v[24:27]
    ds_read_b64_tr_b16 v[60:61], v48 offset:12288
    ds_read_b64_tr_b16 v[62:63], v48 offset:28672
    v_mfma_f32_16x16x32_bf16 v[24:27], v[68:71], a[64:67], v[24:27]
    s_waitcnt lgkmcnt(6)
    ds_read_b64_tr_b16 v[64:65], v48 offset:45056
    v_mfma_f32_16x16x32_bf16 v[32:35], v[76:79], a[64:67], v[32:35]
    s_add_u32 s37, s37, 1024
    ds_read_b64_tr_b16 v[66:67], v48 offset:61440
    v_mfma_f32_16x16x32_bf16 v[32:35], v[80:83], a[72:75], v[32:35]
    buffer_load_dwordx4 a[56:59], v2, s[88:91], s37 offen
    v_mfma_f32_16x16x32_bf16 v[36:39], v[80:83], a[76:79], v[36:39]
    ds_read_b64_tr_b16 v[68:69], v49 offset:12288
    ds_read_b64_tr_b16 v[70:71], v49 offset:28672
    v_mfma_f32_16x16x32_bf16 v[36:39], v[76:79], a[68:71], v[36:39]
    s_waitcnt lgkmcnt(6)
    ds_read_b64_tr_b16 v[72:73], v49 offset:45056
    v_mfma_f32_16x16x32_bf16 v[44:47], v[84:87], a[68:71], v[44:47]
    ds_read_b64_tr_b16 v[74:75], v49 offset:61440
    v_mfma_f32_16x16x32_bf16 v[44:47], v[88:91], a[76:79], v[44:47]
    buffer_load_dwordx4 a[60:63], v3, s[88:91], s37 offen
    v_mfma_f32_16x16x32_bf16 v[40:43], v[88:91], a[72:75], v[40:43]
    s_waitcnt vmcnt(18)
    ds_read_b64_tr_b16 v[76:77], v50 offset:12288
    ds_read_b64_tr_b16 v[78:79], v50 offset:28672
    v_mfma_f32_16x16x32_bf16 v[40:43], v[84:87], a[64:67], v[40:43]
    s_waitcnt lgkmcnt(6)
    ds_read_b64_tr_b16 v[80:81], v50 offset:45056
    v_mfma_f32_16x16x32_bf16 v[16:19], v[60:63], a[80:83], v[16:19]
    s_add_u32 s37, s37, 1024
    ds_read_b64_tr_b16 v[82:83], v50 offset:61440
    v_mfma_f32_16x16x32_bf16 v[16:19], v[64:67], a[88:91], v[16:19]
    buffer_load_dwordx4 a[64:67], v2, s[88:91], s37 offen
    v_mfma_f32_16x16x32_bf16 v[20:23], v[64:67], a[92:95], v[20:23]
    ds_read_b64_tr_b16 v[84:85], v51 offset:12288
    ds_read_b64_tr_b16 v[86:87], v51 offset:28672
    v_mfma_f32_16x16x32_bf16 v[20:23], v[60:63], a[84:87], v[20:23]
    s_waitcnt lgkmcnt(6)
    ds_read_b64_tr_b16 v[88:89], v51 offset:45056
    v_mfma_f32_16x16x32_bf16 v[28:31], v[68:71], a[84:87], v[28:31]
    ds_read_b64_tr_b16 v[90:91], v51 offset:61440
    v_mfma_f32_16x16x32_bf16 v[28:31], v[72:75], a[92:95], v[28:31]
    buffer_load_dwordx4 a[68:71], v3, s[88:91], s37 offen
    v_mfma_f32_16x16x32_bf16 v[24:27], v[72:75], a[88:91], v[24:27]
    ds_read_b64_tr_b16 v[60:61], v48 offset:14336
    ds_read_b64_tr_b16 v[62:63], v48 offset:30720
    v_mfma_f32_16x16x32_bf16 v[24:27], v[68:71], a[80:83], v[24:27]
    s_waitcnt lgkmcnt(6)
    ds_read_b64_tr_b16 v[64:65], v48 offset:47104
    v_mfma_f32_16x16x32_bf16 v[32:35], v[76:79], a[80:83], v[32:35]
    s_add_u32 s37, s37, 1024
    ds_read_b64_tr_b16 v[66:67], v48 offset:63488
    v_mfma_f32_16x16x32_bf16 v[32:35], v[80:83], a[88:91], v[32:35]
    buffer_load_dwordx4 a[72:75], v2, s[88:91], s37 offen
    v_mfma_f32_16x16x32_bf16 v[36:39], v[80:83], a[92:95], v[36:39]
    ds_read_b64_tr_b16 v[68:69], v49 offset:14336
    ds_read_b64_tr_b16 v[70:71], v49 offset:30720
    v_mfma_f32_16x16x32_bf16 v[36:39], v[76:79], a[84:87], v[36:39]
    s_waitcnt lgkmcnt(6)
    ds_read_b64_tr_b16 v[72:73], v49 offset:47104
    v_mfma_f32_16x16x32_bf16 v[44:47], v[84:87], a[84:87], v[44:47]
    buffer_load_dwordx2 v[6:7], v11, s[96:99], s39 offen sc1
    v_mfma_f32_16x16x32_bf16 v[44:47], v[88:91], a[92:95], v[44:47]
    buffer_load_dwordx4 a[76:79], v3, s[88:91], s37 offen
    v_mfma_f32_16x16x32_bf16 v[40:43], v[88:91], a[88:91], v[40:43]
    s_waitcnt vmcnt(19)
    ds_read_b64_tr_b16 v[74:75], v49 offset:63488
    ds_read_b64_tr_b16 v[76:77], v50 offset:14336
    v_mfma_f32_16x16x32_bf16 v[40:43], v[84:87], a[80:83], v[40:43]
    s_waitcnt lgkmcnt(5)
    ds_read_b64_tr_b16 v[78:79], v50 offset:30720
    ds_read_b64_tr_b16 v[80:81], v50 offset:47104
    v_mfma_f32_16x16x32_bf16 v[16:19], v[60:63], a[96:99], v[16:19]
    s_add_u32 s37, s37, 1024
    ds_read_b64_tr_b16 v[82:83], v50 offset:63488
    v_mfma_f32_16x16x32_bf16 v[16:19], v[64:67], a[0:3], v[16:19]
    ds_read_b64_tr_b16 v[84:85], v51 offset:14336
    v_mfma_f32_16x16x32_bf16 v[20:23], v[64:67], a[4:7], v[20:23]
    s_barrier
    ds_read_b64_tr_b16 v[86:87], v51 offset:30720
    v_mfma_f32_16x16x32_bf16 v[20:23], v[60:63], a[100:103], v[20:23]
    s_waitcnt lgkmcnt(6)
    ds_read_b64_tr_b16 v[88:89], v51 offset:47104
    v_mfma_f32_16x16x32_bf16 v[28:31], v[68:71], a[100:103], v[28:31]
    buffer_load_dwordx4 a[80:83], v2, s[88:91], s37 offen
    v_mfma_f32_16x16x32_bf16 v[28:31], v[72:75], a[4:7], v[28:31]
    buffer_load_dwordx4 a[84:87], v3, s[88:91], s37 offen
    v_mfma_f32_16x16x32_bf16 v[24:27], v[72:75], a[0:3], v[24:27]
    ds_read_b64_tr_b16 v[90:91], v51 offset:63488
    ds_read_b64_tr_b16 v[60:61], v52 offset:0
    v_mfma_f32_16x16x32_bf16 v[24:27], v[68:71], a[96:99], v[24:27]
    s_waitcnt lgkmcnt(5)
    ds_read_b64_tr_b16 v[62:63], v52 offset:24576
    ds_read_b64_tr_b16 v[64:65], v52 offset:49152
    v_mfma_f32_16x16x32_bf16 v[32:35], v[76:79], a[96:99], v[32:35]
    s_add_u32 s37, s37, 1024
    ds_read_b64_tr_b16 v[66:67], v56 offset:8192
    v_mfma_f32_16x16x32_bf16 v[32:35], v[80:83], a[0:3], v[32:35]
    buffer_load_dwordx4 a[88:91], v2, s[88:91], s37 offen
    v_mfma_f32_16x16x32_bf16 v[36:39], v[80:83], a[4:7], v[36:39]
    ds_read_b64_tr_b16 v[68:69], v53 offset:0
    ds_read_b64_tr_b16 v[70:71], v53 offset:24576
    v_mfma_f32_16x16x32_bf16 v[36:39], v[76:79], a[100:103], v[36:39]
    s_waitcnt lgkmcnt(6)
    ds_read_b64_tr_b16 v[72:73], v53 offset:49152
    v_mfma_f32_16x16x32_bf16 v[44:47], v[84:87], a[100:103], v[44:47]
    ds_read_b64_tr_b16 v[74:75], v57 offset:8192
    v_mfma_f32_16x16x32_bf16 v[44:47], v[88:91], a[4:7], v[44:47]
    buffer_load_dwordx4 a[92:95], v3, s[88:91], s37 offen
    v_mfma_f32_16x16x32_bf16 v[40:43], v[88:91], a[0:3], v[40:43]
    s_waitcnt vmcnt(19)
    ds_read_b64_tr_b16 v[76:77], v54 offset:0
    ds_read_b64_tr_b16 v[78:79], v54 offset:24576
    v_mfma_f32_16x16x32_bf16 v[40:43], v[84:87], a[96:99], v[40:43]
    s_waitcnt lgkmcnt(6)
    ds_read_b64_tr_b16 v[80:81], v54 offset:49152
    v_mfma_f32_16x16x32_bf16 v[16:19], v[60:63], a[8:11], v[16:19]
    s_add_u32 s37, s37, 1024
    ds_read_b64_tr_b16 v[82:83], v58 offset:8192
    v_mfma_f32_16x16x32_bf16 v[16:19], v[64:67], a[16:19], v[16:19]
    buffer_load_dwordx4 a[96:99], v2, s[88:91], s37 offen
    v_mfma_f32_16x16x32_bf16 v[20:23], v[64:67], a[20:23], v[20:23]
    ds_read_b64_tr_b16 v[84:85], v55 offset:0
    ds_read_b64_tr_b16 v[86:87], v55 offset:24576
    v_mfma_f32_16x16x32_bf16 v[20:23], v[60:63], a[12:15], v[20:23]
    s_waitcnt lgkmcnt(6)
    ds_read_b64_tr_b16 v[88:89], v55 offset:49152
    v_mfma_f32_16x16x32_bf16 v[28:31], v[68:71], a[12:15], v[28:31]
    ds_read_b64_tr_b16 v[90:91], v59 offset:8192
    v_mfma_f32_16x16x32_bf16 v[28:31], v[72:75], a[20:23], v[28:31]
    buffer_load_dwordx4 a[100:103], v3, s[88:91], s37 offen
    v_mfma_f32_16x16x32_bf16 v[24:27], v[72:75], a[16:19], v[24:27]
    ds_read_b64_tr_b16 v[60:61], v52 offset:2048
    ds_read_b64_tr_b16 v[62:63], v52 offset:26624
    v_mfma_f32_16x16x32_bf16 v[24:27], v[68:71], a[8:11], v[24:27]
    s_waitcnt lgkmcnt(6)
    ds_read_b64_tr_b16 v[64:65], v52 offset:51200
    v_mfma_f32_16x16x32_bf16 v[32:35], v[76:79], a[8:11], v[32:35]
    s_add_u32 s37, s37, 1024
    ds_read_b64_tr_b16 v[66:67], v56 offset:10240
    v_mfma_f32_16x16x32_bf16 v[32:35], v[80:83], a[16:19], v[32:35]
    buffer_load_dwordx4 a[0:3], v2, s[88:91], s37 offen sc1
    v_mfma_f32_16x16x32_bf16 v[36:39], v[80:83], a[20:23], v[36:39]
    ds_read_b64_tr_b16 v[68:69], v53 offset:2048
    ds_read_b64_tr_b16 v[70:71], v53 offset:26624
    v_mfma_f32_16x16x32_bf16 v[36:39], v[76:79], a[12:15], v[36:39]
    s_waitcnt lgkmcnt(6)
    ds_read_b64_tr_b16 v[72:73], v53 offset:51200
    v_mfma_f32_16x16x32_bf16 v[44:47], v[84:87], a[12:15], v[44:47]
    ds_read_b64_tr_b16 v[74:75], v57 offset:10240
    v_mfma_f32_16x16x32_bf16 v[44:47], v[88:91], a[20:23], v[44:47]
    buffer_load_dwordx4 a[4:7], v3, s[88:91], s37 offen sc1
    v_mfma_f32_16x16x32_bf16 v[40:43], v[88:91], a[16:19], v[40:43]
    s_waitcnt vmcnt(19)
    ds_read_b64_tr_b16 v[76:77], v54 offset:2048
    ds_read_b64_tr_b16 v[78:79], v54 offset:26624
    v_mfma_f32_16x16x32_bf16 v[40:43], v[84:87], a[8:11], v[40:43]
    s_waitcnt lgkmcnt(6)
    ds_read_b64_tr_b16 v[80:81], v54 offset:51200
    v_mfma_f32_16x16x32_bf16 v[16:19], v[60:63], a[24:27], v[16:19]
    s_add_u32 s37, s37, 1024
    ds_read_b64_tr_b16 v[82:83], v58 offset:10240
    v_mfma_f32_16x16x32_bf16 v[16:19], v[64:67], a[32:35], v[16:19]
    buffer_load_dwordx4 a[8:11], v2, s[88:91], s37 offen
    v_mfma_f32_16x16x32_bf16 v[20:23], v[64:67], a[36:39], v[20:23]
    ds_read_b64_tr_b16 v[84:85], v55 offset:2048
    ds_read_b64_tr_b16 v[86:87], v55 offset:26624
    v_mfma_f32_16x16x32_bf16 v[20:23], v[60:63], a[28:31], v[20:23]
    s_waitcnt lgkmcnt(6)
    ds_read_b64_tr_b16 v[88:89], v55 offset:51200
    v_mfma_f32_16x16x32_bf16 v[28:31], v[68:71], a[28:31], v[28:31]
    ds_read_b64_tr_b16 v[90:91], v59 offset:10240
    v_mfma_f32_16x16x32_bf16 v[28:31], v[72:75], a[36:39], v[28:31]
    buffer_load_dwordx4 a[12:15], v3, s[88:91], s37 offen
    v_mfma_f32_16x16x32_bf16 v[24:27], v[72:75], a[32:35], v[24:27]
    ds_read_b64_tr_b16 v[60:61], v52 offset:4096
    ds_read_b64_tr_b16 v[62:63], v52 offset:28672
    v_mfma_f32_16x16x32_bf16 v[24:27], v[68:71], a[24:27], v[24:27]
    s_waitcnt lgkmcnt(6)
    ds_read_b64_tr_b16 v[64:65], v52 offset:53248
    v_mfma_f32_16x16x32_bf16 v[32:35], v[76:79], a[24:27], v[32:35]
    s_add_u32 s37, s37, 1024
    ds_read_b64_tr_b16 v[66:67], v56 offset:12288
    s_waitcnt vmcnt(11)
    v_cmp_ne_u64 vcc, s[50:51], v[6:7]
    s_nop 1
    s_cmp_eq_u64 vcc, 0
    s_cbranch_scc1 f_s_rdyA
f_s_spinA:
    buffer_load_dwordx2 v[6:7], v11, s[96:99], s39 offen sc1
    s_waitcnt vmcnt(0)
    v_cmp_ne_u64 vcc, s[50:51], v[6:7]
    s_nop 1
    s_cmp_lg_u64 vcc, 0
    s_cbranch_scc1 f_s_spinA
f_s_rdyA:
    v_mfma_f32_16x16x32_bf16 v[32:35], v[80:83], a[32:35], v[32:35]
    buffer_load_dwordx4 a[16:19], v2, s[88:91], s37 offen
    v_mfma_f32_16x16x32_bf16 v[36:39], v[80:83], a[36:39], v[36:39]
    buffer_load_dwordx4 v[92:95], v15, s[20:23], s34 offen offset:0 sc1
    v_mfma_f32_16x16x32_bf16 v[36:39], v[76:79], a[28:31], v[36:39]
    s_waitcnt lgkmcnt(4)
    ds_read_b64_tr_b16 v[68:69], v53 offset:4096
    ds_read_b64_tr_b16 v[70:71], v53 offset:28672
    v_mfma_f32_16x16x32_bf16 v[44:47], v[84:87], a[28:31], v[44:47]
    ds_read_b64_tr_b16 v[72:73], v53 offset:53248
    ds_read_b64_tr_b16 v[74:75], v57 offset:12288
    v_mfma_f32_16x16x32_bf16 v[44:47], v[88:91], a[36:39], v[44:47]
    buffer_load_dwordx4 a[20:23], v3, s[88:91], s37 offen
    v_mfma_f32_16x16x32_bf16 v[40:43], v[88:91], a[32:35], v[40:43]
    ds_read_b64_tr_b16 v[76:77], v54 offset:4096
    ds_read_b64_tr_b16 v[78:79], v54 offset:28672
    v_mfma_f32_16x16x32_bf16 v[40:43], v[84:87], a[24:27], v[40:43]
    s_waitcnt lgkmcnt(6)
    s_add_u32 s37, s37, 1024
    ds_read_b64_tr_b16 v[80:81], v54 offset:53248
    v_mfma_f32_16x16x32_bf16 v[16:19], v[60:63], a[40:43], v[16:19]
    buffer_load_dwordx4 v[96:99], v15, s[20:23], s34 offen offset:1024 sc1
    v_mfma_f32_16x16x32_bf16 v[16:19], v[64:67], a[48:51], v[16:19]
    buffer_load_dwordx4 a[24:27], v2, s[88:91], s37 offen
    v_mfma_f32_16x16x32_bf16 v[20:23], v[64:67], a[52:55], v[20:23]
    s_add_u32 s34, s34, 0x8000
    buffer_load_dwordx4 v[100:103], v15, s[20:23], s34 offen offset:0 sc1
    v_mfma_f32_16x16x32_bf16 v[20:23], v[60:63], a[44:47], v[20:23]
    s_waitcnt lgkmcnt(3)
    ds_read_b64_tr_b16 v[82:83], v58 offset:12288
    ds_read_b64_tr_b16 v[84:85], v55 offset:4096
    v_mfma_f32_16x16x32_bf16 v[28:31], v[68:71], a[44:47], v[28:31]
    ds_read_b64_tr_b16 v[86:87], v55 offset:28672
    ds_read_b64_tr_b16 v[88:89], v55 offset:53248
    v_mfma_f32_16x16x32_bf16 v[28:31], v[72:75], a[52:55], v[28:31]
    buffer_load_dwordx4 a[28:31], v3, s[88:91], s37 offen
    v_mfma_f32_16x16x32_bf16 v[24:27], v[72:75], a[48:51], v[24:27]
    buffer_load_dwordx4 v[104:107], v15, s[20:23], s34 offen offset:1024 sc1
    v_mfma_f32_16x16x32_bf16 v[24:27], v[68:71], a[40:43], v[24:27]
    s_waitcnt lgkmcnt(3)
    ds_read_b64_tr_b16 v[90:91], v59 offset:12288
    ds_read_b64_tr_b16 v[60:61], v52 offset:6144
    v_mfma_f32_16x16x32_bf16 v[32:35], v[76:79], a[40:43], v[32:35]
    ds_read_b64_tr_b16 v[62:63], v52 offset:30720
    ds_read_b64_tr_b16 v[64:65], v52 offset:55296
    v_mfma_f32_16x16x32_bf16 v[32:35], v[80:83], a[48:51], v[32:35]
    s_add_u32 s34, s34, 4161536
    ds_read_b64_tr_b16 v[66:67], v56 offset:14336
    ds_read_b64_tr_b16 v[68:69], v53 offset:6144
    v_mfma_f32_16x16x32_bf16 v[36:39], v[80:83], a[52:55], v[36:39]
    buffer_load_dwordx4 v[108:111], v15, s[20:23], s34 offen offset:0 sc1
    v_mfma_f32_16x16x32_bf16 v[36:39], v[76:79], a[44:47], v[36:39]
    s_waitcnt lgkmcnt(5)
    ds_read_b64_tr_b16 v[70:71], v53 offset:30720
    ds_read_b64_tr_b16 v[72:73], v53 offset:55296
    v_mfma_f32_16x16x32_bf16 v[44:47], v[84:87], a[44:47], v[44:47]
    ds_read_b64_tr_b16 v[74:75], v57 offset:14336
    v_mfma_f32_16x16x32_bf16 v[44:47], v[88:91], a[52:55], v[44:47]
    ds_read_b64_tr_b16 v[76:77], v54 offset:6144
    v_mfma_f32_16x16x32_bf16 v[40:43], v[88:91], a[48:51], v[40:43]
    ds_read_b64_tr_b16 v[78:79], v54 offset:30720
    v_mfma_f32_16x16x32_bf16 v[40:43], v[84:87], a[40:43], v[40:43]
    s_waitcnt lgkmcnt(6)
    ds_read_b64_tr_b16 v[80:81], v54 offset:55296
    v_mfma_f32_16x16x32_bf16 v[16:19], v[60:63], a[56:59], v[16:19]
    buffer_load_dwordx4 v[112:115], v15, s[20:23], s34 offen offset:1024 sc1
    v_mfma_f32_16x16x32_bf16 v[16:19], v[64:67], a[64:67], v[16:19]
    s_add_u32 s34, s34, 0x8000
    ds_read_b64_tr_b16 v[82:83], v58 offset:14336
    ds_read_b64_tr_b16 v[84:85], v55 offset:6144
    v_mfma_f32_16x16x32_bf16 v[20:23], v[64:67], a[68:71], v[20:23]
    buffer_load_dwordx4 v[116:119], v15, s[20:23], s34 offen offset:0 sc1
    v_mfma_f32_16x16x32_bf16 v[20:23], v[60:63], a[60:63], v[20:23]
    s_waitcnt lgkmcnt(5)
    ds_read_b64_tr_b16 v[86:87], v55 offset:30720
    ds_read_b64_tr_b16 v[88:89], v55 offset:55296
    v_mfma_f32_16x16x32_bf16 v[28:31], v[68:71], a[60:63], v[28:31]
    ds_read_b64_tr_b16 v[90:91], v59 offset:14336
    v_mfma_f32_16x16x32_bf16 v[28:31], v[72:75], a[68:71], v[28:31]
    ds_read_b64_tr_b16 v[60:61], v52 offset:8192
    v_mfma_f32_16x16x32_bf16 v[24:27], v[72:75], a[64:67], v[24:27]
    buffer_load_dwordx4 v[120:123], v15, s[20:23], s34 offen offset:1024 sc1
    v_mfma_f32_16x16x32_bf16 v[24:27], v[68:71], a[56:59], v[24:27]
    s_waitcnt lgkmcnt(5)
    ds_read_b64_tr_b16 v[62:63], v52 offset:32768
    ds_read_b64_tr_b16 v[64:65], v52 offset:57344
    v_mfma_f32_16x16x32_bf16 v[32:35], v[76:79], a[56:59], v[32:35]
    ds_read_b64_tr_b16 v[66:67], v56 offset:16384
    v_mfma_f32_16x16x32_bf16 v[32:35], v[80:83], a[64:67], v[32:35]
    ds_read_b64_tr_b16 v[68:69], v53 offset:8192
    v_mfma_f32_16x16x32_bf16 v[36:39], v[80:83], a[68:71], v[36:39]
    ds_read_b64_tr_b16 v[70:71], v53 offset:32768
    v_mfma_f32_16x16x32_bf16 v[36:39], v[76:79], a[60:63], v[36:39]
    s_waitcnt lgkmcnt(6)
    ds_read_b64_tr_b16 v[72:73], v53 offset:57344
    v_mfma_f32_16x16x32_bf16 v[44:47], v[84:87], a[60:63], v[44:47]
    ds_read_b64_tr_b16 v[74:75], v57 offset:16384
    v_mfma_f32_16x16x32_bf16 v[44:47], v[88:91], a[68:71], v[44:47]
    ds_read_b64_tr_b16 v[76:77], v54 offset:8192
    v_mfma_f32_16x16x32_bf16 v[40:43], v[88:91], a[64:67], v[40:43]
    s_waitcnt vmcnt(20)
    ds_read_b64_tr_b16 v[78:79], v54 offset:32768
    v_mfma_f32_16x16x32_bf16 v[40:43], v[84:87], a[56:59], v[40:43]
    s_waitcnt lgkmcnt(6)
    ds_read_b64_tr_b16 v[80:81], v54 offset:57344
    v_mfma_f32_16x16x32_bf16 v[16:19], v[60:63], a[72:75], v[16:19]
    ds_read_b64_tr_b16 v[82:83], v58 offset:16384
    v_mfma_f32_16x16x32_bf16 v[16:19], v[64:67], a[80:83], v[16:19]
    ds_read_b64_tr_b16 v[84:85], v55 offset:8192
    v_mfma_f32_16x16x32_bf16 v[20:23], v[64:67], a[84:87], v[20:23]
    ds_read_b64_tr_b16 v[86:87], v55 offset:32768
    v_mfma_f32_16x16x32_bf16 v[20:23], v[60:63], a[76:79], v[20:23]
    s_waitcnt lgkmcnt(6)
    ds_read_b64_tr_b16 v[88:89], v55 offset:57344
    v_mfma_f32_16x16x32_bf16 v[28:31], v[68:71], a[76:79], v[28:31]
    ds_read_b64_tr_b16 v[90:91], v59 offset:16384
    v_mfma_f32_16x16x32_bf16 v[28:31], v[72:75], a[84:87], v[28:31]
    ds_read_b64_tr_b16 v[60:61], v52 offset:10240
    v_mfma_f32_16x16x32_bf16 v[24:27], v[72:75], a[80:83], v[24:27]
    ds_read_b64_tr_b16 v[62:63], v52 offset:34816
    v_mfma_f32_16x16x32_bf16 v[24:27], v[68:71], a[72:75], v[24:27]
    s_waitcnt lgkmcnt(6)
    ds_read_b64_tr_b16 v[64:65], v52 offset:59392
    v_mfma_f32_16x16x32_bf16 v[32:35], v[76:79], a[72:75], v[32:35]
    ds_read_b64_tr_b16 v[66:67], v56 offset:18432
    v_mfma_f32_16x16x32_bf16 v[32:35], v[80:83], a[80:83], v[32:35]
    ds_read_b64_tr_b16 v[68:69], v53 offset:10240
    v_mfma_f32_16x16x32_bf16 v[36:39], v[80:83], a[84:87], v[36:39]
    ds_read_b64_tr_b16 v[70:71], v53 offset:34816
    v_mfma_f32_16x16x32_bf16 v[36:39], v[76:79], a[76:79], v[36:39]
    s_waitcnt lgkmcnt(6)
    ds_read_b64_tr_b16 v[72:73], v53 offset:59392
    v_mfma_f32_16x16x32_bf16 v[44:47], v[84:87], a[76:79], v[44:47]
    ds_read_b64_tr_b16 v[74:75], v57 offset:18432
    v_mfma_f32_16x16x32_bf16 v[44:47], v[88:91], a[84:87], v[44:47]
    ds_read_b64_tr_b16 v[76:77], v54 offset:10240
    v_mfma_f32_16x16x32_bf16 v[40:43], v[88:91], a[80:83], v[40:43]
    s_waitcnt vmcnt(16)
    ds_read_b64_tr_b16 v[78:79], v54 offset:34816
    v_mfma_f32_16x16x32_bf16 v[40:43], v[84:87], a[72:75], v[40:43]
    s_waitcnt lgkmcnt(6)
    ds_read_b64_tr_b16 v[80:81], v54 offset:59392
    v_mfma_f32_16x16x32_bf16 v[16:19], v[60:63], a[88:91], v[16:19]
    ds_read_b64_tr_b16 v[82:83], v58 offset:18432
    v_mfma_f32_16x16x32_bf16 v[16:19], v[64:67], a[96:99], v[16:19]
    ds_read_b64_tr_b16 v[84:85], v55 offset:10240
    v_mfma_f32_16x16x32_bf16 v[20:23], v[64:67], a[100:103], v[20:23]
    ds_read_b64_tr_b16 v[86:87], v55 offset:34816
    v_mfma_f32_16x16x32_bf16 v[20:23], v[60:63], a[92:95], v[20:23]
    s_waitcnt lgkmcnt(6)
    ds_read_b64_tr_b16 v[88:89], v55 offset:59392
    v_mfma_f32_16x16x32_bf16 v[28:31], v[68:71], a[92:95], v[28:31]
    ds_read_b64_tr_b16 v[90:91], v59 offset:18432
    v_mfma_f32_16x16x32_bf16 v[28:31], v[72:75], a[100:103], v[28:31]
    ds_read_b64_tr_b16 v[60:61], v52 offset:12288
    v_mfma_f32_16x16x32_bf16 v[24:27], v[72:75], a[96:99], v[24:27]
    ds_read_b64_tr_b16 v[62:63], v52 offset:36864
    v_mfma_f32_16x16x32_bf16 v[24:27], v[68:71], a[88:91], v[24:27]
    s_waitcnt lgkmcnt(6)
    ds_read_b64_tr_b16 v[64:65], v52 offset:61440
    v_mfma_f32_16x16x32_bf16 v[32:35], v[76:79], a[88:91], v[32:35]
    ds_read_b64_tr_b16 v[66:67], v56 offset:20480
    v_mfma_f32_16x16x32_bf16 v[32:35], v[80:83], a[96:99], v[32:35]
    ds_read_b64_tr_b16 v[68:69], v53 offset:12288
    v_mfma_f32_16x16x32_bf16 v[36:39], v[80:83], a[100:103], v[36:39]
    ds_read_b64_tr_b16 v[70:71], v53 offset:36864
    v_mfma_f32_16x16x32_bf16 v[36:39], v[76:79], a[92:95], v[36:39]
    s_waitcnt lgkmcnt(6)
    ds_read_b64_tr_b16 v[72:73], v53 offset:61440
    v_mfma_f32_16x16x32_bf16 v[44:47], v[84:87], a[92:95], v[44:47]
    ds_read_b64_tr_b16 v[74:75], v57 offset:20480
    v_mfma_f32_16x16x32_bf16 v[44:47], v[88:91], a[100:103], v[44:47]
    ds_read_b64_tr_b16 v[76:77], v54 offset:12288
    v_mfma_f32_16x16x32_bf16 v[40:43], v[88:91], a[96:99], v[40:43]
    s_waitcnt vmcnt(12)
    ds_read_b64_tr_b16 v[78:79], v54 offset:36864
    v_mfma_f32_16x16x32_bf16 v[40:43], v[84:87], a[88:91], v[40:43]
    s_waitcnt lgkmcnt(6)
    ds_read_b64_tr_b16 v[80:81], v54 offset:61440
    v_mfma_f32_16x16x32_bf16 v[16:19], v[60:63], a[0:3], v[16:19]
    ds_read_b64_tr_b16 v[82:83], v58 offset:20480
    v_mfma_f32_16x16x32_bf16 v[16:19], v[64:67], a[8:11], v[16:19]
    ds_read_b64_tr_b16 v[84:85], v55 offset:12288
    v_mfma_f32_16x16x32_bf16 v[20:23], v[64:67], a[12:15], v[20:23]
    ds_read_b64_tr_b16 v[86:87], v55 offset:36864
    v_mfma_f32_16x16x32_bf16 v[20:23], v[60:63], a[4:7], v[20:23]
    s_waitcnt lgkmcnt(6)
    ds_read_b64_tr_b16 v[88:89], v55 offset:61440
    v_mfma_f32_16x16x32_bf16 v[28:31], v[68:71], a[4:7], v[28:31]
    ds_read_b64_tr_b16 v[90:91], v59 offset:20480
    v_mfma_f32_16x16x32_bf16 v[28:31], v[72:75], a[12:15], v[28:31]
    ds_read_b64_tr_b16 v[60:61], v52 offset:14336
    v_mfma_f32_16x16x32_bf16 v[24:27], v[72:75], a[8:11], v[24:27]
    ds_read_b64_tr_b16 v[62:63], v52 offset:38912
    v_mfma_f32_16x16x32_bf16 v[24:27], v[68:71], a[0:3], v[24:27]
    s_waitcnt lgkmcnt(6)
    ds_read_b64_tr_b16 v[64:65], v52 offset:63488
    v_mfma_f32_16x16x32_bf16 v[32:35], v[76:79], a[0:3], v[32:35]
    ds_read_b64_tr_b16 v[66:67], v56 offset:22528
    v_mfma_f32_16x16x32_bf16 v[32:35], v[80:83], a[8:11], v[32:35]
    ds_read_b64_tr_b16 v[68:69], v53 offset:14336
    v_mfma_f32_16x16x32_bf16 v[36:39], v[80:83], a[12:15], v[36:39]
    ds_read_b64_tr_b16 v[70:71], v53 offset:38912
    v_mfma_f32_16x16x32_bf16 v[36:39], v[76:79], a[4:7], v[36:39]
    s_waitcnt lgkmcnt(6)
    ds_read_b64_tr_b16 v[72:73], v53 offset:63488
    v_mfma_f32_16x16x32_bf16 v[44:47], v[84:87], a[4:7], v[44:47]
    ds_read_b64_tr_b16 v[74:75], v57 offset:22528
    v_mfma_f32_16x16x32_bf16 v[44:47], v[88:91], a[12:15], v[44:47]
    ds_read_b64_tr_b16 v[76:77], v54 offset:14336
    v_mfma_f32_16x16x32_bf16 v[40:43], v[88:91], a[8:11], v[40:43]
    s_waitcnt vmcnt(5)
    ds_read_b64_tr_b16 v[78:79], v54 offset:38912
    v_mfma_f32_16x16x32_bf16 v[40:43], v[84:87], a[0:3], v[40:43]
    s_waitcnt lgkmcnt(6)
    ds_read_b64_tr_b16 v[80:81], v54 offset:63488
    v_mfma_f32_16x16x32_bf16 v[16:19], v[60:63], a[16:19], v[16:19]
    ds_read_b64_tr_b16 v[82:83], v58 offset:22528
    v_mfma_f32_16x16x32_bf16 v[16:19], v[64:67], a[24:27], v[16:19]
    ds_read_b64_tr_b16 v[84:85], v55 offset:14336
    v_mfma_f32_16x16x32_bf16 v[20:23], v[64:67], a[28:31], v[20:23]
    ds_read_b64_tr_b16 v[86:87], v55 offset:38912
    v_mfma_f32_16x16x32_bf16 v[20:23], v[60:63], a[20:23], v[20:23]
    s_waitcnt lgkmcnt(6)
    ds_read_b64_tr_b16 v[88:89], v55 offset:63488
    v_mfma_f32_16x16x32_bf16 v[28:31], v[68:71], a[20:23], v[28:31]
    ds_read_b64_tr_b16 v[90:91], v59 offset:22528
    v_mfma_f32_16x16x32_bf16 v[28:31], v[72:75], a[28:31], v[28:31]
    v_mfma_f32_16x16x32_bf16 v[24:27], v[72:75], a[24:27], v[24:27]
    v_mfma_f32_16x16x32_bf16 v[24:27], v[68:71], a[16:19], v[24:27]
    s_waitcnt lgkmcnt(4)
    v_mfma_f32_16x16x32_bf16 v[32:35], v[76:79], a[16:19], v[32:35]
    v_mfma_f32_16x16x32_bf16 v[32:35], v[80:83], a[24:27], v[32:35]
    v_mfma_f32_16x16x32_bf16 v[36:39], v[80:83], a[28:31], v[36:39]
    v_mfma_f32_16x16x32_bf16 v[36:39], v[76:79], a[20:23], v[36:39]
    s_waitcnt lgkmcnt(0)
    v_mfma_f32_16x16x32_bf16 v[44:47], v[84:87], a[20:23], v[44:47]
    v_mfma_f32_16x16x32_bf16 v[44:47], v[88:91], a[28:31], v[44:47]
    v_mfma_f32_16x16x32_bf16 v[40:43], v[88:91], a[24:27], v[40:43]
    v_mfma_f32_16x16x32_bf16 v[40:43], v[84:87], a[16:19], v[40:43]
    s_branch f_fin
f_late_chk:
f_late_cmp:
    v_cmp_ne_u64 vcc, s[50:51], v[8:9]
    s_nop 1
    s_cmp_eq_u64 vcc, 0
    s_cbranch_scc1 f_late_ok
    buffer_load_dwordx2 v[8:9], v10, s[96:99], s42 offen sc1
    s_waitcnt vmcnt(0)
    s_branch f_late_cmp
f_late_ok:
    s_mov_b32 s42, 0x4000
    s_branch f_late_ret
f_g3:
    s_bfe_u32 s4, s31, 0x10001
    s_lshl_b32 s4, s4, 2
    s_and_b32 s34, s32, 3
    s_add_u32 s4, s4, s34
    s_and_b32 s5, s31, 1
    s_lshl_b32 s5, s5, 3
    s_lshr_b32 s34, s32, 2
    s_add_u32 s5, s5, s34
    s_add_u32 s12, s8, 20971520
    s_addc_u32 s13, s9, 0
    s_mov_b32 s14, 8388608
    s_mov_b32 s15, 0x20000
    s_add_u32 s16, s8, 62914560
    s_addc_u32 s17, s9, 0
    s_mov_b32 s18, 8388608
    s_mov_b32 s19, 0x20000
    s_add_u32 s20, s8, 46137344
    s_addc_u32 s21, s9, 0
    s_mov_b32 s22, 7340032
    s_mov_b32 s23, 0x20000
    s_add_u32 s36, s8, 4194304
    s_addc_u32 s37, s9, 0
    s_mov_b32 s38, 7340032
    s_mov_b32 s39, 0x20000
    s_mov_b32 s40, s10
    s_mov_b32 s41, s11
    s_mov_b32 s42, 4096
    s_mov_b32 s43, 0x20000
    v_bfe_u32 v8, v1, 4, 1
    v_lshlrev_b32 v8, 6, v8
    v_bfe_u32 v9, v1, 2, 2
    v_lshl_add_u32 v8, v9, 3, v8
    v_bfe_u32 v9, v1, 1, 1
    v_lshl_add_u32 v8, v9, 5, v8
    v_and_b32 v9, 3, v1
    v_lshlrev_b32 v9, 7, v9
    v_lshrrev_b32 v10, 5, v1
    v_lshl_add_u32 v9, v10, 12, v9
    v_add_u32 v11, 0, v8
    v_and_b32 v11, 127, v11
    v_add_u32 v144, v11, v9
    v_add_u32 v11, 32, v8
    v_and_b32 v11, 127, v11
    v_add_u32 v145, v11, v9
    s_lshl_b32 s27, s3, 12
    v_lshlrev_b32 v8, 4, v1
    v_add_u32 v160, s27, v8
    v_mov_b32 v161, 0x40000000
    v_cmp_gt_u32 vcc, 32, v1
    s_nop 1
    v_cndmask_b32 v161, v161, v160, vcc
    s_lshl_b32 s28, s5, 19
    s_sub_u32 s28, s28, 0x4000
    s_lshl_b32 s24, s4, 4
    s_lshl_b32 s25, s3, 2
    s_add_u32 s24, s24, s25
    s_lshl_b32 s26, s24, 16
    v_add_u32 v164, s26, v8
    v_add_u32 v165, 0x10000, v164
    v_add_u32 v166, 0x10000, v165
    v_add_u32 v167, 0x10000, v166
    s_mov_b32 s29, 0
    v_lshlrev_b32 v146, 3, v1
    s_mul_i32 s34, s24, 57344
    s_mul_i32 s35, s5, 3584
    s_add_u32 s34, s34, s35
    v_and_b32 v147, 15, v1
    v_lshlrev_b32 v147, 1, v147
    s_lshl_b32 s35, s24, 5
    buffer_load_ushort v128, v147, s[40:43], s35 offen offset:0
    buffer_load_ushort v129, v147, s[40:43], s35 offen offset:32
    buffer_load_ushort v130, v147, s[40:43], s35 offen offset:64
    buffer_load_ushort v131, v147, s[40:43], s35 offen offset:96
    s_sub_u32 s29, s29, 4096
    s_cmp_lg_u32 s3, 0
    s_cbranch_scc1 f_fl_rdyB
    v_cmp_ne_u64 vcc, s[50:51], v[168:169]
    v_cmp_ne_u64 s[30:31], s[50:51], v[170:171]
    s_nop 1
    s_or_b64 vcc, vcc, s[30:31]
    v_cmp_ne_u64 s[30:31], s[50:51], v[172:173]
    s_nop 1
    s_or_b64 vcc, vcc, s[30:31]
    v_cmp_ne_u64 s[30:31], s[50:51], v[174:175]
    s_nop 1
    s_or_b64 vcc, vcc, s[30:31]
    s_cmp_eq_u64 vcc, 0
    s_cbranch_scc1 f_f1_okB
    v_lshlrev_b32 v176, 5, v1
    v_add_u32 v176, 8192, v176
f_fl_spinB:
    buffer_load_dwordx4 v[168:171], v176, s[96:99], 0 offen sc1
    buffer_load_dwordx4 v[172:175], v176, s[96:99], 0 offen offset:16 sc1
    s_waitcnt vmcnt(0)
    v_cmp_ne_u64 vcc, s[50:51], v[168:169]
    v_cmp_ne_u64 s[30:31], s[50:51], v[170:171]
    s_nop 1
    s_or_b64 vcc, vcc, s[30:31]
    v_cmp_ne_u64 s[30:31], s[50:51], v[172:173]
    s_nop 1
    s_or_b64 vcc, vcc, s[30:31]
    v_cmp_ne_u64 s[30:31], s[50:51], v[174:175]
    s_nop 1
    s_or_b64 vcc, vcc, s[30:31]
    s_cmp_lg_u64 vcc, 0
    s_cbranch_scc1 f_fl_spinB
f_f1_okB:
f_fl_rdyB:
    s_barrier
    s_add_u32 s28, s28, 0x4000
    s_add_u32 m0, s27, 0
    s_nop 0
    buffer_load_dwordx4 v160, s[12:15], s28 offen offset:0 lds
    s_add_u32 m0, s27, 0
    s_nop 0
    buffer_load_dwordx4 v160, s[12:15], s28 offen offset:1024 lds
    s_add_u32 m0, s27, 0
    s_nop 0
    buffer_load_dwordx4 v160, s[12:15], s28 offen offset:2048 lds
    s_add_u32 m0, s27, 0
    s_nop 0
    buffer_load_dwordx4 v161, s[12:15], s28 offen offset:3072 lds
    s_add_u32 s29, s29, 4096
    buffer_load_dwordx4 a[0:3], v164, s[16:19], s29 offen offset:0
    buffer_load_dwordx4 a[4:7], v165, s[16:19], s29 offen offset:0
    buffer_load_dwordx4 a[8:11], v166, s[16:19], s29 offen offset:0
    buffer_load_dwordx4 a[12:15], v167, s[16:19], s29 offen offset:0
    buffer_load_dwordx4 a[16:19], v164, s[16:19], s29 offen offset:1024
    buffer_load_dwordx4 a[20:23], v165, s[16:19], s29 offen offset:1024
    buffer_load_dwordx4 a[24:27], v166, s[16:19], s29 offen offset:1024
    buffer_load_dwordx4 a[28:31], v167, s[16:19], s29 offen offset:1024
    buffer_load_dwordx4 a[32:35], v164, s[16:19], s29 offen offset:2048
    buffer_load_dwordx4 a[36:39], v165, s[16:19], s29 offen offset:2048
    buffer_load_dwordx4 a[40:43], v166, s[16:19], s29 offen offset:2048
    buffer_load_dwordx4 a[44:47], v167, s[16:19], s29 offen offset:2048
    buffer_load_dwordx4 a[48:51], v164, s[16:19], s29 offen offset:3072
    buffer_load_dwordx4 a[52:55], v165, s[16:19], s29 offen offset:3072
    buffer_load_dwordx4 a[56:59], v166, s[16:19], s29 offen offset:3072
    buffer_load_dwordx4 a[60:63], v167, s[16:19], s29 offen offset:3072
    s_add_u32 s28, s28, 0x4000
    s_add_u32 m0, s27, 16384
    s_nop 0
    buffer_load_dwordx4 v160, s[12:15], s28 offen offset:0 lds
    s_add_u32 m0, s27, 16384
    s_nop 0
    buffer_load_dwordx4 v160, s[12:15], s28 offen offset:1024 lds
    s_add_u32 m0, s27, 16384
    s_nop 0
    buffer_load_dwordx4 v160, s[12:15], s28 offen offset:2048 lds
    s_add_u32 m0, s27, 16384
    s_nop 0
    buffer_load_dwordx4 v161, s[12:15], s28 offen offset:3072 lds
    s_add_u32 s28, s28, 0x4000
    s_add_u32 m0, s27, 32768
    s_nop 0
    buffer_load_dwordx4 v160, s[12:15], s28 offen offset:0 lds
    s_waitcnt vmcnt(25)
    v_lshlrev_b32 v128, 16, v128
    v_lshlrev_b32 v129, 16, v129
    v_lshlrev_b32 v130, 16, v130
    v_lshlrev_b32 v131, 16, v131
    v_mov_b32 v16, v128
    v_mov_b32 v17, v128
    v_mov_b32 v18, v128
    v_mov_b32 v19, v128
    v_mov_b32 v20, v129
    v_mov_b32 v21, v129
    v_mov_b32 v22, v129
    v_mov_b32 v23, v129
    v_mov_b32 v24, v130
    v_mov_b32 v25, v130
    v_mov_b32 v26, v130
    v_mov_b32 v27, v130
    v_mov_b32 v28, v131
    v_mov_b32 v29, v131
    v_mov_b32 v30, v131
    v_mov_b32 v31, v131
    v_mov_b32 v32, v128
    v_mov_b32 v33, v128
    v_mov_b32 v34, v128
    v_mov_b32 v35, v128
    v_mov_b32 v36, v129
    v_mov_b32 v37, v129
    v_mov_b32 v38, v129
    v_mov_b32 v39, v129
    v_mov_b32 v40, v130
    v_mov_b32 v41, v130
    v_mov_b32 v42, v130
    v_mov_b32 v43, v130
    v_mov_b32 v44, v131
    v_mov_b32 v45, v131
    v_mov_b32 v46, v131
    v_mov_b32 v47, v131
    v_mov_b32 v48, v128
    v_mov_b32 v49, v128
    v_mov_b32 v50, v128
    v_mov_b32 v51, v128
    v_mov_b32 v52, v129
    v_mov_b32 v53, v129
    v_mov_b32 v54, v129
    v_mov_b32 v55, v129
    v_mov_b32 v56, v130
    v_mov_b32 v57, v130
    v_mov_b32 v58, v130
    v_mov_b32 v59, v130
    v_mov_b32 v60, v131
    v_mov_b32 v61, v131
    v_mov_b32 v62, v131
    v_mov_b32 v63, v131
    v_mov_b32 v64, v128
    v_mov_b32 v65, v128
    v_mov_b32 v66, v128
    v_mov_b32 v67, v128
    v_mov_b32 v68, v129
    v_mov_b32 v69, v129
    v_mov_b32 v70, v129
    v_mov_b32 v71, v129
    v_mov_b32 v72, v130
    v_mov_b32 v73, v130
    v_mov_b32 v74, v130
    v_mov_b32 v75, v130
    v_mov_b32 v76, v131
    v_mov_b32 v77, v131
    v_mov_b32 v78, v131
    v_mov_b32 v79, v131
    v_mov_b32 v80, v128
    v_mov_b32 v81, v128
    v_mov_b32 v82, v128
    v_mov_b32 v83, v128
    v_mov_b32 v84, v129
    v_mov_b32 v85, v129
    v_mov_b32 v86, v129
    v_mov_b32 v87, v129
    v_mov_b32 v88, v130
    v_mov_b32 v89, v130
    v_mov_b32 v90, v130
    v_mov_b32 v91, v130
    v_mov_b32 v92, v131
    v_mov_b32 v93, v131
    v_mov_b32 v94, v131
    v_mov_b32 v95, v131
    v_mov_b32 v96, v128
    v_mov_b32 v97, v128
    v_mov_b32 v98, v128
    v_mov_b32 v99, v128
    v_mov_b32 v100, v129
    v_mov_b32 v101, v129
    v_mov_b32 v102, v129
    v_mov_b32 v103, v129
    v_mov_b32 v104, v130
    v_mov_b32 v105, v130
    v_mov_b32 v106, v130
    v_mov_b32 v107, v130
    v_mov_b32 v108, v131
    v_mov_b32 v109, v131
    v_mov_b32 v110, v131
    v_mov_b32 v111, v131
    v_mov_b32 v112, v128
    v_mov_b32 v113, v128
    v_mov_b32 v114, v128
    v_mov_b32 v115, v128
    v_mov_b32 v116, v129
    v_mov_b32 v117, v129
    v_mov_b32 v118, v129
    v_mov_b32 v119, v129
    v_mov_b32 v120, v130
    v_mov_b32 v121, v130
    v_mov_b32 v122, v130
    v_mov_b32 v123, v130
    v_mov_b32 v124, v131
    v_mov_b32 v125, v131
    v_mov_b32 v126, v131
    v_mov_b32 v127, v131
    s_waitcnt vmcnt(21)
    s_barrier
    ds_read_b64_tr_b16 v[168:169], v144 offset:0
    ds_read_b64_tr_b16 v[170:171], v145 offset:0
    ds_read_b64_tr_b16 v[172:173], v144 offset:8192
    ds_read_b64_tr_b16 v[174:175], v145 offset:8192
    ds_read_b64_tr_b16 v[176:177], v144 offset:512
    ds_read_b64_tr_b16 v[178:179], v145 offset:512
    ds_read_b64_tr_b16 v[180:181], v144 offset:8704
    ds_read_b64_tr_b16 v[182:183], v145 offset:8704
    s_cmp_lg_u32 s3, 0
    s_cbranch_scc1 f_f2_skipB
    v_mov_b32 v8, s50
    v_mov_b32 v9, s51
    s_mov_b64 exec, 1
    buffer_store_dwordx2 v[8:9], off, s[96:99], s101 sc1
    s_mov_b64 exec, -1
f_f2_skipB:
    s_waitcnt vmcnt(13)
    s_waitcnt lgkmcnt(4)
    s_mov_b32 s30, 6
f_g3_loop:
    v_mfma_f32_16x16x32_bf16 v[16:19], v[168:171], a[0:3], v[16:19]
    s_add_u32 s29, s29, 4096
    ds_read_b64_tr_b16 v[184:185], v144 offset:1024
    v_mfma_f32_16x16x32_bf16 v[16:19], v[172:175], a[16:19], v[16:19]
    buffer_load_dwordx4 a[64:67], v164, s[16:19], s29 offen offset:0
    v_mfma_f32_16x16x32_bf16 v[20:23], v[172:175], a[20:23], v[20:23]
    ds_read_b64_tr_b16 v[186:187], v145 offset:1024
    v_mfma_f32_16x16x32_bf16 v[20:23], v[168:171], a[4:7], v[20:23]
    s_add_u32 m0, s27, 32768
    ds_read_b64_tr_b16 v[188:189], v144 offset:9216
    v_mfma_f32_16x16x32_bf16 v[24:27], v[168:171], a[8:11], v[24:27]
    buffer_load_dwordx4 v160, s[12:15], s28 offen offset:1024 lds
    v_mfma_f32_16x16x32_bf16 v[24:27], v[172:175], a[24:27], v[24:27]
    v_mfma_f32_16x16x32_bf16 v[28:31], v[172:175], a[28:31], v[28:31]
    ds_read_b64_tr_b16 v[190:191], v145 offset:9216
    v_mfma_f32_16x16x32_bf16 v[28:31], v[168:171], a[12:15], v[28:31]
    s_waitcnt lgkmcnt(4)
    ds_read_b64_tr_b16 v[192:193], v144 offset:1536
    v_mfma_f32_16x16x32_bf16 v[44:47], v[176:179], a[12:15], v[44:47]
    buffer_load_dwordx4 a[68:71], v165, s[16:19], s29 offen offset:0
    v_mfma_f32_16x16x32_bf16 v[44:47], v[180:183], a[28:31], v[44:47]
    v_mfma_f32_16x16x32_bf16 v[40:43], v[180:183], a[24:27], v[40:43]
    ds_read_b64_tr_b16 v[194:195], v145 offset:1536
    v_mfma_f32_16x16x32_bf16 v[40:43], v[176:179], a[8:11], v[40:43]
    ds_read_b64_tr_b16 v[196:197], v144 offset:9728
    v_mfma_f32_16x16x32_bf16 v[36:39], v[176:179], a[4:7], v[36:39]
    v_mfma_f32_16x16x32_bf16 v[36:39], v[180:183], a[20:23], v[36:39]
    ds_read_b64_tr_b16 v[198:199], v145 offset:9728
    v_mfma_f32_16x16x32_bf16 v[32:35], v[180:183], a[16:19], v[32:35]
    ds_read_b64_tr_b16 v[168:169], v144 offset:2048
    v_mfma_f32_16x16x32_bf16 v[32:35], v[176:179], a[0:3], v[32:35]
    s_waitcnt lgkmcnt(5)
    v_mfma_f32_16x16x32_bf16 v[48:51], v[184:187], a[0:3], v[48:51]
    buffer_load_dwordx4 a[72:75], v166, s[16:19], s29 offen offset:0
    v_mfma_f32_16x16x32_bf16 v[48:51], v[188:191], a[16:19], v[48:51]
    s_add_u32 m0, s27, 32768
    ds_read_b64_tr_b16 v[170:171], v145 offset:2048
    v_mfma_f32_16x16x32_bf16 v[52:55], v[188:191], a[20:23], v[52:55]
    buffer_load_dwordx4 v160, s[12:15], s28 offen offset:2048 lds
    v_mfma_f32_16x16x32_bf16 v[52:55], v[184:187], a[4:7], v[52:55]
    ds_read_b64_tr_b16 v[172:173], v144 offset:10240
    v_mfma_f32_16x16x32_bf16 v[56:59], v[184:187], a[8:11], v[56:59]
    ds_read_b64_tr_b16 v[174:175], v145 offset:10240
    v_mfma_f32_16x16x32_bf16 v[56:59], v[188:191], a[24:27], v[56:59]
    v_mfma_f32_16x16x32_bf16 v[60:63], v[188:191], a[28:31], v[60:63]
    buffer_load_dwordx4 a[76:79], v167, s[16:19], s29 offen offset:0
    v_mfma_f32_16x16x32_bf16 v[60:63], v[184:187], a[12:15], v[60:63]
    s_waitcnt lgkmcnt(4)
    ds_read_b64_tr_b16 v[176:177], v144 offset:2560
    v_mfma_f32_16x16x32_bf16 v[76:79], v[192:195], a[12:15], v[76:79]
    ds_read_b64_tr_b16 v[178:179], v145 offset:2560
    v_mfma_f32_16x16x32_bf16 v[76:79], v[196:199], a[28:31], v[76:79]
    v_mfma_f32_16x16x32_bf16 v[72:75], v[196:199], a[24:27], v[72:75]
    ds_read_b64_tr_b16 v[180:181], v144 offset:10752
    v_mfma_f32_16x16x32_bf16 v[72:75], v[192:195], a[8:11], v[72:75]
    ds_read_b64_tr_b16 v[182:183], v145 offset:10752
    v_mfma_f32_16x16x32_bf16 v[68:71], v[192:195], a[4:7], v[68:71]
    v_mfma_f32_16x16x32_bf16 v[68:71], v[196:199], a[20:23], v[68:71]
    buffer_load_dwordx4 a[80:83], v164, s[16:19], s29 offen offset:1024
    v_mfma_f32_16x16x32_bf16 v[64:67], v[196:199], a[16:19], v[64:67]
    s_add_u32 m0, s27, 32768
    ds_read_b64_tr_b16 v[184:185], v144 offset:3072
    v_mfma_f32_16x16x32_bf16 v[64:67], v[192:195], a[0:3], v[64:67]
    s_waitcnt lgkmcnt(5)
    ds_read_b64_tr_b16 v[186:187], v145 offset:3072
    v_mfma_f32_16x16x32_bf16 v[80:83], v[168:171], a[0:3], v[80:83]
    buffer_load_dwordx4 v161, s[12:15], s28 offen offset:3072 lds
    v_mfma_f32_16x16x32_bf16 v[80:83], v[172:175], a[16:19], v[80:83]
    v_mfma_f32_16x16x32_bf16 v[84:87], v[172:175], a[20:23], v[84:87]
    ds_read_b64_tr_b16 v[188:189], v144 offset:11264
    v_mfma_f32_16x16x32_bf16 v[84:87], v[168:171], a[4:7], v[84:87]
    ds_read_b64_tr_b16 v[190:191], v145 offset:11264
    v_mfma_f32_16x16x32_bf16 v[88:91], v[168:171], a[8:11], v[88:91]
    buffer_load_dwordx4 a[84:87], v165, s[16:19], s29 offen offset:1024
    v_mfma_f32_16x16x32_bf16 v[88:91], v[172:175], a[24:27], v[88:91]
    s_waitcnt vmcnt(10)
    v_mfma_f32_16x16x32_bf16 v[92:95], v[172:175], a[28:31], v[92:95]
    s_barrier
    v_mfma_f32_16x16x32_bf16 v[92:95], v[168:171], a[12:15], v[92:95]
    s_waitcnt lgkmcnt(4)
    ds_read_b64_tr_b16 v[192:193], v144 offset:16384
    v_mfma_f32_16x16x32_bf16 v[108:111], v[176:179], a[12:15], v[108:111]
    global_load_dword v5, v[6:7], off
    v_mfma_f32_16x16x32_bf16 v[108:111], v[180:183], a[28:31], v[108:111]
    ds_read_b64_tr_b16 v[194:195], v145 offset:16384
    v_mfma_f32_16x16x32_bf16 v[104:107], v[180:183], a[24:27], v[104:107]
    v_mfma_f32_16x16x32_bf16 v[104:107], v[176:179], a[8:11], v[104:107]
    buffer_load_dwordx4 a[88:91], v166, s[16:19], s29 offen offset:1024
    v_mfma_f32_16x16x32_bf16 v[100:103], v[176:179], a[4:7], v[100:103]
    s_add_u32 s28, s28, 0x4000
    ds_read_b64_tr_b16 v[196:197], v144 offset:24576
    v_mfma_f32_16x16x32_bf16 v[100:103], v[180:183], a[20:23], v[100:103]
    s_add_u32 m0, s27, 49152
    ds_read_b64_tr_b16 v[198:199], v145 offset:24576
    v_mfma_f32_16x16x32_bf16 v[96:99], v[180:183], a[16:19], v[96:99]
    buffer_load_dwordx4 v160, s[12:15], s28 offen offset:0 lds
    v_mfma_f32_16x16x32_bf16 v[96:99], v[176:179], a[0:3], v[96:99]
    s_waitcnt lgkmcnt(4)
    v_mfma_f32_16x16x32_bf16 v[112:115], v[184:187], a[0:3], v[112:115]
    ds_read_b64_tr_b16 v[168:169], v144 offset:16896
    v_mfma_f32_16x16x32_bf16 v[112:115], v[188:191], a[16:19], v[112:115]
    ds_read_b64_tr_b16 v[170:171], v145 offset:16896
    v_mfma_f32_16x16x32_bf16 v[116:119], v[188:191], a[20:23], v[116:119]
    buffer_load_dwordx4 a[92:95], v167, s[16:19], s29 offen offset:1024
    v_mfma_f32_16x16x32_bf16 v[116:119], v[184:187], a[4:7], v[116:119]
    v_mfma_f32_16x16x32_bf16 v[120:123], v[184:187], a[8:11], v[120:123]
    ds_read_b64_tr_b16 v[172:173], v144 offset:25088
    v_mfma_f32_16x16x32_bf16 v[120:123], v[188:191], a[24:27], v[120:123]
    ds_read_b64_tr_b16 v[174:175], v145 offset:25088
    v_mfma_f32_16x16x32_bf16 v[124:127], v[188:191], a[28:31], v[124:127]
    s_waitcnt vmcnt(13)
    v_mfma_f32_16x16x32_bf16 v[124:127], v[184:187], a[12:15], v[124:127]
    s_waitcnt lgkmcnt(4)
    ds_read_b64_tr_b16 v[176:177], v144 offset:17408
    v_mfma_f32_16x16x32_bf16 v[16:19], v[192:195], a[32:35], v[16:19]
    ds_read_b64_tr_b16 v[178:179], v145 offset:17408
    v_mfma_f32_16x16x32_bf16 v[16:19], v[196:199], a[48:51], v[16:19]
    buffer_load_dwordx4 a[96:99], v164, s[16:19], s29 offen offset:2048
    v_mfma_f32_16x16x32_bf16 v[20:23], v[196:199], a[52:55], v[20:23]
    v_mfma_f32_16x16x32_bf16 v[20:23], v[192:195], a[36:39], v[20:23]
    s_add_u32 m0, s27, 49152
    ds_read_b64_tr_b16 v[180:181], v144 offset:25600
    v_mfma_f32_16x16x32_bf16 v[24:27], v[192:195], a[40:43], v[24:27]
    buffer_load_dwordx4 v160, s[12:15], s28 offen offset:1024 lds
    v_mfma_f32_16x16x32_bf16 v[24:27], v[196:199], a[56:59], v[24:27]
    ds_read_b64_tr_b16 v[182:183], v145 offset:25600
    v_mfma_f32_16x16x32_bf16 v[28:31], v[196:199], a[60:63], v[28:31]
    v_mfma_f32_16x16x32_bf16 v[28:31], v[192:195], a[44:47], v[28:31]
    s_waitcnt lgkmcnt(4)
    ds_read_b64_tr_b16 v[184:185], v144 offset:17920
    v_mfma_f32_16x16x32_bf16 v[44:47], v[168:171], a[44:47], v[44:47]
    buffer_load_dwordx4 a[100:103], v165, s[16:19], s29 offen offset:2048
    v_mfma_f32_16x16x32_bf16 v[44:47], v[172:175], a[60:63], v[44:47]
    ds_read_b64_tr_b16 v[186:187], v145 offset:17920
    v_mfma_f32_16x16x32_bf16 v[40:43], v[172:175], a[56:59], v[40:43]
    v_mfma_f32_16x16x32_bf16 v[40:43], v[168:171], a[40:43], v[40:43]
    ds_read_b64_tr_b16 v[188:189], v144 offset:26112
    v_mfma_f32_16x16x32_bf16 v[36:39], v[168:171], a[36:39], v[36:39]
    ds_read_b64_tr_b16 v[190:191], v145 offset:26112
    v_mfma_f32_16x16x32_bf16 v[36:39], v[172:175], a[52:55], v[36:39]
    v_mfma_f32_16x16x32_bf16 v[32:35], v[172:175], a[48:51], v[32:35]
    ds_read_b64_tr_b16 v[192:193], v144 offset:18432
    v_mfma_f32_16x16x32_bf16 v[32:35], v[168:171], a[32:35], v[32:35]
    s_waitcnt lgkmcnt(5)
    ds_read_b64_tr_b16 v[194:195], v145 offset:18432
    v_mfma_f32_16x16x32_bf16 v[48:51], v[176:179], a[32:35], v[48:51]
    buffer_load_dwordx4 a[104:107], v166, s[16:19], s29 offen offset:2048
    v_mfma_f32_16x16x32_bf16 v[48:51], v[180:183], a[48:51], v[48:51]
    s_add_u32 m0, s27, 49152
    v_mfma_f32_16x16x32_bf16 v[52:55], v[180:183], a[52:55], v[52:55]
    buffer_load_dwordx4 v160, s[12:15], s28 offen offset:2048 lds
    v_mfma_f32_16x16x32_bf16 v[52:55], v[176:179], a[36:39], v[52:55]
    ds_read_b64_tr_b16 v[196:197], v144 offset:26624
    v_mfma_f32_16x16x32_bf16 v[56:59], v[176:179], a[40:43], v[56:59]
    ds_read_b64_tr_b16 v[198:199], v145 offset:26624
    v_mfma_f32_16x16x32_bf16 v[56:59], v[180:183], a[56:59], v[56:59]
    v_mfma_f32_16x16x32_bf16 v[60:63], v[180:183], a[60:63], v[60:63]
    buffer_load_dwordx4 a[108:111], v167, s[16:19], s29 offen offset:2048
    v_mfma_f32_16x16x32_bf16 v[60:63], v[176:179], a[44:47], v[60:63]
    s_waitcnt lgkmcnt(4)
    ds_read_b64_tr_b16 v[168:169], v144 offset:18944
    v_mfma_f32_16x16x32_bf16 v[76:79], v[184:187], a[44:47], v[76:79]
    ds_read_b64_tr_b16 v[170:171], v145 offset:18944
    v_mfma_f32_16x16x32_bf16 v[76:79], v[188:191], a[60:63], v[76:79]
    v_mfma_f32_16x16x32_bf16 v[72:75], v[188:191], a[56:59], v[72:75]
    ds_read_b64_tr_b16 v[172:173], v144 offset:27136
    v_mfma_f32_16x16x32_bf16 v[72:75], v[184:187], a[40:43], v[72:75]
    ds_read_b64_tr_b16 v[174:175], v145 offset:27136
    v_mfma_f32_16x16x32_bf16 v[68:71], v[184:187], a[36:39], v[68:71]
    v_mfma_f32_16x16x32_bf16 v[68:71], v[188:191], a[52:55], v[68:71]
    buffer_load_dwordx4 a[112:115], v164, s[16:19], s29 offen offset:3072
    v_mfma_f32_16x16x32_bf16 v[64:67], v[188:191], a[48:51], v[64:67]
    s_add_u32 m0, s27, 49152
    ds_read_b64_tr_b16 v[176:177], v144 offset:19456
    v_mfma_f32_16x16x32_bf16 v[64:67], v[184:187], a[32:35], v[64:67]
    s_waitcnt lgkmcnt(5)
    ds_read_b64_tr_b16 v[178:179], v145 offset:19456
    v_mfma_f32_16x16x32_bf16 v[80:83], v[192:195], a[32:35], v[80:83]
    buffer_load_dwordx4 v161, s[12:15], s28 offen offset:3072 lds
    v_mfma_f32_16x16x32_bf16 v[80:83], v[196:199], a[48:51], v[80:83]
    v_mfma_f32_16x16x32_bf16 v[84:87], v[196:199], a[52:55], v[84:87]
    ds_read_b64_tr_b16 v[180:181], v144 offset:27648
    v_mfma_f32_16x16x32_bf16 v[84:87], v[192:195], a[36:39], v[84:87]
    ds_read_b64_tr_b16 v[182:183], v145 offset:27648
    v_mfma_f32_16x16x32_bf16 v[88:91], v[192:195], a[40:43], v[88:91]
    buffer_load_dwordx4 a[116:119], v165, s[16:19], s29 offen offset:3072
    v_mfma_f32_16x16x32_bf16 v[88:91], v[196:199], a[56:59], v[88:91]
    s_waitcnt vmcnt(14)
    v_mfma_f32_16x16x32_bf16 v[92:95], v[196:199], a[60:63], v[92:95]
    s_barrier
    v_mfma_f32_16x16x32_bf16 v[92:95], v[192:195], a[44:47], v[92:95]
    s_waitcnt lgkmcnt(4)
    ds_read_b64_tr_b16 v[184:185], v144 offset:32768
    v_mfma_f32_16x16x32_bf16 v[108:111], v[168:171], a[44:47], v[108:111]
    ds_read_b64_tr_b16 v[186:187], v145 offset:32768
    v_mfma_f32_16x16x32_bf16 v[108:111], v[172:175], a[60:63], v[108:111]
    v_mfma_f32_16x16x32_bf16 v[104:107], v[172:175], a[56:59], v[104:107]
    ds_read_b64_tr_b16 v[188:189], v144 offset:40960
    v_mfma_f32_16x16x32_bf16 v[104:107], v[168:171], a[40:43], v[104:107]
    buffer_load_dwordx4 a[120:123], v166, s[16:19], s29 offen offset:3072
    v_mfma_f32_16x16x32_bf16 v[100:103], v[168:171], a[36:39], v[100:103]
    s_add_u32 s28, s28, 0x4000
    ds_read_b64_tr_b16 v[190:191], v145 offset:40960
    v_mfma_f32_16x16x32_bf16 v[100:103], v[172:175], a[52:55], v[100:103]
    s_add_u32 m0, s27, 0
    v_mfma_f32_16x16x32_bf16 v[96:99], v[172:175], a[48:51], v[96:99]
    buffer_load_dwordx4 v160, s[12:15], s28 offen offset:0 lds
    v_mfma_f32_16x16x32_bf16 v[96:99], v[168:171], a[32:35], v[96:99]
    s_waitcnt lgkmcnt(4)
    ds_read_b64_tr_b16 v[192:193], v144 offset:33280
    v_mfma_f32_16x16x32_bf16 v[112:115], v[176:179], a[32:35], v[112:115]
    ds_read_b64_tr_b16 v[194:195], v145 offset:33280
    v_mfma_f32_16x16x32_bf16 v[112:115], v[180:183], a[48:51], v[112:115]
    v_mfma_f32_16x16x32_bf16 v[116:119], v[180:183], a[52:55], v[116:119]
    buffer_load_dwordx4 a[124:127], v167, s[16:19], s29 offen offset:3072
    v_mfma_f32_16x16x32_bf16 v[116:119], v[176:179], a[36:39], v[116:119]
    ds_read_b64_tr_b16 v[196:197], v144 offset:41472
    v_mfma_f32_16x16x32_bf16 v[120:123], v[176:179], a[40:43], v[120:123]
    ds_read_b64_tr_b16 v[198:199], v145 offset:41472
    v_mfma_f32_16x16x32_bf16 v[120:123], v[180:183], a[56:59], v[120:123]
    v_mfma_f32_16x16x32_bf16 v[124:127], v[180:183], a[60:63], v[124:127]
    s_waitcnt vmcnt(12)
    ds_read_b64_tr_b16 v[168:169], v144 offset:33792
    v_mfma_f32_16x16x32_bf16 v[124:127], v[176:179], a[44:47], v[124:127]
    s_waitcnt lgkmcnt(5)
    ds_read_b64_tr_b16 v[170:171], v145 offset:33792
    v_mfma_f32_16x16x32_bf16 v[16:19], v[184:187], a[64:67], v[16:19]
    s_add_u32 s29, s29, 4096
    v_mfma_f32_16x16x32_bf16 v[16:19], v[188:191], a[80:83], v[16:19]
    buffer_load_dwordx4 a[0:3], v164, s[16:19], s29 offen offset:0
    v_mfma_f32_16x16x32_bf16 v[20:23], v[188:191], a[84:87], v[20:23]
    ds_read_b64_tr_b16 v[172:173], v144 offset:41984
    v_mfma_f32_16x16x32_bf16 v[20:23], v[184:187], a[68:71], v[20:23]
    s_add_u32 m0, s27, 0
    ds_read_b64_tr_b16 v[174:175], v145 offset:41984
    v_mfma_f32_16x16x32_bf16 v[24:27], v[184:187], a[72:75], v[24:27]
    buffer_load_dwordx4 v160, s[12:15], s28 offen offset:1024 lds
    v_mfma_f32_16x16x32_bf16 v[24:27], v[188:191], a[88:91], v[24:27]
    v_mfma_f32_16x16x32_bf16 v[28:31], v[188:191], a[92:95], v[28:31]
    ds_read_b64_tr_b16 v[176:177], v144 offset:34304
    v_mfma_f32_16x16x32_bf16 v[28:31], v[184:187], a[76:79], v[28:31]
    s_waitcnt lgkmcnt(5)
    ds_read_b64_tr_b16 v[178:179], v145 offset:34304
    v_mfma_f32_16x16x32_bf16 v[44:47], v[192:195], a[76:79], v[44:47]
    buffer_load_dwordx4 a[4:7], v165, s[16:19], s29 offen offset:0
    v_mfma_f32_16x16x32_bf16 v[44:47], v[196:199], a[92:95], v[44:47]
    v_mfma_f32_16x16x32_bf16 v[40:43], v[196:199], a[88:91], v[40:43]
    ds_read_b64_tr_b16 v[180:181], v144 offset:42496
    v_mfma_f32_16x16x32_bf16 v[40:43], v[192:195], a[72:75], v[40:43]
    v_mfma_f32_16x16x32_bf16 v[36:39], v[192:195], a[68:71], v[36:39]
    ds_read_b64_tr_b16 v[182:183], v145 offset:42496
    v_mfma_f32_16x16x32_bf16 v[36:39], v[196:199], a[84:87], v[36:39]
    ds_read_b64_tr_b16 v[184:185], v144 offset:34816
    v_mfma_f32_16x16x32_bf16 v[32:35], v[196:199], a[80:83], v[32:35]
    v_mfma_f32_16x16x32_bf16 v[32:35], v[192:195], a[64:67], v[32:35]
    s_waitcnt lgkmcnt(5)
    ds_read_b64_tr_b16 v[186:187], v145 offset:34816
    v_mfma_f32_16x16x32_bf16 v[48:51], v[168:171], a[64:67], v[48:51]
    buffer_load_dwordx4 a[8:11], v166, s[16:19], s29 offen offset:0
    v_mfma_f32_16x16x32_bf16 v[48:51], v[172:175], a[80:83], v[48:51]
    s_add_u32 m0, s27, 0
    ds_read_b64_tr_b16 v[188:189], v144 offset:43008
    v_mfma_f32_16x16x32_bf16 v[52:55], v[172:175], a[84:87], v[52:55]
    buffer_load_dwordx4 v160, s[12:15], s28 offen offset:2048 lds
    v_mfma_f32_16x16x32_bf16 v[52:55], v[168:171], a[68:71], v[52:55]
    v_mfma_f32_16x16x32_bf16 v[56:59], v[168:171], a[72:75], v[56:59]
    ds_read_b64_tr_b16 v[190:191], v145 offset:43008
    v_mfma_f32_16x16x32_bf16 v[56:59], v[172:175], a[88:91], v[56:59]
    ds_read_b64_tr_b16 v[192:193], v144 offset:35328
    v_mfma_f32_16x16x32_bf16 v[60:63], v[172:175], a[92:95], v[60:63]
    buffer_load_dwordx4 a[12:15], v167, s[16:19], s29 offen offset:0
    v_mfma_f32_16x16x32_bf16 v[60:63], v[168:171], a[76:79], v[60:63]
    s_waitcnt lgkmcnt(5)
    v_mfma_f32_16x16x32_bf16 v[76:79], v[176:179], a[76:79], v[76:79]
    ds_read_b64_tr_b16 v[194:195], v145 offset:35328
    v_mfma_f32_16x16x32_bf16 v[76:79], v[180:183], a[92:95], v[76:79]
    ds_read_b64_tr_b16 v[196:197], v144 offset:43520
    v_mfma_f32_16x16x32_bf16 v[72:75], v[180:183], a[88:91], v[72:75]
    v_mfma_f32_16x16x32_bf16 v[72:75], v[176:179], a[72:75], v[72:75]
    ds_read_b64_tr_b16 v[198:199], v145 offset:43520
    v_mfma_f32_16x16x32_bf16 v[68:71], v[176:179], a[68:71], v[68:71]
    ds_read_b64_tr_b16 v[168:169], v144 offset:35840
    v_mfma_f32_16x16x32_bf16 v[68:71], v[180:183], a[84:87], v[68:71]
    buffer_load_dwordx4 a[16:19], v164, s[16:19], s29 offen offset:1024
    v_mfma_f32_16x16x32_bf16 v[64:67], v[180:183], a[80:83], v[64:67]
    s_add_u32 m0, s27, 0
    v_mfma_f32_16x16x32_bf16 v[64:67], v[176:179], a[64:67], v[64:67]
    s_waitcnt lgkmcnt(5)
    ds_read_b64_tr_b16 v[170:171], v145 offset:35840
    v_mfma_f32_16x16x32_bf16 v[80:83], v[184:187], a[64:67], v[80:83]
    buffer_load_dwordx4 v161, s[12:15], s28 offen offset:3072 lds
    v_mfma_f32_16x16x32_bf16 v[80:83], v[188:191], a[80:83], v[80:83]
    ds_read_b64_tr_b16 v[172:173], v144 offset:44032
    v_mfma_f32_16x16x32_bf16 v[84:87], v[188:191], a[84:87], v[84:87]
    v_mfma_f32_16x16x32_bf16 v[84:87], v[184:187], a[68:71], v[84:87]
    ds_read_b64_tr_b16 v[174:175], v145 offset:44032
    v_mfma_f32_16x16x32_bf16 v[88:91], v[184:187], a[72:75], v[88:91]
    buffer_load_dwordx4 a[20:23], v165, s[16:19], s29 offen offset:1024
    v_mfma_f32_16x16x32_bf16 v[88:91], v[188:191], a[88:91], v[88:91]
    s_waitcnt vmcnt(13)
    v_mfma_f32_16x16x32_bf16 v[92:95], v[188:191], a[92:95], v[92:95]
    s_barrier
    v_mfma_f32_16x16x32_bf16 v[92:95], v[184:187], a[76:79], v[92:95]
    s_waitcnt lgkmcnt(4)
    ds_read_b64_tr_b16 v[176:177], v144 offset:49152
    v_mfma_f32_16x16x32_bf16 v[108:111], v[192:195], a[76:79], v[108:111]
    ds_read_b64_tr_b16 v[178:179], v145 offset:49152
    v_mfma_f32_16x16x32_bf16 v[108:111], v[196:199], a[92:95], v[108:111]
    v_mfma_f32_16x16x32_bf16 v[104:107], v[196:199], a[88:91], v[104:107]
    ds_read_b64_tr_b16 v[180:181], v144 offset:57344
    v_mfma_f32_16x16x32_bf16 v[104:107], v[192:195], a[72:75], v[104:107]
    buffer_load_dwordx4 a[24:27], v166, s[16:19], s29 offen offset:1024
    v_mfma_f32_16x16x32_bf16 v[100:103], v[192:195], a[68:71], v[100:103]
    s_add_u32 s28, s28, 0x4000
    ds_read_b64_tr_b16 v[182:183], v145 offset:57344
    v_mfma_f32_16x16x32_bf16 v[100:103], v[196:199], a[84:87], v[100:103]
    s_add_u32 m0, s27, 16384
    v_mfma_f32_16x16x32_bf16 v[96:99], v[196:199], a[80:83], v[96:99]
    buffer_load_dwordx4 v160, s[12:15], s28 offen offset:0 lds
    v_mfma_f32_16x16x32_bf16 v[96:99], v[192:195], a[64:67], v[96:99]
    s_waitcnt lgkmcnt(4)
    ds_read_b64_tr_b16 v[184:185], v144 offset:49664
    v_mfma_f32_16x16x32_bf16 v[112:115], v[168:171], a[64:67], v[112:115]
    ds_read_b64_tr_b16 v[186:187], v145 offset:49664
    v_mfma_f32_16x16x32_bf16 v[112:115], v[172:175], a[80:83], v[112:115]
    v_mfma_f32_16x16x32_bf16 v[116:119], v[172:175], a[84:87], v[116:119]
    buffer_load_dwordx4 a[28:31], v167, s[16:19], s29 offen offset:1024
    v_mfma_f32_16x16x32_bf16 v[116:119], v[168:171], a[68:71], v[116:119]
    ds_read_b64_tr_b16 v[188:189], v144 offset:57856
    v_mfma_f32_16x16x32_bf16 v[120:123], v[168:171], a[72:75], v[120:123]
    ds_read_b64_tr_b16 v[190:191], v145 offset:57856
    v_mfma_f32_16x16x32_bf16 v[120:123], v[172:175], a[88:91], v[120:123]
    v_mfma_f32_16x16x32_bf16 v[124:127], v[172:175], a[92:95], v[124:127]
    s_waitcnt vmcnt(12)
    ds_read_b64_tr_b16 v[192:193], v144 offset:50176
    v_mfma_f32_16x16x32_bf16 v[124:127], v[168:171], a[76:79], v[124:127]
    s_waitcnt lgkmcnt(5)
    ds_read_b64_tr_b16 v[194:195], v145 offset:50176
    v_mfma_f32_16x16x32_bf16 v[16:19], v[176:179], a[96:99], v[16:19]
    v_mfma_f32_16x16x32_bf16 v[16:19], v[180:183], a[112:115], v[16:19]
    buffer_load_dwordx4 a[32:35], v164, s[16:19], s29 offen offset:2048
    v_mfma_f32_16x16x32_bf16 v[20:23], v[180:183], a[116:119], v[20:23]
    ds_read_b64_tr_b16 v[196:197], v144 offset:58368
    v_mfma_f32_16x16x32_bf16 v[20:23], v[176:179], a[100:103], v[20:23]
    s_add_u32 m0, s27, 16384
    ds_read_b64_tr_b16 v[198:199], v145 offset:58368
    v_mfma_f32_16x16x32_bf16 v[24:27], v[176:179], a[104:107], v[24:27]
    buffer_load_dwordx4 v160, s[12:15], s28 offen offset:1024 lds
    v_mfma_f32_16x16x32_bf16 v[24:27], v[180:183], a[120:123], v[24:27]
    v_mfma_f32_16x16x32_bf16 v[28:31], v[180:183], a[124:127], v[28:31]
    ds_read_b64_tr_b16 v[168:169], v144 offset:50688
    v_mfma_f32_16x16x32_bf16 v[28:31], v[176:179], a[108:111], v[28:31]
    s_waitcnt lgkmcnt(5)
    ds_read_b64_tr_b16 v[170:171], v145 offset:50688
    v_mfma_f32_16x16x32_bf16 v[44:47], v[184:187], a[108:111], v[44:47]
    buffer_load_dwordx4 a[36:39], v165, s[16:19], s29 offen offset:2048
    v_mfma_f32_16x16x32_bf16 v[44:47], v[188:191], a[124:127], v[44:47]
    v_mfma_f32_16x16x32_bf16 v[40:43], v[188:191], a[120:123], v[40:43]
    ds_read_b64_tr_b16 v[172:173], v144 offset:58880
    v_mfma_f32_16x16x32_bf16 v[40:43], v[184:187], a[104:107], v[40:43]
    v_mfma_f32_16x16x32_bf16 v[36:39], v[184:187], a[100:103], v[36:39]
    ds_read_b64_tr_b16 v[174:175], v145 offset:58880
    v_mfma_f32_16x16x32_bf16 v[36:39], v[188:191], a[116:119], v[36:39]
    ds_read_b64_tr_b16 v[176:177], v144 offset:51200
    v_mfma_f32_16x16x32_bf16 v[32:35], v[188:191], a[112:115], v[32:35]
    v_mfma_f32_16x16x32_bf16 v[32:35], v[184:187], a[96:99], v[32:35]
    s_waitcnt lgkmcnt(5)
    ds_read_b64_tr_b16 v[178:179], v145 offset:51200
    v_mfma_f32_16x16x32_bf16 v[48:51], v[192:195], a[96:99], v[48:51]
    buffer_load_dwordx4 a[40:43], v166, s[16:19], s29 offen offset:2048
    v_mfma_f32_16x16x32_bf16 v[48:51], v[196:199], a[112:115], v[48:51]
    s_add_u32 m0, s27, 16384
    ds_read_b64_tr_b16 v[180:181], v144 offset:59392
    v_mfma_f32_16x16x32_bf16 v[52:55], v[196:199], a[116:119], v[52:55]
    buffer_load_dwordx4 v160, s[12:15], s28 offen offset:2048 lds
    v_mfma_f32_16x16x32_bf16 v[52:55], v[192:195], a[100:103], v[52:55]
    v_mfma_f32_16x16x32_bf16 v[56:59], v[192:195], a[104:107], v[56:59]
    ds_read_b64_tr_b16 v[182:183], v145 offset:59392
    v_mfma_f32_16x16x32_bf16 v[56:59], v[196:199], a[120:123], v[56:59]
    ds_read_b64_tr_b16 v[184:185], v144 offset:51712
    v_mfma_f32_16x16x32_bf16 v[60:63], v[196:199], a[124:127], v[60:63]
    buffer_load_dwordx4 a[44:47], v167, s[16:19], s29 offen offset:2048
    v_mfma_f32_16x16x32_bf16 v[60:63], v[192:195], a[108:111], v[60:63]
    s_waitcnt lgkmcnt(5)
    v_mfma_f32_16x16x32_bf16 v[76:79], v[168:171], a[108:111], v[76:79]
    ds_read_b64_tr_b16 v[186:187], v145 offset:51712
    v_mfma_f32_16x16x32_bf16 v[76:79], v[172:175], a[124:127], v[76:79]
    ds_read_b64_tr_b16 v[188:189], v144 offset:59904
    v_mfma_f32_16x16x32_bf16 v[72:75], v[172:175], a[120:123], v[72:75]
    v_mfma_f32_16x16x32_bf16 v[72:75], v[168:171], a[104:107], v[72:75]
    ds_read_b64_tr_b16 v[190:191], v145 offset:59904
    v_mfma_f32_16x16x32_bf16 v[68:71], v[168:171], a[100:103], v[68:71]
    ds_read_b64_tr_b16 v[192:193], v144 offset:52224
    v_mfma_f32_16x16x32_bf16 v[68:71], v[172:175], a[116:119], v[68:71]
    buffer_load_dwordx4 a[48:51], v164, s[16:19], s29 offen offset:3072
    v_mfma_f32_16x16x32_bf16 v[64:67], v[172:175], a[112:115], v[64:67]
    s_add_u32 m0, s27, 16384
    v_mfma_f32_16x16x32_bf16 v[64:67], v[168:171], a[96:99], v[64:67]
    s_waitcnt lgkmcnt(5)
    ds_read_b64_tr_b16 v[194:195], v145 offset:52224
    v_mfma_f32_16x16x32_bf16 v[80:83], v[176:179], a[96:99], v[80:83]
    buffer_load_dwordx4 v161, s[12:15], s28 offen offset:3072 lds
    v_mfma_f32_16x16x32_bf16 v[80:83], v[180:183], a[112:115], v[80:83]
    ds_read_b64_tr_b16 v[196:197], v144 offset:60416
    v_mfma_f32_16x16x32_bf16 v[84:87], v[180:183], a[116:119], v[84:87]
    v_mfma_f32_16x16x32_bf16 v[84:87], v[176:179], a[100:103], v[84:87]
    ds_read_b64_tr_b16 v[198:199], v145 offset:60416
    v_mfma_f32_16x16x32_bf16 v[88:91], v[176:179], a[104:107], v[88:91]
    buffer_load_dwordx4 a[52:55], v165, s[16:19], s29 offen offset:3072
    v_mfma_f32_16x16x32_bf16 v[88:91], v[180:183], a[120:123], v[88:91]
    s_waitcnt vmcnt(13)
    v_mfma_f32_16x16x32_bf16 v[92:95], v[180:183], a[124:127], v[92:95]
    s_barrier
    v_mfma_f32_16x16x32_bf16 v[92:95], v[176:179], a[108:111], v[92:95]
    s_waitcnt lgkmcnt(4)
    ds_read_b64_tr_b16 v[168:169], v144 offset:0
    v_mfma_f32_16x16x32_bf16 v[108:111], v[184:187], a[108:111], v[108:111]
    ds_read_b64_tr_b16 v[170:171], v145 offset:0
    v_mfma_f32_16x16x32_bf16 v[108:111], v[188:191], a[124:127], v[108:111]
    v_mfma_f32_16x16x32_bf16 v[104:107], v[188:191], a[120:123], v[104:107]
    ds_read_b64_tr_b16 v[172:173], v144 offset:8192
    v_mfma_f32_16x16x32_bf16 v[104:107], v[184:187], a[104:107], v[104:107]
    buffer_load_dwordx4 a[56:59], v166, s[16:19], s29 offen offset:3072
    v_mfma_f32_16x16x32_bf16 v[100:103], v[184:187], a[100:103], v[100:103]
    s_add_u32 s28, s28, 0x4000
    v_mfma_f32_16x16x32_bf16 v[100:103], v[188:191], a[116:119], v[100:103]
    s_add_u32 m0, s27, 32768
    ds_read_b64_tr_b16 v[174:175], v145 offset:8192
    v_mfma_f32_16x16x32_bf16 v[96:99], v[188:191], a[112:115], v[96:99]
    buffer_load_dwordx4 v160, s[12:15], s28 offen offset:0 lds
    v_mfma_f32_16x16x32_bf16 v[96:99], v[184:187], a[96:99], v[96:99]
    s_waitcnt lgkmcnt(4)
    v_mfma_f32_16x16x32_bf16 v[112:115], v[192:195], a[96:99], v[112:115]
    ds_read_b64_tr_b16 v[176:177], v144 offset:512
    v_mfma_f32_16x16x32_bf16 v[112:115], v[196:199], a[112:115], v[112:115]
    ds_read_b64_tr_b16 v[178:179], v145 offset:512
    v_mfma_f32_16x16x32_bf16 v[116:119], v[196:199], a[116:119], v[116:119]
    buffer_load_dwordx4 a[60:63], v167, s[16:19], s29 offen offset:3072
    v_mfma_f32_16x16x32_bf16 v[116:119], v[192:195], a[100:103], v[116:119]
    v_mfma_f32_16x16x32_bf16 v[120:123], v[192:195], a[104:107], v[120:123]
    ds_read_b64_tr_b16 v[180:181], v144 offset:8704
    v_mfma_f32_16x16x32_bf16 v[120:123], v[196:199], a[120:123], v[120:123]
    v_mfma_f32_16x16x32_bf16 v[124:127], v[196:199], a[124:127], v[124:127]
    s_waitcnt vmcnt(12)
    ds_read_b64_tr_b16 v[182:183], v145 offset:8704
    v_mfma_f32_16x16x32_bf16 v[124:127], v[192:195], a[108:111], v[124:127]
    s_waitcnt lgkmcnt(4)
    s_sub_u32 s30, s30, 1
    s_cmp_lg_u32 s30, 0
    s_cbranch_scc1 f_g3_loop
    v_mfma_f32_16x16x32_bf16 v[16:19], v[168:171], a[0:3], v[16:19]
    s_add_u32 s29, s29, 4096
    ds_read_b64_tr_b16 v[184:185], v144 offset:1024
    v_mfma_f32_16x16x32_bf16 v[16:19], v[172:175], a[16:19], v[16:19]
    buffer_load_dwordx4 a[64:67], v164, s[16:19], s29 offen offset:0
    v_mfma_f32_16x16x32_bf16 v[20:23], v[172:175], a[20:23], v[20:23]
    ds_read_b64_tr_b16 v[186:187], v145 offset:1024
    v_mfma_f32_16x16x32_bf16 v[20:23], v[168:171], a[4:7], v[20:23]
    s_add_u32 m0, s27, 32768
    ds_read_b64_tr_b16 v[188:189], v144 offset:9216
    v_mfma_f32_16x16x32_bf16 v[24:27], v[168:171], a[8:11], v[24:27]
    buffer_load_dwordx4 v160, s[12:15], s28 offen offset:1024 lds
    v_mfma_f32_16x16x32_bf16 v[24:27], v[172:175], a[24:27], v[24:27]
    v_mfma_f32_16x16x32_bf16 v[28:31], v[172:175], a[28:31], v[28:31]
    ds_read_b64_tr_b16 v[190:191], v145 offset:9216
    v_mfma_f32_16x16x32_bf16 v[28:31], v[168:171], a[12:15], v[28:31]
    s_waitcnt lgkmcnt(4)
    ds_read_b64_tr_b16 v[192:193], v144 offset:1536
    v_mfma_f32_16x16x32_bf16 v[44:47], v[176:179], a[12:15], v[44:47]
    buffer_load_dwordx4 a[68:71], v165, s[16:19], s29 offen offset:0
    v_mfma_f32_16x16x32_bf16 v[44:47], v[180:183], a[28:31], v[44:47]
    v_mfma_f32_16x16x32_bf16 v[40:43], v[180:183], a[24:27], v[40:43]
    ds_read_b64_tr_b16 v[194:195], v145 offset:1536
    v_mfma_f32_16x16x32_bf16 v[40:43], v[176:179], a[8:11], v[40:43]
    ds_read_b64_tr_b16 v[196:197], v144 offset:9728
    v_mfma_f32_16x16x32_bf16 v[36:39], v[176:179], a[4:7], v[36:39]
    ds_read_b64_tr_b16 v[198:199], v145 offset:9728
    v_mfma_f32_16x16x32_bf16 v[36:39], v[180:183], a[20:23], v[36:39]
    v_mfma_f32_16x16x32_bf16 v[32:35], v[180:183], a[16:19], v[32:35]
    ds_read_b64_tr_b16 v[168:169], v144 offset:2048
    v_mfma_f32_16x16x32_bf16 v[32:35], v[176:179], a[0:3], v[32:35]
    s_waitcnt lgkmcnt(5)
    ds_read_b64_tr_b16 v[170:171], v145 offset:2048
    v_mfma_f32_16x16x32_bf16 v[48:51], v[184:187], a[0:3], v[48:51]
    buffer_load_dwordx4 a[72:75], v166, s[16:19], s29 offen offset:0
    v_mfma_f32_16x16x32_bf16 v[48:51], v[188:191], a[16:19], v[48:51]
    s_add_u32 m0, s27, 32768
    v_mfma_f32_16x16x32_bf16 v[52:55], v[188:191], a[20:23], v[52:55]
    buffer_load_dwordx4 v160, s[12:15], s28 offen offset:2048 lds
    v_mfma_f32_16x16x32_bf16 v[52:55], v[184:187], a[4:7], v[52:55]
    ds_read_b64_tr_b16 v[172:173], v144 offset:10240
    v_mfma_f32_16x16x32_bf16 v[56:59], v[184:187], a[8:11], v[56:59]
    buffer_load_dwordx4 a[240:243], v4, s[56:59], s48 offen offset:0
    v_mfma_f32_16x16x32_bf16 v[56:59], v[188:191], a[24:27], v[56:59]
    ds_read_b64_tr_b16 v[174:175], v145 offset:10240
    v_mfma_f32_16x16x32_bf16 v[60:63], v[188:191], a[28:31], v[60:63]
    buffer_load_dwordx4 a[76:79], v167, s[16:19], s29 offen offset:0
    v_mfma_f32_16x16x32_bf16 v[60:63], v[184:187], a[12:15], v[60:63]
    s_waitcnt lgkmcnt(4)
    ds_read_b64_tr_b16 v[176:177], v144 offset:2560
    v_mfma_f32_16x16x32_bf16 v[76:79], v[192:195], a[12:15], v[76:79]
    v_mfma_f32_16x16x32_bf16 v[76:79], v[196:199], a[28:31], v[76:79]
    ds_read_b64_tr_b16 v[178:179], v145 offset:2560
    v_mfma_f32_16x16x32_bf16 v[72:75], v[196:199], a[24:27], v[72:75]
    ds_read_b64_tr_b16 v[180:181], v144 offset:10752
    v_mfma_f32_16x16x32_bf16 v[72:75], v[192:195], a[8:11], v[72:75]
    v_mfma_f32_16x16x32_bf16 v[68:71], v[192:195], a[4:7], v[68:71]
    ds_read_b64_tr_b16 v[182:183], v145 offset:10752
    v_mfma_f32_16x16x32_bf16 v[68:71], v[196:199], a[20:23], v[68:71]
    buffer_load_dwordx4 a[80:83], v164, s[16:19], s29 offen offset:1024
    v_mfma_f32_16x16x32_bf16 v[64:67], v[196:199], a[16:19], v[64:67]
    s_add_u32 m0, s27, 32768
    ds_read_b64_tr_b16 v[184:185], v144 offset:3072
    v_mfma_f32_16x16x32_bf16 v[64:67], v[192:195], a[0:3], v[64:67]
    s_waitcnt lgkmcnt(5)
    ds_read_b64_tr_b16 v[186:187], v145 offset:3072
    v_mfma_f32_16x16x32_bf16 v[80:83], v[168:171], a[0:3], v[80:83]
    buffer_load_dwordx4 v161, s[12:15], s28 offen offset:3072 lds
    v_mfma_f32_16x16x32_bf16 v[80:83], v[172:175], a[16:19], v[80:83]
    v_mfma_f32_16x16x32_bf16 v[84:87], v[172:175], a[20:23], v[84:87]
    ds_read_b64_tr_b16 v[188:189], v144 offset:11264
    v_mfma_f32_16x16x32_bf16 v[84:87], v[168:171], a[4:7], v[84:87]
    ds_read_b64_tr_b16 v[190:191], v145 offset:11264
    v_mfma_f32_16x16x32_bf16 v[88:91], v[168:171], a[8:11], v[88:91]
    buffer_load_dwordx4 a[84:87], v165, s[16:19], s29 offen offset:1024
    v_mfma_f32_16x16x32_bf16 v[88:91], v[172:175], a[24:27], v[88:91]
    s_waitcnt vmcnt(14)
    v_mfma_f32_16x16x32_bf16 v[92:95], v[172:175], a[28:31], v[92:95]
    s_barrier
    v_mfma_f32_16x16x32_bf16 v[92:95], v[168:171], a[12:15], v[92:95]
    s_waitcnt lgkmcnt(4)
    ds_read_b64_tr_b16 v[192:193], v144 offset:16384
    v_mfma_f32_16x16x32_bf16 v[108:111], v[176:179], a[12:15], v[108:111]
    ds_read_b64_tr_b16 v[194:195], v145 offset:16384
    v_mfma_f32_16x16x32_bf16 v[108:111], v[180:183], a[28:31], v[108:111]
    ds_read_b64_tr_b16 v[196:197], v144 offset:24576
    v_mfma_f32_16x16x32_bf16 v[104:107], v[180:183], a[24:27], v[104:107]
    s_add_u32 s28, s28, 0x4000
    v_mfma_f32_16x16x32_bf16 v[104:107], v[176:179], a[8:11], v[104:107]
    buffer_load_dwordx4 a[88:91], v166, s[16:19], s29 offen offset:1024
    v_mfma_f32_16x16x32_bf16 v[100:103], v[176:179], a[4:7], v[100:103]
    buffer_load_dwordx4 a[244:247], v4, s[56:59], s48 offen offset:64
    v_mfma_f32_16x16x32_bf16 v[100:103], v[180:183], a[20:23], v[100:103]
    s_add_u32 m0, s27, 49152
    ds_read_b64_tr_b16 v[198:199], v145 offset:24576
    v_mfma_f32_16x16x32_bf16 v[96:99], v[180:183], a[16:19], v[96:99]
    buffer_load_dwordx4 v160, s[12:15], s28 offen offset:0 lds
    v_mfma_f32_16x16x32_bf16 v[96:99], v[176:179], a[0:3], v[96:99]
    s_waitcnt lgkmcnt(4)
    ds_read_b64_tr_b16 v[168:169], v144 offset:16896
    v_mfma_f32_16x16x32_bf16 v[112:115], v[184:187], a[0:3], v[112:115]
    v_mfma_f32_16x16x32_bf16 v[112:115], v[188:191], a[16:19], v[112:115]
    ds_read_b64_tr_b16 v[170:171], v145 offset:16896
    v_mfma_f32_16x16x32_bf16 v[116:119], v[188:191], a[20:23], v[116:119]
    buffer_load_dwordx4 a[92:95], v167, s[16:19], s29 offen offset:1024
    v_mfma_f32_16x16x32_bf16 v[116:119], v[184:187], a[4:7], v[116:119]
    ds_read_b64_tr_b16 v[172:173], v144 offset:25088
    v_mfma_f32_16x16x32_bf16 v[120:123], v[184:187], a[8:11], v[120:123]
    v_mfma_f32_16x16x32_bf16 v[120:123], v[188:191], a[24:27], v[120:123]
    ds_read_b64_tr_b16 v[174:175], v145 offset:25088
    v_mfma_f32_16x16x32_bf16 v[124:127], v[188:191], a[28:31], v[124:127]
    s_waitcnt vmcnt(14)
    ds_read_b64_tr_b16 v[176:177], v144 offset:17408
    v_mfma_f32_16x16x32_bf16 v[124:127], v[184:187], a[12:15], v[124:127]
    s_waitcnt lgkmcnt(5)
    v_mfma_f32_16x16x32_bf16 v[16:19], v[192:195], a[32:35], v[16:19]
    ds_read_b64_tr_b16 v[178:179], v145 offset:17408
    v_mfma_f32_16x16x32_bf16 v[16:19], v[196:199], a[48:51], v[16:19]
    buffer_load_dwordx4 a[96:99], v164, s[16:19], s29 offen offset:2048
    v_mfma_f32_16x16x32_bf16 v[20:23], v[196:199], a[52:55], v[20:23]
    ds_read_b64_tr_b16 v[180:181], v144 offset:25600
    v_mfma_f32_16x16x32_bf16 v[20:23], v[192:195], a[36:39], v[20:23]
    s_add_u32 m0, s27, 49152
    v_mfma_f32_16x16x32_bf16 v[24:27], v[192:195], a[40:43], v[24:27]
    buffer_load_dwordx4 v160, s[12:15], s28 offen offset:1024 lds
    v_mfma_f32_16x16x32_bf16 v[24:27], v[196:199], a[56:59], v[24:27]
    ds_read_b64_tr_b16 v[182:183], v145 offset:25600
    v_mfma_f32_16x16x32_bf16 v[28:31], v[196:199], a[60:63], v[28:31]
    ds_read_b64_tr_b16 v[184:185], v144 offset:17920
    v_mfma_f32_16x16x32_bf16 v[28:31], v[192:195], a[44:47], v[28:31]
    s_waitcnt lgkmcnt(5)
    v_mfma_f32_16x16x32_bf16 v[44:47], v[168:171], a[44:47], v[44:47]
    buffer_load_dwordx4 a[100:103], v165, s[16:19], s29 offen offset:2048
    v_mfma_f32_16x16x32_bf16 v[44:47], v[172:175], a[60:63], v[44:47]
    ds_read_b64_tr_b16 v[186:187], v145 offset:17920
    v_mfma_f32_16x16x32_bf16 v[40:43], v[172:175], a[56:59], v[40:43]
    ds_read_b64_tr_b16 v[188:189], v144 offset:26112
    v_mfma_f32_16x16x32_bf16 v[40:43], v[168:171], a[40:43], v[40:43]
    ds_read_b64_tr_b16 v[190:191], v145 offset:26112
    v_mfma_f32_16x16x32_bf16 v[36:39], v[168:171], a[36:39], v[36:39]
    buffer_load_dwordx4 a[248:251], v4, s[56:59], s49 offen offset:0
    v_mfma_f32_16x16x32_bf16 v[36:39], v[172:175], a[52:55], v[36:39]
    v_mfma_f32_16x16x32_bf16 v[32:35], v[172:175], a[48:51], v[32:35]
    ds_read_b64_tr_b16 v[192:193], v144 offset:18432
    v_mfma_f32_16x16x32_bf16 v[32:35], v[168:171], a[32:35], v[32:35]
    s_waitcnt lgkmcnt(5)
    ds_read_b64_tr_b16 v[194:195], v145 offset:18432
    v_mfma_f32_16x16x32_bf16 v[48:51], v[176:179], a[32:35], v[48:51]
    buffer_load_dwordx4 a[104:107], v166, s[16:19], s29 offen offset:2048
    v_mfma_f32_16x16x32_bf16 v[48:51], v[180:183], a[48:51], v[48:51]
    s_add_u32 m0, s27, 49152
    v_mfma_f32_16x16x32_bf16 v[52:55], v[180:183], a[52:55], v[52:55]
    buffer_load_dwordx4 v160, s[12:15], s28 offen offset:2048 lds
    v_mfma_f32_16x16x32_bf16 v[52:55], v[176:179], a[36:39], v[52:55]
    ds_read_b64_tr_b16 v[196:197], v144 offset:26624
    v_mfma_f32_16x16x32_bf16 v[56:59], v[176:179], a[40:43], v[56:59]
    ds_read_b64_tr_b16 v[198:199], v145 offset:26624
    v_mfma_f32_16x16x32_bf16 v[56:59], v[180:183], a[56:59], v[56:59]
    v_mfma_f32_16x16x32_bf16 v[60:63], v[180:183], a[60:63], v[60:63]
    buffer_load_dwordx4 a[108:111], v167, s[16:19], s29 offen offset:2048
    v_mfma_f32_16x16x32_bf16 v[60:63], v[176:179], a[44:47], v[60:63]
    s_waitcnt lgkmcnt(4)
    ds_read_b64_tr_b16 v[168:169], v144 offset:18944
    v_mfma_f32_16x16x32_bf16 v[76:79], v[184:187], a[44:47], v[76:79]
    ds_read_b64_tr_b16 v[170:171], v145 offset:18944
    v_mfma_f32_16x16x32_bf16 v[76:79], v[188:191], a[60:63], v[76:79]
    v_mfma_f32_16x16x32_bf16 v[72:75], v[188:191], a[56:59], v[72:75]
    ds_read_b64_tr_b16 v[172:173], v144 offset:27136
    v_mfma_f32_16x16x32_bf16 v[72:75], v[184:187], a[40:43], v[72:75]
    ds_read_b64_tr_b16 v[174:175], v145 offset:27136
    v_mfma_f32_16x16x32_bf16 v[68:71], v[184:187], a[36:39], v[68:71]
    v_mfma_f32_16x16x32_bf16 v[68:71], v[188:191], a[52:55], v[68:71]
    buffer_load_dwordx4 a[112:115], v164, s[16:19], s29 offen offset:3072
    v_mfma_f32_16x16x32_bf16 v[64:67], v[188:191], a[48:51], v[64:67]
    s_add_u32 m0, s27, 49152
    ds_read_b64_tr_b16 v[176:177], v144 offset:19456
    v_mfma_f32_16x16x32_bf16 v[64:67], v[184:187], a[32:35], v[64:67]
    s_waitcnt lgkmcnt(5)
    ds_read_b64_tr_b16 v[178:179], v145 offset:19456
    v_mfma_f32_16x16x32_bf16 v[80:83], v[192:195], a[32:35], v[80:83]
    buffer_load_dwordx4 v161, s[12:15], s28 offen offset:3072 lds
    v_mfma_f32_16x16x32_bf16 v[80:83], v[196:199], a[48:51], v[80:83]
    v_mfma_f32_16x16x32_bf16 v[84:87], v[196:199], a[52:55], v[84:87]
    ds_read_b64_tr_b16 v[180:181], v144 offset:27648
    v_mfma_f32_16x16x32_bf16 v[84:87], v[192:195], a[36:39], v[84:87]
    ds_read_b64_tr_b16 v[182:183], v145 offset:27648
    v_mfma_f32_16x16x32_bf16 v[88:91], v[192:195], a[40:43], v[88:91]
    buffer_load_dwordx4 a[116:119], v165, s[16:19], s29 offen offset:3072
    v_mfma_f32_16x16x32_bf16 v[88:91], v[196:199], a[56:59], v[88:91]
    s_waitcnt vmcnt(15)
    v_mfma_f32_16x16x32_bf16 v[92:95], v[196:199], a[60:63], v[92:95]
    s_barrier
    v_mfma_f32_16x16x32_bf16 v[92:95], v[192:195], a[44:47], v[92:95]
    s_waitcnt lgkmcnt(4)
    ds_read_b64_tr_b16 v[184:185], v144 offset:32768
    v_mfma_f32_16x16x32_bf16 v[108:111], v[168:171], a[44:47], v[108:111]
    buffer_load_dwordx4 a[252:255], v4, s[56:59], s49 offen offset:64
    v_mfma_f32_16x16x32_bf16 v[108:111], v[172:175], a[60:63], v[108:111]
    ds_read_b64_tr_b16 v[186:187], v145 offset:32768
    v_mfma_f32_16x16x32_bf16 v[104:107], v[172:175], a[56:59], v[104:107]
    v_mfma_f32_16x16x32_bf16 v[104:107], v[168:171], a[40:43], v[104:107]
    buffer_load_dwordx4 a[120:123], v166, s[16:19], s29 offen offset:3072
    v_mfma_f32_16x16x32_bf16 v[100:103], v[168:171], a[36:39], v[100:103]
    s_add_u32 s28, s28, 0x4000
    ds_read_b64_tr_b16 v[188:189], v144 offset:40960
    v_mfma_f32_16x16x32_bf16 v[100:103], v[172:175], a[52:55], v[100:103]
    s_add_u32 m0, s27, 0
    ds_read_b64_tr_b16 v[190:191], v145 offset:40960
    v_mfma_f32_16x16x32_bf16 v[96:99], v[172:175], a[48:51], v[96:99]
    buffer_load_dwordx4 v160, s[12:15], s28 offen offset:0 lds
    v_mfma_f32_16x16x32_bf16 v[96:99], v[168:171], a[32:35], v[96:99]
    s_waitcnt lgkmcnt(4)
    v_mfma_f32_16x16x32_bf16 v[112:115], v[176:179], a[32:35], v[112:115]
    ds_read_b64_tr_b16 v[192:193], v144 offset:33280
    v_mfma_f32_16x16x32_bf16 v[112:115], v[180:183], a[48:51], v[112:115]
    ds_read_b64_tr_b16 v[194:195], v145 offset:33280
    v_mfma_f32_16x16x32_bf16 v[116:119], v[180:183], a[52:55], v[116:119]
    buffer_load_dwordx4 a[124:127], v167, s[16:19], s29 offen offset:3072
    v_mfma_f32_16x16x32_bf16 v[116:119], v[176:179], a[36:39], v[116:119]
    v_mfma_f32_16x16x32_bf16 v[120:123], v[176:179], a[40:43], v[120:123]
    ds_read_b64_tr_b16 v[196:197], v144 offset:41472
    v_mfma_f32_16x16x32_bf16 v[120:123], v[180:183], a[56:59], v[120:123]
    ds_read_b64_tr_b16 v[198:199], v145 offset:41472
    v_mfma_f32_16x16x32_bf16 v[124:127], v[180:183], a[60:63], v[124:127]
    s_waitcnt vmcnt(14)
    v_mfma_f32_16x16x32_bf16 v[124:127], v[176:179], a[44:47], v[124:127]
    s_waitcnt lgkmcnt(4)
    ds_read_b64_tr_b16 v[168:169], v144 offset:33792
    v_mfma_f32_16x16x32_bf16 v[16:19], v[184:187], a[64:67], v[16:19]
    s_add_u32 s29, s29, 4096
    ds_read_b64_tr_b16 v[170:171], v145 offset:33792
    v_mfma_f32_16x16x32_bf16 v[16:19], v[188:191], a[80:83], v[16:19]
    buffer_load_dwordx4 a[0:3], v164, s[16:19], s29 offen offset:0
    v_mfma_f32_16x16x32_bf16 v[20:23], v[188:191], a[84:87], v[20:23]
    v_mfma_f32_16x16x32_bf16 v[20:23], v[184:187], a[68:71], v[20:23]
    s_add_u32 m0, s27, 0
    ds_read_b64_tr_b16 v[172:173], v144 offset:41984
    v_mfma_f32_16x16x32_bf16 v[24:27], v[184:187], a[72:75], v[24:27]
    buffer_load_dwordx4 v160, s[12:15], s28 offen offset:1024 lds
    v_mfma_f32_16x16x32_bf16 v[24:27], v[188:191], a[88:91], v[24:27]
    ds_read_b64_tr_b16 v[174:175], v145 offset:41984
    v_mfma_f32_16x16x32_bf16 v[28:31], v[188:191], a[92:95], v[28:31]
    v_mfma_f32_16x16x32_bf16 v[28:31], v[184:187], a[76:79], v[28:31]
    s_waitcnt lgkmcnt(4)
    ds_read_b64_tr_b16 v[176:177], v144 offset:34304
    v_mfma_f32_16x16x32_bf16 v[44:47], v[192:195], a[76:79], v[44:47]
    buffer_load_dwordx4 a[4:7], v165, s[16:19], s29 offen offset:0
    v_mfma_f32_16x16x32_bf16 v[44:47], v[196:199], a[92:95], v[44:47]
    ds_read_b64_tr_b16 v[178:179], v145 offset:34304
    v_mfma_f32_16x16x32_bf16 v[40:43], v[196:199], a[88:91], v[40:43]
    v_mfma_f32_16x16x32_bf16 v[40:43], v[192:195], a[72:75], v[40:43]
    ds_read_b64_tr_b16 v[180:181], v144 offset:42496
    v_mfma_f32_16x16x32_bf16 v[36:39], v[192:195], a[68:71], v[36:39]
    ds_read_b64_tr_b16 v[182:183], v145 offset:42496
    v_mfma_f32_16x16x32_bf16 v[36:39], v[196:199], a[84:87], v[36:39]
    v_mfma_f32_16x16x32_bf16 v[32:35], v[196:199], a[80:83], v[32:35]
    ds_read_b64_tr_b16 v[184:185], v144 offset:34816
    v_mfma_f32_16x16x32_bf16 v[32:35], v[192:195], a[64:67], v[32:35]
    s_waitcnt lgkmcnt(5)
    ds_read_b64_tr_b16 v[186:187], v145 offset:34816
    v_mfma_f32_16x16x32_bf16 v[48:51], v[168:171], a[64:67], v[48:51]
    buffer_load_dwordx4 a[8:11], v166, s[16:19], s29 offen offset:0
    v_mfma_f32_16x16x32_bf16 v[48:51], v[172:175], a[80:83], v[48:51]
    s_add_u32 m0, s27, 0
    v_mfma_f32_16x16x32_bf16 v[52:55], v[172:175], a[84:87], v[52:55]
    buffer_load_dwordx4 v160, s[12:15], s28 offen offset:2048 lds
    v_mfma_f32_16x16x32_bf16 v[52:55], v[168:171], a[68:71], v[52:55]
    ds_read_b64_tr_b16 v[188:189], v144 offset:43008
    v_mfma_f32_16x16x32_bf16 v[56:59], v[168:171], a[72:75], v[56:59]
    ds_read_b64_tr_b16 v[190:191], v145 offset:43008
    v_mfma_f32_16x16x32_bf16 v[56:59], v[172:175], a[88:91], v[56:59]
    v_mfma_f32_16x16x32_bf16 v[60:63], v[172:175], a[92:95], v[60:63]
    buffer_load_dwordx4 a[12:15], v167, s[16:19], s29 offen offset:0
    v_mfma_f32_16x16x32_bf16 v[60:63], v[168:171], a[76:79], v[60:63]
    s_waitcnt lgkmcnt(4)
    ds_read_b64_tr_b16 v[192:193], v144 offset:35328
    v_mfma_f32_16x16x32_bf16 v[76:79], v[176:179], a[76:79], v[76:79]
    ds_read_b64_tr_b16 v[194:195], v145 offset:35328
    v_mfma_f32_16x16x32_bf16 v[76:79], v[180:183], a[92:95], v[76:79]
    v_mfma_f32_16x16x32_bf16 v[72:75], v[180:183], a[88:91], v[72:75]
    ds_read_b64_tr_b16 v[196:197], v144 offset:43520
    v_mfma_f32_16x16x32_bf16 v[72:75], v[176:179], a[72:75], v[72:75]
    ds_read_b64_tr_b16 v[198:199], v145 offset:43520
    v_mfma_f32_16x16x32_bf16 v[68:71], v[176:179], a[68:71], v[68:71]
    v_mfma_f32_16x16x32_bf16 v[68:71], v[180:183], a[84:87], v[68:71]
    buffer_load_dwordx4 a[16:19], v164, s[16:19], s29 offen offset:1024
    v_mfma_f32_16x16x32_bf16 v[64:67], v[180:183], a[80:83], v[64:67]
    s_add_u32 m0, s27, 0
    ds_read_b64_tr_b16 v[168:169], v144 offset:35840
    v_mfma_f32_16x16x32_bf16 v[64:67], v[176:179], a[64:67], v[64:67]
    s_waitcnt lgkmcnt(5)
    ds_read_b64_tr_b16 v[170:171], v145 offset:35840
    v_mfma_f32_16x16x32_bf16 v[80:83], v[184:187], a[64:67], v[80:83]
    buffer_load_dwordx4 v161, s[12:15], s28 offen offset:3072 lds
    v_mfma_f32_16x16x32_bf16 v[80:83], v[188:191], a[80:83], v[80:83]
    v_mfma_f32_16x16x32_bf16 v[84:87], v[188:191], a[84:87], v[84:87]
    ds_read_b64_tr_b16 v[172:173], v144 offset:44032
    v_mfma_f32_16x16x32_bf16 v[84:87], v[184:187], a[68:71], v[84:87]
    ds_read_b64_tr_b16 v[174:175], v145 offset:44032
    v_mfma_f32_16x16x32_bf16 v[88:91], v[184:187], a[72:75], v[88:91]
    buffer_load_dwordx4 a[20:23], v165, s[16:19], s29 offen offset:1024
    v_mfma_f32_16x16x32_bf16 v[88:91], v[188:191], a[88:91], v[88:91]
    s_waitcnt vmcnt(14)
    v_mfma_f32_16x16x32_bf16 v[92:95], v[188:191], a[92:95], v[92:95]
    s_barrier
    v_mfma_f32_16x16x32_bf16 v[92:95], v[184:187], a[76:79], v[92:95]
    s_waitcnt lgkmcnt(4)
    ds_read_b64_tr_b16 v[176:177], v144 offset:49152
    v_mfma_f32_16x16x32_bf16 v[108:111], v[192:195], a[76:79], v[108:111]
    ds_read_b64_tr_b16 v[178:179], v145 offset:49152
    v_mfma_f32_16x16x32_bf16 v[108:111], v[196:199], a[92:95], v[108:111]
    v_mfma_f32_16x16x32_bf16 v[104:107], v[196:199], a[88:91], v[104:107]
    ds_read_b64_tr_b16 v[180:181], v144 offset:57344
    v_mfma_f32_16x16x32_bf16 v[104:107], v[192:195], a[72:75], v[104:107]
    buffer_load_dwordx4 a[24:27], v166, s[16:19], s29 offen offset:1024
    v_mfma_f32_16x16x32_bf16 v[100:103], v[192:195], a[68:71], v[100:103]
    s_add_u32 s28, s28, 0x4000
    ds_read_b64_tr_b16 v[182:183], v145 offset:57344
    v_mfma_f32_16x16x32_bf16 v[100:103], v[196:199], a[84:87], v[100:103]
    s_add_u32 m0, s27, 16384
    v_mfma_f32_16x16x32_bf16 v[96:99], v[196:199], a[80:83], v[96:99]
    buffer_load_dwordx4 v160, s[12:15], s28 offen offset:0 lds
    v_mfma_f32_16x16x32_bf16 v[96:99], v[192:195], a[64:67], v[96:99]
    s_waitcnt lgkmcnt(4)
    ds_read_b64_tr_b16 v[184:185], v144 offset:49664
    v_mfma_f32_16x16x32_bf16 v[112:115], v[168:171], a[64:67], v[112:115]
    ds_read_b64_tr_b16 v[186:187], v145 offset:49664
    v_mfma_f32_16x16x32_bf16 v[112:115], v[172:175], a[80:83], v[112:115]
    v_mfma_f32_16x16x32_bf16 v[116:119], v[172:175], a[84:87], v[116:119]
    buffer_load_dwordx4 a[28:31], v167, s[16:19], s29 offen offset:1024
    v_mfma_f32_16x16x32_bf16 v[116:119], v[168:171], a[68:71], v[116:119]
    ds_read_b64_tr_b16 v[188:189], v144 offset:57856
    v_mfma_f32_16x16x32_bf16 v[120:123], v[168:171], a[72:75], v[120:123]
    ds_read_b64_tr_b16 v[190:191], v145 offset:57856
    v_mfma_f32_16x16x32_bf16 v[120:123], v[172:175], a[88:91], v[120:123]
    v_mfma_f32_16x16x32_bf16 v[124:127], v[172:175], a[92:95], v[124:127]
    s_waitcnt vmcnt(12)
    ds_read_b64_tr_b16 v[192:193], v144 offset:50176
    v_mfma_f32_16x16x32_bf16 v[124:127], v[168:171], a[76:79], v[124:127]
    s_waitcnt lgkmcnt(5)
    ds_read_b64_tr_b16 v[194:195], v145 offset:50176
    v_mfma_f32_16x16x32_bf16 v[16:19], v[176:179], a[96:99], v[16:19]
    v_mfma_f32_16x16x32_bf16 v[16:19], v[180:183], a[112:115], v[16:19]
    buffer_load_dwordx4 a[32:35], v164, s[16:19], s29 offen offset:2048
    v_mfma_f32_16x16x32_bf16 v[20:23], v[180:183], a[116:119], v[20:23]
    ds_read_b64_tr_b16 v[196:197], v144 offset:58368
    v_mfma_f32_16x16x32_bf16 v[20:23], v[176:179], a[100:103], v[20:23]
    s_add_u32 m0, s27, 16384
    ds_read_b64_tr_b16 v[198:199], v145 offset:58368
    v_mfma_f32_16x16x32_bf16 v[24:27], v[176:179], a[104:107], v[24:27]
    buffer_load_dwordx4 v160, s[12:15], s28 offen offset:1024 lds
    v_mfma_f32_16x16x32_bf16 v[24:27], v[180:183], a[120:123], v[24:27]
    v_mfma_f32_16x16x32_bf16 v[28:31], v[180:183], a[124:127], v[28:31]
    ds_read_b64_tr_b16 v[168:169], v144 offset:50688
    v_mfma_f32_16x16x32_bf16 v[28:31], v[176:179], a[108:111], v[28:31]
    s_waitcnt lgkmcnt(5)
    ds_read_b64_tr_b16 v[170:171], v145 offset:50688
    v_mfma_f32_16x16x32_bf16 v[44:47], v[184:187], a[108:111], v[44:47]
    buffer_load_dwordx4 a[36:39], v165, s[16:19], s29 offen offset:2048
    v_mfma_f32_16x16x32_bf16 v[44:47], v[188:191], a[124:127], v[44:47]
    v_mfma_f32_16x16x32_bf16 v[40:43], v[188:191], a[120:123], v[40:43]
    ds_read_b64_tr_b16 v[172:173], v144 offset:58880
    v_mfma_f32_16x16x32_bf16 v[40:43], v[184:187], a[104:107], v[40:43]
    v_mfma_f32_16x16x32_bf16 v[36:39], v[184:187], a[100:103], v[36:39]
    ds_read_b64_tr_b16 v[174:175], v145 offset:58880
    v_mfma_f32_16x16x32_bf16 v[36:39], v[188:191], a[116:119], v[36:39]
    ds_read_b64_tr_b16 v[176:177], v144 offset:51200
    v_mfma_f32_16x16x32_bf16 v[32:35], v[188:191], a[112:115], v[32:35]
    v_mfma_f32_16x16x32_bf16 v[32:35], v[184:187], a[96:99], v[32:35]
    s_waitcnt lgkmcnt(5)
    ds_read_b64_tr_b16 v[178:179], v145 offset:51200
    v_mfma_f32_16x16x32_bf16 v[48:51], v[192:195], a[96:99], v[48:51]
    buffer_load_dwordx4 a[40:43], v166, s[16:19], s29 offen offset:2048
    v_mfma_f32_16x16x32_bf16 v[48:51], v[196:199], a[112:115], v[48:51]
    s_add_u32 m0, s27, 16384
    ds_read_b64_tr_b16 v[180:181], v144 offset:59392
    v_mfma_f32_16x16x32_bf16 v[52:55], v[196:199], a[116:119], v[52:55]
    buffer_load_dwordx4 v160, s[12:15], s28 offen offset:2048 lds
    v_mfma_f32_16x16x32_bf16 v[52:55], v[192:195], a[100:103], v[52:55]
    v_mfma_f32_16x16x32_bf16 v[56:59], v[192:195], a[104:107], v[56:59]
    ds_read_b64_tr_b16 v[182:183], v145 offset:59392
    v_mfma_f32_16x16x32_bf16 v[56:59], v[196:199], a[120:123], v[56:59]
    ds_read_b64_tr_b16 v[184:185], v144 offset:51712
    v_mfma_f32_16x16x32_bf16 v[60:63], v[196:199], a[124:127], v[60:63]
    buffer_load_dwordx4 a[44:47], v167, s[16:19], s29 offen offset:2048
    v_mfma_f32_16x16x32_bf16 v[60:63], v[192:195], a[108:111], v[60:63]
    s_waitcnt lgkmcnt(5)
    v_mfma_f32_16x16x32_bf16 v[76:79], v[168:171], a[108:111], v[76:79]
    ds_read_b64_tr_b16 v[186:187], v145 offset:51712
    v_mfma_f32_16x16x32_bf16 v[76:79], v[172:175], a[124:127], v[76:79]
    ds_read_b64_tr_b16 v[188:189], v144 offset:59904
    v_mfma_f32_16x16x32_bf16 v[72:75], v[172:175], a[120:123], v[72:75]
    v_mfma_f32_16x16x32_bf16 v[72:75], v[168:171], a[104:107], v[72:75]
    ds_read_b64_tr_b16 v[190:191], v145 offset:59904
    v_mfma_f32_16x16x32_bf16 v[68:71], v[168:171], a[100:103], v[68:71]
    ds_read_b64_tr_b16 v[192:193], v144 offset:52224
    v_mfma_f32_16x16x32_bf16 v[68:71], v[172:175], a[116:119], v[68:71]
    buffer_load_dwordx4 a[48:51], v164, s[16:19], s29 offen offset:3072
    v_mfma_f32_16x16x32_bf16 v[64:67], v[172:175], a[112:115], v[64:67]
    s_add_u32 m0, s27, 16384
    v_mfma_f32_16x16x32_bf16 v[64:67], v[168:171], a[96:99], v[64:67]
    s_waitcnt lgkmcnt(5)
    ds_read_b64_tr_b16 v[194:195], v145 offset:52224
    v_mfma_f32_16x16x32_bf16 v[80:83], v[176:179], a[96:99], v[80:83]
    buffer_load_dwordx4 v161, s[12:15], s28 offen offset:3072 lds
    v_mfma_f32_16x16x32_bf16 v[80:83], v[180:183], a[112:115], v[80:83]
    ds_read_b64_tr_b16 v[196:197], v144 offset:60416
    v_mfma_f32_16x16x32_bf16 v[84:87], v[180:183], a[116:119], v[84:87]
    v_mfma_f32_16x16x32_bf16 v[84:87], v[176:179], a[100:103], v[84:87]
    ds_read_b64_tr_b16 v[198:199], v145 offset:60416
    v_mfma_f32_16x16x32_bf16 v[88:91], v[176:179], a[104:107], v[88:91]
    buffer_load_dwordx4 a[52:55], v165, s[16:19], s29 offen offset:3072
    v_mfma_f32_16x16x32_bf16 v[88:91], v[180:183], a[120:123], v[88:91]
    s_waitcnt vmcnt(13)
    v_mfma_f32_16x16x32_bf16 v[92:95], v[180:183], a[124:127], v[92:95]
    s_barrier
    v_mfma_f32_16x16x32_bf16 v[92:95], v[176:179], a[108:111], v[92:95]
    s_waitcnt lgkmcnt(4)
    ds_read_b64_tr_b16 v[168:169], v144 offset:0
    v_mfma_f32_16x16x32_bf16 v[108:111], v[184:187], a[108:111], v[108:111]
    ds_read_b64_tr_b16 v[170:171], v145 offset:0
    v_mfma_f32_16x16x32_bf16 v[108:111], v[188:191], a[124:127], v[108:111]
    v_mfma_f32_16x16x32_bf16 v[104:107], v[188:191], a[120:123], v[104:107]
    ds_read_b64_tr_b16 v[172:173], v144 offset:8192
    v_mfma_f32_16x16x32_bf16 v[104:107], v[184:187], a[104:107], v[104:107]
    buffer_load_dwordx4 a[56:59], v166, s[16:19], s29 offen offset:3072
    v_mfma_f32_16x16x32_bf16 v[100:103], v[184:187], a[100:103], v[100:103]
    s_add_u32 s28, s28, 0x4000
    v_mfma_f32_16x16x32_bf16 v[100:103], v[188:191], a[116:119], v[100:103]
    s_add_u32 m0, s27, 32768
    ds_read_b64_tr_b16 v[174:175], v145 offset:8192
    v_mfma_f32_16x16x32_bf16 v[96:99], v[188:191], a[112:115], v[96:99]
    buffer_load_dwordx4 v160, s[12:15], s28 offen offset:0 lds
    v_mfma_f32_16x16x32_bf16 v[96:99], v[184:187], a[96:99], v[96:99]
    s_waitcnt lgkmcnt(4)
    v_mfma_f32_16x16x32_bf16 v[112:115], v[192:195], a[96:99], v[112:115]
    ds_read_b64_tr_b16 v[176:177], v144 offset:512
    v_mfma_f32_16x16x32_bf16 v[112:115], v[196:199], a[112:115], v[112:115]
    ds_read_b64_tr_b16 v[178:179], v145 offset:512
    v_mfma_f32_16x16x32_bf16 v[116:119], v[196:199], a[116:119], v[116:119]
    buffer_load_dwordx4 a[60:63], v167, s[16:19], s29 offen offset:3072
    v_mfma_f32_16x16x32_bf16 v[116:119], v[192:195], a[100:103], v[116:119]
    v_mfma_f32_16x16x32_bf16 v[120:123], v[192:195], a[104:107], v[120:123]
    ds_read_b64_tr_b16 v[180:181], v144 offset:8704
    v_mfma_f32_16x16x32_bf16 v[120:123], v[196:199], a[120:123], v[120:123]
    v_mfma_f32_16x16x32_bf16 v[124:127], v[196:199], a[124:127], v[124:127]
    s_waitcnt vmcnt(12)
    ds_read_b64_tr_b16 v[182:183], v145 offset:8704
    v_mfma_f32_16x16x32_bf16 v[124:127], v[192:195], a[108:111], v[124:127]
    s_waitcnt lgkmcnt(4)
    v_mfma_f32_16x16x32_bf16 v[16:19], v[168:171], a[0:3], v[16:19]
    s_add_u32 s29, s29, 4096
    ds_read_b64_tr_b16 v[184:185], v144 offset:1024
    v_mfma_f32_16x16x32_bf16 v[16:19], v[172:175], a[16:19], v[16:19]
    buffer_load_dwordx4 a[64:67], v164, s[16:19], s29 offen offset:0
    v_mfma_f32_16x16x32_bf16 v[20:23], v[172:175], a[20:23], v[20:23]
    buffer_load_dwordx4 v[200:203], v15, s[36:39], s34 offen offset:0
    v_mfma_f32_16x16x32_bf16 v[20:23], v[168:171], a[4:7], v[20:23]
    s_add_u32 m0, s27, 32768
    ds_read_b64_tr_b16 v[186:187], v145 offset:1024
    v_mfma_f32_16x16x32_bf16 v[24:27], v[168:171], a[8:11], v[24:27]
    buffer_load_dwordx4 v160, s[12:15], s28 offen offset:1024 lds
    v_mfma_f32_16x16x32_bf16 v[24:27], v[172:175], a[24:27], v[24:27]
    ds_read_b64_tr_b16 v[188:189], v144 offset:9216
    v_mfma_f32_16x16x32_bf16 v[28:31], v[172:175], a[28:31], v[28:31]
    ds_read_b64_tr_b16 v[190:191], v145 offset:9216
    v_mfma_f32_16x16x32_bf16 v[28:31], v[168:171], a[12:15], v[28:31]
    s_waitcnt lgkmcnt(4)
    ds_read_b64_tr_b16 v[192:193], v144 offset:1536
    v_mfma_f32_16x16x32_bf16 v[44:47], v[176:179], a[12:15], v[44:47]
    buffer_load_dwordx4 v[204:207], v15, s[36:39], s34 offen offset:1024
    v_mfma_f32_16x16x32_bf16 v[44:47], v[180:183], a[28:31], v[44:47]
    buffer_load_dwordx4 a[68:71], v165, s[16:19], s29 offen offset:0
    v_mfma_f32_16x16x32_bf16 v[40:43], v[180:183], a[24:27], v[40:43]
    ds_read_b64_tr_b16 v[194:195], v145 offset:1536
    v_mfma_f32_16x16x32_bf16 v[40:43], v[176:179], a[8:11], v[40:43]
    ds_read_b64_tr_b16 v[196:197], v144 offset:9728
    v_mfma_f32_16x16x32_bf16 v[36:39], v[176:179], a[4:7], v[36:39]
    buffer_load_dwordx4 v[208:211], v15, s[36:39], s34 offen offset:2048
    v_mfma_f32_16x16x32_bf16 v[36:39], v[180:183], a[20:23], v[36:39]
    ds_read_b64_tr_b16 v[198:199], v145 offset:9728
    v_mfma_f32_16x16x32_bf16 v[32:35], v[180:183], a[16:19], v[32:35]
    s_add_u32 m0, s27, 32768
    ds_read_b64_tr_b16 v[168:169], v144 offset:2048
    v_mfma_f32_16x16x32_bf16 v[32:35], v[176:179], a[0:3], v[32:35]
    s_waitcnt lgkmcnt(5)
    ds_read_b64_tr_b16 v[170:171], v145 offset:2048
    v_mfma_f32_16x16x32_bf16 v[48:51], v[184:187], a[0:3], v[48:51]
    buffer_load_dwordx4 a[72:75], v166, s[16:19], s29 offen offset:0
    v_mfma_f32_16x16x32_bf16 v[48:51], v[188:191], a[16:19], v[48:51]
    buffer_load_dwordx2 v[212:213], v146, s[36:39], s34 offen offset:3072
    v_mfma_f32_16x16x32_bf16 v[52:55], v[188:191], a[20:23], v[52:55]
    buffer_load_dwordx4 v160, s[12:15], s28 offen offset:2048 lds
    v_mfma_f32_16x16x32_bf16 v[52:55], v[184:187], a[4:7], v[52:55]
    v_mfma_f32_16x16x32_bf16 v[56:59], v[184:187], a[8:11], v[56:59]
    ds_read_b64_tr_b16 v[172:173], v144 offset:10240
    v_mfma_f32_16x16x32_bf16 v[56:59], v[188:191], a[24:27], v[56:59]
    s_add_u32 s34, s34, 57344
    ds_read_b64_tr_b16 v[174:175], v145 offset:10240
    v_mfma_f32_16x16x32_bf16 v[60:63], v[188:191], a[28:31], v[60:63]
    buffer_load_dwordx4 a[76:79], v167, s[16:19], s29 offen offset:0
    v_mfma_f32_16x16x32_bf16 v[60:63], v[184:187], a[12:15], v[60:63]
    s_waitcnt lgkmcnt(4)
    ds_read_b64_tr_b16 v[176:177], v144 offset:2560
    v_mfma_f32_16x16x32_bf16 v[76:79], v[192:195], a[12:15], v[76:79]
    buffer_load_dwordx4 v[214:217], v15, s[36:39], s34 offen offset:0
    v_mfma_f32_16x16x32_bf16 v[76:79], v[196:199], a[28:31], v[76:79]
    ds_read_b64_tr_b16 v[178:179], v145 offset:2560
    v_mfma_f32_16x16x32_bf16 v[72:75], v[196:199], a[24:27], v[72:75]
    ds_read_b64_tr_b16 v[180:181], v144 offset:10752
    v_mfma_f32_16x16x32_bf16 v[72:75], v[192:195], a[8:11], v[72:75]
    buffer_load_dwordx4 v[218:221], v15, s[36:39], s34 offen offset:1024
    v_mfma_f32_16x16x32_bf16 v[68:71], v[192:195], a[4:7], v[68:71]
    ds_read_b64_tr_b16 v[182:183], v145 offset:10752
    v_mfma_f32_16x16x32_bf16 v[68:71], v[196:199], a[20:23], v[68:71]
    buffer_load_dwordx4 a[80:83], v164, s[16:19], s29 offen offset:1024
    v_mfma_f32_16x16x32_bf16 v[64:67], v[196:199], a[16:19], v[64:67]
    s_add_u32 m0, s27, 32768
    ds_read_b64_tr_b16 v[184:185], v144 offset:3072
    v_mfma_f32_16x16x32_bf16 v[64:67], v[192:195], a[0:3], v[64:67]
    s_waitcnt lgkmcnt(5)
    ds_read_b64_tr_b16 v[186:187], v145 offset:3072
    v_mfma_f32_16x16x32_bf16 v[80:83], v[168:171], a[0:3], v[80:83]
    buffer_load_dwordx4 v161, s[12:15], s28 offen offset:3072 lds
    v_mfma_f32_16x16x32_bf16 v[80:83], v[172:175], a[16:19], v[80:83]
    buffer_load_dwordx4 v[222:225], v15, s[36:39], s34 offen offset:2048
    v_mfma_f32_16x16x32_bf16 v[84:87], v[172:175], a[20:23], v[84:87]
    ds_read_b64_tr_b16 v[188:189], v144 offset:11264
    v_mfma_f32_16x16x32_bf16 v[84:87], v[168:171], a[4:7], v[84:87]
    ds_read_b64_tr_b16 v[190:191], v145 offset:11264
    v_mfma_f32_16x16x32_bf16 v[88:91], v[168:171], a[8:11], v[88:91]
    buffer_load_dwordx4 a[84:87], v165, s[16:19], s29 offen offset:1024
    v_mfma_f32_16x16x32_bf16 v[88:91], v[172:175], a[24:27], v[88:91]
    s_waitcnt vmcnt(20)
    v_mfma_f32_16x16x32_bf16 v[92:95], v[172:175], a[28:31], v[92:95]
    s_barrier
    v_mfma_f32_16x16x32_bf16 v[92:95], v[168:171], a[12:15], v[92:95]
    s_waitcnt lgkmcnt(4)
    ds_read_b64_tr_b16 v[192:193], v144 offset:16384
    v_mfma_f32_16x16x32_bf16 v[108:111], v[176:179], a[12:15], v[108:111]
    buffer_load_dwordx2 v[226:227], v146, s[36:39], s34 offen offset:3072
    v_mfma_f32_16x16x32_bf16 v[108:111], v[180:183], a[28:31], v[108:111]
    s_add_u32 s34, s34, 57344
    ds_read_b64_tr_b16 v[194:195], v145 offset:16384
    v_mfma_f32_16x16x32_bf16 v[104:107], v[180:183], a[24:27], v[104:107]
    buffer_load_dwordx4 v[228:231], v15, s[36:39], s34 offen offset:0
    v_mfma_f32_16x16x32_bf16 v[104:107], v[176:179], a[8:11], v[104:107]
    buffer_load_dwordx4 a[88:91], v166, s[16:19], s29 offen offset:1024
    v_mfma_f32_16x16x32_bf16 v[100:103], v[176:179], a[4:7], v[100:103]
    s_add_u32 s28, s28, 0x4000
    ds_read_b64_tr_b16 v[196:197], v144 offset:24576
    v_mfma_f32_16x16x32_bf16 v[100:103], v[180:183], a[20:23], v[100:103]
    s_add_u32 m0, s27, 49152
    ds_read_b64_tr_b16 v[198:199], v145 offset:24576
    v_mfma_f32_16x16x32_bf16 v[96:99], v[180:183], a[16:19], v[96:99]
    buffer_load_dwordx4 v160, s[12:15], s28 offen offset:0 lds
    v_mfma_f32_16x16x32_bf16 v[96:99], v[176:179], a[0:3], v[96:99]
    s_waitcnt lgkmcnt(4)
    ds_read_b64_tr_b16 v[168:169], v144 offset:16896
    v_mfma_f32_16x16x32_bf16 v[112:115], v[184:187], a[0:3], v[112:115]
    buffer_load_dwordx4 v[232:235], v15, s[36:39], s34 offen offset:1024
    v_mfma_f32_16x16x32_bf16 v[112:115], v[188:191], a[16:19], v[112:115]
    v_mfma_f32_16x16x32_bf16 v[116:119], v[188:191], a[20:23], v[116:119]
    buffer_load_dwordx4 a[92:95], v167, s[16:19], s29 offen offset:1024
    v_mfma_f32_16x16x32_bf16 v[116:119], v[184:187], a[4:7], v[116:119]
    ds_read_b64_tr_b16 v[170:171], v145 offset:16896
    v_mfma_f32_16x16x32_bf16 v[120:123], v[184:187], a[8:11], v[120:123]
    buffer_load_dwordx4 v[236:239], v15, s[36:39], s34 offen offset:2048
    v_mfma_f32_16x16x32_bf16 v[120:123], v[188:191], a[24:27], v[120:123]
    ds_read_b64_tr_b16 v[172:173], v144 offset:25088
    v_mfma_f32_16x16x32_bf16 v[124:127], v[188:191], a[28:31], v[124:127]
    s_waitcnt vmcnt(23)
    ds_read_b64_tr_b16 v[174:175], v145 offset:25088
    v_mfma_f32_16x16x32_bf16 v[124:127], v[184:187], a[12:15], v[124:127]
    s_waitcnt lgkmcnt(4)
    ds_read_b64_tr_b16 v[176:177], v144 offset:17408
    v_mfma_f32_16x16x32_bf16 v[16:19], v[192:195], a[32:35], v[16:19]
    ds_read_b64_tr_b16 v[178:179], v145 offset:17408
    v_mfma_f32_16x16x32_bf16 v[16:19], v[196:199], a[48:51], v[16:19]
    buffer_load_dwordx4 a[96:99], v164, s[16:19], s29 offen offset:2048
    v_mfma_f32_16x16x32_bf16 v[20:23], v[196:199], a[52:55], v[20:23]
    buffer_load_dwordx2 v[240:241], v146, s[36:39], s34 offen offset:3072
    v_mfma_f32_16x16x32_bf16 v[20:23], v[192:195], a[36:39], v[20:23]
    s_add_u32 m0, s27, 49152
    v_mfma_f32_16x16x32_bf16 v[24:27], v[192:195], a[40:43], v[24:27]
    buffer_load_dwordx4 v160, s[12:15], s28 offen offset:1024 lds
    v_mfma_f32_16x16x32_bf16 v[24:27], v[196:199], a[56:59], v[24:27]
    s_add_u32 s34, s34, 57344
    ds_read_b64_tr_b16 v[180:181], v144 offset:25600
    v_mfma_f32_16x16x32_bf16 v[28:31], v[196:199], a[60:63], v[28:31]
    buffer_load_dwordx4 v[242:245], v15, s[36:39], s34 offen offset:0
    v_mfma_f32_16x16x32_bf16 v[28:31], v[192:195], a[44:47], v[28:31]
    s_waitcnt lgkmcnt(3)
    ds_read_b64_tr_b16 v[182:183], v145 offset:25600
    v_mfma_f32_16x16x32_bf16 v[44:47], v[168:171], a[44:47], v[44:47]
    buffer_load_dwordx4 a[100:103], v165, s[16:19], s29 offen offset:2048
    v_mfma_f32_16x16x32_bf16 v[44:47], v[172:175], a[60:63], v[44:47]
    ds_read_b64_tr_b16 v[184:185], v144 offset:17920
    v_mfma_f32_16x16x32_bf16 v[40:43], v[172:175], a[56:59], v[40:43]
    ds_read_b64_tr_b16 v[186:187], v145 offset:17920
    v_mfma_f32_16x16x32_bf16 v[40:43], v[168:171], a[40:43], v[40:43]
    buffer_load_dwordx4 v[246:249], v15, s[36:39], s34 offen offset:1024
    v_mfma_f32_16x16x32_bf16 v[36:39], v[168:171], a[36:39], v[36:39]
    v_mfma_f32_16x16x32_bf16 v[36:39], v[172:175], a[52:55], v[36:39]
    ds_read_b64_tr_b16 v[188:189], v144 offset:26112
    v_mfma_f32_16x16x32_bf16 v[32:35], v[172:175], a[48:51], v[32:35]
    s_add_u32 m0, s27, 49152
    ds_read_b64_tr_b16 v[190:191], v145 offset:26112
    v_mfma_f32_16x16x32_bf16 v[32:35], v[168:171], a[32:35], v[32:35]
    s_waitcnt lgkmcnt(4)
    ds_read_b64_tr_b16 v[192:193], v144 offset:18432
    v_mfma_f32_16x16x32_bf16 v[48:51], v[176:179], a[32:35], v[48:51]
    buffer_load_dwordx4 a[104:107], v166, s[16:19], s29 offen offset:2048
    v_mfma_f32_16x16x32_bf16 v[48:51], v[180:183], a[48:51], v[48:51]
    buffer_load_dwordx4 v[250:253], v15, s[36:39], s34 offen offset:2048
    v_mfma_f32_16x16x32_bf16 v[52:55], v[180:183], a[52:55], v[52:55]
    buffer_load_dwordx4 v160, s[12:15], s28 offen offset:2048 lds
    v_mfma_f32_16x16x32_bf16 v[52:55], v[176:179], a[36:39], v[52:55]
    ds_read_b64_tr_b16 v[194:195], v145 offset:18432
    v_mfma_f32_16x16x32_bf16 v[56:59], v[176:179], a[40:43], v[56:59]
    ds_read_b64_tr_b16 v[196:197], v144 offset:26624
    v_mfma_f32_16x16x32_bf16 v[56:59], v[180:183], a[56:59], v[56:59]
    buffer_load_dwordx2 v[254:255], v146, s[36:39], s34 offen offset:3072
    v_mfma_f32_16x16x32_bf16 v[60:63], v[180:183], a[60:63], v[60:63]
    buffer_load_dwordx4 a[108:111], v167, s[16:19], s29 offen offset:2048
    v_mfma_f32_16x16x32_bf16 v[60:63], v[176:179], a[44:47], v[60:63]
    s_waitcnt lgkmcnt(3)
    v_mfma_f32_16x16x32_bf16 v[76:79], v[184:187], a[44:47], v[76:79]
    ds_read_b64_tr_b16 v[198:199], v145 offset:26624
    v_mfma_f32_16x16x32_bf16 v[76:79], v[188:191], a[60:63], v[76:79]
    ds_read_b64_tr_b16 v[168:169], v144 offset:18944
    v_mfma_f32_16x16x32_bf16 v[72:75], v[188:191], a[56:59], v[72:75]
    ds_read_b64_tr_b16 v[170:171], v145 offset:18944
    v_mfma_f32_16x16x32_bf16 v[72:75], v[184:187], a[40:43], v[72:75]
    ds_read_b64_tr_b16 v[172:173], v144 offset:27136
    v_mfma_f32_16x16x32_bf16 v[68:71], v[184:187], a[36:39], v[68:71]
    ds_read_b64_tr_b16 v[174:175], v145 offset:27136
    v_mfma_f32_16x16x32_bf16 v[68:71], v[188:191], a[52:55], v[68:71]
    buffer_load_dwordx4 a[112:115], v164, s[16:19], s29 offen offset:3072
    v_mfma_f32_16x16x32_bf16 v[64:67], v[188:191], a[48:51], v[64:67]
    s_add_u32 m0, s27, 49152
    v_mfma_f32_16x16x32_bf16 v[64:67], v[184:187], a[32:35], v[64:67]
    s_waitcnt lgkmcnt(4)
    ds_read_b64_tr_b16 v[176:177], v144 offset:19456
    v_mfma_f32_16x16x32_bf16 v[80:83], v[192:195], a[32:35], v[80:83]
    buffer_load_dwordx4 v161, s[12:15], s28 offen offset:3072 lds
    v_mfma_f32_16x16x32_bf16 v[80:83], v[196:199], a[48:51], v[80:83]
    ds_read_b64_tr_b16 v[178:179], v145 offset:19456
    v_mfma_f32_16x16x32_bf16 v[84:87], v[196:199], a[52:55], v[84:87]
    ds_read_b64_tr_b16 v[180:181], v144 offset:27648
    v_mfma_f32_16x16x32_bf16 v[84:87], v[192:195], a[36:39], v[84:87]
    ds_read_b64_tr_b16 v[182:183], v145 offset:27648
    v_mfma_f32_16x16x32_bf16 v[88:91], v[192:195], a[40:43], v[88:91]
    buffer_load_dwordx4 a[116:119], v165, s[16:19], s29 offen offset:3072
    v_mfma_f32_16x16x32_bf16 v[88:91], v[196:199], a[56:59], v[88:91]
    s_waitcnt vmcnt(23)
    v_mfma_f32_16x16x32_bf16 v[92:95], v[196:199], a[60:63], v[92:95]
    s_barrier
    v_mfma_f32_16x16x32_bf16 v[92:95], v[192:195], a[44:47], v[92:95]
    s_waitcnt lgkmcnt(4)
    ds_read_b64_tr_b16 v[184:185], v144 offset:32768
    v_mfma_f32_16x16x32_bf16 v[108:111], v[168:171], a[44:47], v[108:111]
    ds_read_b64_tr_b16 v[186:187], v145 offset:32768
    v_mfma_f32_16x16x32_bf16 v[108:111], v[172:175], a[60:63], v[108:111]
    v_mfma_f32_16x16x32_bf16 v[104:107], v[172:175], a[56:59], v[104:107]
    ds_read_b64_tr_b16 v[188:189], v144 offset:40960
    v_mfma_f32_16x16x32_bf16 v[104:107], v[168:171], a[40:43], v[104:107]
    buffer_load_dwordx4 a[120:123], v166, s[16:19], s29 offen offset:3072
    v_mfma_f32_16x16x32_bf16 v[100:103], v[168:171], a[36:39], v[100:103]
    v_mfma_f32_16x16x32_bf16 v[100:103], v[172:175], a[52:55], v[100:103]
    ds_read_b64_tr_b16 v[190:191], v145 offset:40960
    v_mfma_f32_16x16x32_bf16 v[96:99], v[172:175], a[48:51], v[96:99]
    v_mfma_f32_16x16x32_bf16 v[96:99], v[168:171], a[32:35], v[96:99]
    s_waitcnt lgkmcnt(4)
    ds_read_b64_tr_b16 v[192:193], v144 offset:33280
    v_mfma_f32_16x16x32_bf16 v[112:115], v[176:179], a[32:35], v[112:115]
    v_mfma_f32_16x16x32_bf16 v[112:115], v[180:183], a[48:51], v[112:115]
    ds_read_b64_tr_b16 v[194:195], v145 offset:33280
    v_mfma_f32_16x16x32_bf16 v[116:119], v[180:183], a[52:55], v[116:119]
    buffer_load_dwordx4 a[124:127], v167, s[16:19], s29 offen offset:3072
    v_mfma_f32_16x16x32_bf16 v[116:119], v[176:179], a[36:39], v[116:119]
    v_mfma_f32_16x16x32_bf16 v[120:123], v[176:179], a[40:43], v[120:123]
    ds_read_b64_tr_b16 v[196:197], v144 offset:41472
    v_mfma_f32_16x16x32_bf16 v[120:123], v[180:183], a[56:59], v[120:123]
    v_mfma_f32_16x16x32_bf16 v[124:127], v[180:183], a[60:63], v[124:127]
    s_waitcnt vmcnt(17)
    ds_read_b64_tr_b16 v[198:199], v145 offset:41472
    v_mfma_f32_16x16x32_bf16 v[124:127], v[176:179], a[44:47], v[124:127]
    s_waitcnt lgkmcnt(4)
    v_mfma_f32_16x16x32_bf16 v[16:19], v[184:187], a[64:67], v[16:19]
    ds_read_b64_tr_b16 v[168:169], v144 offset:33792
    v_mfma_f32_16x16x32_bf16 v[16:19], v[188:191], a[80:83], v[16:19]
    v_mfma_f32_16x16x32_bf16 v[20:23], v[188:191], a[84:87], v[20:23]
    ds_read_b64_tr_b16 v[170:171], v145 offset:33792
    v_mfma_f32_16x16x32_bf16 v[20:23], v[184:187], a[68:71], v[20:23]
    ds_read_b64_tr_b16 v[172:173], v144 offset:41984
    v_mfma_f32_16x16x32_bf16 v[24:27], v[184:187], a[72:75], v[24:27]
    v_mfma_f32_16x16x32_bf16 v[24:27], v[188:191], a[88:91], v[24:27]
    ds_read_b64_tr_b16 v[174:175], v145 offset:41984
    v_mfma_f32_16x16x32_bf16 v[28:31], v[188:191], a[92:95], v[28:31]
    v_mfma_f32_16x16x32_bf16 v[28:31], v[184:187], a[76:79], v[28:31]
    s_waitcnt lgkmcnt(4)
    ds_read_b64_tr_b16 v[176:177], v144 offset:34304
    v_mfma_f32_16x16x32_bf16 v[44:47], v[192:195], a[76:79], v[44:47]
    v_mfma_f32_16x16x32_bf16 v[44:47], v[196:199], a[92:95], v[44:47]
    ds_read_b64_tr_b16 v[178:179], v145 offset:34304
    v_mfma_f32_16x16x32_bf16 v[40:43], v[196:199], a[88:91], v[40:43]
    v_mfma_f32_16x16x32_bf16 v[40:43], v[192:195], a[72:75], v[40:43]
    ds_read_b64_tr_b16 v[180:181], v144 offset:42496
    v_mfma_f32_16x16x32_bf16 v[36:39], v[192:195], a[68:71], v[36:39]
    v_mfma_f32_16x16x32_bf16 v[36:39], v[196:199], a[84:87], v[36:39]
    ds_read_b64_tr_b16 v[182:183], v145 offset:42496
    v_mfma_f32_16x16x32_bf16 v[32:35], v[196:199], a[80:83], v[32:35]
    v_mfma_f32_16x16x32_bf16 v[32:35], v[192:195], a[64:67], v[32:35]
    s_waitcnt lgkmcnt(4)
    ds_read_b64_tr_b16 v[184:185], v144 offset:34816
    v_mfma_f32_16x16x32_bf16 v[48:51], v[168:171], a[64:67], v[48:51]
    v_mfma_f32_16x16x32_bf16 v[48:51], v[172:175], a[80:83], v[48:51]
    ds_read_b64_tr_b16 v[186:187], v145 offset:34816
    v_mfma_f32_16x16x32_bf16 v[52:55], v[172:175], a[84:87], v[52:55]
    v_mfma_f32_16x16x32_bf16 v[52:55], v[168:171], a[68:71], v[52:55]
    ds_read_b64_tr_b16 v[188:189], v144 offset:43008
    v_mfma_f32_16x16x32_bf16 v[56:59], v[168:171], a[72:75], v[56:59]
    ds_read_b64_tr_b16 v[190:191], v145 offset:43008
    v_mfma_f32_16x16x32_bf16 v[56:59], v[172:175], a[88:91], v[56:59]
    v_mfma_f32_16x16x32_bf16 v[60:63], v[172:175], a[92:95], v[60:63]
    ds_read_b64_tr_b16 v[192:193], v144 offset:35328
    v_mfma_f32_16x16x32_bf16 v[60:63], v[168:171], a[76:79], v[60:63]
    s_waitcnt lgkmcnt(5)
    v_mfma_f32_16x16x32_bf16 v[76:79], v[176:179], a[76:79], v[76:79]
    ds_read_b64_tr_b16 v[194:195], v145 offset:35328
    v_mfma_f32_16x16x32_bf16 v[76:79], v[180:183], a[92:95], v[76:79]
    v_mfma_f32_16x16x32_bf16 v[72:75], v[180:183], a[88:91], v[72:75]
    ds_read_b64_tr_b16 v[196:197], v144 offset:43520
    v_mfma_f32_16x16x32_bf16 v[72:75], v[176:179], a[72:75], v[72:75]
    v_mfma_f32_16x16x32_bf16 v[68:71], v[176:179], a[68:71], v[68:71]
    ds_read_b64_tr_b16 v[198:199], v145 offset:43520
    v_mfma_f32_16x16x32_bf16 v[68:71], v[180:183], a[84:87], v[68:71]
    v_mfma_f32_16x16x32_bf16 v[64:67], v[180:183], a[80:83], v[64:67]
    ds_read_b64_tr_b16 v[168:169], v144 offset:35840
    v_mfma_f32_16x16x32_bf16 v[64:67], v[176:179], a[64:67], v[64:67]
    s_waitcnt lgkmcnt(5)
    v_mfma_f32_16x16x32_bf16 v[80:83], v[184:187], a[64:67], v[80:83]
    ds_read_b64_tr_b16 v[170:171], v145 offset:35840
    v_mfma_f32_16x16x32_bf16 v[80:83], v[188:191], a[80:83], v[80:83]
    v_mfma_f32_16x16x32_bf16 v[84:87], v[188:191], a[84:87], v[84:87]
    ds_read_b64_tr_b16 v[172:173], v144 offset:44032
    v_mfma_f32_16x16x32_bf16 v[84:87], v[184:187], a[68:71], v[84:87]
    v_mfma_f32_16x16x32_bf16 v[88:91], v[184:187], a[72:75], v[88:91]
    ds_read_b64_tr_b16 v[174:175], v145 offset:44032
    v_mfma_f32_16x16x32_bf16 v[88:91], v[188:191], a[88:91], v[88:91]
    s_waitcnt vmcnt(3)
    v_mfma_f32_16x16x32_bf16 v[92:95], v[188:191], a[92:95], v[92:95]
    s_barrier
    v_mfma_f32_16x16x32_bf16 v[92:95], v[184:187], a[76:79], v[92:95]
    s_waitcnt lgkmcnt(4)
    ds_read_b64_tr_b16 v[176:177], v144 offset:49152
    v_mfma_f32_16x16x32_bf16 v[108:111], v[192:195], a[76:79], v[108:111]
    v_mfma_f32_16x16x32_bf16 v[108:111], v[196:199], a[92:95], v[108:111]
    ds_read_b64_tr_b16 v[178:179], v145 offset:49152
    v_mfma_f32_16x16x32_bf16 v[104:107], v[196:199], a[88:91], v[104:107]
    v_mfma_f32_16x16x32_bf16 v[104:107], v[192:195], a[72:75], v[104:107]
    ds_read_b64_tr_b16 v[180:181], v144 offset:57344
    v_mfma_f32_16x16x32_bf16 v[100:103], v[192:195], a[68:71], v[100:103]
    v_mfma_f32_16x16x32_bf16 v[100:103], v[196:199], a[84:87], v[100:103]
    ds_read_b64_tr_b16 v[182:183], v145 offset:57344
    v_mfma_f32_16x16x32_bf16 v[96:99], v[196:199], a[80:83], v[96:99]
    v_mfma_f32_16x16x32_bf16 v[96:99], v[192:195], a[64:67], v[96:99]
    s_waitcnt lgkmcnt(4)
    ds_read_b64_tr_b16 v[184:185], v144 offset:49664
    v_mfma_f32_16x16x32_bf16 v[112:115], v[168:171], a[64:67], v[112:115]
    v_mfma_f32_16x16x32_bf16 v[112:115], v[172:175], a[80:83], v[112:115]
    ds_read_b64_tr_b16 v[186:187], v145 offset:49664
    v_mfma_f32_16x16x32_bf16 v[116:119], v[172:175], a[84:87], v[116:119]
    v_mfma_f32_16x16x32_bf16 v[116:119], v[168:171], a[68:71], v[116:119]
    ds_read_b64_tr_b16 v[188:189], v144 offset:57856
    v_mfma_f32_16x16x32_bf16 v[120:123], v[168:171], a[72:75], v[120:123]
    v_mfma_f32_16x16x32_bf16 v[120:123], v[172:175], a[88:91], v[120:123]
    ds_read_b64_tr_b16 v[190:191], v145 offset:57856
    v_mfma_f32_16x16x32_bf16 v[124:127], v[172:175], a[92:95], v[124:127]
    s_waitcnt vmcnt(0)
    v_mfma_f32_16x16x32_bf16 v[124:127], v[168:171], a[76:79], v[124:127]
    s_waitcnt lgkmcnt(4)
    ds_read_b64_tr_b16 v[192:193], v144 offset:50176
    v_mfma_f32_16x16x32_bf16 v[16:19], v[176:179], a[96:99], v[16:19]
    v_mfma_f32_16x16x32_bf16 v[16:19], v[180:183], a[112:115], v[16:19]
    ds_read_b64_tr_b16 v[194:195], v145 offset:50176
    v_mfma_f32_16x16x32_bf16 v[20:23], v[180:183], a[116:119], v[20:23]
    v_mfma_f32_16x16x32_bf16 v[20:23], v[176:179], a[100:103], v[20:23]
    ds_read_b64_tr_b16 v[196:197], v144 offset:58368
    v_mfma_f32_16x16x32_bf16 v[24:27], v[176:179], a[104:107], v[24:27]
    v_mfma_f32_16x16x32_bf16 v[24:27], v[180:183], a[120:123], v[24:27]
    ds_read_b64_tr_b16 v[198:199], v145 offset:58368
    v_mfma_f32_16x16x32_bf16 v[28:31], v[180:183], a[124:127], v[28:31]
    v_mfma_f32_16x16x32_bf16 v[28:31], v[176:179], a[108:111], v[28:31]
    s_waitcnt lgkmcnt(4)
    ds_read_b64_tr_b16 v[168:169], v144 offset:50688
    v_mfma_f32_16x16x32_bf16 v[44:47], v[184:187], a[108:111], v[44:47]
    v_mfma_f32_16x16x32_bf16 v[44:47], v[188:191], a[124:127], v[44:47]
    ds_read_b64_tr_b16 v[170:171], v145 offset:50688
    v_mfma_f32_16x16x32_bf16 v[40:43], v[188:191], a[120:123], v[40:43]
    v_mfma_f32_16x16x32_bf16 v[40:43], v[184:187], a[104:107], v[40:43]
    ds_read_b64_tr_b16 v[172:173], v144 offset:58880
    v_mfma_f32_16x16x32_bf16 v[36:39], v[184:187], a[100:103], v[36:39]
    v_mfma_f32_16x16x32_bf16 v[36:39], v[188:191], a[116:119], v[36:39]
    ds_read_b64_tr_b16 v[174:175], v145 offset:58880
    v_mfma_f32_16x16x32_bf16 v[32:35], v[188:191], a[112:115], v[32:35]
    v_mfma_f32_16x16x32_bf16 v[32:35], v[184:187], a[96:99], v[32:35]
    s_waitcnt lgkmcnt(4)
    ds_read_b64_tr_b16 v[176:177], v144 offset:51200
    v_mfma_f32_16x16x32_bf16 v[48:51], v[192:195], a[96:99], v[48:51]
    v_mfma_f32_16x16x32_bf16 v[48:51], v[196:199], a[112:115], v[48:51]
    ds_read_b64_tr_b16 v[178:179], v145 offset:51200
    v_mfma_f32_16x16x32_bf16 v[52:55], v[196:199], a[116:119], v[52:55]
    v_mfma_f32_16x16x32_bf16 v[52:55], v[192:195], a[100:103], v[52:55]
    ds_read_b64_tr_b16 v[180:181], v144 offset:59392
    v_mfma_f32_16x16x32_bf16 v[56:59], v[192:195], a[104:107], v[56:59]
    v_mfma_f32_16x16x32_bf16 v[56:59], v[196:199], a[120:123], v[56:59]
    ds_read_b64_tr_b16 v[182:183], v145 offset:59392
    v_mfma_f32_16x16x32_bf16 v[60:63], v[196:199], a[124:127], v[60:63]
    v_mfma_f32_16x16x32_bf16 v[60:63], v[192:195], a[108:111], v[60:63]
    s_waitcnt lgkmcnt(4)
    ds_read_b64_tr_b16 v[184:185], v144 offset:51712
    v_mfma_f32_16x16x32_bf16 v[76:79], v[168:171], a[108:111], v[76:79]
    v_mfma_f32_16x16x32_bf16 v[76:79], v[172:175], a[124:127], v[76:79]
    ds_read_b64_tr_b16 v[186:187], v145 offset:51712
    v_mfma_f32_16x16x32_bf16 v[72:75], v[172:175], a[120:123], v[72:75]
    v_mfma_f32_16x16x32_bf16 v[72:75], v[168:171], a[104:107], v[72:75]
    ds_read_b64_tr_b16 v[188:189], v144 offset:59904
    v_mfma_f32_16x16x32_bf16 v[68:71], v[168:171], a[100:103], v[68:71]
    v_mfma_f32_16x16x32_bf16 v[68:71], v[172:175], a[116:119], v[68:71]
    ds_read_b64_tr_b16 v[190:191], v145 offset:59904
    v_mfma_f32_16x16x32_bf16 v[64:67], v[172:175], a[112:115], v[64:67]
    v_mfma_f32_16x16x32_bf16 v[64:67], v[168:171], a[96:99], v[64:67]
    s_waitcnt lgkmcnt(4)
    ds_read_b64_tr_b16 v[192:193], v144 offset:52224
    v_mfma_f32_16x16x32_bf16 v[80:83], v[176:179], a[96:99], v[80:83]
    v_mfma_f32_16x16x32_bf16 v[80:83], v[180:183], a[112:115], v[80:83]
    ds_read_b64_tr_b16 v[194:195], v145 offset:52224
    v_mfma_f32_16x16x32_bf16 v[84:87], v[180:183], a[116:119], v[84:87]
    v_mfma_f32_16x16x32_bf16 v[84:87], v[176:179], a[100:103], v[84:87]
    ds_read_b64_tr_b16 v[196:197], v144 offset:60416
    v_mfma_f32_16x16x32_bf16 v[88:91], v[176:179], a[104:107], v[88:91]
    v_mfma_f32_16x16x32_bf16 v[88:91], v[180:183], a[120:123], v[88:91]
    ds_read_b64_tr_b16 v[198:199], v145 offset:60416
    v_mfma_f32_16x16x32_bf16 v[92:95], v[180:183], a[124:127], v[92:95]
    v_mfma_f32_16x16x32_bf16 v[92:95], v[176:179], a[108:111], v[92:95]
    s_waitcnt lgkmcnt(4)
    v_mfma_f32_16x16x32_bf16 v[108:111], v[184:187], a[108:111], v[108:111]
    v_mfma_f32_16x16x32_bf16 v[108:111], v[188:191], a[124:127], v[108:111]
    v_mfma_f32_16x16x32_bf16 v[104:107], v[188:191], a[120:123], v[104:107]
    v_mfma_f32_16x16x32_bf16 v[104:107], v[184:187], a[104:107], v[104:107]
    v_mfma_f32_16x16x32_bf16 v[100:103], v[184:187], a[100:103], v[100:103]
    v_mfma_f32_16x16x32_bf16 v[100:103], v[188:191], a[116:119], v[100:103]
    v_mfma_f32_16x16x32_bf16 v[96:99], v[188:191], a[112:115], v[96:99]
    v_mfma_f32_16x16x32_bf16 v[96:99], v[184:187], a[96:99], v[96:99]
    s_waitcnt lgkmcnt(0)
    v_mfma_f32_16x16x32_bf16 v[112:115], v[192:195], a[96:99], v[112:115]
    v_mfma_f32_16x16x32_bf16 v[112:115], v[196:199], a[112:115], v[112:115]
    v_mfma_f32_16x16x32_bf16 v[116:119], v[196:199], a[116:119], v[116:119]
    v_mfma_f32_16x16x32_bf16 v[116:119], v[192:195], a[100:103], v[116:119]
    v_mfma_f32_16x16x32_bf16 v[120:123], v[192:195], a[104:107], v[120:123]
    v_mfma_f32_16x16x32_bf16 v[120:123], v[196:199], a[120:123], v[120:123]
    v_mfma_f32_16x16x32_bf16 v[124:127], v[196:199], a[124:127], v[124:127]
    v_mfma_f32_16x16x32_bf16 v[124:127], v[192:195], a[108:111], v[124:127]
    s_barrier
    s_mul_i32 s24, s24, 57344
    s_mul_i32 s25, s5, 7
    s_lshr_b32 s25, s25, 1
    s_lshl_b32 s25, s25, 10
    s_add_u32 s24, s24, s25
    v_lshlrev_b32 v8, 4, v1
    s_bitcmp1_b32 s5, 0
    s_cbranch_scc1 f_g3_odd
    v_lshlrev_b32 v168, 16, v200
    v_and_b32 v169, 0xffff0000, v200
    v_lshlrev_b32 v170, 16, v201
    v_and_b32 v171, 0xffff0000, v201
    v_pk_mul_f32 v[16:17], v[16:17], v[168:169]
    v_pk_mul_f32 v[18:19], v[18:19], v[170:171]
    v_cvt_pk_bf16_f32 v16, v16, v17
    v_cvt_pk_bf16_f32 v17, v18, v19
    v_lshlrev_b32 v172, 16, v202
    v_and_b32 v173, 0xffff0000, v202
    v_lshlrev_b32 v174, 16, v203
    v_and_b32 v175, 0xffff0000, v203
    v_pk_mul_f32 v[32:33], v[32:33], v[172:173]
    v_pk_mul_f32 v[34:35], v[34:35], v[174:175]
    v_cvt_pk_bf16_f32 v18, v32, v33
    v_cvt_pk_bf16_f32 v19, v34, v35
    buffer_store_dwordx4 v[16:19], v8, s[20:23], s24 offen offset:0 sc1
    v_lshlrev_b32 v176, 16, v204
    v_and_b32 v177, 0xffff0000, v204
    v_lshlrev_b32 v178, 16, v205
    v_and_b32 v179, 0xffff0000, v205
    v_pk_mul_f32 v[48:49], v[48:49], v[176:177]
    v_pk_mul_f32 v[50:51], v[50:51], v[178:179]
    v_cvt_pk_bf16_f32 v48, v48, v49
    v_cvt_pk_bf16_f32 v49, v50, v51
    v_lshlrev_b32 v180, 16, v206
    v_and_b32 v181, 0xffff0000, v206
    v_lshlrev_b32 v182, 16, v207
    v_and_b32 v183, 0xffff0000, v207
    v_pk_mul_f32 v[64:65], v[64:65], v[180:181]
    v_pk_mul_f32 v[66:67], v[66:67], v[182:183]
    v_cvt_pk_bf16_f32 v50, v64, v65
    v_cvt_pk_bf16_f32 v51, v66, v67
    buffer_store_dwordx4 v[48:51], v8, s[20:23], s24 offen offset:1024 sc1
    v_lshlrev_b32 v168, 16, v208
    v_and_b32 v169, 0xffff0000, v208
    v_lshlrev_b32 v170, 16, v209
    v_and_b32 v171, 0xffff0000, v209
    v_pk_mul_f32 v[80:81], v[80:81], v[168:169]
    v_pk_mul_f32 v[82:83], v[82:83], v[170:171]
    v_cvt_pk_bf16_f32 v80, v80, v81
    v_cvt_pk_bf16_f32 v81, v82, v83
    v_lshlrev_b32 v172, 16, v210
    v_and_b32 v173, 0xffff0000, v210
    v_lshlrev_b32 v174, 16, v211
    v_and_b32 v175, 0xffff0000, v211
    v_pk_mul_f32 v[96:97], v[96:97], v[172:173]
    v_pk_mul_f32 v[98:99], v[98:99], v[174:175]
    v_cvt_pk_bf16_f32 v82, v96, v97
    v_cvt_pk_bf16_f32 v83, v98, v99
    buffer_store_dwordx4 v[80:83], v8, s[20:23], s24 offen offset:2048 sc1
    v_lshlrev_b32 v176, 16, v212
    v_and_b32 v177, 0xffff0000, v212
    v_lshlrev_b32 v178, 16, v213
    v_and_b32 v179, 0xffff0000, v213
    v_pk_mul_f32 v[112:113], v[112:113], v[176:177]
    v_pk_mul_f32 v[114:115], v[114:115], v[178:179]
    v_cvt_pk_bf16_f32 v112, v112, v113
    v_cvt_pk_bf16_f32 v113, v114, v115
    buffer_store_dwordx2 v[112:113], v8, s[20:23], s24 offen offset:3072 sc1
    s_add_u32 s24, s24, 57344
    v_lshlrev_b32 v180, 16, v214
    v_and_b32 v181, 0xffff0000, v214
    v_lshlrev_b32 v182, 16, v215
    v_and_b32 v183, 0xffff0000, v215
    v_pk_mul_f32 v[20:21], v[20:21], v[180:181]
    v_pk_mul_f32 v[22:23], v[22:23], v[182:183]
    v_cvt_pk_bf16_f32 v20, v20, v21
    v_cvt_pk_bf16_f32 v21, v22, v23
    v_lshlrev_b32 v168, 16, v216
    v_and_b32 v169, 0xffff0000, v216
    v_lshlrev_b32 v170, 16, v217
    v_and_b32 v171, 0xffff0000, v217
    v_pk_mul_f32 v[36:37], v[36:37], v[168:169]
    v_pk_mul_f32 v[38:39], v[38:39], v[170:171]
    v_cvt_pk_bf16_f32 v22, v36, v37
    v_cvt_pk_bf16_f32 v23, v38, v39
    buffer_store_dwordx4 v[20:23], v8, s[20:23], s24 offen offset:0 sc1
    v_lshlrev_b32 v172, 16, v218
    v_and_b32 v173, 0xffff0000, v218
    v_lshlrev_b32 v174, 16, v219
    v_and_b32 v175, 0xffff0000, v219
    v_pk_mul_f32 v[52:53], v[52:53], v[172:173]
    v_pk_mul_f32 v[54:55], v[54:55], v[174:175]
    v_cvt_pk_bf16_f32 v52, v52, v53
    v_cvt_pk_bf16_f32 v53, v54, v55
    v_lshlrev_b32 v176, 16, v220
    v_and_b32 v177, 0xffff0000, v220
    v_lshlrev_b32 v178, 16, v221
    v_and_b32 v179, 0xffff0000, v221
    v_pk_mul_f32 v[68:69], v[68:69], v[176:177]
    v_pk_mul_f32 v[70:71], v[70:71], v[178:179]
    v_cvt_pk_bf16_f32 v54, v68, v69
    v_cvt_pk_bf16_f32 v55, v70, v71
    buffer_store_dwordx4 v[52:55], v8, s[20:23], s24 offen offset:1024 sc1
    v_lshlrev_b32 v180, 16, v222
    v_and_b32 v181, 0xffff0000, v222
    v_lshlrev_b32 v182, 16, v223
    v_and_b32 v183, 0xffff0000, v223
    v_pk_mul_f32 v[84:85], v[84:85], v[180:181]
    v_pk_mul_f32 v[86:87], v[86:87], v[182:183]
    v_cvt_pk_bf16_f32 v84, v84, v85
    v_cvt_pk_bf16_f32 v85, v86, v87
    v_lshlrev_b32 v168, 16, v224
    v_and_b32 v169, 0xffff0000, v224
    v_lshlrev_b32 v170, 16, v225
    v_and_b32 v171, 0xffff0000, v225
    v_pk_mul_f32 v[100:101], v[100:101], v[168:169]
    v_pk_mul_f32 v[102:103], v[102:103], v[170:171]
    v_cvt_pk_bf16_f32 v86, v100, v101
    v_cvt_pk_bf16_f32 v87, v102, v103
    buffer_store_dwordx4 v[84:87], v8, s[20:23], s24 offen offset:2048 sc1
    v_lshlrev_b32 v172, 16, v226
    v_and_b32 v173, 0xffff0000, v226
    v_lshlrev_b32 v174, 16, v227
    v_and_b32 v175, 0xffff0000, v227
    v_pk_mul_f32 v[116:117], v[116:117], v[172:173]
    v_pk_mul_f32 v[118:119], v[118:119], v[174:175]
    v_cvt_pk_bf16_f32 v116, v116, v117
    v_cvt_pk_bf16_f32 v117, v118, v119
    buffer_store_dwordx2 v[116:117], v8, s[20:23], s24 offen offset:3072 sc1
    s_add_u32 s24, s24, 57344
    v_lshlrev_b32 v176, 16, v228
    v_and_b32 v177, 0xffff0000, v228
    v_lshlrev_b32 v178, 16, v229
    v_and_b32 v179, 0xffff0000, v229
    v_pk_mul_f32 v[24:25], v[24:25], v[176:177]
    v_pk_mul_f32 v[26:27], v[26:27], v[178:179]
    v_cvt_pk_bf16_f32 v24, v24, v25
    v_cvt_pk_bf16_f32 v25, v26, v27
    v_lshlrev_b32 v180, 16, v230
    v_and_b32 v181, 0xffff0000, v230
    v_lshlrev_b32 v182, 16, v231
    v_and_b32 v183, 0xffff0000, v231
    v_pk_mul_f32 v[40:41], v[40:41], v[180:181]
    v_pk_mul_f32 v[42:43], v[42:43], v[182:183]
    v_cvt_pk_bf16_f32 v26, v40, v41
    v_cvt_pk_bf16_f32 v27, v42, v43
    buffer_store_dwordx4 v[24:27], v8, s[20:23], s24 offen offset:0 sc1
    v_lshlrev_b32 v168, 16, v232
    v_and_b32 v169, 0xffff0000, v232
    v_lshlrev_b32 v170, 16, v233
    v_and_b32 v171, 0xffff0000, v233
    v_pk_mul_f32 v[56:57], v[56:57], v[168:169]
    v_pk_mul_f32 v[58:59], v[58:59], v[170:171]
    v_cvt_pk_bf16_f32 v56, v56, v57
    v_cvt_pk_bf16_f32 v57, v58, v59
    v_lshlrev_b32 v172, 16, v234
    v_and_b32 v173, 0xffff0000, v234
    v_lshlrev_b32 v174, 16, v235
    v_and_b32 v175, 0xffff0000, v235
    v_pk_mul_f32 v[72:73], v[72:73], v[172:173]
    v_pk_mul_f32 v[74:75], v[74:75], v[174:175]
    v_cvt_pk_bf16_f32 v58, v72, v73
    v_cvt_pk_bf16_f32 v59, v74, v75
    buffer_store_dwordx4 v[56:59], v8, s[20:23], s24 offen offset:1024 sc1
    v_lshlrev_b32 v176, 16, v236
    v_and_b32 v177, 0xffff0000, v236
    v_lshlrev_b32 v178, 16, v237
    v_and_b32 v179, 0xffff0000, v237
    v_pk_mul_f32 v[88:89], v[88:89], v[176:177]
    v_pk_mul_f32 v[90:91], v[90:91], v[178:179]
    v_cvt_pk_bf16_f32 v88, v88, v89
    v_cvt_pk_bf16_f32 v89, v90, v91
    v_lshlrev_b32 v180, 16, v238
    v_and_b32 v181, 0xffff0000, v238
    v_lshlrev_b32 v182, 16, v239
    v_and_b32 v183, 0xffff0000, v239
    v_pk_mul_f32 v[104:105], v[104:105], v[180:181]
    v_pk_mul_f32 v[106:107], v[106:107], v[182:183]
    v_cvt_pk_bf16_f32 v90, v104, v105
    v_cvt_pk_bf16_f32 v91, v106, v107
    buffer_store_dwordx4 v[88:91], v8, s[20:23], s24 offen offset:2048 sc1
    v_lshlrev_b32 v168, 16, v240
    v_and_b32 v169, 0xffff0000, v240
    v_lshlrev_b32 v170, 16, v241
    v_and_b32 v171, 0xffff0000, v241
    v_pk_mul_f32 v[120:121], v[120:121], v[168:169]
    v_pk_mul_f32 v[122:123], v[122:123], v[170:171]
    v_cvt_pk_bf16_f32 v120, v120, v121
    v_cvt_pk_bf16_f32 v121, v122, v123
    buffer_store_dwordx2 v[120:121], v8, s[20:23], s24 offen offset:3072 sc1
    s_add_u32 s24, s24, 57344
    v_lshlrev_b32 v172, 16, v242
    v_and_b32 v173, 0xffff0000, v242
    v_lshlrev_b32 v174, 16, v243
    v_and_b32 v175, 0xffff0000, v243
    v_pk_mul_f32 v[28:29], v[28:29], v[172:173]
    v_pk_mul_f32 v[30:31], v[30:31], v[174:175]
    v_cvt_pk_bf16_f32 v28, v28, v29
    v_cvt_pk_bf16_f32 v29, v30, v31
    v_lshlrev_b32 v176, 16, v244
    v_and_b32 v177, 0xffff0000, v244
    v_lshlrev_b32 v178, 16, v245
    v_and_b32 v179, 0xffff0000, v245
    v_pk_mul_f32 v[44:45], v[44:45], v[176:177]
    v_pk_mul_f32 v[46:47], v[46:47], v[178:179]
    v_cvt_pk_bf16_f32 v30, v44, v45
    v_cvt_pk_bf16_f32 v31, v46, v47
    buffer_store_dwordx4 v[28:31], v8, s[20:23], s24 offen offset:0 sc1
    v_lshlrev_b32 v180, 16, v246
    v_and_b32 v181, 0xffff0000, v246
    v_lshlrev_b32 v182, 16, v247
    v_and_b32 v183, 0xffff0000, v247
    v_pk_mul_f32 v[60:61], v[60:61], v[180:181]
    v_pk_mul_f32 v[62:63], v[62:63], v[182:183]
    v_cvt_pk_bf16_f32 v60, v60, v61
    v_cvt_pk_bf16_f32 v61, v62, v63
    v_lshlrev_b32 v168, 16, v248
    v_and_b32 v169, 0xffff0000, v248
    v_lshlrev_b32 v170, 16, v249
    v_and_b32 v171, 0xffff0000, v249
    v_pk_mul_f32 v[76:77], v[76:77], v[168:169]
    v_pk_mul_f32 v[78:79], v[78:79], v[170:171]
    v_cvt_pk_bf16_f32 v62, v76, v77
    v_cvt_pk_bf16_f32 v63, v78, v79
    buffer_store_dwordx4 v[60:63], v8, s[20:23], s24 offen offset:1024 sc1
    v_lshlrev_b32 v172, 16, v250
    v_and_b32 v173, 0xffff0000, v250
    v_lshlrev_b32 v174, 16, v251
    v_and_b32 v175, 0xffff0000, v251
    v_pk_mul_f32 v[92:93], v[92:93], v[172:173]
    v_pk_mul_f32 v[94:95], v[94:95], v[174:175]
    v_cvt_pk_bf16_f32 v92, v92, v93
    v_cvt_pk_bf16_f32 v93, v94, v95
    v_lshlrev_b32 v176, 16, v252
    v_and_b32 v177, 0xffff0000, v252
    v_lshlrev_b32 v178, 16, v253
    v_and_b32 v179, 0xffff0000, v253
    v_pk_mul_f32 v[108:109], v[108:109], v[176:177]
    v_pk_mul_f32 v[110:111], v[110:111], v[178:179]
    v_cvt_pk_bf16_f32 v94, v108, v109
    v_cvt_pk_bf16_f32 v95, v110, v111
    buffer_store_dwordx4 v[92:95], v8, s[20:23], s24 offen offset:2048 sc1
    v_lshlrev_b32 v180, 16, v254
    v_and_b32 v181, 0xffff0000, v254
    v_lshlrev_b32 v182, 16, v255
    v_and_b32 v183, 0xffff0000, v255
    v_pk_mul_f32 v[124:125], v[124:125], v[180:181]
    v_pk_mul_f32 v[126:127], v[126:127], v[182:183]
    v_cvt_pk_bf16_f32 v124, v124, v125
    v_cvt_pk_bf16_f32 v125, v126, v127
    buffer_store_dwordx2 v[124:125], v8, s[20:23], s24 offen offset:3072 sc1
    s_branch f_g3_st
f_g3_odd:
    v_lshlrev_b32 v168, 16, v200
    v_and_b32 v169, 0xffff0000, v200
    v_lshlrev_b32 v170, 16, v201
    v_and_b32 v171, 0xffff0000, v201
    v_pk_mul_f32 v[16:17], v[16:17], v[168:169]
    v_pk_mul_f32 v[18:19], v[18:19], v[170:171]
    v_cvt_pk_bf16_f32 v16, v16, v17
    v_cvt_pk_bf16_f32 v17, v18, v19
    buffer_store_dwordx2 v[16:17], v8, s[20:23], s24 offen offset:8 sc1
    v_lshlrev_b32 v172, 16, v202
    v_and_b32 v173, 0xffff0000, v202
    v_lshlrev_b32 v174, 16, v203
    v_and_b32 v175, 0xffff0000, v203
    v_pk_mul_f32 v[32:33], v[32:33], v[172:173]
    v_pk_mul_f32 v[34:35], v[34:35], v[174:175]
    v_cvt_pk_bf16_f32 v32, v32, v33
    v_cvt_pk_bf16_f32 v33, v34, v35
    v_lshlrev_b32 v176, 16, v204
    v_and_b32 v177, 0xffff0000, v204
    v_lshlrev_b32 v178, 16, v205
    v_and_b32 v179, 0xffff0000, v205
    v_pk_mul_f32 v[48:49], v[48:49], v[176:177]
    v_pk_mul_f32 v[50:51], v[50:51], v[178:179]
    v_cvt_pk_bf16_f32 v34, v48, v49
    v_cvt_pk_bf16_f32 v35, v50, v51
    buffer_store_dwordx4 v[32:35], v8, s[20:23], s24 offen offset:1024 sc1
    v_lshlrev_b32 v180, 16, v206
    v_and_b32 v181, 0xffff0000, v206
    v_lshlrev_b32 v182, 16, v207
    v_and_b32 v183, 0xffff0000, v207
    v_pk_mul_f32 v[64:65], v[64:65], v[180:181]
    v_pk_mul_f32 v[66:67], v[66:67], v[182:183]
    v_cvt_pk_bf16_f32 v64, v64, v65
    v_cvt_pk_bf16_f32 v65, v66, v67
    v_lshlrev_b32 v168, 16, v208
    v_and_b32 v169, 0xffff0000, v208
    v_lshlrev_b32 v170, 16, v209
    v_and_b32 v171, 0xffff0000, v209
    v_pk_mul_f32 v[80:81], v[80:81], v[168:169]
    v_pk_mul_f32 v[82:83], v[82:83], v[170:171]
    v_cvt_pk_bf16_f32 v66, v80, v81
    v_cvt_pk_bf16_f32 v67, v82, v83
    buffer_store_dwordx4 v[64:67], v8, s[20:23], s24 offen offset:2048 sc1
    v_lshlrev_b32 v172, 16, v210
    v_and_b32 v173, 0xffff0000, v210
    v_lshlrev_b32 v174, 16, v211
    v_and_b32 v175, 0xffff0000, v211
    v_pk_mul_f32 v[96:97], v[96:97], v[172:173]
    v_pk_mul_f32 v[98:99], v[98:99], v[174:175]
    v_cvt_pk_bf16_f32 v96, v96, v97
    v_cvt_pk_bf16_f32 v97, v98, v99
    v_lshlrev_b32 v176, 16, v212
    v_and_b32 v177, 0xffff0000, v212
    v_lshlrev_b32 v178, 16, v213
    v_and_b32 v179, 0xffff0000, v213
    v_pk_mul_f32 v[112:113], v[112:113], v[176:177]
    v_pk_mul_f32 v[114:115], v[114:115], v[178:179]
    v_cvt_pk_bf16_f32 v98, v112, v113
    v_cvt_pk_bf16_f32 v99, v114, v115
    buffer_store_dwordx4 v[96:99], v8, s[20:23], s24 offen offset:3072 sc1
    s_add_u32 s24, s24, 57344
    v_lshlrev_b32 v180, 16, v214
    v_and_b32 v181, 0xffff0000, v214
    v_lshlrev_b32 v182, 16, v215
    v_and_b32 v183, 0xffff0000, v215
    v_pk_mul_f32 v[20:21], v[20:21], v[180:181]
    v_pk_mul_f32 v[22:23], v[22:23], v[182:183]
    v_cvt_pk_bf16_f32 v20, v20, v21
    v_cvt_pk_bf16_f32 v21, v22, v23
    buffer_store_dwordx2 v[20:21], v8, s[20:23], s24 offen offset:8 sc1
    v_lshlrev_b32 v168, 16, v216
    v_and_b32 v169, 0xffff0000, v216
    v_lshlrev_b32 v170, 16, v217
    v_and_b32 v171, 0xffff0000, v217
    v_pk_mul_f32 v[36:37], v[36:37], v[168:169]
    v_pk_mul_f32 v[38:39], v[38:39], v[170:171]
    v_cvt_pk_bf16_f32 v36, v36, v37
    v_cvt_pk_bf16_f32 v37, v38, v39
    v_lshlrev_b32 v172, 16, v218
    v_and_b32 v173, 0xffff0000, v218
    v_lshlrev_b32 v174, 16, v219
    v_and_b32 v175, 0xffff0000, v219
    v_pk_mul_f32 v[52:53], v[52:53], v[172:173]
    v_pk_mul_f32 v[54:55], v[54:55], v[174:175]
    v_cvt_pk_bf16_f32 v38, v52, v53
    v_cvt_pk_bf16_f32 v39, v54, v55
    buffer_store_dwordx4 v[36:39], v8, s[20:23], s24 offen offset:1024 sc1
    v_lshlrev_b32 v176, 16, v220
    v_and_b32 v177, 0xffff0000, v220
    v_lshlrev_b32 v178, 16, v221
    v_and_b32 v179, 0xffff0000, v221
    v_pk_mul_f32 v[68:69], v[68:69], v[176:177]
    v_pk_mul_f32 v[70:71], v[70:71], v[178:179]
    v_cvt_pk_bf16_f32 v68, v68, v69
    v_cvt_pk_bf16_f32 v69, v70, v71
    v_lshlrev_b32 v180, 16, v222
    v_and_b32 v181, 0xffff0000, v222
    v_lshlrev_b32 v182, 16, v223
    v_and_b32 v183, 0xffff0000, v223
    v_pk_mul_f32 v[84:85], v[84:85], v[180:181]
    v_pk_mul_f32 v[86:87], v[86:87], v[182:183]
    v_cvt_pk_bf16_f32 v70, v84, v85
    v_cvt_pk_bf16_f32 v71, v86, v87
    buffer_store_dwordx4 v[68:71], v8, s[20:23], s24 offen offset:2048 sc1
    v_lshlrev_b32 v168, 16, v224
    v_and_b32 v169, 0xffff0000, v224
    v_lshlrev_b32 v170, 16, v225
    v_and_b32 v171, 0xffff0000, v225
    v_pk_mul_f32 v[100:101], v[100:101], v[168:169]
    v_pk_mul_f32 v[102:103], v[102:103], v[170:171]
    v_cvt_pk_bf16_f32 v100, v100, v101
    v_cvt_pk_bf16_f32 v101, v102, v103
    v_lshlrev_b32 v172, 16, v226
    v_and_b32 v173, 0xffff0000, v226
    v_lshlrev_b32 v174, 16, v227
    v_and_b32 v175, 0xffff0000, v227
    v_pk_mul_f32 v[116:117], v[116:117], v[172:173]
    v_pk_mul_f32 v[118:119], v[118:119], v[174:175]
    v_cvt_pk_bf16_f32 v102, v116, v117
    v_cvt_pk_bf16_f32 v103, v118, v119
    buffer_store_dwordx4 v[100:103], v8, s[20:23], s24 offen offset:3072 sc1
    s_add_u32 s24, s24, 57344
    v_lshlrev_b32 v176, 16, v228
    v_and_b32 v177, 0xffff0000, v228
    v_lshlrev_b32 v178, 16, v229
    v_and_b32 v179, 0xffff0000, v229
    v_pk_mul_f32 v[24:25], v[24:25], v[176:177]
    v_pk_mul_f32 v[26:27], v[26:27], v[178:179]
    v_cvt_pk_bf16_f32 v24, v24, v25
    v_cvt_pk_bf16_f32 v25, v26, v27
    buffer_store_dwordx2 v[24:25], v8, s[20:23], s24 offen offset:8 sc1
    v_lshlrev_b32 v180, 16, v230
    v_and_b32 v181, 0xffff0000, v230
    v_lshlrev_b32 v182, 16, v231
    v_and_b32 v183, 0xffff0000, v231
    v_pk_mul_f32 v[40:41], v[40:41], v[180:181]
    v_pk_mul_f32 v[42:43], v[42:43], v[182:183]
    v_cvt_pk_bf16_f32 v40, v40, v41
    v_cvt_pk_bf16_f32 v41, v42, v43
    v_lshlrev_b32 v168, 16, v232
    v_and_b32 v169, 0xffff0000, v232
    v_lshlrev_b32 v170, 16, v233
    v_and_b32 v171, 0xffff0000, v233
    v_pk_mul_f32 v[56:57], v[56:57], v[168:169]
    v_pk_mul_f32 v[58:59], v[58:59], v[170:171]
    v_cvt_pk_bf16_f32 v42, v56, v57
    v_cvt_pk_bf16_f32 v43, v58, v59
    buffer_store_dwordx4 v[40:43], v8, s[20:23], s24 offen offset:1024 sc1
    v_lshlrev_b32 v172, 16, v234
    v_and_b32 v173, 0xffff0000, v234
    v_lshlrev_b32 v174, 16, v235
    v_and_b32 v175, 0xffff0000, v235
    v_pk_mul_f32 v[72:73], v[72:73], v[172:173]
    v_pk_mul_f32 v[74:75], v[74:75], v[174:175]
    v_cvt_pk_bf16_f32 v72, v72, v73
    v_cvt_pk_bf16_f32 v73, v74, v75
    v_lshlrev_b32 v176, 16, v236
    v_and_b32 v177, 0xffff0000, v236
    v_lshlrev_b32 v178, 16, v237
    v_and_b32 v179, 0xffff0000, v237
    v_pk_mul_f32 v[88:89], v[88:89], v[176:177]
    v_pk_mul_f32 v[90:91], v[90:91], v[178:179]
    v_cvt_pk_bf16_f32 v74, v88, v89
    v_cvt_pk_bf16_f32 v75, v90, v91
    buffer_store_dwordx4 v[72:75], v8, s[20:23], s24 offen offset:2048 sc1
    v_lshlrev_b32 v180, 16, v238
    v_and_b32 v181, 0xffff0000, v238
    v_lshlrev_b32 v182, 16, v239
    v_and_b32 v183, 0xffff0000, v239
    v_pk_mul_f32 v[104:105], v[104:105], v[180:181]
    v_pk_mul_f32 v[106:107], v[106:107], v[182:183]
    v_cvt_pk_bf16_f32 v104, v104, v105
    v_cvt_pk_bf16_f32 v105, v106, v107
    v_lshlrev_b32 v168, 16, v240
    v_and_b32 v169, 0xffff0000, v240
    v_lshlrev_b32 v170, 16, v241
    v_and_b32 v171, 0xffff0000, v241
    v_pk_mul_f32 v[120:121], v[120:121], v[168:169]
    v_pk_mul_f32 v[122:123], v[122:123], v[170:171]
    v_cvt_pk_bf16_f32 v106, v120, v121
    v_cvt_pk_bf16_f32 v107, v122, v123
    buffer_store_dwordx4 v[104:107], v8, s[20:23], s24 offen offset:3072 sc1
    s_add_u32 s24, s24, 57344
    v_lshlrev_b32 v172, 16, v242
    v_and_b32 v173, 0xffff0000, v242
    v_lshlrev_b32 v174, 16, v243
    v_and_b32 v175, 0xffff0000, v243
    v_pk_mul_f32 v[28:29], v[28:29], v[172:173]
    v_pk_mul_f32 v[30:31], v[30:31], v[174:175]
    v_cvt_pk_bf16_f32 v28, v28, v29
    v_cvt_pk_bf16_f32 v29, v30, v31
    buffer_store_dwordx2 v[28:29], v8, s[20:23], s24 offen offset:8 sc1
    v_lshlrev_b32 v176, 16, v244
    v_and_b32 v177, 0xffff0000, v244
    v_lshlrev_b32 v178, 16, v245
    v_and_b32 v179, 0xffff0000, v245
    v_pk_mul_f32 v[44:45], v[44:45], v[176:177]
    v_pk_mul_f32 v[46:47], v[46:47], v[178:179]
    v_cvt_pk_bf16_f32 v44, v44, v45
    v_cvt_pk_bf16_f32 v45, v46, v47
    v_lshlrev_b32 v180, 16, v246
    v_and_b32 v181, 0xffff0000, v246
    v_lshlrev_b32 v182, 16, v247
    v_and_b32 v183, 0xffff0000, v247
    v_pk_mul_f32 v[60:61], v[60:61], v[180:181]
    v_pk_mul_f32 v[62:63], v[62:63], v[182:183]
    v_cvt_pk_bf16_f32 v46, v60, v61
    v_cvt_pk_bf16_f32 v47, v62, v63
    buffer_store_dwordx4 v[44:47], v8, s[20:23], s24 offen offset:1024 sc1
    v_lshlrev_b32 v168, 16, v248
    v_and_b32 v169, 0xffff0000, v248
    v_lshlrev_b32 v170, 16, v249
    v_and_b32 v171, 0xffff0000, v249
    v_pk_mul_f32 v[76:77], v[76:77], v[168:169]
    v_pk_mul_f32 v[78:79], v[78:79], v[170:171]
    v_cvt_pk_bf16_f32 v76, v76, v77
    v_cvt_pk_bf16_f32 v77, v78, v79
    v_lshlrev_b32 v172, 16, v250
    v_and_b32 v173, 0xffff0000, v250
    v_lshlrev_b32 v174, 16, v251
    v_and_b32 v175, 0xffff0000, v251
    v_pk_mul_f32 v[92:93], v[92:93], v[172:173]
    v_pk_mul_f32 v[94:95], v[94:95], v[174:175]
    v_cvt_pk_bf16_f32 v78, v92, v93
    v_cvt_pk_bf16_f32 v79, v94, v95
    buffer_store_dwordx4 v[76:79], v8, s[20:23], s24 offen offset:2048 sc1
    v_lshlrev_b32 v176, 16, v252
    v_and_b32 v177, 0xffff0000, v252
    v_lshlrev_b32 v178, 16, v253
    v_and_b32 v179, 0xffff0000, v253
    v_pk_mul_f32 v[108:109], v[108:109], v[176:177]
    v_pk_mul_f32 v[110:111], v[110:111], v[178:179]
    v_cvt_pk_bf16_f32 v108, v108, v109
    v_cvt_pk_bf16_f32 v109, v110, v111
    v_lshlrev_b32 v180, 16, v254
    v_and_b32 v181, 0xffff0000, v254
    v_lshlrev_b32 v182, 16, v255
    v_and_b32 v183, 0xffff0000, v255
    v_pk_mul_f32 v[124:125], v[124:125], v[180:181]
    v_pk_mul_f32 v[126:127], v[126:127], v[182:183]
    v_cvt_pk_bf16_f32 v110, v124, v125
    v_cvt_pk_bf16_f32 v111, v126, v127
    buffer_store_dwordx4 v[108:111], v8, s[20:23], s24 offen offset:3072 sc1
f_g3_st:
    s_lshl_b32 s39, s4, 7
    s_lshl_b32 s25, s5, 3
    s_add_u32 s39, s39, s25
    s_waitcnt vmcnt(0)
    s_barrier
    s_cmp_lg_u32 s3, 0
    s_cbranch_scc1 f_y_nopub
    v_mov_b32 v8, s50
    v_mov_b32 v9, s51
    s_mov_b64 exec, 1
    buffer_store_dwordx2 v[8:9], off, s[96:99], s39 sc1
    s_mov_b64 exec, -1
f_y_nopub:
    s_add_u32 s45, s45, 0x2000
    s_add_u32 m0, s46, 0
    s_nop 0
    buffer_load_dwordx4 v12, s[52:55], s45 offen offset:0 lds
    s_add_u32 m0, s46, 0
    s_nop 0
    buffer_load_dwordx4 v12, s[52:55], s45 offen offset:1024 lds
    s_add_u32 s45, s45, 0x2000
    s_add_u32 m0, s46, 2048
    s_nop 0
    buffer_load_dwordx4 v12, s[52:55], s45 offen offset:0 lds
    s_add_u32 m0, s46, 2048
    s_nop 0
    buffer_load_dwordx4 v12, s[52:55], s45 offen offset:1024 lds
    s_add_u32 s45, s45, 0x2000
    s_add_u32 m0, s46, 4096
    s_nop 0
    buffer_load_dwordx4 v12, s[52:55], s45 offen offset:0 lds
    s_add_u32 m0, s46, 4096
    s_nop 0
    buffer_load_dwordx4 v12, s[52:55], s45 offen offset:1024 lds
    s_add_u32 s45, s45, 0x2000
    s_add_u32 m0, s46, 6144
    s_nop 0
    buffer_load_dwordx4 v12, s[52:55], s45 offen offset:0 lds
    s_add_u32 m0, s46, 6144
    s_nop 0
    buffer_load_dwordx4 v12, s[52:55], s45 offen offset:1024 lds
    s_add_u32 s45, s45, 0x2000
    s_add_u32 m0, s46, 8192
    s_nop 0
    buffer_load_dwordx4 v12, s[52:55], s45 offen offset:0 lds
    s_add_u32 m0, s46, 8192
    s_nop 0
    buffer_load_dwordx4 v12, s[52:55], s45 offen offset:1024 lds
    s_add_u32 s45, s45, 0x2000
    s_add_u32 m0, s46, 10240
    s_nop 0
    buffer_load_dwordx4 v12, s[52:55], s45 offen offset:0 lds
    s_add_u32 m0, s46, 10240
    s_nop 0
    buffer_load_dwordx4 v12, s[52:55], s45 offen offset:1024 lds
    s_add_u32 s45, s45, 0x2000
    s_add_u32 m0, s46, 12288
    s_nop 0
    buffer_load_dwordx4 v12, s[52:55], s45 offen offset:0 lds
    s_add_u32 m0, s46, 12288
    s_nop 0
    buffer_load_dwordx4 v12, s[52:55], s45 offen offset:1024 lds
    s_add_u32 s45, s45, 0x2000
    s_add_u32 m0, s46, 14336
    s_nop 0
    buffer_load_dwordx4 v12, s[52:55], s45 offen offset:0 lds
    s_add_u32 m0, s46, 14336
    s_nop 0
    buffer_load_dwordx4 v12, s[52:55], s45 offen offset:1024 lds
    s_add_u32 s45, s45, 0x2000
    s_add_u32 m0, s46, 16384
    s_nop 0
    buffer_load_dwordx4 v12, s[52:55], s45 offen offset:0 lds
    s_add_u32 m0, s46, 16384
    s_nop 0
    buffer_load_dwordx4 v12, s[52:55], s45 offen offset:1024 lds
    s_add_u32 s45, s45, 0x2000
    s_add_u32 m0, s46, 18432
    s_nop 0
    buffer_load_dwordx4 v12, s[52:55], s45 offen offset:0 lds
    s_add_u32 m0, s46, 18432
    s_nop 0
    buffer_load_dwordx4 v12, s[52:55], s45 offen offset:1024 lds
    s_add_u32 s45, s45, 0x2000
    s_add_u32 m0, s46, 20480
    s_nop 0
    buffer_load_dwordx4 v12, s[52:55], s45 offen offset:0 lds
    s_add_u32 m0, s46, 20480
    s_nop 0
    buffer_load_dwordx4 v12, s[52:55], s45 offen offset:1024 lds
    s_add_u32 s45, s45, 0x2000
    s_add_u32 m0, s46, 22528
    s_nop 0
    buffer_load_dwordx4 v12, s[52:55], s45 offen offset:0 lds
    s_add_u32 m0, s46, 22528
    s_nop 0
    buffer_load_dwordx4 v12, s[52:55], s45 offen offset:1024 lds
    s_add_u32 s45, s45, 0x2000
    s_add_u32 m0, s47, 0
    s_nop 0
    buffer_load_dwordx4 v12, s[52:55], s45 offen offset:0 lds
    s_add_u32 m0, s47, 0
    s_nop 0
    buffer_load_dwordx4 v12, s[52:55], s45 offen offset:1024 lds
    s_add_u32 s45, s45, 0x2000
    s_add_u32 m0, s47, 2048
    s_nop 0
    buffer_load_dwordx4 v12, s[52:55], s45 offen offset:0 lds
    s_add_u32 m0, s47, 2048
    s_nop 0
    buffer_load_dwordx4 v12, s[52:55], s45 offen offset:1024 lds
    s_add_u32 s45, s45, 0x2000
    s_add_u32 m0, s47, 4096
    s_nop 0
    buffer_load_dwordx4 v12, s[52:55], s45 offen offset:0 lds
    s_add_u32 m0, s47, 4096
    s_nop 0
    buffer_load_dwordx4 v12, s[52:55], s45 offen offset:1024 lds
    s_add_u32 s45, s45, 0x2000
    s_add_u32 m0, s47, 6144
    s_nop 0
    buffer_load_dwordx4 v12, s[52:55], s45 offen offset:0 lds
    s_add_u32 m0, s47, 6144
    s_nop 0
    buffer_load_dwordx4 v12, s[52:55], s45 offen offset:1024 lds
    s_add_u32 s45, s45, 0x2000
    s_add_u32 m0, s47, 8192
    s_nop 0
    buffer_load_dwordx4 v12, s[52:55], s45 offen offset:0 lds
    s_add_u32 m0, s47, 8192
    s_nop 0
    buffer_load_dwordx4 v12, s[52:55], s45 offen offset:1024 lds
    s_add_u32 s45, s45, 0x2000
    s_add_u32 m0, s47, 10240
    s_nop 0
    buffer_load_dwordx4 v12, s[52:55], s45 offen offset:0 lds
    s_add_u32 m0, s47, 10240
    s_nop 0
    buffer_load_dwordx4 v12, s[52:55], s45 offen offset:1024 lds
    s_add_u32 s45, s45, 0x2000
    s_add_u32 m0, s47, 12288
    s_nop 0
    buffer_load_dwordx4 v12, s[52:55], s45 offen offset:0 lds
    s_add_u32 m0, s47, 12288
    s_nop 0
    buffer_load_dwordx4 v12, s[52:55], s45 offen offset:1024 lds
    s_add_u32 s45, s45, 0x2000
    s_add_u32 m0, s47, 14336
    s_nop 0
    buffer_load_dwordx4 v12, s[52:55], s45 offen offset:0 lds
    s_add_u32 m0, s47, 14336
    s_nop 0
    buffer_load_dwordx4 v12, s[52:55], s45 offen offset:1024 lds
    s_waitcnt vmcnt(0)
    s_cmp_lg_u32 s3, 0
    s_cbranch_scc1 f_y_rdy2
    v_lshlrev_b32 v10, 3, v1
    s_mov_b64 exec, 0xffff
f_y_spin2:
    buffer_load_dwordx2 v[8:9], v10, s[96:99], s63 offen sc1
    s_waitcnt vmcnt(0)
    v_cmp_ne_u64 vcc, s[50:51], v[8:9]
    s_nop 1
    s_cmp_lg_u64 vcc, 0
    s_cbranch_scc1 f_y_spin2
f_y_got2:
    s_mov_b64 exec, -1
f_y_rdy2:
    s_barrier
    s_mov_b32 s37, 4294966272
    s_add_u32 s37, s37, 1024
    buffer_load_dwordx4 a[0:3], v2, s[88:91], s37 offen
    buffer_load_dwordx4 a[4:7], v3, s[88:91], s37 offen
    s_add_u32 s37, s37, 1024
    buffer_load_dwordx4 a[8:11], v2, s[88:91], s37 offen
    buffer_load_dwordx4 a[12:15], v3, s[88:91], s37 offen
    s_add_u32 s37, s37, 1024
    buffer_load_dwordx4 a[16:19], v2, s[88:91], s37 offen
    buffer_load_dwordx4 a[20:23], v3, s[88:91], s37 offen
    s_add_u32 s37, s37, 1024
    buffer_load_dwordx4 a[24:27], v2, s[88:91], s37 offen sc1
    buffer_load_dwordx4 a[28:31], v3, s[88:91], s37 offen sc1
    s_add_u32 s37, s37, 1024
    buffer_load_dwordx4 a[32:35], v2, s[88:91], s37 offen
    buffer_load_dwordx4 a[36:39], v3, s[88:91], s37 offen
    s_add_u32 s37, s37, 1024
    buffer_load_dwordx4 a[40:43], v2, s[88:91], s37 offen
    buffer_load_dwordx4 a[44:47], v3, s[88:91], s37 offen
    s_add_u32 s37, s37, 1024
    buffer_load_dwordx4 a[48:51], v2, s[88:91], s37 offen
    buffer_load_dwordx4 a[52:55], v3, s[88:91], s37 offen
    s_add_u32 s37, s37, 1024
    buffer_load_dwordx4 a[56:59], v2, s[88:91], s37 offen
    buffer_load_dwordx4 a[60:63], v3, s[88:91], s37 offen
    s_add_u32 s37, s37, 1024
    buffer_load_dwordx4 a[64:67], v2, s[88:91], s37 offen
    buffer_load_dwordx4 a[68:71], v3, s[88:91], s37 offen
    s_add_u32 s37, s37, 1024
    buffer_load_dwordx4 a[72:75], v2, s[88:91], s37 offen
    buffer_load_dwordx4 a[76:79], v3, s[88:91], s37 offen
    s_add_u32 s37, s37, 1024
    buffer_load_dwordx4 a[80:83], v2, s[88:91], s37 offen sc1
    buffer_load_dwordx4 a[84:87], v3, s[88:91], s37 offen sc1
    v_lshrrev_b32 v8, 2, v1
    v_bfe_u32 v9, v8, 1, 2
    v_lshlrev_b32 v9, 1, v9
    v_bfe_u32 v10, v1, 1, 1
    v_xor_b32 v9, v9, v10
    v_lshlrev_b32 v8, 7, v8
    v_and_b32 v10, 1, v1
    v_lshl_add_u32 v8, v10, 3, v8
    v_xor_b32 v10, 0, v9
    v_lshl_add_u32 v48, v10, 4, v8
    v_add_u32 v52, 0x10000, v48
    v_add_u32 v56, 0x20000, v48
    v_xor_b32 v10, 2, v9
    v_lshl_add_u32 v49, v10, 4, v8
    v_add_u32 v53, 0x10000, v49
    v_add_u32 v57, 0x20000, v49
    v_xor_b32 v10, 4, v9
    v_lshl_add_u32 v50, v10, 4, v8
    v_add_u32 v54, 0x10000, v50
    v_add_u32 v58, 0x20000, v50
    v_xor_b32 v10, 6, v9
    v_lshl_add_u32 v51, v10, 4, v8
    v_add_u32 v55, 0x10000, v51
    v_add_u32 v59, 0x20000, v51
    ds_read_b64_tr_b16 v[60:61], v52 offset:0
    ds_read_b64_tr_b16 v[62:63], v52 offset:24576
    ds_read_b64_tr_b16 v[64:65], v52 offset:49152
    ds_read_b64_tr_b16 v[66:67], v56 offset:8192
    ds_read_b64_tr_b16 v[68:69], v53 offset:0
    ds_read_b64_tr_b16 v[70:71], v53 offset:24576
    ds_read_b64_tr_b16 v[72:73], v53 offset:49152
    ds_read_b64_tr_b16 v[74:75], v57 offset:8192
    ds_read_b64_tr_b16 v[76:77], v54 offset:0
    ds_read_b64_tr_b16 v[78:79], v54 offset:24576
    ds_read_b64_tr_b16 v[80:81], v54 offset:49152
    ds_read_b64_tr_b16 v[82:83], v58 offset:8192
    v_mov_b32 v16, 0
    v_mov_b32 v17, 0
    v_mov_b32 v18, 0
    v_mov_b32 v19, 0
    v_mov_b32 v20, 0
    v_mov_b32 v21, 0
    v_mov_b32 v22, 0
    v_mov_b32 v23, 0
    v_mov_b32 v24, 0
    v_mov_b32 v25, 0
    v_mov_b32 v26, 0
    v_mov_b32 v27, 0
    v_mov_b32 v28, 0
    v_mov_b32 v29, 0
    v_mov_b32 v30, 0
    v_mov_b32 v31, 0
    v_mov_b32 v32, 0
    v_mov_b32 v33, 0
    v_mov_b32 v34, 0
    v_mov_b32 v35, 0
    v_mov_b32 v36, 0
    v_mov_b32 v37, 0
    v_mov_b32 v38, 0
    v_mov_b32 v39, 0
    v_mov_b32 v40, 0
    v_mov_b32 v41, 0
    v_mov_b32 v42, 0
    v_mov_b32 v43, 0
    v_mov_b32 v44, 0
    v_mov_b32 v45, 0
    v_mov_b32 v46, 0
    v_mov_b32 v47, 0
    s_lshl_b32 s34, s60, 15
    s_lshl_b32 s35, s61, 11
    s_add_u32 s34, s34, s35
    v_and_b32 v9, 15, v1
    v_lshlrev_b32 v9, 11, v9
    v_lshrrev_b32 v10, 4, v1
    v_lshl_add_u32 v4, v10, 4, v9
    s_add_u32 s20, s8, 54525952
    s_addc_u32 s21, s9, 0
    s_mov_b32 s22, 8388608
    s_mov_b32 s23, 0x20000
    s_lshr_b32 s39, s61, 1
    s_lshl_b32 s39, s39, 4
    s_add_u32 s39, s39, s63
    s_add_u32 s39, s39, 1024
    s_cmp_eq_u32 s3, 0
    s_cselect_b32 s43, s43, 0x4000
    v_mov_b32 v8, s50
    v_mov_b32 v9, s51
    v_mov_b32 v10, 0x4000
    v_cmp_eq_u32 vcc, 0, v1
    s_nop 1
    v_cndmask_b32 v10, v10, 0, vcc
    v_and_b32 v11, 1, v1
    v_lshlrev_b32 v11, 3, v11
    s_waitcnt vmcnt(18)
    s_waitcnt lgkmcnt(8)
    v_mfma_f32_16x16x32_bf16 v[16:19], v[60:63], a[0:3], v[16:19]
    s_add_u32 s37, s37, 1024
    ds_read_b64_tr_b16 v[84:85], v55 offset:0
    v_mfma_f32_16x16x32_bf16 v[16:19], v[64:67], a[8:11], v[16:19]
    buffer_load_dwordx4 a[88:91], v2, s[88:91], s37 offen
    v_mfma_f32_16x16x32_bf16 v[20:23], v[64:67], a[12:15], v[20:23]
    ds_read_b64_tr_b16 v[86:87], v55 offset:24576
    v_mfma_f32_16x16x32_bf16 v[20:23], v[60:63], a[4:7], v[20:23]
    s_waitcnt lgkmcnt(6)
    ds_read_b64_tr_b16 v[88:89], v55 offset:49152
    v_mfma_f32_16x16x32_bf16 v[28:31], v[68:71], a[4:7], v[28:31]
    ds_read_b64_tr_b16 v[90:91], v59 offset:8192
    v_mfma_f32_16x16x32_bf16 v[28:31], v[72:75], a[12:15], v[28:31]
    buffer_load_dwordx4 a[92:95], v3, s[88:91], s37 offen
    v_mfma_f32_16x16x32_bf16 v[24:27], v[72:75], a[8:11], v[24:27]
    ds_read_b64_tr_b16 v[60:61], v52 offset:2048
    ds_read_b64_tr_b16 v[62:63], v52 offset:26624
    v_mfma_f32_16x16x32_bf16 v[24:27], v[68:71], a[0:3], v[24:27]
    s_waitcnt lgkmcnt(6)
    ds_read_b64_tr_b16 v[64:65], v52 offset:51200
    v_mfma_f32_16x16x32_bf16 v[32:35], v[76:79], a[0:3], v[32:35]
    s_add_u32 s37, s37, 1024
    ds_read_b64_tr_b16 v[66:67], v56 offset:10240
    v_mfma_f32_16x16x32_bf16 v[32:35], v[80:83], a[8:11], v[32:35]
    buffer_load_dwordx4 a[96:99], v2, s[88:91], s37 offen
    v_mfma_f32_16x16x32_bf16 v[36:39], v[80:83], a[12:15], v[36:39]
    ds_read_b64_tr_b16 v[68:69], v53 offset:2048
    ds_read_b64_tr_b16 v[70:71], v53 offset:26624
    v_mfma_f32_16x16x32_bf16 v[36:39], v[76:79], a[4:7], v[36:39]
    s_waitcnt lgkmcnt(6)
    ds_read_b64_tr_b16 v[72:73], v53 offset:51200
    v_mfma_f32_16x16x32_bf16 v[44:47], v[84:87], a[4:7], v[44:47]
    ds_read_b64_tr_b16 v[74:75], v57 offset:10240
    v_mfma_f32_16x16x32_bf16 v[44:47], v[88:91], a[12:15], v[44:47]
    buffer_load_dwordx4 a[100:103], v3, s[88:91], s37 offen
    v_mfma_f32_16x16x32_bf16 v[40:43], v[88:91], a[8:11], v[40:43]
    s_waitcnt vmcnt(18)
    ds_read_b64_tr_b16 v[76:77], v54 offset:2048
    ds_read_b64_tr_b16 v[78:79], v54 offset:26624
    v_mfma_f32_16x16x32_bf16 v[40:43], v[84:87], a[0:3], v[40:43]
    s_waitcnt lgkmcnt(6)
    ds_read_b64_tr_b16 v[80:81], v54 offset:51200
    v_mfma_f32_16x16x32_bf16 v[16:19], v[60:63], a[16:19], v[16:19]
    s_add_u32 s37, s37, 1024
    ds_read_b64_tr_b16 v[82:83], v58 offset:10240
    v_mfma_f32_16x16x32_bf16 v[16:19], v[64:67], a[24:27], v[16:19]
    buffer_load_dwordx4 a[0:3], v2, s[88:91], s37 offen
    v_mfma_f32_16x16x32_bf16 v[20:23], v[64:67], a[28:31], v[20:23]
    ds_read_b64_tr_b16 v[84:85], v55 offset:2048
    ds_read_b64_tr_b16 v[86:87], v55 offset:26624
    v_mfma_f32_16x16x32_bf16 v[20:23], v[60:63], a[20:23], v[20:23]
    s_waitcnt lgkmcnt(6)
    ds_read_b64_tr_b16 v[88:89], v55 offset:51200
    v_mfma_f32_16x16x32_bf16 v[28:31], v[68:71], a[20:23], v[28:31]
    ds_read_b64_tr_b16 v[90:91], v59 offset:10240
    v_mfma_f32_16x16x32_bf16 v[28:31], v[72:75], a[28:31], v[28:31]
    buffer_load_dwordx4 a[4:7], v3, s[88:91], s37 offen
    v_mfma_f32_16x16x32_bf16 v[24:27], v[72:75], a[24:27], v[24:27]
    ds_read_b64_tr_b16 v[60:61], v52 offset:4096
    ds_read_b64_tr_b16 v[62:63], v52 offset:28672
    v_mfma_f32_16x16x32_bf16 v[24:27], v[68:71], a[16:19], v[24:27]
    s_waitcnt lgkmcnt(6)
    ds_read_b64_tr_b16 v[64:65], v52 offset:53248
    v_mfma_f32_16x16x32_bf16 v[32:35], v[76:79], a[16:19], v[32:35]
    s_add_u32 s37, s37, 1024
    ds_read_b64_tr_b16 v[66:67], v56 offset:12288
    v_mfma_f32_16x16x32_bf16 v[32:35], v[80:83], a[24:27], v[32:35]
    buffer_load_dwordx4 a[8:11], v2, s[88:91], s37 offen
    v_mfma_f32_16x16x32_bf16 v[36:39], v[80:83], a[28:31], v[36:39]
    ds_read_b64_tr_b16 v[68:69], v53 offset:4096
    ds_read_b64_tr_b16 v[70:71], v53 offset:28672
    v_mfma_f32_16x16x32_bf16 v[36:39], v[76:79], a[20:23], v[36:39]
    s_waitcnt lgkmcnt(6)
    ds_read_b64_tr_b16 v[72:73], v53 offset:53248
    v_mfma_f32_16x16x32_bf16 v[44:47], v[84:87], a[20:23], v[44:47]
    ds_read_b64_tr_b16 v[74:75], v57 offset:12288
    v_mfma_f32_16x16x32_bf16 v[44:47], v[88:91], a[28:31], v[44:47]
    buffer_load_dwordx4 a[12:15], v3, s[88:91], s37 offen
    v_mfma_f32_16x16x32_bf16 v[40:43], v[88:91], a[24:27], v[40:43]
    s_waitcnt vmcnt(18)
    ds_read_b64_tr_b16 v[76:77], v54 offset:4096
    ds_read_b64_tr_b16 v[78:79], v54 offset:28672
    v_mfma_f32_16x16x32_bf16 v[40:43], v[84:87], a[16:19], v[40:43]
    s_waitcnt lgkmcnt(6)
    ds_read_b64_tr_b16 v[80:81], v54 offset:53248
    v_mfma_f32_16x16x32_bf16 v[16:19], v[60:63], a[32:35], v[16:19]
    s_add_u32 s37, s37, 1024
    ds_read_b64_tr_b16 v[82:83], v58 offset:12288
    v_mfma_f32_16x16x32_bf16 v[16:19], v[64:67], a[40:43], v[16:19]
    buffer_load_dwordx4 a[16:19], v2, s[88:91], s37 offen
    v_mfma_f32_16x16x32_bf16 v[20:23], v[64:67], a[44:47], v[20:23]
    ds_read_b64_tr_b16 v[84:85], v55 offset:4096
    ds_read_b64_tr_b16 v[86:87], v55 offset:28672
    v_mfma_f32_16x16x32_bf16 v[20:23], v[60:63], a[36:39], v[20:23]
    s_waitcnt lgkmcnt(6)
    ds_read_b64_tr_b16 v[88:89], v55 offset:53248
    v_mfma_f32_16x16x32_bf16 v[28:31], v[68:71], a[36:39], v[28:31]
    ds_read_b64_tr_b16 v[90:91], v59 offset:12288
    v_mfma_f32_16x16x32_bf16 v[28:31], v[72:75], a[44:47], v[28:31]
    buffer_load_dwordx4 a[20:23], v3, s[88:91], s37 offen
    v_mfma_f32_16x16x32_bf16 v[24:27], v[72:75], a[40:43], v[24:27]
    ds_read_b64_tr_b16 v[60:61], v52 offset:6144
    ds_read_b64_tr_b16 v[62:63], v52 offset:30720
    v_mfma_f32_16x16x32_bf16 v[24:27], v[68:71], a[32:35], v[24:27]
    s_waitcnt lgkmcnt(6)
    ds_read_b64_tr_b16 v[64:65], v52 offset:55296
    v_mfma_f32_16x16x32_bf16 v[32:35], v[76:79], a[32:35], v[32:35]
    s_add_u32 s37, s37, 1024
    ds_read_b64_tr_b16 v[66:67], v56 offset:14336
    v_mfma_f32_16x16x32_bf16 v[32:35], v[80:83], a[40:43], v[32:35]
    buffer_load_dwordx4 a[24:27], v2, s[88:91], s37 offen
    v_mfma_f32_16x16x32_bf16 v[36:39], v[80:83], a[44:47], v[36:39]
    ds_read_b64_tr_b16 v[68:69], v53 offset:6144
    ds_read_b64_tr_b16 v[70:71], v53 offset:30720
    v_mfma_f32_16x16x32_bf16 v[36:39], v[76:79], a[36:39], v[36:39]
    s_waitcnt lgkmcnt(6)
    ds_read_b64_tr_b16 v[72:73], v53 offset:55296
    v_mfma_f32_16x16x32_bf16 v[44:47], v[84:87], a[36:39], v[44:47]
    ds_read_b64_tr_b16 v[74:75], v57 offset:14336
    v_mfma_f32_16x16x32_bf16 v[44:47], v[88:91], a[44:47], v[44:47]
    buffer_load_dwordx4 a[28:31], v3, s[88:91], s37 offen
    v_mfma_f32_16x16x32_bf16 v[40:43], v[88:91], a[40:43], v[40:43]
    s_waitcnt vmcnt(18)
    ds_read_b64_tr_b16 v[76:77], v54 offset:6144
    ds_read_b64_tr_b16 v[78:79], v54 offset:30720
    v_mfma_f32_16x16x32_bf16 v[40:43], v[84:87], a[32:35], v[40:43]
    s_waitcnt lgkmcnt(6)
    ds_read_b64_tr_b16 v[80:81], v54 offset:55296
    v_mfma_f32_16x16x32_bf16 v[16:19], v[60:63], a[48:51], v[16:19]
    s_add_u32 s37, s37, 1024
    ds_read_b64_tr_b16 v[82:83], v58 offset:14336
    v_mfma_f32_16x16x32_bf16 v[16:19], v[64:67], a[56:59], v[16:19]
    buffer_load_dwordx4 a[32:35], v2, s[88:91], s37 offen sc1
    v_mfma_f32_16x16x32_bf16 v[20:23], v[64:67], a[60:63], v[20:23]
    ds_read_b64_tr_b16 v[84:85], v55 offset:6144
    ds_read_b64_tr_b16 v[86:87], v55 offset:30720
    v_mfma_f32_16x16x32_bf16 v[20:23], v[60:63], a[52:55], v[20:23]
    s_waitcnt lgkmcnt(6)
    ds_read_b64_tr_b16 v[88:89], v55 offset:55296
    v_mfma_f32_16x16x32_bf16 v[28:31], v[68:71], a[52:55], v[28:31]
    ds_read_b64_tr_b16 v[90:91], v59 offset:14336
    v_mfma_f32_16x16x32_bf16 v[28:31], v[72:75], a[60:63], v[28:31]
    buffer_load_dwordx4 a[36:39], v3, s[88:91], s37 offen sc1
    v_mfma_f32_16x16x32_bf16 v[24:27], v[72:75], a[56:59], v[24:27]
    ds_read_b64_tr_b16 v[60:61], v52 offset:8192
    ds_read_b64_tr_b16 v[62:63], v52 offset:32768
    v_mfma_f32_16x16x32_bf16 v[24:27], v[68:71], a[48:51], v[24:27]
    s_waitcnt lgkmcnt(6)
    ds_read_b64_tr_b16 v[64:65], v52 offset:57344
    v_mfma_f32_16x16x32_bf16 v[32:35], v[76:79], a[48:51], v[32:35]
    s_add_u32 s37, s37, 1024
    ds_read_b64_tr_b16 v[66:67], v56 offset:16384
    v_mfma_f32_16x16x32_bf16 v[32:35], v[80:83], a[56:59], v[32:35]
    buffer_load_dwordx4 a[40:43], v2, s[88:91], s37 offen
    v_mfma_f32_16x16x32_bf16 v[36:39], v[80:83], a[60:63], v[36:39]
    s_add_u32 s45, s45, 0x2000
    ds_read_b64_tr_b16 v[68:69], v53 offset:8192
    ds_read_b64_tr_b16 v[70:71], v53 offset:32768
    v_mfma_f32_16x16x32_bf16 v[36:39], v[76:79], a[52:55], v[36:39]
    s_waitcnt lgkmcnt(6)
    ds_read_b64_tr_b16 v[72:73], v53 offset:57344
    v_mfma_f32_16x16x32_bf16 v[44:47], v[84:87], a[52:55], v[44:47]
    s_add_u32 m0, s46, 0
    ds_read_b64_tr_b16 v[74:75], v57 offset:16384
    v_mfma_f32_16x16x32_bf16 v[44:47], v[88:91], a[60:63], v[44:47]
    buffer_load_dwordx4 a[44:47], v3, s[88:91], s37 offen
    v_mfma_f32_16x16x32_bf16 v[40:43], v[88:91], a[56:59], v[40:43]
    s_waitcnt vmcnt(18)
    ds_read_b64_tr_b16 v[76:77], v54 offset:8192
    ds_read_b64_tr_b16 v[78:79], v54 offset:32768
    v_mfma_f32_16x16x32_bf16 v[40:43], v[84:87], a[48:51], v[40:43]
    s_waitcnt lgkmcnt(6)
    ds_read_b64_tr_b16 v[80:81], v54 offset:57344
    v_mfma_f32_16x16x32_bf16 v[16:19], v[60:63], a[64:67], v[16:19]
    s_add_u32 s37, s37, 1024
    ds_read_b64_tr_b16 v[82:83], v58 offset:16384
    v_mfma_f32_16x16x32_bf16 v[16:19], v[64:67], a[72:75], v[16:19]
    s_barrier
    ds_read_b64_tr_b16 v[84:85], v55 offset:8192
    v_mfma_f32_16x16x32_bf16 v[20:23], v[64:67], a[76:79], v[20:23]
    buffer_load_dwordx4 a[48:51], v2, s[88:91], s37 offen
    v_mfma_f32_16x16x32_bf16 v[20:23], v[60:63], a[68:71], v[20:23]
    s_waitcnt lgkmcnt(5)
    ds_read_b64_tr_b16 v[86:87], v55 offset:32768
    ds_read_b64_tr_b16 v[88:89], v55 offset:57344
    v_mfma_f32_16x16x32_bf16 v[28:31], v[68:71], a[68:71], v[28:31]
    buffer_load_dwordx4 v12, s[52:55], s45 offen offset:0 lds
    v_mfma_f32_16x16x32_bf16 v[28:31], v[72:75], a[76:79], v[28:31]
    buffer_load_dwordx4 a[52:55], v3, s[88:91], s37 offen
    v_mfma_f32_16x16x32_bf16 v[24:27], v[72:75], a[72:75], v[24:27]
    ds_read_b64_tr_b16 v[90:91], v59 offset:16384
    ds_read_b64_tr_b16 v[60:61], v52 offset:10240
    v_mfma_f32_16x16x32_bf16 v[24:27], v[68:71], a[64:67], v[24:27]
    s_waitcnt lgkmcnt(5)
    ds_read_b64_tr_b16 v[62:63], v52 offset:34816
    ds_read_b64_tr_b16 v[64:65], v52 offset:59392
    v_mfma_f32_16x16x32_bf16 v[32:35], v[76:79], a[64:67], v[32:35]
    s_add_u32 s37, s37, 1024
    ds_read_b64_tr_b16 v[66:67], v56 offset:18432
    v_mfma_f32_16x16x32_bf16 v[32:35], v[80:83], a[72:75], v[32:35]
    buffer_load_dwordx4 a[56:59], v2, s[88:91], s37 offen
    v_mfma_f32_16x16x32_bf16 v[36:39], v[80:83], a[76:79], v[36:39]
    s_add_u32 m0, s46, 0
    ds_read_b64_tr_b16 v[68:69], v53 offset:10240
    ds_read_b64_tr_b16 v[70:71], v53 offset:34816
    v_mfma_f32_16x16x32_bf16 v[36:39], v[76:79], a[68:71], v[36:39]
    s_waitcnt lgkmcnt(6)
    ds_read_b64_tr_b16 v[72:73], v53 offset:59392
    v_mfma_f32_16x16x32_bf16 v[44:47], v[84:87], a[68:71], v[44:47]
    buffer_load_dwordx4 v12, s[52:55], s45 offen offset:1024 lds
    v_mfma_f32_16x16x32_bf16 v[44:47], v[88:91], a[76:79], v[44:47]
    buffer_load_dwordx4 a[60:63], v3, s[88:91], s37 offen
    v_mfma_f32_16x16x32_bf16 v[40:43], v[88:91], a[72:75], v[40:43]
    s_waitcnt vmcnt(20)
    ds_read_b64_tr_b16 v[74:75], v57 offset:18432
    ds_read_b64_tr_b16 v[76:77], v54 offset:10240
    v_mfma_f32_16x16x32_bf16 v[40:43], v[84:87], a[64:67], v[40:43]
    s_waitcnt lgkmcnt(5)
    ds_read_b64_tr_b16 v[78:79], v54 offset:34816
    ds_read_b64_tr_b16 v[80:81], v54 offset:59392
    v_mfma_f32_16x16x32_bf16 v[16:19], v[60:63], a[80:83], v[16:19]
    s_add_u32 s37, s37, 1024
    s_add_u32 s45, s45, 0x2000
    ds_read_b64_tr_b16 v[82:83], v58 offset:18432
    v_mfma_f32_16x16x32_bf16 v[16:19], v[64:67], a[88:91], v[16:19]
    buffer_load_dwordx4 a[64:67], v2, s[88:91], s37 offen
    v_mfma_f32_16x16x32_bf16 v[20:23], v[64:67], a[92:95], v[20:23]
    s_add_u32 m0, s46, 2048
    ds_read_b64_tr_b16 v[84:85], v55 offset:10240
    ds_read_b64_tr_b16 v[86:87], v55 offset:34816
    v_mfma_f32_16x16x32_bf16 v[20:23], v[60:63], a[84:87], v[20:23]
    s_waitcnt lgkmcnt(6)
    ds_read_b64_tr_b16 v[88:89], v55 offset:59392
    v_mfma_f32_16x16x32_bf16 v[28:31], v[68:71], a[84:87], v[28:31]
    buffer_load_dwordx4 v12, s[52:55], s45 offen offset:0 lds
    v_mfma_f32_16x16x32_bf16 v[28:31], v[72:75], a[92:95], v[28:31]
    buffer_load_dwordx4 a[68:71], v3, s[88:91], s37 offen
    v_mfma_f32_16x16x32_bf16 v[24:27], v[72:75], a[88:91], v[24:27]
    ds_read_b64_tr_b16 v[90:91], v59 offset:18432
    ds_read_b64_tr_b16 v[60:61], v52 offset:12288
    v_mfma_f32_16x16x32_bf16 v[24:27], v[68:71], a[80:83], v[24:27]
    s_waitcnt lgkmcnt(5)
    ds_read_b64_tr_b16 v[62:63], v52 offset:36864
    ds_read_b64_tr_b16 v[64:65], v52 offset:61440
    v_mfma_f32_16x16x32_bf16 v[32:35], v[76:79], a[80:83], v[32:35]
    s_add_u32 s37, s37, 1024
    ds_read_b64_tr_b16 v[66:67], v56 offset:20480
    v_mfma_f32_16x16x32_bf16 v[32:35], v[80:83], a[88:91], v[32:35]
    buffer_load_dwordx4 a[72:75], v2, s[88:91], s37 offen
    v_mfma_f32_16x16x32_bf16 v[36:39], v[80:83], a[92:95], v[36:39]
    s_add_u32 m0, s46, 2048
    ds_read_b64_tr_b16 v[68:69], v53 offset:12288
    ds_read_b64_tr_b16 v[70:71], v53 offset:36864
    v_mfma_f32_16x16x32_bf16 v[36:39], v[76:79], a[84:87], v[36:39]
    s_waitcnt lgkmcnt(6)
    ds_read_b64_tr_b16 v[72:73], v53 offset:61440
    v_mfma_f32_16x16x32_bf16 v[44:47], v[84:87], a[84:87], v[44:47]
    buffer_load_dwordx4 v12, s[52:55], s45 offen offset:1024 lds
    v_mfma_f32_16x16x32_bf16 v[44:47], v[88:91], a[92:95], v[44:47]
    buffer_load_dwordx4 a[76:79], v3, s[88:91], s37 offen
    v_mfma_f32_16x16x32_bf16 v[40:43], v[88:91], a[88:91], v[40:43]
    s_waitcnt vmcnt(22)
    ds_read_b64_tr_b16 v[74:75], v57 offset:20480
    ds_read_b64_tr_b16 v[76:77], v54 offset:12288
    v_mfma_f32_16x16x32_bf16 v[40:43], v[84:87], a[80:83], v[40:43]
    s_waitcnt lgkmcnt(5)
    ds_read_b64_tr_b16 v[78:79], v54 offset:36864
    ds_read_b64_tr_b16 v[80:81], v54 offset:61440
    v_mfma_f32_16x16x32_bf16 v[16:19], v[60:63], a[96:99], v[16:19]
    s_add_u32 s37, s37, 1024
    s_add_u32 s45, s45, 0x2000
    ds_read_b64_tr_b16 v[82:83], v58 offset:20480
    v_mfma_f32_16x16x32_bf16 v[16:19], v[64:67], a[0:3], v[16:19]
    buffer_load_dwordx4 a[80:83], v2, s[88:91], s37 offen
    v_mfma_f32_16x16x32_bf16 v[20:23], v[64:67], a[4:7], v[20:23]
    s_add_u32 m0, s46, 4096
    ds_read_b64_tr_b16 v[84:85], v55 offset:12288
    ds_read_b64_tr_b16 v[86:87], v55 offset:36864
    v_mfma_f32_16x16x32_bf16 v[20:23], v[60:63], a[100:103], v[20:23]
    s_waitcnt lgkmcnt(6)
    ds_read_b64_tr_b16 v[88:89], v55 offset:61440
    v_mfma_f32_16x16x32_bf16 v[28:31], v[68:71], a[100:103], v[28:31]
    buffer_load_dwordx4 v12, s[52:55], s45 offen offset:0 lds
    v_mfma_f32_16x16x32_bf16 v[28:31], v[72:75], a[4:7], v[28:31]
    buffer_load_dwordx4 a[84:87], v3, s[88:91], s37 offen
    v_mfma_f32_16x16x32_bf16 v[24:27], v[72:75], a[0:3], v[24:27]
    ds_read_b64_tr_b16 v[90:91], v59 offset:20480
    ds_read_b64_tr_b16 v[60:61], v52 offset:14336
    v_mfma_f32_16x16x32_bf16 v[24:27], v[68:71], a[96:99], v[24:27]
    s_waitcnt lgkmcnt(5)
    ds_read_b64_tr_b16 v[62:63], v52 offset:38912
    ds_read_b64_tr_b16 v[64:65], v52 offset:63488
    v_mfma_f32_16x16x32_bf16 v[32:35], v[76:79], a[96:99], v[32:35]
    s_add_u32 s37, s37, 1024
    ds_read_b64_tr_b16 v[66:67], v56 offset:22528
    v_mfma_f32_16x16x32_bf16 v[32:35], v[80:83], a[0:3], v[32:35]
    buffer_load_dwordx4 a[88:91], v2, s[88:91], s37 offen sc1
    v_mfma_f32_16x16x32_bf16 v[36:39], v[80:83], a[4:7], v[36:39]
    s_add_u32 m0, s46, 4096
    ds_read_b64_tr_b16 v[68:69], v53 offset:14336
    ds_read_b64_tr_b16 v[70:71], v53 offset:38912
    v_mfma_f32_16x16x32_bf16 v[36:39], v[76:79], a[100:103], v[36:39]
    s_waitcnt lgkmcnt(6)
    ds_read_b64_tr_b16 v[72:73], v53 offset:63488
    v_mfma_f32_16x16x32_bf16 v[44:47], v[84:87], a[100:103], v[44:47]
    buffer_load_dwordx4 v12, s[52:55], s45 offen offset:1024 lds
    v_mfma_f32_16x16x32_bf16 v[44:47], v[88:91], a[4:7], v[44:47]
    buffer_load_dwordx4 a[92:95], v3, s[88:91], s37 offen sc1
    v_mfma_f32_16x16x32_bf16 v[40:43], v[88:91], a[0:3], v[40:43]
    s_waitcnt vmcnt(24)
    ds_read_b64_tr_b16 v[74:75], v57 offset:22528
    ds_read_b64_tr_b16 v[76:77], v54 offset:14336
    v_mfma_f32_16x16x32_bf16 v[40:43], v[84:87], a[96:99], v[40:43]
    s_waitcnt lgkmcnt(5)
    ds_read_b64_tr_b16 v[78:79], v54 offset:38912
    ds_read_b64_tr_b16 v[80:81], v54 offset:63488
    v_mfma_f32_16x16x32_bf16 v[16:19], v[60:63], a[8:11], v[16:19]
    s_add_u32 s37, s37, 1024
    ds_read_b64_tr_b16 v[82:83], v58 offset:22528
    v_mfma_f32_16x16x32_bf16 v[16:19], v[64:67], a[16:19], v[16:19]
    ds_read_b64_tr_b16 v[84:85], v55 offset:14336
    v_mfma_f32_16x16x32_bf16 v[20:23], v[64:67], a[20:23], v[20:23]
    s_barrier
    ds_read_b64_tr_b16 v[86:87], v55 offset:38912
    v_mfma_f32_16x16x32_bf16 v[20:23], v[60:63], a[12:15], v[20:23]
    s_waitcnt lgkmcnt(6)
    s_add_u32 m0, s46, 6144
    s_add_u32 s45, s45, 0x2000
    ds_read_b64_tr_b16 v[88:89], v55 offset:63488
    v_mfma_f32_16x16x32_bf16 v[28:31], v[68:71], a[12:15], v[28:31]
    buffer_load_dwordx4 a[96:99], v2, s[88:91], s37 offen
    v_mfma_f32_16x16x32_bf16 v[28:31], v[72:75], a[20:23], v[28:31]
    buffer_load_dwordx4 v12, s[52:55], s45 offen offset:0 lds
    v_mfma_f32_16x16x32_bf16 v[24:27], v[72:75], a[16:19], v[24:27]
    buffer_load_dwordx4 a[100:103], v3, s[88:91], s37 offen
    v_mfma_f32_16x16x32_bf16 v[24:27], v[68:71], a[8:11], v[24:27]
    s_waitcnt lgkmcnt(3)
    ds_read_b64_tr_b16 v[90:91], v59 offset:22528
    ds_read_b64_tr_b16 v[60:61], v52 offset:16384
    v_mfma_f32_16x16x32_bf16 v[32:35], v[76:79], a[8:11], v[32:35]
    s_add_u32 s37, s37, 1024
    ds_read_b64_tr_b16 v[62:63], v52 offset:40960
    ds_read_b64_tr_b16 v[64:65], v56 offset:0
    v_mfma_f32_16x16x32_bf16 v[32:35], v[80:83], a[16:19], v[32:35]
    buffer_load_dwordx4 a[0:3], v2, s[88:91], s37 offen
    v_mfma_f32_16x16x32_bf16 v[36:39], v[80:83], a[20:23], v[36:39]
    s_add_u32 m0, s46, 6144
    ds_read_b64_tr_b16 v[66:67], v56 offset:24576
    ds_read_b64_tr_b16 v[68:69], v53 offset:16384
    v_mfma_f32_16x16x32_bf16 v[36:39], v[76:79], a[12:15], v[36:39]
    s_waitcnt lgkmcnt(5)
    ds_read_b64_tr_b16 v[70:71], v53 offset:40960
    ds_read_b64_tr_b16 v[72:73], v57 offset:0
    v_mfma_f32_16x16x32_bf16 v[44:47], v[84:87], a[12:15], v[44:47]
    buffer_load_dwordx4 v12, s[52:55], s45 offen offset:1024 lds
    v_mfma_f32_16x16x32_bf16 v[44:47], v[88:91], a[20:23], v[44:47]
    buffer_load_dwordx4 a[4:7], v3, s[88:91], s37 offen
    v_mfma_f32_16x16x32_bf16 v[40:43], v[88:91], a[16:19], v[40:43]
    s_waitcnt vmcnt(26)
    ds_read_b64_tr_b16 v[74:75], v57 offset:24576
    ds_read_b64_tr_b16 v[76:77], v54 offset:16384
    v_mfma_f32_16x16x32_bf16 v[40:43], v[84:87], a[8:11], v[40:43]
    s_waitcnt lgkmcnt(5)
    ds_read_b64_tr_b16 v[78:79], v54 offset:40960
    ds_read_b64_tr_b16 v[80:81], v58 offset:0
    v_mfma_f32_16x16x32_bf16 v[16:19], v[60:63], a[24:27], v[16:19]
    s_add_u32 s37, s37, 1024
    s_add_u32 s45, s45, 0x2000
    ds_read_b64_tr_b16 v[82:83], v58 offset:24576
    v_mfma_f32_16x16x32_bf16 v[16:19], v[64:67], a[32:35], v[16:19]
    buffer_load_dwordx4 a[8:11], v2, s[88:91], s37 offen
    v_mfma_f32_16x16x32_bf16 v[20:23], v[64:67], a[36:39], v[20:23]
    s_add_u32 m0, s46, 8192
    ds_read_b64_tr_b16 v[84:85], v55 offset:16384
    ds_read_b64_tr_b16 v[86:87], v55 offset:40960
    v_mfma_f32_16x16x32_bf16 v[20:23], v[60:63], a[28:31], v[20:23]
    s_waitcnt lgkmcnt(6)
    ds_read_b64_tr_b16 v[88:89], v59 offset:0
    v_mfma_f32_16x16x32_bf16 v[28:31], v[68:71], a[28:31], v[28:31]
    buffer_load_dwordx4 v12, s[52:55], s45 offen offset:0 lds
    v_mfma_f32_16x16x32_bf16 v[28:31], v[72:75], a[36:39], v[28:31]
    buffer_load_dwordx4 a[12:15], v3, s[88:91], s37 offen
    v_mfma_f32_16x16x32_bf16 v[24:27], v[72:75], a[32:35], v[24:27]
    ds_read_b64_tr_b16 v[90:91], v59 offset:24576
    ds_read_b64_tr_b16 v[60:61], v52 offset:18432
    v_mfma_f32_16x16x32_bf16 v[24:27], v[68:71], a[24:27], v[24:27]
    s_waitcnt lgkmcnt(5)
    ds_read_b64_tr_b16 v[62:63], v52 offset:43008
    ds_read_b64_tr_b16 v[64:65], v56 offset:2048
    v_mfma_f32_16x16x32_bf16 v[32:35], v[76:79], a[24:27], v[32:35]
    s_add_u32 s37, s37, 1024
    ds_read_b64_tr_b16 v[66:67], v56 offset:26624
    v_mfma_f32_16x16x32_bf16 v[32:35], v[80:83], a[32:35], v[32:35]
    buffer_load_dwordx4 a[16:19], v2, s[88:91], s37 offen
    v_mfma_f32_16x16x32_bf16 v[36:39], v[80:83], a[36:39], v[36:39]
    s_add_u32 m0, s46, 8192
    ds_read_b64_tr_b16 v[68:69], v53 offset:18432
    ds_read_b64_tr_b16 v[70:71], v53 offset:43008
    v_mfma_f32_16x16x32_bf16 v[36:39], v[76:79], a[28:31], v[36:39]
    s_waitcnt lgkmcnt(6)
    ds_read_b64_tr_b16 v[72:73], v57 offset:2048
    v_mfma_f32_16x16x32_bf16 v[44:47], v[84:87], a[28:31], v[44:47]
    buffer_load_dwordx4 v12, s[52:55], s45 offen offset:1024 lds
    v_mfma_f32_16x16x32_bf16 v[44:47], v[88:91], a[36:39], v[44:47]
    buffer_load_dwordx4 a[20:23], v3, s[88:91], s37 offen
    v_mfma_f32_16x16x32_bf16 v[40:43], v[88:91], a[32:35], v[40:43]
    s_waitcnt vmcnt(27)
    ds_read_b64_tr_b16 v[74:75], v57 offset:26624
    ds_read_b64_tr_b16 v[76:77], v54 offset:18432
    v_mfma_f32_16x16x32_bf16 v[40:43], v[84:87], a[24:27], v[40:43]
    s_waitcnt lgkmcnt(5)
    ds_read_b64_tr_b16 v[78:79], v54 offset:43008
    ds_read_b64_tr_b16 v[80:81], v58 offset:2048
    v_mfma_f32_16x16x32_bf16 v[16:19], v[60:63], a[40:43], v[16:19]
    s_add_u32 s37, s37, 1024
    s_add_u32 s45, s45, 0x2000
    ds_read_b64_tr_b16 v[82:83], v58 offset:26624
    v_mfma_f32_16x16x32_bf16 v[16:19], v[64:67], a[48:51], v[16:19]
    buffer_load_dwordx4 a[24:27], v2, s[88:91], s37 offen
    v_mfma_f32_16x16x32_bf16 v[20:23], v[64:67], a[52:55], v[20:23]
    s_add_u32 m0, s46, 10240
    ds_read_b64_tr_b16 v[84:85], v55 offset:18432
    ds_read_b64_tr_b16 v[86:87], v55 offset:43008
    v_mfma_f32_16x16x32_bf16 v[20:23], v[60:63], a[44:47], v[20:23]
    s_waitcnt lgkmcnt(6)
    ds_read_b64_tr_b16 v[88:89], v59 offset:2048
    v_mfma_f32_16x16x32_bf16 v[28:31], v[68:71], a[44:47], v[28:31]
    buffer_load_dwordx4 v12, s[52:55], s45 offen offset:0 lds
    v_mfma_f32_16x16x32_bf16 v[28:31], v[72:75], a[52:55], v[28:31]
    buffer_load_dwordx4 a[28:31], v3, s[88:91], s37 offen
    v_mfma_f32_16x16x32_bf16 v[24:27], v[72:75], a[48:51], v[24:27]
    ds_read_b64_tr_b16 v[90:91], v59 offset:26624
    ds_read_b64_tr_b16 v[60:61], v52 offset:20480
    v_mfma_f32_16x16x32_bf16 v[24:27], v[68:71], a[40:43], v[24:27]
    s_waitcnt lgkmcnt(5)
    ds_read_b64_tr_b16 v[62:63], v52 offset:45056
    ds_read_b64_tr_b16 v[64:65], v56 offset:4096
    v_mfma_f32_16x16x32_bf16 v[32:35], v[76:79], a[40:43], v[32:35]
    s_add_u32 s37, s37, 1024
    ds_read_b64_tr_b16 v[66:67], v56 offset:28672
    v_mfma_f32_16x16x32_bf16 v[32:35], v[80:83], a[48:51], v[32:35]
    buffer_load_dwordx4 a[32:35], v2, s[88:91], s37 offen
    v_mfma_f32_16x16x32_bf16 v[36:39], v[80:83], a[52:55], v[36:39]
    s_add_u32 m0, s46, 10240
    ds_read_b64_tr_b16 v[68:69], v53 offset:20480
    ds_read_b64_tr_b16 v[70:71], v53 offset:45056
    v_mfma_f32_16x16x32_bf16 v[36:39], v[76:79], a[44:47], v[36:39]
    s_waitcnt lgkmcnt(6)
    ds_read_b64_tr_b16 v[72:73], v57 offset:4096
    v_mfma_f32_16x16x32_bf16 v[44:47], v[84:87], a[44:47], v[44:47]
    buffer_load_dwordx4 v12, s[52:55], s45 offen offset:1024 lds
    v_mfma_f32_16x16x32_bf16 v[44:47], v[88:91], a[52:55], v[44:47]
    buffer_load_dwordx4 a[36:39], v3, s[88:91], s37 offen
    v_mfma_f32_16x16x32_bf16 v[40:43], v[88:91], a[48:51], v[40:43]
    s_waitcnt vmcnt(27)
    ds_read_b64_tr_b16 v[74:75], v57 offset:28672
    ds_read_b64_tr_b16 v[76:77], v54 offset:20480
    v_mfma_f32_16x16x32_bf16 v[40:43], v[84:87], a[40:43], v[40:43]
    s_waitcnt lgkmcnt(5)
    ds_read_b64_tr_b16 v[78:79], v54 offset:45056
    ds_read_b64_tr_b16 v[80:81], v58 offset:4096
    v_mfma_f32_16x16x32_bf16 v[16:19], v[60:63], a[56:59], v[16:19]
    s_add_u32 s37, s37, 1024
    s_add_u32 s45, s45, 0x2000
    ds_read_b64_tr_b16 v[82:83], v58 offset:28672
    v_mfma_f32_16x16x32_bf16 v[16:19], v[64:67], a[64:67], v[16:19]
    buffer_load_dwordx4 a[40:43], v2, s[88:91], s37 offen sc1
    v_mfma_f32_16x16x32_bf16 v[20:23], v[64:67], a[68:71], v[20:23]
    s_add_u32 m0, s46, 12288
    ds_read_b64_tr_b16 v[84:85], v55 offset:20480
    ds_read_b64_tr_b16 v[86:87], v55 offset:45056
    v_mfma_f32_16x16x32_bf16 v[20:23], v[60:63], a[60:63], v[20:23]
    s_waitcnt lgkmcnt(6)
    ds_read_b64_tr_b16 v[88:89], v59 offset:4096
    v_mfma_f32_16x16x32_bf16 v[28:31], v[68:71], a[60:63], v[28:31]
    buffer_load_dwordx4 v12, s[52:55], s45 offen offset:0 lds
    v_mfma_f32_16x16x32_bf16 v[28:31], v[72:75], a[68:71], v[28:31]
    buffer_load_dwordx4 a[44:47], v3, s[88:91], s37 offen sc1
    v_mfma_f32_16x16x32_bf16 v[24:27], v[72:75], a[64:67], v[24:27]
    ds_read_b64_tr_b16 v[90:91], v59 offset:28672
    ds_read_b64_tr_b16 v[60:61], v52 offset:22528
    v_mfma_f32_16x16x32_bf16 v[24:27], v[68:71], a[56:59], v[24:27]
    s_waitcnt lgkmcnt(5)
    ds_read_b64_tr_b16 v[62:63], v52 offset:47104
    ds_read_b64_tr_b16 v[64:65], v56 offset:6144
    v_mfma_f32_16x16x32_bf16 v[32:35], v[76:79], a[56:59], v[32:35]
    s_add_u32 s37, s37, 1024
    ds_read_b64_tr_b16 v[66:67], v56 offset:30720
    v_mfma_f32_16x16x32_bf16 v[32:35], v[80:83], a[64:67], v[32:35]
    buffer_load_dwordx4 a[48:51], v2, s[88:91], s37 offen
    v_mfma_f32_16x16x32_bf16 v[36:39], v[80:83], a[68:71], v[36:39]
    s_add_u32 m0, s46, 12288
    ds_read_b64_tr_b16 v[68:69], v53 offset:22528
    ds_read_b64_tr_b16 v[70:71], v53 offset:47104
    v_mfma_f32_16x16x32_bf16 v[36:39], v[76:79], a[60:63], v[36:39]
    s_waitcnt lgkmcnt(6)
    ds_read_b64_tr_b16 v[72:73], v57 offset:6144
    v_mfma_f32_16x16x32_bf16 v[44:47], v[84:87], a[60:63], v[44:47]
    buffer_load_dwordx4 v12, s[52:55], s45 offen offset:1024 lds
    v_mfma_f32_16x16x32_bf16 v[44:47], v[88:91], a[68:71], v[44:47]
    buffer_load_dwordx4 a[52:55], v3, s[88:91], s37 offen
    v_mfma_f32_16x16x32_bf16 v[40:43], v[88:91], a[64:67], v[40:43]
    s_waitcnt vmcnt(27)
    ds_read_b64_tr_b16 v[74:75], v57 offset:30720
    ds_read_b64_tr_b16 v[76:77], v54 offset:22528
    v_mfma_f32_16x16x32_bf16 v[40:43], v[84:87], a[56:59], v[40:43]
    s_waitcnt lgkmcnt(5)
    ds_read_b64_tr_b16 v[78:79], v54 offset:47104
    ds_read_b64_tr_b16 v[80:81], v58 offset:6144
    v_mfma_f32_16x16x32_bf16 v[16:19], v[60:63], a[72:75], v[16:19]
    s_add_u32 s37, s37, 1024
    ds_read_b64_tr_b16 v[82:83], v58 offset:30720
    v_mfma_f32_16x16x32_bf16 v[16:19], v[64:67], a[80:83], v[16:19]
    buffer_load_dwordx4 a[56:59], v2, s[88:91], s37 offen
    v_mfma_f32_16x16x32_bf16 v[20:23], v[64:67], a[84:87], v[20:23]
    ds_read_b64_tr_b16 v[84:85], v55 offset:22528
    ds_read_b64_tr_b16 v[86:87], v55 offset:47104
    v_mfma_f32_16x16x32_bf16 v[20:23], v[60:63], a[76:79], v[20:23]
    s_waitcnt lgkmcnt(6)
    ds_read_b64_tr_b16 v[88:89], v59 offset:6144
    v_mfma_f32_16x16x32_bf16 v[28:31], v[68:71], a[76:79], v[28:31]
    ds_read_b64_tr_b16 v[90:91], v59 offset:30720
    v_mfma_f32_16x16x32_bf16 v[28:31], v[72:75], a[84:87], v[28:31]
    buffer_load_dwordx4 a[60:63], v3, s[88:91], s37 offen
    v_mfma_f32_16x16x32_bf16 v[24:27], v[72:75], a[80:83], v[24:27]
    ds_read_b64_tr_b16 v[60:61], v48 offset:0
    ds_read_b64_tr_b16 v[62:63], v48 offset:16384
    v_mfma_f32_16x16x32_bf16 v[24:27], v[68:71], a[72:75], v[24:27]
    s_waitcnt lgkmcnt(6)
    ds_read_b64_tr_b16 v[64:65], v48 offset:32768
    v_mfma_f32_16x16x32_bf16 v[32:35], v[76:79], a[72:75], v[32:35]
    s_add_u32 s37, s37, 1024
    ds_read_b64_tr_b16 v[66:67], v48 offset:49152
    v_mfma_f32_16x16x32_bf16 v[32:35], v[80:83], a[80:83], v[32:35]
    buffer_load_dwordx4 a[64:67], v2, s[88:91], s37 offen
    v_mfma_f32_16x16x32_bf16 v[36:39], v[80:83], a[84:87], v[36:39]
    s_add_u32 s45, s45, 0x2000
    ds_read_b64_tr_b16 v[68:69], v49 offset:0
    ds_read_b64_tr_b16 v[70:71], v49 offset:16384
    v_mfma_f32_16x16x32_bf16 v[36:39], v[76:79], a[76:79], v[36:39]
    s_waitcnt lgkmcnt(6)
    ds_read_b64_tr_b16 v[72:73], v49 offset:32768
    v_mfma_f32_16x16x32_bf16 v[44:47], v[84:87], a[76:79], v[44:47]
    s_add_u32 m0, s46, 14336
    ds_read_b64_tr_b16 v[74:75], v49 offset:49152
    v_mfma_f32_16x16x32_bf16 v[44:47], v[88:91], a[84:87], v[44:47]
    buffer_load_dwordx4 a[68:71], v3, s[88:91], s37 offen
    v_mfma_f32_16x16x32_bf16 v[40:43], v[88:91], a[80:83], v[40:43]
    s_waitcnt vmcnt(25)
    ds_read_b64_tr_b16 v[76:77], v50 offset:0
    ds_read_b64_tr_b16 v[78:79], v50 offset:16384
    v_mfma_f32_16x16x32_bf16 v[40:43], v[84:87], a[72:75], v[40:43]
    s_waitcnt lgkmcnt(6)
    ds_read_b64_tr_b16 v[80:81], v50 offset:32768
    v_mfma_f32_16x16x32_bf16 v[16:19], v[60:63], a[88:91], v[16:19]
    s_add_u32 s37, s37, 1024
    ds_read_b64_tr_b16 v[82:83], v50 offset:49152
    v_mfma_f32_16x16x32_bf16 v[16:19], v[64:67], a[96:99], v[16:19]
    s_barrier
    ds_read_b64_tr_b16 v[84:85], v51 offset:0
    v_mfma_f32_16x16x32_bf16 v[20:23], v[64:67], a[100:103], v[20:23]
    buffer_load_dwordx4 a[72:75], v2, s[88:91], s37 offen
    v_mfma_f32_16x16x32_bf16 v[20:23], v[60:63], a[92:95], v[20:23]
    s_waitcnt lgkmcnt(5)
    ds_read_b64_tr_b16 v[86:87], v51 offset:16384
    ds_read_b64_tr_b16 v[88:89], v51 offset:32768
    v_mfma_f32_16x16x32_bf16 v[28:31], v[68:71], a[92:95], v[28:31]
    buffer_load_dwordx4 v12, s[52:55], s45 offen offset:0 lds
    v_mfma_f32_16x16x32_bf16 v[28:31], v[72:75], a[100:103], v[28:31]
    buffer_load_dwordx4 a[76:79], v3, s[88:91], s37 offen
    v_mfma_f32_16x16x32_bf16 v[24:27], v[72:75], a[96:99], v[24:27]
    ds_read_b64_tr_b16 v[90:91], v51 offset:49152
    ds_read_b64_tr_b16 v[60:61], v48 offset:2048
    v_mfma_f32_16x16x32_bf16 v[24:27], v[68:71], a[88:91], v[24:27]
    s_waitcnt lgkmcnt(5)
    ds_read_b64_tr_b16 v[62:63], v48 offset:18432
    ds_read_b64_tr_b16 v[64:65], v48 offset:34816
    v_mfma_f32_16x16x32_bf16 v[32:35], v[76:79], a[88:91], v[32:35]
    s_add_u32 s37, s37, 1024
    ds_read_b64_tr_b16 v[66:67], v48 offset:51200
    v_mfma_f32_16x16x32_bf16 v[32:35], v[80:83], a[96:99], v[32:35]
    buffer_load_dwordx4 a[80:83], v2, s[88:91], s37 offen
    v_mfma_f32_16x16x32_bf16 v[36:39], v[80:83], a[100:103], v[36:39]
    s_add_u32 m0, s46, 14336
    ds_read_b64_tr_b16 v[68:69], v49 offset:2048
    ds_read_b64_tr_b16 v[70:71], v49 offset:18432
    v_mfma_f32_16x16x32_bf16 v[36:39], v[76:79], a[92:95], v[36:39]
    s_waitcnt lgkmcnt(6)
    ds_read_b64_tr_b16 v[72:73], v49 offset:34816
    v_mfma_f32_16x16x32_bf16 v[44:47], v[84:87], a[92:95], v[44:47]
    buffer_load_dwordx4 v12, s[52:55], s45 offen offset:1024 lds
    v_mfma_f32_16x16x32_bf16 v[44:47], v[88:91], a[100:103], v[44:47]
    buffer_load_dwordx4 a[84:87], v3, s[88:91], s37 offen
    v_mfma_f32_16x16x32_bf16 v[40:43], v[88:91], a[96:99], v[40:43]
    s_waitcnt vmcnt(25)
    ds_read_b64_tr_b16 v[74:75], v49 offset:51200
    ds_read_b64_tr_b16 v[76:77], v50 offset:2048
    v_mfma_f32_16x16x32_bf16 v[40:43], v[84:87], a[88:91], v[40:43]
    s_waitcnt lgkmcnt(5)
    ds_read_b64_tr_b16 v[78:79], v50 offset:18432
    ds_read_b64_tr_b16 v[80:81], v50 offset:34816
    v_mfma_f32_16x16x32_bf16 v[16:19], v[60:63], a[0:3], v[16:19]
    s_add_u32 s37, s37, 1024
    ds_read_b64_tr_b16 v[82:83], v50 offset:51200
    v_mfma_f32_16x16x32_bf16 v[16:19], v[64:67], a[8:11], v[16:19]
    buffer_load_dwordx4 a[88:91], v2, s[88:91], s37 offen
    v_mfma_f32_16x16x32_bf16 v[20:23], v[64:67], a[12:15], v[20:23]
    ds_read_b64_tr_b16 v[84:85], v51 offset:2048
    ds_read_b64_tr_b16 v[86:87], v51 offset:18432
    v_mfma_f32_16x16x32_bf16 v[20:23], v[60:63], a[4:7], v[20:23]
    s_waitcnt lgkmcnt(6)
    ds_read_b64_tr_b16 v[88:89], v51 offset:34816
    v_mfma_f32_16x16x32_bf16 v[28:31], v[68:71], a[4:7], v[28:31]
    ds_read_b64_tr_b16 v[90:91], v51 offset:51200
    v_mfma_f32_16x16x32_bf16 v[28:31], v[72:75], a[12:15], v[28:31]
    buffer_load_dwordx4 a[92:95], v3, s[88:91], s37 offen
    v_mfma_f32_16x16x32_bf16 v[24:27], v[72:75], a[8:11], v[24:27]
    ds_read_b64_tr_b16 v[60:61], v48 offset:4096
    ds_read_b64_tr_b16 v[62:63], v48 offset:20480
    v_mfma_f32_16x16x32_bf16 v[24:27], v[68:71], a[0:3], v[24:27]
    s_waitcnt lgkmcnt(6)
    ds_read_b64_tr_b16 v[64:65], v48 offset:36864
    v_mfma_f32_16x16x32_bf16 v[32:35], v[76:79], a[0:3], v[32:35]
    s_add_u32 s37, s37, 1024
    ds_read_b64_tr_b16 v[66:67], v48 offset:53248
    v_mfma_f32_16x16x32_bf16 v[32:35], v[80:83], a[8:11], v[32:35]
    buffer_load_dwordx4 a[96:99], v2, s[88:91], s37 offen sc1
    v_mfma_f32_16x16x32_bf16 v[36:39], v[80:83], a[12:15], v[36:39]
    ds_read_b64_tr_b16 v[68:69], v49 offset:4096
    ds_read_b64_tr_b16 v[70:71], v49 offset:20480
    v_mfma_f32_16x16x32_bf16 v[36:39], v[76:79], a[4:7], v[36:39]
    s_waitcnt lgkmcnt(6)
    ds_read_b64_tr_b16 v[72:73], v49 offset:36864
    v_mfma_f32_16x16x32_bf16 v[44:47], v[84:87], a[4:7], v[44:47]
    ds_read_b64_tr_b16 v[74:75], v49 offset:53248
    v_mfma_f32_16x16x32_bf16 v[44:47], v[88:91], a[12:15], v[44:47]
    buffer_load_dwordx4 a[100:103], v3, s[88:91], s37 offen sc1
    v_mfma_f32_16x16x32_bf16 v[40:43], v[88:91], a[8:11], v[40:43]
    s_waitcnt vmcnt(23)
    ds_read_b64_tr_b16 v[76:77], v50 offset:4096
    ds_read_b64_tr_b16 v[78:79], v50 offset:20480
    v_mfma_f32_16x16x32_bf16 v[40:43], v[84:87], a[0:3], v[40:43]
    s_waitcnt lgkmcnt(6)
    ds_read_b64_tr_b16 v[80:81], v50 offset:36864
    v_mfma_f32_16x16x32_bf16 v[16:19], v[60:63], a[16:19], v[16:19]
    s_add_u32 s37, s37, 1024
    ds_read_b64_tr_b16 v[82:83], v50 offset:53248
    v_mfma_f32_16x16x32_bf16 v[16:19], v[64:67], a[24:27], v[16:19]
    buffer_load_dwordx4 a[0:3], v2, s[88:91], s37 offen
    v_mfma_f32_16x16x32_bf16 v[20:23], v[64:67], a[28:31], v[20:23]
    ds_read_b64_tr_b16 v[84:85], v51 offset:4096
    ds_read_b64_tr_b16 v[86:87], v51 offset:20480
    v_mfma_f32_16x16x32_bf16 v[20:23], v[60:63], a[20:23], v[20:23]
    s_waitcnt lgkmcnt(6)
    ds_read_b64_tr_b16 v[88:89], v51 offset:36864
    v_mfma_f32_16x16x32_bf16 v[28:31], v[68:71], a[20:23], v[28:31]
    ds_read_b64_tr_b16 v[90:91], v51 offset:53248
    v_mfma_f32_16x16x32_bf16 v[28:31], v[72:75], a[28:31], v[28:31]
    buffer_load_dwordx4 a[4:7], v3, s[88:91], s37 offen
    v_mfma_f32_16x16x32_bf16 v[24:27], v[72:75], a[24:27], v[24:27]
    ds_read_b64_tr_b16 v[60:61], v48 offset:6144
    ds_read_b64_tr_b16 v[62:63], v48 offset:22528
    v_mfma_f32_16x16x32_bf16 v[24:27], v[68:71], a[16:19], v[24:27]
    s_waitcnt lgkmcnt(6)
    ds_read_b64_tr_b16 v[64:65], v48 offset:38912
    v_mfma_f32_16x16x32_bf16 v[32:35], v[76:79], a[16:19], v[32:35]
    s_add_u32 s37, s37, 1024
    ds_read_b64_tr_b16 v[66:67], v48 offset:55296
    v_mfma_f32_16x16x32_bf16 v[32:35], v[80:83], a[24:27], v[32:35]
    buffer_load_dwordx4 a[8:11], v2, s[88:91], s37 offen
    v_mfma_f32_16x16x32_bf16 v[36:39], v[80:83], a[28:31], v[36:39]
    ds_read_b64_tr_b16 v[68:69], v49 offset:6144
    ds_read_b64_tr_b16 v[70:71], v49 offset:22528
    v_mfma_f32_16x16x32_bf16 v[36:39], v[76:79], a[20:23], v[36:39]
    s_waitcnt lgkmcnt(6)
    ds_read_b64_tr_b16 v[72:73], v49 offset:38912
    v_mfma_f32_16x16x32_bf16 v[44:47], v[84:87], a[20:23], v[44:47]
    ds_read_b64_tr_b16 v[74:75], v49 offset:55296
    v_mfma_f32_16x16x32_bf16 v[44:47], v[88:91], a[28:31], v[44:47]
    buffer_load_dwordx4 a[12:15], v3, s[88:91], s37 offen
    v_mfma_f32_16x16x32_bf16 v[40:43], v[88:91], a[24:27], v[40:43]
    s_waitcnt vmcnt(21)
    ds_read_b64_tr_b16 v[76:77], v50 offset:6144
    ds_read_b64_tr_b16 v[78:79], v50 offset:22528
    v_mfma_f32_16x16x32_bf16 v[40:43], v[84:87], a[16:19], v[40:43]
    s_waitcnt lgkmcnt(6)
    ds_read_b64_tr_b16 v[80:81], v50 offset:38912
    v_mfma_f32_16x16x32_bf16 v[16:19], v[60:63], a[32:35], v[16:19]
    s_add_u32 s37, s37, 1024
    ds_read_b64_tr_b16 v[82:83], v50 offset:55296
    v_mfma_f32_16x16x32_bf16 v[16:19], v[64:67], a[40:43], v[16:19]
    buffer_load_dwordx4 a[16:19], v2, s[88:91], s37 offen
    v_mfma_f32_16x16x32_bf16 v[20:23], v[64:67], a[44:47], v[20:23]
    ds_read_b64_tr_b16 v[84:85], v51 offset:6144
    ds_read_b64_tr_b16 v[86:87], v51 offset:22528
    v_mfma_f32_16x16x32_bf16 v[20:23], v[60:63], a[36:39], v[20:23]
    s_waitcnt lgkmcnt(6)
    ds_read_b64_tr_b16 v[88:89], v51 offset:38912
    v_mfma_f32_16x16x32_bf16 v[28:31], v[68:71], a[36:39], v[28:31]
    ds_read_b64_tr_b16 v[90:91], v51 offset:55296
    v_mfma_f32_16x16x32_bf16 v[28:31], v[72:75], a[44:47], v[28:31]
    buffer_load_dwordx4 a[20:23], v3, s[88:91], s37 offen
    v_mfma_f32_16x16x32_bf16 v[24:27], v[72:75], a[40:43], v[24:27]
    ds_read_b64_tr_b16 v[60:61], v48 offset:8192
    ds_read_b64_tr_b16 v[62:63], v48 offset:24576
    v_mfma_f32_16x16x32_bf16 v[24:27], v[68:71], a[32:35], v[24:27]
    s_waitcnt lgkmcnt(6)
    ds_read_b64_tr_b16 v[64:65], v48 offset:40960
    v_mfma_f32_16x16x32_bf16 v[32:35], v[76:79], a[32:35], v[32:35]
    s_add_u32 s37, s37, 1024
    ds_read_b64_tr_b16 v[66:67], v48 offset:57344
    v_mfma_f32_16x16x32_bf16 v[32:35], v[80:83], a[40:43], v[32:35]
    buffer_load_dwordx4 a[24:27], v2, s[88:91], s37 offen
    v_mfma_f32_16x16x32_bf16 v[36:39], v[80:83], a[44:47], v[36:39]
    ds_read_b64_tr_b16 v[68:69], v49 offset:8192
    ds_read_b64_tr_b16 v[70:71], v49 offset:24576
    v_mfma_f32_16x16x32_bf16 v[36:39], v[76:79], a[36:39], v[36:39]
    s_waitcnt lgkmcnt(6)
    ds_read_b64_tr_b16 v[72:73], v49 offset:40960
    v_mfma_f32_16x16x32_bf16 v[44:47], v[84:87], a[36:39], v[44:47]
    ds_read_b64_tr_b16 v[74:75], v49 offset:57344
    v_mfma_f32_16x16x32_bf16 v[44:47], v[88:91], a[44:47], v[44:47]
    buffer_load_dwordx4 a[28:31], v3, s[88:91], s37 offen
    v_mfma_f32_16x16x32_bf16 v[40:43], v[88:91], a[40:43], v[40:43]
    s_waitcnt vmcnt(20)
    ds_read_b64_tr_b16 v[76:77], v50 offset:8192
    ds_read_b64_tr_b16 v[78:79], v50 offset:24576
    v_mfma_f32_16x16x32_bf16 v[40:43], v[84:87], a[32:35], v[40:43]
    s_waitcnt lgkmcnt(6)
    ds_read_b64_tr_b16 v[80:81], v50 offset:40960
    v_mfma_f32_16x16x32_bf16 v[16:19], v[60:63], a[48:51], v[16:19]
    s_add_u32 s37, s37, 1024
    ds_read_b64_tr_b16 v[82:83], v50 offset:57344
    v_mfma_f32_16x16x32_bf16 v[16:19], v[64:67], a[56:59], v[16:19]
    buffer_load_dwordx4 a[32:35], v2, s[88:91], s37 offen
    v_mfma_f32_16x16x32_bf16 v[20:23], v[64:67], a[60:63], v[20:23]
    ds_read_b64_tr_b16 v[84:85], v51 offset:8192
    ds_read_b64_tr_b16 v[86:87], v51 offset:24576
    v_mfma_f32_16x16x32_bf16 v[20:23], v[60:63], a[52:55], v[20:23]
    s_waitcnt lgkmcnt(6)
    ds_read_b64_tr_b16 v[88:89], v51 offset:40960
    v_mfma_f32_16x16x32_bf16 v[28:31], v[68:71], a[52:55], v[28:31]
    ds_read_b64_tr_b16 v[90:91], v51 offset:57344
    v_mfma_f32_16x16x32_bf16 v[28:31], v[72:75], a[60:63], v[28:31]
    buffer_load_dwordx4 a[36:39], v3, s[88:91], s37 offen
    v_mfma_f32_16x16x32_bf16 v[24:27], v[72:75], a[56:59], v[24:27]
    ds_read_b64_tr_b16 v[60:61], v48 offset:10240
    ds_read_b64_tr_b16 v[62:63], v48 offset:26624
    v_mfma_f32_16x16x32_bf16 v[24:27], v[68:71], a[48:51], v[24:27]
    s_waitcnt lgkmcnt(6)
    ds_read_b64_tr_b16 v[64:65], v48 offset:43008
    v_mfma_f32_16x16x32_bf16 v[32:35], v[76:79], a[48:51], v[32:35]
    s_add_u32 s37, s37, 1024
    ds_read_b64_tr_b16 v[66:67], v48 offset:59392
    v_mfma_f32_16x16x32_bf16 v[32:35], v[80:83], a[56:59], v[32:35]
    buffer_load_dwordx4 a[40:43], v2, s[88:91], s37 offen
    v_mfma_f32_16x16x32_bf16 v[36:39], v[80:83], a[60:63], v[36:39]
    ds_read_b64_tr_b16 v[68:69], v49 offset:10240
    ds_read_b64_tr_b16 v[70:71], v49 offset:26624
    v_mfma_f32_16x16x32_bf16 v[36:39], v[76:79], a[52:55], v[36:39]
    s_waitcnt lgkmcnt(6)
    ds_read_b64_tr_b16 v[72:73], v49 offset:43008
    v_mfma_f32_16x16x32_bf16 v[44:47], v[84:87], a[52:55], v[44:47]
    ds_read_b64_tr_b16 v[74:75], v49 offset:59392
    v_mfma_f32_16x16x32_bf16 v[44:47], v[88:91], a[60:63], v[44:47]
    buffer_load_dwordx4 a[44:47], v3, s[88:91], s37 offen
    v_mfma_f32_16x16x32_bf16 v[40:43], v[88:91], a[56:59], v[40:43]
    s_waitcnt vmcnt(19)
    ds_read_b64_tr_b16 v[76:77], v50 offset:10240
    ds_read_b64_tr_b16 v[78:79], v50 offset:26624
    v_mfma_f32_16x16x32_bf16 v[40:43], v[84:87], a[48:51], v[40:43]
    s_waitcnt lgkmcnt(6)
    ds_read_b64_tr_b16 v[80:81], v50 offset:43008
    v_mfma_f32_16x16x32_bf16 v[16:19], v[60:63], a[64:67], v[16:19]
    s_add_u32 s37, s37, 1024
    ds_read_b64_tr_b16 v[82:83], v50 offset:59392
    v_mfma_f32_16x16x32_bf16 v[16:19], v[64:67], a[72:75], v[16:19]
    buffer_load_dwordx4 a[48:51], v2, s[88:91], s37 offen sc1
    v_mfma_f32_16x16x32_bf16 v[20:23], v[64:67], a[76:79], v[20:23]
    ds_read_b64_tr_b16 v[84:85], v51 offset:10240
    ds_read_b64_tr_b16 v[86:87], v51 offset:26624
    v_mfma_f32_16x16x32_bf16 v[20:23], v[60:63], a[68:71], v[20:23]
    s_waitcnt lgkmcnt(6)
    ds_read_b64_tr_b16 v[88:89], v51 offset:43008
    v_mfma_f32_16x16x32_bf16 v[28:31], v[68:71], a[68:71], v[28:31]
    ds_read_b64_tr_b16 v[90:91], v51 offset:59392
    v_mfma_f32_16x16x32_bf16 v[28:31], v[72:75], a[76:79], v[28:31]
    buffer_load_dwordx4 a[52:55], v3, s[88:91], s37 offen sc1
    v_mfma_f32_16x16x32_bf16 v[24:27], v[72:75], a[72:75], v[24:27]
    ds_read_b64_tr_b16 v[60:61], v48 offset:12288
    ds_read_b64_tr_b16 v[62:63], v48 offset:28672
    v_mfma_f32_16x16x32_bf16 v[24:27], v[68:71], a[64:67], v[24:27]
    s_waitcnt lgkmcnt(6)
    ds_read_b64_tr_b16 v[64:65], v48 offset:45056
    v_mfma_f32_16x16x32_bf16 v[32:35], v[76:79], a[64:67], v[32:35]
    s_add_u32 s37, s37, 1024
    ds_read_b64_tr_b16 v[66:67], v48 offset:61440
    v_mfma_f32_16x16x32_bf16 v[32:35], v[80:83], a[72:75], v[32:35]
    buffer_load_dwordx4 a[56:59], v2, s[88:91], s37 offen
    v_mfma_f32_16x16x32_bf16 v[36:39], v[80:83], a[76:79], v[36:39]
    ds_read_b64_tr_b16 v[68:69], v49 offset:12288
    ds_read_b64_tr_b16 v[70:71], v49 offset:28672
    v_mfma_f32_16x16x32_bf16 v[36:39], v[76:79], a[68:71], v[36:39]
    s_waitcnt lgkmcnt(6)
    ds_read_b64_tr_b16 v[72:73], v49 offset:45056
    v_mfma_f32_16x16x32_bf16 v[44:47], v[84:87], a[68:71], v[44:47]
    ds_read_b64_tr_b16 v[74:75], v49 offset:61440
    v_mfma_f32_16x16x32_bf16 v[44:47], v[88:91], a[76:79], v[44:47]
    buffer_load_dwordx4 a[60:63], v3, s[88:91], s37 offen
    v_mfma_f32_16x16x32_bf16 v[40:43], v[88:91], a[72:75], v[40:43]
    s_waitcnt vmcnt(18)
    ds_read_b64_tr_b16 v[76:77], v50 offset:12288
    ds_read_b64_tr_b16 v[78:79], v50 offset:28672
    v_mfma_f32_16x16x32_bf16 v[40:43], v[84:87], a[64:67], v[40:43]
    s_waitcnt lgkmcnt(6)
    ds_read_b64_tr_b16 v[80:81], v50 offset:45056
    v_mfma_f32_16x16x32_bf16 v[16:19], v[60:63], a[80:83], v[16:19]
    s_add_u32 s37, s37, 1024
    ds_read_b64_tr_b16 v[82:83], v50 offset:61440
    v_mfma_f32_16x16x32_bf16 v[16:19], v[64:67], a[88:91], v[16:19]
    buffer_load_dwordx4 a[64:67], v2, s[88:91], s37 offen
    v_mfma_f32_16x16x32_bf16 v[20:23], v[64:67], a[92:95], v[20:23]
    ds_read_b64_tr_b16 v[84:85], v51 offset:12288
    ds_read_b64_tr_b16 v[86:87], v51 offset:28672
    v_mfma_f32_16x16x32_bf16 v[20:23], v[60:63], a[84:87], v[20:23]
    s_waitcnt lgkmcnt(6)
    ds_read_b64_tr_b16 v[88:89], v51 offset:45056
    v_mfma_f32_16x16x32_bf16 v[28:31], v[68:71], a[84:87], v[28:31]
    ds_read_b64_tr_b16 v[90:91], v51 offset:61440
    v_mfma_f32_16x16x32_bf16 v[28:31], v[72:75], a[92:95], v[28:31]
    buffer_load_dwordx4 a[68:71], v3, s[88:91], s37 offen
    v_mfma_f32_16x16x32_bf16 v[24:27], v[72:75], a[88:91], v[24:27]
    ds_read_b64_tr_b16 v[60:61], v48 offset:14336
    ds_read_b64_tr_b16 v[62:63], v48 offset:30720
    v_mfma_f32_16x16x32_bf16 v[24:27], v[68:71], a[80:83], v[24:27]
    s_waitcnt lgkmcnt(6)
    ds_read_b64_tr_b16 v[64:65], v48 offset:47104
    v_mfma_f32_16x16x32_bf16 v[32:35], v[76:79], a[80:83], v[32:35]
    s_add_u32 s37, s37, 1024
    ds_read_b64_tr_b16 v[66:67], v48 offset:63488
    v_mfma_f32_16x16x32_bf16 v[32:35], v[80:83], a[88:91], v[32:35]
    buffer_load_dwordx4 a[72:75], v2, s[88:91], s37 offen
    v_mfma_f32_16x16x32_bf16 v[36:39], v[80:83], a[92:95], v[36:39]
    ds_read_b64_tr_b16 v[68:69], v49 offset:14336
    ds_read_b64_tr_b16 v[70:71], v49 offset:30720
    v_mfma_f32_16x16x32_bf16 v[36:39], v[76:79], a[84:87], v[36:39]
    s_waitcnt lgkmcnt(6)
    ds_read_b64_tr_b16 v[72:73], v49 offset:47104
    v_mfma_f32_16x16x32_bf16 v[44:47], v[84:87], a[84:87], v[44:47]
    buffer_load_dwordx2 v[6:7], v11, s[96:99], s39 offen sc1
    v_mfma_f32_16x16x32_bf16 v[44:47], v[88:91], a[92:95], v[44:47]
    buffer_load_dwordx4 a[76:79], v3, s[88:91], s37 offen
    v_mfma_f32_16x16x32_bf16 v[40:43], v[88:91], a[88:91], v[40:43]
    s_waitcnt vmcnt(19)
    ds_read_b64_tr_b16 v[74:75], v49 offset:63488
    ds_read_b64_tr_b16 v[76:77], v50 offset:14336
    v_mfma_f32_16x16x32_bf16 v[40:43], v[84:87], a[80:83], v[40:43]
    s_waitcnt lgkmcnt(5)
    ds_read_b64_tr_b16 v[78:79], v50 offset:30720
    ds_read_b64_tr_b16 v[80:81], v50 offset:47104
    v_mfma_f32_16x16x32_bf16 v[16:19], v[60:63], a[96:99], v[16:19]
    s_add_u32 s37, s37, 1024
    ds_read_b64_tr_b16 v[82:83], v50 offset:63488
    v_mfma_f32_16x16x32_bf16 v[16:19], v[64:67], a[0:3], v[16:19]
    ds_read_b64_tr_b16 v[84:85], v51 offset:14336
    v_mfma_f32_16x16x32_bf16 v[20:23], v[64:67], a[4:7], v[20:23]
    s_barrier
    ds_read_b64_tr_b16 v[86:87], v51 offset:30720
    v_mfma_f32_16x16x32_bf16 v[20:23], v[60:63], a[100:103], v[20:23]
    s_waitcnt lgkmcnt(6)
    ds_read_b64_tr_b16 v[88:89], v51 offset:47104
    v_mfma_f32_16x16x32_bf16 v[28:31], v[68:71], a[100:103], v[28:31]
    buffer_load_dwordx4 a[80:83], v2, s[88:91], s37 offen
    v_mfma_f32_16x16x32_bf16 v[28:31], v[72:75], a[4:7], v[28:31]
    buffer_load_dwordx4 a[84:87], v3, s[88:91], s37 offen
    v_mfma_f32_16x16x32_bf16 v[24:27], v[72:75], a[0:3], v[24:27]
    ds_read_b64_tr_b16 v[90:91], v51 offset:63488
    ds_read_b64_tr_b16 v[60:61], v52 offset:0
    v_mfma_f32_16x16x32_bf16 v[24:27], v[68:71], a[96:99], v[24:27]
    s_waitcnt lgkmcnt(5)
    ds_read_b64_tr_b16 v[62:63], v52 offset:24576
    ds_read_b64_tr_b16 v[64:65], v52 offset:49152
    v_mfma_f32_16x16x32_bf16 v[32:35], v[76:79], a[96:99], v[32:35]
    s_add_u32 s37, s37, 1024
    ds_read_b64_tr_b16 v[66:67], v56 offset:8192
    v_mfma_f32_16x16x32_bf16 v[32:35], v[80:83], a[0:3], v[32:35]
    buffer_load_dwordx4 a[88:91], v2, s[88:91], s37 offen
    v_mfma_f32_16x16x32_bf16 v[36:39], v[80:83], a[4:7], v[36:39]
    ds_read_b64_tr_b16 v[68:69], v53 offset:0
    ds_read_b64_tr_b16 v[70:71], v53 offset:24576
    v_mfma_f32_16x16x32_bf16 v[36:39], v[76:79], a[100:103], v[36:39]
    s_waitcnt lgkmcnt(6)
    ds_read_b64_tr_b16 v[72:73], v53 offset:49152
    v_mfma_f32_16x16x32_bf16 v[44:47], v[84:87], a[100:103], v[44:47]
    ds_read_b64_tr_b16 v[74:75], v57 offset:8192
    v_mfma_f32_16x16x32_bf16 v[44:47], v[88:91], a[4:7], v[44:47]
    buffer_load_dwordx4 a[92:95], v3, s[88:91], s37 offen
    v_mfma_f32_16x16x32_bf16 v[40:43], v[88:91], a[0:3], v[40:43]
    s_waitcnt vmcnt(19)
    ds_read_b64_tr_b16 v[76:77], v54 offset:0
    ds_read_b64_tr_b16 v[78:79], v54 offset:24576
    v_mfma_f32_16x16x32_bf16 v[40:43], v[84:87], a[96:99], v[40:43]
    s_waitcnt lgkmcnt(6)
    ds_read_b64_tr_b16 v[80:81], v54 offset:49152
    v_mfma_f32_16x16x32_bf16 v[16:19], v[60:63], a[8:11], v[16:19]
    s_add_u32 s37, s37, 1024
    ds_read_b64_tr_b16 v[82:83], v58 offset:8192
    v_mfma_f32_16x16x32_bf16 v[16:19], v[64:67], a[16:19], v[16:19]
    buffer_load_dwordx4 a[96:99], v2, s[88:91], s37 offen
    v_mfma_f32_16x16x32_bf16 v[20:23], v[64:67], a[20:23], v[20:23]
    ds_read_b64_tr_b16 v[84:85], v55 offset:0
    ds_read_b64_tr_b16 v[86:87], v55 offset:24576
    v_mfma_f32_16x16x32_bf16 v[20:23], v[60:63], a[12:15], v[20:23]
    s_waitcnt lgkmcnt(6)
    ds_read_b64_tr_b16 v[88:89], v55 offset:49152
    v_mfma_f32_16x16x32_bf16 v[28:31], v[68:71], a[12:15], v[28:31]
    ds_read_b64_tr_b16 v[90:91], v59 offset:8192
    v_mfma_f32_16x16x32_bf16 v[28:31], v[72:75], a[20:23], v[28:31]
    buffer_load_dwordx4 a[100:103], v3, s[88:91], s37 offen
    v_mfma_f32_16x16x32_bf16 v[24:27], v[72:75], a[16:19], v[24:27]
    ds_read_b64_tr_b16 v[60:61], v52 offset:2048
    ds_read_b64_tr_b16 v[62:63], v52 offset:26624
    v_mfma_f32_16x16x32_bf16 v[24:27], v[68:71], a[8:11], v[24:27]
    s_waitcnt lgkmcnt(6)
    ds_read_b64_tr_b16 v[64:65], v52 offset:51200
    v_mfma_f32_16x16x32_bf16 v[32:35], v[76:79], a[8:11], v[32:35]
    s_add_u32 s37, s37, 1024
    ds_read_b64_tr_b16 v[66:67], v56 offset:10240
    v_mfma_f32_16x16x32_bf16 v[32:35], v[80:83], a[16:19], v[32:35]
    buffer_load_dwordx4 a[0:3], v2, s[88:91], s37 offen sc1
    v_mfma_f32_16x16x32_bf16 v[36:39], v[80:83], a[20:23], v[36:39]
    ds_read_b64_tr_b16 v[68:69], v53 offset:2048
    ds_read_b64_tr_b16 v[70:71], v53 offset:26624
    v_mfma_f32_16x16x32_bf16 v[36:39], v[76:79], a[12:15], v[36:39]
    s_waitcnt lgkmcnt(6)
    ds_read_b64_tr_b16 v[72:73], v53 offset:51200
    v_mfma_f32_16x16x32_bf16 v[44:47], v[84:87], a[12:15], v[44:47]
    ds_read_b64_tr_b16 v[74:75], v57 offset:10240
    v_mfma_f32_16x16x32_bf16 v[44:47], v[88:91], a[20:23], v[44:47]
    buffer_load_dwordx4 a[4:7], v3, s[88:91], s37 offen sc1
    v_mfma_f32_16x16x32_bf16 v[40:43], v[88:91], a[16:19], v[40:43]
    s_waitcnt vmcnt(19)
    ds_read_b64_tr_b16 v[76:77], v54 offset:2048
    ds_read_b64_tr_b16 v[78:79], v54 offset:26624
    v_mfma_f32_16x16x32_bf16 v[40:43], v[84:87], a[8:11], v[40:43]
    s_waitcnt lgkmcnt(6)
    ds_read_b64_tr_b16 v[80:81], v54 offset:51200
    v_mfma_f32_16x16x32_bf16 v[16:19], v[60:63], a[24:27], v[16:19]
    s_add_u32 s37, s37, 1024
    ds_read_b64_tr_b16 v[82:83], v58 offset:10240
    v_mfma_f32_16x16x32_bf16 v[16:19], v[64:67], a[32:35], v[16:19]
    buffer_load_dwordx4 a[8:11], v2, s[88:91], s37 offen
    v_mfma_f32_16x16x32_bf16 v[20:23], v[64:67], a[36:39], v[20:23]
    ds_read_b64_tr_b16 v[84:85], v55 offset:2048
    ds_read_b64_tr_b16 v[86:87], v55 offset:26624
    v_mfma_f32_16x16x32_bf16 v[20:23], v[60:63], a[28:31], v[20:23]
    s_waitcnt lgkmcnt(6)
    ds_read_b64_tr_b16 v[88:89], v55 offset:51200
    v_mfma_f32_16x16x32_bf16 v[28:31], v[68:71], a[28:31], v[28:31]
    ds_read_b64_tr_b16 v[90:91], v59 offset:10240
    v_mfma_f32_16x16x32_bf16 v[28:31], v[72:75], a[36:39], v[28:31]
    buffer_load_dwordx4 a[12:15], v3, s[88:91], s37 offen
    v_mfma_f32_16x16x32_bf16 v[24:27], v[72:75], a[32:35], v[24:27]
    ds_read_b64_tr_b16 v[60:61], v52 offset:4096
    ds_read_b64_tr_b16 v[62:63], v52 offset:28672
    v_mfma_f32_16x16x32_bf16 v[24:27], v[68:71], a[24:27], v[24:27]
    s_waitcnt lgkmcnt(6)
    ds_read_b64_tr_b16 v[64:65], v52 offset:53248
    v_mfma_f32_16x16x32_bf16 v[32:35], v[76:79], a[24:27], v[32:35]
    s_add_u32 s37, s37, 1024
    ds_read_b64_tr_b16 v[66:67], v56 offset:12288
    s_waitcnt vmcnt(11)
    v_cmp_ne_u64 vcc, s[50:51], v[6:7]
    s_nop 1
    s_cmp_eq_u64 vcc, 0
    s_cbranch_scc1 f_s_rdyB
f_s_spinB:
    buffer_load_dwordx2 v[6:7], v11, s[96:99], s39 offen sc1
    s_waitcnt vmcnt(0)
    v_cmp_ne_u64 vcc, s[50:51], v[6:7]
    s_nop 1
    s_cmp_lg_u64 vcc, 0
    s_cbranch_scc1 f_s_spinB
f_s_rdyB:
    v_mfma_f32_16x16x32_bf16 v[32:35], v[80:83], a[32:35], v[32:35]
    buffer_load_dwordx4 a[16:19], v2, s[88:91], s37 offen
    v_mfma_f32_16x16x32_bf16 v[36:39], v[80:83], a[36:39], v[36:39]
    buffer_load_dwordx4 v[92:95], v15, s[20:23], s34 offen offset:0 sc1
    v_mfma_f32_16x16x32_bf16 v[36:39], v[76:79], a[28:31], v[36:39]
    s_waitcnt lgkmcnt(4)
    ds_read_b64_tr_b16 v[68:69], v53 offset:4096
    ds_read_b64_tr_b16 v[70:71], v53 offset:28672
    v_mfma_f32_16x16x32_bf16 v[44:47], v[84:87], a[28:31], v[44:47]
    ds_read_b64_tr_b16 v[72:73], v53 offset:53248
    ds_read_b64_tr_b16 v[74:75], v57 offset:12288
    v_mfma_f32_16x16x32_bf16 v[44:47], v[88:91], a[36:39], v[44:47]
    buffer_load_dwordx4 a[20:23], v3, s[88:91], s37 offen
    v_mfma_f32_16x16x32_bf16 v[40:43], v[88:91], a[32:35], v[40:43]
    ds_read_b64_tr_b16 v[76:77], v54 offset:4096
    ds_read_b64_tr_b16 v[78:79], v54 offset:28672
    v_mfma_f32_16x16x32_bf16 v[40:43], v[84:87], a[24:27], v[40:43]
    s_waitcnt lgkmcnt(6)
    s_add_u32 s37, s37, 1024
    ds_read_b64_tr_b16 v[80:81], v54 offset:53248
    v_mfma_f32_16x16x32_bf16 v[16:19], v[60:63], a[40:43], v[16:19]
    buffer_load_dwordx4 v[96:99], v15, s[20:23], s34 offen offset:1024 sc1
    v_mfma_f32_16x16x32_bf16 v[16:19], v[64:67], a[48:51], v[16:19]
    buffer_load_dwordx4 a[24:27], v2, s[88:91], s37 offen
    v_mfma_f32_16x16x32_bf16 v[20:23], v[64:67], a[52:55], v[20:23]
    s_add_u32 s34, s34, 0x8000
    buffer_load_dwordx4 v[100:103], v15, s[20:23], s34 offen offset:0 sc1
    v_mfma_f32_16x16x32_bf16 v[20:23], v[60:63], a[44:47], v[20:23]
    s_waitcnt lgkmcnt(3)
    ds_read_b64_tr_b16 v[82:83], v58 offset:12288
    ds_read_b64_tr_b16 v[84:85], v55 offset:4096
    v_mfma_f32_16x16x32_bf16 v[28:31], v[68:71], a[44:47], v[28:31]
    ds_read_b64_tr_b16 v[86:87], v55 offset:28672
    ds_read_b64_tr_b16 v[88:89], v55 offset:53248
    v_mfma_f32_16x16x32_bf16 v[28:31], v[72:75], a[52:55], v[28:31]
    buffer_load_dwordx4 a[28:31], v3, s[88:91], s37 offen
    v_mfma_f32_16x16x32_bf16 v[24:27], v[72:75], a[48:51], v[24:27]
    buffer_load_dwordx4 v[104:107], v15, s[20:23], s34 offen offset:1024 sc1
    v_mfma_f32_16x16x32_bf16 v[24:27], v[68:71], a[40:43], v[24:27]
    s_waitcnt lgkmcnt(3)
    ds_read_b64_tr_b16 v[90:91], v59 offset:12288
    ds_read_b64_tr_b16 v[60:61], v52 offset:6144
    v_mfma_f32_16x16x32_bf16 v[32:35], v[76:79], a[40:43], v[32:35]
    ds_read_b64_tr_b16 v[62:63], v52 offset:30720
    ds_read_b64_tr_b16 v[64:65], v52 offset:55296
    v_mfma_f32_16x16x32_bf16 v[32:35], v[80:83], a[48:51], v[32:35]
    s_add_u32 s34, s34, 4161536
    ds_read_b64_tr_b16 v[66:67], v56 offset:14336
    ds_read_b64_tr_b16 v[68:69], v53 offset:6144
    v_mfma_f32_16x16x32_bf16 v[36:39], v[80:83], a[52:55], v[36:39]
    buffer_load_dwordx4 v[108:111], v15, s[20:23], s34 offen offset:0 sc1
    v_mfma_f32_16x16x32_bf16 v[36:39], v[76:79], a[44:47], v[36:39]
    s_waitcnt lgkmcnt(5)
    ds_read_b64_tr_b16 v[70:71], v53 offset:30720
    ds_read_b64_tr_b16 v[72:73], v53 offset:55296
    v_mfma_f32_16x16x32_bf16 v[44:47], v[84:87], a[44:47], v[44:47]
    ds_read_b64_tr_b16 v[74:75], v57 offset:14336
    v_mfma_f32_16x16x32_bf16 v[44:47], v[88:91], a[52:55], v[44:47]
    ds_read_b64_tr_b16 v[76:77], v54 offset:6144
    v_mfma_f32_16x16x32_bf16 v[40:43], v[88:91], a[48:51], v[40:43]
    ds_read_b64_tr_b16 v[78:79], v54 offset:30720
    v_mfma_f32_16x16x32_bf16 v[40:43], v[84:87], a[40:43], v[40:43]
    s_waitcnt lgkmcnt(6)
    ds_read_b64_tr_b16 v[80:81], v54 offset:55296
    v_mfma_f32_16x16x32_bf16 v[16:19], v[60:63], a[56:59], v[16:19]
    buffer_load_dwordx4 v[112:115], v15, s[20:23], s34 offen offset:1024 sc1
    v_mfma_f32_16x16x32_bf16 v[16:19], v[64:67], a[64:67], v[16:19]
    s_add_u32 s34, s34, 0x8000
    ds_read_b64_tr_b16 v[82:83], v58 offset:14336
    ds_read_b64_tr_b16 v[84:85], v55 offset:6144
    v_mfma_f32_16x16x32_bf16 v[20:23], v[64:67], a[68:71], v[20:23]
    buffer_load_dwordx4 v[116:119], v15, s[20:23], s34 offen offset:0 sc1
    v_mfma_f32_16x16x32_bf16 v[20:23], v[60:63], a[60:63], v[20:23]
    s_waitcnt lgkmcnt(5)
    ds_read_b64_tr_b16 v[86:87], v55 offset:30720
    ds_read_b64_tr_b16 v[88:89], v55 offset:55296
    v_mfma_f32_16x16x32_bf16 v[28:31], v[68:71], a[60:63], v[28:31]
    ds_read_b64_tr_b16 v[90:91], v59 offset:14336
    v_mfma_f32_16x16x32_bf16 v[28:31], v[72:75], a[68:71], v[28:31]
    ds_read_b64_tr_b16 v[60:61], v52 offset:8192
    v_mfma_f32_16x16x32_bf16 v[24:27], v[72:75], a[64:67], v[24:27]
    buffer_load_dwordx4 v[120:123], v15, s[20:23], s34 offen offset:1024 sc1
    v_mfma_f32_16x16x32_bf16 v[24:27], v[68:71], a[56:59], v[24:27]
    s_waitcnt lgkmcnt(5)
    ds_read_b64_tr_b16 v[62:63], v52 offset:32768
    ds_read_b64_tr_b16 v[64:65], v52 offset:57344
    v_mfma_f32_16x16x32_bf16 v[32:35], v[76:79], a[56:59], v[32:35]
    ds_read_b64_tr_b16 v[66:67], v56 offset:16384
    v_mfma_f32_16x16x32_bf16 v[32:35], v[80:83], a[64:67], v[32:35]
    ds_read_b64_tr_b16 v[68:69], v53 offset:8192
    v_mfma_f32_16x16x32_bf16 v[36:39], v[80:83], a[68:71], v[36:39]
    ds_read_b64_tr_b16 v[70:71], v53 offset:32768
    v_mfma_f32_16x16x32_bf16 v[36:39], v[76:79], a[60:63], v[36:39]
    s_waitcnt lgkmcnt(6)
    ds_read_b64_tr_b16 v[72:73], v53 offset:57344
    v_mfma_f32_16x16x32_bf16 v[44:47], v[84:87], a[60:63], v[44:47]
    ds_read_b64_tr_b16 v[74:75], v57 offset:16384
    v_mfma_f32_16x16x32_bf16 v[44:47], v[88:91], a[68:71], v[44:47]
    ds_read_b64_tr_b16 v[76:77], v54 offset:8192
    v_mfma_f32_16x16x32_bf16 v[40:43], v[88:91], a[64:67], v[40:43]
    s_waitcnt vmcnt(20)
    ds_read_b64_tr_b16 v[78:79], v54 offset:32768
    v_mfma_f32_16x16x32_bf16 v[40:43], v[84:87], a[56:59], v[40:43]
    s_waitcnt lgkmcnt(6)
    ds_read_b64_tr_b16 v[80:81], v54 offset:57344
    v_mfma_f32_16x16x32_bf16 v[16:19], v[60:63], a[72:75], v[16:19]
    ds_read_b64_tr_b16 v[82:83], v58 offset:16384
    v_mfma_f32_16x16x32_bf16 v[16:19], v[64:67], a[80:83], v[16:19]
    ds_read_b64_tr_b16 v[84:85], v55 offset:8192
    v_mfma_f32_16x16x32_bf16 v[20:23], v[64:67], a[84:87], v[20:23]
    ds_read_b64_tr_b16 v[86:87], v55 offset:32768
    v_mfma_f32_16x16x32_bf16 v[20:23], v[60:63], a[76:79], v[20:23]
    s_waitcnt lgkmcnt(6)
    ds_read_b64_tr_b16 v[88:89], v55 offset:57344
    v_mfma_f32_16x16x32_bf16 v[28:31], v[68:71], a[76:79], v[28:31]
    ds_read_b64_tr_b16 v[90:91], v59 offset:16384
    v_mfma_f32_16x16x32_bf16 v[28:31], v[72:75], a[84:87], v[28:31]
    ds_read_b64_tr_b16 v[60:61], v52 offset:10240
    v_mfma_f32_16x16x32_bf16 v[24:27], v[72:75], a[80:83], v[24:27]
    ds_read_b64_tr_b16 v[62:63], v52 offset:34816
    v_mfma_f32_16x16x32_bf16 v[24:27], v[68:71], a[72:75], v[24:27]
    s_waitcnt lgkmcnt(6)
    ds_read_b64_tr_b16 v[64:65], v52 offset:59392
    v_mfma_f32_16x16x32_bf16 v[32:35], v[76:79], a[72:75], v[32:35]
    ds_read_b64_tr_b16 v[66:67], v56 offset:18432
    v_mfma_f32_16x16x32_bf16 v[32:35], v[80:83], a[80:83], v[32:35]
    ds_read_b64_tr_b16 v[68:69], v53 offset:10240
    v_mfma_f32_16x16x32_bf16 v[36:39], v[80:83], a[84:87], v[36:39]
    ds_read_b64_tr_b16 v[70:71], v53 offset:34816
    v_mfma_f32_16x16x32_bf16 v[36:39], v[76:79], a[76:79], v[36:39]
    s_waitcnt lgkmcnt(6)
    ds_read_b64_tr_b16 v[72:73], v53 offset:59392
    v_mfma_f32_16x16x32_bf16 v[44:47], v[84:87], a[76:79], v[44:47]
    ds_read_b64_tr_b16 v[74:75], v57 offset:18432
    v_mfma_f32_16x16x32_bf16 v[44:47], v[88:91], a[84:87], v[44:47]
    ds_read_b64_tr_b16 v[76:77], v54 offset:10240
    v_mfma_f32_16x16x32_bf16 v[40:43], v[88:91], a[80:83], v[40:43]
    s_waitcnt vmcnt(16)
    ds_read_b64_tr_b16 v[78:79], v54 offset:34816
    v_mfma_f32_16x16x32_bf16 v[40:43], v[84:87], a[72:75], v[40:43]
    s_waitcnt lgkmcnt(6)
    ds_read_b64_tr_b16 v[80:81], v54 offset:59392
    v_mfma_f32_16x16x32_bf16 v[16:19], v[60:63], a[88:91], v[16:19]
    ds_read_b64_tr_b16 v[82:83], v58 offset:18432
    v_mfma_f32_16x16x32_bf16 v[16:19], v[64:67], a[96:99], v[16:19]
    ds_read_b64_tr_b16 v[84:85], v55 offset:10240
    v_mfma_f32_16x16x32_bf16 v[20:23], v[64:67], a[100:103], v[20:23]
    ds_read_b64_tr_b16 v[86:87], v55 offset:34816
    v_mfma_f32_16x16x32_bf16 v[20:23], v[60:63], a[92:95], v[20:23]
    s_waitcnt lgkmcnt(6)
    ds_read_b64_tr_b16 v[88:89], v55 offset:59392
    v_mfma_f32_16x16x32_bf16 v[28:31], v[68:71], a[92:95], v[28:31]
    ds_read_b64_tr_b16 v[90:91], v59 offset:18432
    v_mfma_f32_16x16x32_bf16 v[28:31], v[72:75], a[100:103], v[28:31]
    ds_read_b64_tr_b16 v[60:61], v52 offset:12288
    v_mfma_f32_16x16x32_bf16 v[24:27], v[72:75], a[96:99], v[24:27]
    ds_read_b64_tr_b16 v[62:63], v52 offset:36864
    v_mfma_f32_16x16x32_bf16 v[24:27], v[68:71], a[88:91], v[24:27]
    s_waitcnt lgkmcnt(6)
    ds_read_b64_tr_b16 v[64:65], v52 offset:61440
    v_mfma_f32_16x16x32_bf16 v[32:35], v[76:79], a[88:91], v[32:35]
    ds_read_b64_tr_b16 v[66:67], v56 offset:20480
    v_mfma_f32_16x16x32_bf16 v[32:35], v[80:83], a[96:99], v[32:35]
    ds_read_b64_tr_b16 v[68:69], v53 offset:12288
    v_mfma_f32_16x16x32_bf16 v[36:39], v[80:83], a[100:103], v[36:39]
    ds_read_b64_tr_b16 v[70:71], v53 offset:36864
    v_mfma_f32_16x16x32_bf16 v[36:39], v[76:79], a[92:95], v[36:39]
    s_waitcnt lgkmcnt(6)
    ds_read_b64_tr_b16 v[72:73], v53 offset:61440
    v_mfma_f32_16x16x32_bf16 v[44:47], v[84:87], a[92:95], v[44:47]
    ds_read_b64_tr_b16 v[74:75], v57 offset:20480
    v_mfma_f32_16x16x32_bf16 v[44:47], v[88:91], a[100:103], v[44:47]
    ds_read_b64_tr_b16 v[76:77], v54 offset:12288
    v_mfma_f32_16x16x32_bf16 v[40:43], v[88:91], a[96:99], v[40:43]
    s_waitcnt vmcnt(12)
    ds_read_b64_tr_b16 v[78:79], v54 offset:36864
    v_mfma_f32_16x16x32_bf16 v[40:43], v[84:87], a[88:91], v[40:43]
    s_waitcnt lgkmcnt(6)
    ds_read_b64_tr_b16 v[80:81], v54 offset:61440
    v_mfma_f32_16x16x32_bf16 v[16:19], v[60:63], a[0:3], v[16:19]
    ds_read_b64_tr_b16 v[82:83], v58 offset:20480
    v_mfma_f32_16x16x32_bf16 v[16:19], v[64:67], a[8:11], v[16:19]
    ds_read_b64_tr_b16 v[84:85], v55 offset:12288
    v_mfma_f32_16x16x32_bf16 v[20:23], v[64:67], a[12:15], v[20:23]
    ds_read_b64_tr_b16 v[86:87], v55 offset:36864
    v_mfma_f32_16x16x32_bf16 v[20:23], v[60:63], a[4:7], v[20:23]
    s_waitcnt lgkmcnt(6)
    ds_read_b64_tr_b16 v[88:89], v55 offset:61440
    v_mfma_f32_16x16x32_bf16 v[28:31], v[68:71], a[4:7], v[28:31]
    ds_read_b64_tr_b16 v[90:91], v59 offset:20480
    v_mfma_f32_16x16x32_bf16 v[28:31], v[72:75], a[12:15], v[28:31]
    ds_read_b64_tr_b16 v[60:61], v52 offset:14336
    v_mfma_f32_16x16x32_bf16 v[24:27], v[72:75], a[8:11], v[24:27]
    ds_read_b64_tr_b16 v[62:63], v52 offset:38912
    v_mfma_f32_16x16x32_bf16 v[24:27], v[68:71], a[0:3], v[24:27]
    s_waitcnt lgkmcnt(6)
    ds_read_b64_tr_b16 v[64:65], v52 offset:63488
    v_mfma_f32_16x16x32_bf16 v[32:35], v[76:79], a[0:3], v[32:35]
    ds_read_b64_tr_b16 v[66:67], v56 offset:22528
    v_mfma_f32_16x16x32_bf16 v[32:35], v[80:83], a[8:11], v[32:35]
    ds_read_b64_tr_b16 v[68:69], v53 offset:14336
    v_mfma_f32_16x16x32_bf16 v[36:39], v[80:83], a[12:15], v[36:39]
    ds_read_b64_tr_b16 v[70:71], v53 offset:38912
    v_mfma_f32_16x16x32_bf16 v[36:39], v[76:79], a[4:7], v[36:39]
    s_waitcnt lgkmcnt(6)
    ds_read_b64_tr_b16 v[72:73], v53 offset:63488
    v_mfma_f32_16x16x32_bf16 v[44:47], v[84:87], a[4:7], v[44:47]
    ds_read_b64_tr_b16 v[74:75], v57 offset:22528
    v_mfma_f32_16x16x32_bf16 v[44:47], v[88:91], a[12:15], v[44:47]
    ds_read_b64_tr_b16 v[76:77], v54 offset:14336
    v_mfma_f32_16x16x32_bf16 v[40:43], v[88:91], a[8:11], v[40:43]
    s_waitcnt vmcnt(5)
    ds_read_b64_tr_b16 v[78:79], v54 offset:38912
    v_mfma_f32_16x16x32_bf16 v[40:43], v[84:87], a[0:3], v[40:43]
    s_waitcnt lgkmcnt(6)
    ds_read_b64_tr_b16 v[80:81], v54 offset:63488
    v_mfma_f32_16x16x32_bf16 v[16:19], v[60:63], a[16:19], v[16:19]
    ds_read_b64_tr_b16 v[82:83], v58 offset:22528
    v_mfma_f32_16x16x32_bf16 v[16:19], v[64:67], a[24:27], v[16:19]
    ds_read_b64_tr_b16 v[84:85], v55 offset:14336
    v_mfma_f32_16x16x32_bf16 v[20:23], v[64:67], a[28:31], v[20:23]
    ds_read_b64_tr_b16 v[86:87], v55 offset:38912
    v_mfma_f32_16x16x32_bf16 v[20:23], v[60:63], a[20:23], v[20:23]
    s_waitcnt lgkmcnt(6)
    ds_read_b64_tr_b16 v[88:89], v55 offset:63488
    v_mfma_f32_16x16x32_bf16 v[28:31], v[68:71], a[20:23], v[28:31]
    ds_read_b64_tr_b16 v[90:91], v59 offset:22528
    v_mfma_f32_16x16x32_bf16 v[28:31], v[72:75], a[28:31], v[28:31]
    v_mfma_f32_16x16x32_bf16 v[24:27], v[72:75], a[24:27], v[24:27]
    v_mfma_f32_16x16x32_bf16 v[24:27], v[68:71], a[16:19], v[24:27]
    s_waitcnt lgkmcnt(4)
    v_mfma_f32_16x16x32_bf16 v[32:35], v[76:79], a[16:19], v[32:35]
    v_mfma_f32_16x16x32_bf16 v[32:35], v[80:83], a[24:27], v[32:35]
    v_mfma_f32_16x16x32_bf16 v[36:39], v[80:83], a[28:31], v[36:39]
    v_mfma_f32_16x16x32_bf16 v[36:39], v[76:79], a[20:23], v[36:39]
    s_waitcnt lgkmcnt(0)
    v_mfma_f32_16x16x32_bf16 v[44:47], v[84:87], a[20:23], v[44:47]
    v_mfma_f32_16x16x32_bf16 v[44:47], v[88:91], a[28:31], v[44:47]
    v_mfma_f32_16x16x32_bf16 v[40:43], v[88:91], a[24:27], v[40:43]
    v_mfma_f32_16x16x32_bf16 v[40:43], v[84:87], a[16:19], v[40:43]
f_fin:
    s_waitcnt vmcnt(0) lgkmcnt(0)
    v_mov_b32 v6, 0xbfb8aa3b
    v_mov_b32 v7, 0xbfb8aa3b
    v_mov_b32 v12, 1.0
    v_mov_b32 v13, 1.0
    v_cvt_pk_bf16_f32 v164, v16, v17
    v_cvt_pk_bf16_f32 v165, v18, v19
    v_lshlrev_b32 v16, 16, v164
    v_and_b32 v17, 0xffff0000, v164
    v_lshlrev_b32 v18, 16, v165
    v_and_b32 v19, 0xffff0000, v165
    v_pk_mul_f32 v[166:167], v[16:17], v[6:7]
    v_pk_mul_f32 v[168:169], v[18:19], v[6:7]
    v_exp_f32 v166, v166
    v_exp_f32 v167, v167
    v_exp_f32 v168, v168
    v_exp_f32 v169, v169
    v_pk_add_f32 v[166:167], v[166:167], v[12:13]
    v_pk_add_f32 v[168:169], v[168:169], v[12:13]
    v_rcp_f32 v166, v166
    v_rcp_f32 v167, v167
    v_rcp_f32 v168, v168
    v_rcp_f32 v169, v169
    v_pk_mul_f32 v[166:167], v[166:167], v[16:17]
    v_pk_mul_f32 v[168:169], v[168:169], v[18:19]
    v_cvt_pk_bf16_f32 v164, v166, v167
    v_cvt_pk_bf16_f32 v165, v168, v169
    v_lshlrev_b32 v166, 16, v164
    v_and_b32 v167, 0xffff0000, v164
    v_lshlrev_b32 v168, 16, v165
    v_and_b32 v169, 0xffff0000, v165
    v_lshlrev_b32 v170, 16, v92
    v_and_b32 v171, 0xffff0000, v92
    v_lshlrev_b32 v174, 16, v108
    v_and_b32 v175, 0xffff0000, v108
    v_lshlrev_b32 v172, 16, v93
    v_and_b32 v173, 0xffff0000, v93
    v_lshlrev_b32 v176, 16, v109
    v_and_b32 v177, 0xffff0000, v109
    v_pk_add_f32 v[170:171], v[170:171], v[174:175]
    v_pk_add_f32 v[172:173], v[172:173], v[176:177]
    v_cvt_pk_bf16_f32 v164, v170, v171
    v_cvt_pk_bf16_f32 v165, v172, v173
    v_lshlrev_b32 v170, 16, v164
    v_and_b32 v171, 0xffff0000, v164
    v_lshlrev_b32 v172, 16, v165
    v_and_b32 v173, 0xffff0000, v165
    v_pk_mul_f32 v[166:167], v[166:167], v[170:171]
    v_pk_mul_f32 v[168:169], v[168:169], v[172:173]
    v_cvt_pk_bf16_f32 v196, v166, v167
    v_cvt_pk_bf16_f32 v197, v168, v169
    v_cvt_pk_bf16_f32 v180, v24, v25
    v_cvt_pk_bf16_f32 v181, v26, v27
    v_lshlrev_b32 v24, 16, v180
    v_and_b32 v25, 0xffff0000, v180
    v_lshlrev_b32 v26, 16, v181
    v_and_b32 v27, 0xffff0000, v181
    v_pk_mul_f32 v[182:183], v[24:25], v[6:7]
    v_pk_mul_f32 v[184:185], v[26:27], v[6:7]
    v_exp_f32 v182, v182
    v_exp_f32 v183, v183
    v_exp_f32 v184, v184
    v_exp_f32 v185, v185
    v_pk_add_f32 v[182:183], v[182:183], v[12:13]
    v_pk_add_f32 v[184:185], v[184:185], v[12:13]
    v_rcp_f32 v182, v182
    v_rcp_f32 v183, v183
    v_rcp_f32 v184, v184
    v_rcp_f32 v185, v185
    v_pk_mul_f32 v[182:183], v[182:183], v[24:25]
    v_pk_mul_f32 v[184:185], v[184:185], v[26:27]
    v_cvt_pk_bf16_f32 v180, v182, v183
    v_cvt_pk_bf16_f32 v181, v184, v185
    v_lshlrev_b32 v182, 16, v180
    v_and_b32 v183, 0xffff0000, v180
    v_lshlrev_b32 v184, 16, v181
    v_and_b32 v185, 0xffff0000, v181
    v_lshlrev_b32 v186, 16, v94
    v_and_b32 v187, 0xffff0000, v94
    v_lshlrev_b32 v190, 16, v110
    v_and_b32 v191, 0xffff0000, v110
    v_lshlrev_b32 v188, 16, v95
    v_and_b32 v189, 0xffff0000, v95
    v_lshlrev_b32 v192, 16, v111
    v_and_b32 v193, 0xffff0000, v111
    v_pk_add_f32 v[186:187], v[186:187], v[190:191]
    v_pk_add_f32 v[188:189], v[188:189], v[192:193]
    v_cvt_pk_bf16_f32 v180, v186, v187
    v_cvt_pk_bf16_f32 v181, v188, v189
    v_lshlrev_b32 v186, 16, v180
    v_and_b32 v187, 0xffff0000, v180
    v_lshlrev_b32 v188, 16, v181
    v_and_b32 v189, 0xffff0000, v181
    v_pk_mul_f32 v[182:183], v[182:183], v[186:187]
    v_pk_mul_f32 v[184:185], v[184:185], v[188:189]
    v_cvt_pk_bf16_f32 v198, v182, v183
    v_cvt_pk_bf16_f32 v199, v184, v185
    s_nop 0
    v_permlane32_swap_b32 v196, v198
    v_permlane32_swap_b32 v197, v199
    s_nop 0
    v_permlane16_swap_b32 v196, v198
    v_permlane16_swap_b32 v197, v199
    v_accvgpr_read_b32 v188, a240
    v_accvgpr_read_b32 v189, a241
    v_accvgpr_read_b32 v190, a242
    v_accvgpr_read_b32 v191, a243
    v_lshlrev_b32 v164, 16, v196
    v_and_b32 v165, 0xffff0000, v196
    v_lshlrev_b32 v172, 16, v188
    v_and_b32 v173, 0xffff0000, v188
    v_lshlrev_b32 v166, 16, v197
    v_and_b32 v167, 0xffff0000, v197
    v_lshlrev_b32 v174, 16, v189
    v_and_b32 v175, 0xffff0000, v189
    v_lshlrev_b32 v168, 16, v198
    v_and_b32 v169, 0xffff0000, v198
    v_lshlrev_b32 v176, 16, v190
    v_and_b32 v177, 0xffff0000, v190
    v_lshlrev_b32 v170, 16, v199
    v_and_b32 v171, 0xffff0000, v199
    v_lshlrev_b32 v178, 16, v191
    v_and_b32 v179, 0xffff0000, v191
    v_pk_add_f32 v[164:165], v[164:165], v[172:173]
    v_pk_add_f32 v[166:167], v[166:167], v[174:175]
    v_pk_add_f32 v[168:169], v[168:169], v[176:177]
    v_pk_add_f32 v[170:171], v[170:171], v[178:179]
    v_cvt_pk_bf16_f32 v196, v164, v165
    v_cvt_pk_bf16_f32 v197, v166, v167
    v_cvt_pk_bf16_f32 v198, v168, v169
    v_cvt_pk_bf16_f32 v199, v170, v171
    buffer_store_dwordx4 v[196:199], v4, s[92:95], s48 offen offset:0 nt
    v_cvt_pk_bf16_f32 v164, v32, v33
    v_cvt_pk_bf16_f32 v165, v34, v35
    v_lshlrev_b32 v32, 16, v164
    v_and_b32 v33, 0xffff0000, v164
    v_lshlrev_b32 v34, 16, v165
    v_and_b32 v35, 0xffff0000, v165
    v_pk_mul_f32 v[166:167], v[32:33], v[6:7]
    v_pk_mul_f32 v[168:169], v[34:35], v[6:7]
    v_exp_f32 v166, v166
    v_exp_f32 v167, v167
    v_exp_f32 v168, v168
    v_exp_f32 v169, v169
    v_pk_add_f32 v[166:167], v[166:167], v[12:13]
    v_pk_add_f32 v[168:169], v[168:169], v[12:13]
    v_rcp_f32 v166, v166
    v_rcp_f32 v167, v167
    v_rcp_f32 v168, v168
    v_rcp_f32 v169, v169
    v_pk_mul_f32 v[166:167], v[166:167], v[32:33]
    v_pk_mul_f32 v[168:169], v[168:169], v[34:35]
    v_cvt_pk_bf16_f32 v164, v166, v167
    v_cvt_pk_bf16_f32 v165, v168, v169
    v_lshlrev_b32 v166, 16, v164
    v_and_b32 v167, 0xffff0000, v164
    v_lshlrev_b32 v168, 16, v165
    v_and_b32 v169, 0xffff0000, v165
    v_lshlrev_b32 v170, 16, v96
    v_and_b32 v171, 0xffff0000, v96
    v_lshlrev_b32 v174, 16, v112
    v_and_b32 v175, 0xffff0000, v112
    v_lshlrev_b32 v172, 16, v97
    v_and_b32 v173, 0xffff0000, v97
    v_lshlrev_b32 v176, 16, v113
    v_and_b32 v177, 0xffff0000, v113
    v_pk_add_f32 v[170:171], v[170:171], v[174:175]
    v_pk_add_f32 v[172:173], v[172:173], v[176:177]
    v_cvt_pk_bf16_f32 v164, v170, v171
    v_cvt_pk_bf16_f32 v165, v172, v173
    v_lshlrev_b32 v170, 16, v164
    v_and_b32 v171, 0xffff0000, v164
    v_lshlrev_b32 v172, 16, v165
    v_and_b32 v173, 0xffff0000, v165
    v_pk_mul_f32 v[166:167], v[166:167], v[170:171]
    v_pk_mul_f32 v[168:169], v[168:169], v[172:173]
    v_cvt_pk_bf16_f32 v200, v166, v167
    v_cvt_pk_bf16_f32 v201, v168, v169
    v_cvt_pk_bf16_f32 v180, v40, v41
    v_cvt_pk_bf16_f32 v181, v42, v43
    v_lshlrev_b32 v40, 16, v180
    v_and_b32 v41, 0xffff0000, v180
    v_lshlrev_b32 v42, 16, v181
    v_and_b32 v43, 0xffff0000, v181
    v_pk_mul_f32 v[182:183], v[40:41], v[6:7]
    v_pk_mul_f32 v[184:185], v[42:43], v[6:7]
    v_exp_f32 v182, v182
    v_exp_f32 v183, v183
    v_exp_f32 v184, v184
    v_exp_f32 v185, v185
    v_pk_add_f32 v[182:183], v[182:183], v[12:13]
    v_pk_add_f32 v[184:185], v[184:185], v[12:13]
    v_rcp_f32 v182, v182
    v_rcp_f32 v183, v183
    v_rcp_f32 v184, v184
    v_rcp_f32 v185, v185
    v_pk_mul_f32 v[182:183], v[182:183], v[40:41]
    v_pk_mul_f32 v[184:185], v[184:185], v[42:43]
    v_cvt_pk_bf16_f32 v180, v182, v183
    v_cvt_pk_bf16_f32 v181, v184, v185
    v_lshlrev_b32 v182, 16, v180
    v_and_b32 v183, 0xffff0000, v180
    v_lshlrev_b32 v184, 16, v181
    v_and_b32 v185, 0xffff0000, v181
    v_lshlrev_b32 v186, 16, v98
    v_and_b32 v187, 0xffff0000, v98
    v_lshlrev_b32 v190, 16, v114
    v_and_b32 v191, 0xffff0000, v114
    v_lshlrev_b32 v188, 16, v99
    v_and_b32 v189, 0xffff0000, v99
    v_lshlrev_b32 v192, 16, v115
    v_and_b32 v193, 0xffff0000, v115
    v_pk_add_f32 v[186:187], v[186:187], v[190:191]
    v_pk_add_f32 v[188:189], v[188:189], v[192:193]
    v_cvt_pk_bf16_f32 v180, v186, v187
    v_cvt_pk_bf16_f32 v181, v188, v189
    v_lshlrev_b32 v186, 16, v180
    v_and_b32 v187, 0xffff0000, v180
    v_lshlrev_b32 v188, 16, v181
    v_and_b32 v189, 0xffff0000, v181
    v_pk_mul_f32 v[182:183], v[182:183], v[186:187]
    v_pk_mul_f32 v[184:185], v[184:185], v[188:189]
    v_cvt_pk_bf16_f32 v202, v182, v183
    v_cvt_pk_bf16_f32 v203, v184, v185
    s_nop 0
    v_permlane32_swap_b32 v200, v202
    v_permlane32_swap_b32 v201, v203
    s_nop 0
    v_permlane16_swap_b32 v200, v202
    v_permlane16_swap_b32 v201, v203
    v_accvgpr_read_b32 v188, a244
    v_accvgpr_read_b32 v189, a245
    v_accvgpr_read_b32 v190, a246
    v_accvgpr_read_b32 v191, a247
    v_lshlrev_b32 v164, 16, v200
    v_and_b32 v165, 0xffff0000, v200
    v_lshlrev_b32 v172, 16, v188
    v_and_b32 v173, 0xffff0000, v188
    v_lshlrev_b32 v166, 16, v201
    v_and_b32 v167, 0xffff0000, v201
    v_lshlrev_b32 v174, 16, v189
    v_and_b32 v175, 0xffff0000, v189
    v_lshlrev_b32 v168, 16, v202
    v_and_b32 v169, 0xffff0000, v202
    v_lshlrev_b32 v176, 16, v190
    v_and_b32 v177, 0xffff0000, v190
    v_lshlrev_b32 v170, 16, v203
    v_and_b32 v171, 0xffff0000, v203
    v_lshlrev_b32 v178, 16, v191
    v_and_b32 v179, 0xffff0000, v191
    v_pk_add_f32 v[164:165], v[164:165], v[172:173]
    v_pk_add_f32 v[166:167], v[166:167], v[174:175]
    v_pk_add_f32 v[168:169], v[168:169], v[176:177]
    v_pk_add_f32 v[170:171], v[170:171], v[178:179]
    v_cvt_pk_bf16_f32 v200, v164, v165
    v_cvt_pk_bf16_f32 v201, v166, v167
    v_cvt_pk_bf16_f32 v202, v168, v169
    v_cvt_pk_bf16_f32 v203, v170, v171
    buffer_store_dwordx4 v[200:203], v4, s[92:95], s48 offen offset:64 nt
    v_cvt_pk_bf16_f32 v164, v20, v21
    v_cvt_pk_bf16_f32 v165, v22, v23
    v_lshlrev_b32 v20, 16, v164
    v_and_b32 v21, 0xffff0000, v164
    v_lshlrev_b32 v22, 16, v165
    v_and_b32 v23, 0xffff0000, v165
    v_pk_mul_f32 v[166:167], v[20:21], v[6:7]
    v_pk_mul_f32 v[168:169], v[22:23], v[6:7]
    v_exp_f32 v166, v166
    v_exp_f32 v167, v167
    v_exp_f32 v168, v168
    v_exp_f32 v169, v169
    v_pk_add_f32 v[166:167], v[166:167], v[12:13]
    v_pk_add_f32 v[168:169], v[168:169], v[12:13]
    v_rcp_f32 v166, v166
    v_rcp_f32 v167, v167
    v_rcp_f32 v168, v168
    v_rcp_f32 v169, v169
    v_pk_mul_f32 v[166:167], v[166:167], v[20:21]
    v_pk_mul_f32 v[168:169], v[168:169], v[22:23]
    v_cvt_pk_bf16_f32 v164, v166, v167
    v_cvt_pk_bf16_f32 v165, v168, v169
    v_lshlrev_b32 v166, 16, v164
    v_and_b32 v167, 0xffff0000, v164
    v_lshlrev_b32 v168, 16, v165
    v_and_b32 v169, 0xffff0000, v165
    v_lshlrev_b32 v170, 16, v100
    v_and_b32 v171, 0xffff0000, v100
    v_lshlrev_b32 v174, 16, v116
    v_and_b32 v175, 0xffff0000, v116
    v_lshlrev_b32 v172, 16, v101
    v_and_b32 v173, 0xffff0000, v101
    v_lshlrev_b32 v176, 16, v117
    v_and_b32 v177, 0xffff0000, v117
    v_pk_add_f32 v[170:171], v[170:171], v[174:175]
    v_pk_add_f32 v[172:173], v[172:173], v[176:177]
    v_cvt_pk_bf16_f32 v164, v170, v171
    v_cvt_pk_bf16_f32 v165, v172, v173
    v_lshlrev_b32 v170, 16, v164
    v_and_b32 v171, 0xffff0000, v164
    v_lshlrev_b32 v172, 16, v165
    v_and_b32 v173, 0xffff0000, v165
    v_pk_mul_f32 v[166:167], v[166:167], v[170:171]
    v_pk_mul_f32 v[168:169], v[168:169], v[172:173]
    v_cvt_pk_bf16_f32 v204, v166, v167
    v_cvt_pk_bf16_f32 v205, v168, v169
    v_cvt_pk_bf16_f32 v180, v28, v29
    v_cvt_pk_bf16_f32 v181, v30, v31
    v_lshlrev_b32 v28, 16, v180
    v_and_b32 v29, 0xffff0000, v180
    v_lshlrev_b32 v30, 16, v181
    v_and_b32 v31, 0xffff0000, v181
    v_pk_mul_f32 v[182:183], v[28:29], v[6:7]
    v_pk_mul_f32 v[184:185], v[30:31], v[6:7]
    v_exp_f32 v182, v182
    v_exp_f32 v183, v183
    v_exp_f32 v184, v184
    v_exp_f32 v185, v185
    v_pk_add_f32 v[182:183], v[182:183], v[12:13]
    v_pk_add_f32 v[184:185], v[184:185], v[12:13]
    v_rcp_f32 v182, v182
    v_rcp_f32 v183, v183
    v_rcp_f32 v184, v184
    v_rcp_f32 v185, v185
    v_pk_mul_f32 v[182:183], v[182:183], v[28:29]
    v_pk_mul_f32 v[184:185], v[184:185], v[30:31]
    v_cvt_pk_bf16_f32 v180, v182, v183
    v_cvt_pk_bf16_f32 v181, v184, v185
    v_lshlrev_b32 v182, 16, v180
    v_and_b32 v183, 0xffff0000, v180
    v_lshlrev_b32 v184, 16, v181
    v_and_b32 v185, 0xffff0000, v181
    v_lshlrev_b32 v186, 16, v102
    v_and_b32 v187, 0xffff0000, v102
    v_lshlrev_b32 v190, 16, v118
    v_and_b32 v191, 0xffff0000, v118
    v_lshlrev_b32 v188, 16, v103
    v_and_b32 v189, 0xffff0000, v103
    v_lshlrev_b32 v192, 16, v119
    v_and_b32 v193, 0xffff0000, v119
    v_pk_add_f32 v[186:187], v[186:187], v[190:191]
    v_pk_add_f32 v[188:189], v[188:189], v[192:193]
    v_cvt_pk_bf16_f32 v180, v186, v187
    v_cvt_pk_bf16_f32 v181, v188, v189
    v_lshlrev_b32 v186, 16, v180
    v_and_b32 v187, 0xffff0000, v180
    v_lshlrev_b32 v188, 16, v181
    v_and_b32 v189, 0xffff0000, v181
    v_pk_mul_f32 v[182:183], v[182:183], v[186:187]
    v_pk_mul_f32 v[184:185], v[184:185], v[188:189]
    v_cvt_pk_bf16_f32 v206, v182, v183
    v_cvt_pk_bf16_f32 v207, v184, v185
    s_nop 0
    v_permlane32_swap_b32 v204, v206
    v_permlane32_swap_b32 v205, v207
    s_nop 0
    v_permlane16_swap_b32 v204, v206
    v_permlane16_swap_b32 v205, v207
    v_accvgpr_read_b32 v188, a248
    v_accvgpr_read_b32 v189, a249
    v_accvgpr_read_b32 v190, a250
    v_accvgpr_read_b32 v191, a251
    v_lshlrev_b32 v164, 16, v204
    v_and_b32 v165, 0xffff0000, v204
    v_lshlrev_b32 v172, 16, v188
    v_and_b32 v173, 0xffff0000, v188
    v_lshlrev_b32 v166, 16, v205
    v_and_b32 v167, 0xffff0000, v205
    v_lshlrev_b32 v174, 16, v189
    v_and_b32 v175, 0xffff0000, v189
    v_lshlrev_b32 v168, 16, v206
    v_and_b32 v169, 0xffff0000, v206
    v_lshlrev_b32 v176, 16, v190
    v_and_b32 v177, 0xffff0000, v190
    v_lshlrev_b32 v170, 16, v207
    v_and_b32 v171, 0xffff0000, v207
    v_lshlrev_b32 v178, 16, v191
    v_and_b32 v179, 0xffff0000, v191
    v_pk_add_f32 v[164:165], v[164:165], v[172:173]
    v_pk_add_f32 v[166:167], v[166:167], v[174:175]
    v_pk_add_f32 v[168:169], v[168:169], v[176:177]
    v_pk_add_f32 v[170:171], v[170:171], v[178:179]
    v_cvt_pk_bf16_f32 v204, v164, v165
    v_cvt_pk_bf16_f32 v205, v166, v167
    v_cvt_pk_bf16_f32 v206, v168, v169
    v_cvt_pk_bf16_f32 v207, v170, v171
    buffer_store_dwordx4 v[204:207], v4, s[92:95], s49 offen offset:0 nt
    v_cvt_pk_bf16_f32 v164, v36, v37
    v_cvt_pk_bf16_f32 v165, v38, v39
    v_lshlrev_b32 v36, 16, v164
    v_and_b32 v37, 0xffff0000, v164
    v_lshlrev_b32 v38, 16, v165
    v_and_b32 v39, 0xffff0000, v165
    v_pk_mul_f32 v[166:167], v[36:37], v[6:7]
    v_pk_mul_f32 v[168:169], v[38:39], v[6:7]
    v_exp_f32 v166, v166
    v_exp_f32 v167, v167
    v_exp_f32 v168, v168
    v_exp_f32 v169, v169
    v_pk_add_f32 v[166:167], v[166:167], v[12:13]
    v_pk_add_f32 v[168:169], v[168:169], v[12:13]
    v_rcp_f32 v166, v166
    v_rcp_f32 v167, v167
    v_rcp_f32 v168, v168
    v_rcp_f32 v169, v169
    v_pk_mul_f32 v[166:167], v[166:167], v[36:37]
    v_pk_mul_f32 v[168:169], v[168:169], v[38:39]
    v_cvt_pk_bf16_f32 v164, v166, v167
    v_cvt_pk_bf16_f32 v165, v168, v169
    v_lshlrev_b32 v166, 16, v164
    v_and_b32 v167, 0xffff0000, v164
    v_lshlrev_b32 v168, 16, v165
    v_and_b32 v169, 0xffff0000, v165
    v_lshlrev_b32 v170, 16, v104
    v_and_b32 v171, 0xffff0000, v104
    v_lshlrev_b32 v174, 16, v120
    v_and_b32 v175, 0xffff0000, v120
    v_lshlrev_b32 v172, 16, v105
    v_and_b32 v173, 0xffff0000, v105
    v_lshlrev_b32 v176, 16, v121
    v_and_b32 v177, 0xffff0000, v121
    v_pk_add_f32 v[170:171], v[170:171], v[174:175]
    v_pk_add_f32 v[172:173], v[172:173], v[176:177]
    v_cvt_pk_bf16_f32 v164, v170, v171
    v_cvt_pk_bf16_f32 v165, v172, v173
    v_lshlrev_b32 v170, 16, v164
    v_and_b32 v171, 0xffff0000, v164
    v_lshlrev_b32 v172, 16, v165
    v_and_b32 v173, 0xffff0000, v165
    v_pk_mul_f32 v[166:167], v[166:167], v[170:171]
    v_pk_mul_f32 v[168:169], v[168:169], v[172:173]
    v_cvt_pk_bf16_f32 v208, v166, v167
    v_cvt_pk_bf16_f32 v209, v168, v169
    v_cvt_pk_bf16_f32 v180, v44, v45
    v_cvt_pk_bf16_f32 v181, v46, v47
    v_lshlrev_b32 v44, 16, v180
    v_and_b32 v45, 0xffff0000, v180
    v_lshlrev_b32 v46, 16, v181
    v_and_b32 v47, 0xffff0000, v181
    v_pk_mul_f32 v[182:183], v[44:45], v[6:7]
    v_pk_mul_f32 v[184:185], v[46:47], v[6:7]
    v_exp_f32 v182, v182
    v_exp_f32 v183, v183
    v_exp_f32 v184, v184
    v_exp_f32 v185, v185
    v_pk_add_f32 v[182:183], v[182:183], v[12:13]
    v_pk_add_f32 v[184:185], v[184:185], v[12:13]
    v_rcp_f32 v182, v182
    v_rcp_f32 v183, v183
    v_rcp_f32 v184, v184
    v_rcp_f32 v185, v185
    v_pk_mul_f32 v[182:183], v[182:183], v[44:45]
    v_pk_mul_f32 v[184:185], v[184:185], v[46:47]
    v_cvt_pk_bf16_f32 v180, v182, v183
    v_cvt_pk_bf16_f32 v181, v184, v185
    v_lshlrev_b32 v182, 16, v180
    v_and_b32 v183, 0xffff0000, v180
    v_lshlrev_b32 v184, 16, v181
    v_and_b32 v185, 0xffff0000, v181
    v_lshlrev_b32 v186, 16, v106
    v_and_b32 v187, 0xffff0000, v106
    v_lshlrev_b32 v190, 16, v122
    v_and_b32 v191, 0xffff0000, v122
    v_lshlrev_b32 v188, 16, v107
    v_and_b32 v189, 0xffff0000, v107
    v_lshlrev_b32 v192, 16, v123
    v_and_b32 v193, 0xffff0000, v123
    v_pk_add_f32 v[186:187], v[186:187], v[190:191]
    v_pk_add_f32 v[188:189], v[188:189], v[192:193]
    v_cvt_pk_bf16_f32 v180, v186, v187
    v_cvt_pk_bf16_f32 v181, v188, v189
    v_lshlrev_b32 v186, 16, v180
    v_and_b32 v187, 0xffff0000, v180
    v_lshlrev_b32 v188, 16, v181
    v_and_b32 v189, 0xffff0000, v181
    v_pk_mul_f32 v[182:183], v[182:183], v[186:187]
    v_pk_mul_f32 v[184:185], v[184:185], v[188:189]
    v_cvt_pk_bf16_f32 v210, v182, v183
    v_cvt_pk_bf16_f32 v211, v184, v185
    s_nop 0
    v_permlane32_swap_b32 v208, v210
    v_permlane32_swap_b32 v209, v211
    s_nop 0
    v_permlane16_swap_b32 v208, v210
    v_permlane16_swap_b32 v209, v211
    v_accvgpr_read_b32 v188, a252
    v_accvgpr_read_b32 v189, a253
    v_accvgpr_read_b32 v190, a254
    v_accvgpr_read_b32 v191, a255
    v_lshlrev_b32 v164, 16, v208
    v_and_b32 v165, 0xffff0000, v208
    v_lshlrev_b32 v172, 16, v188
    v_and_b32 v173, 0xffff0000, v188
    v_lshlrev_b32 v166, 16, v209
    v_and_b32 v167, 0xffff0000, v209
    v_lshlrev_b32 v174, 16, v189
    v_and_b32 v175, 0xffff0000, v189
    v_lshlrev_b32 v168, 16, v210
    v_and_b32 v169, 0xffff0000, v210
    v_lshlrev_b32 v176, 16, v190
    v_and_b32 v177, 0xffff0000, v190
    v_lshlrev_b32 v170, 16, v211
    v_and_b32 v171, 0xffff0000, v211
    v_lshlrev_b32 v178, 16, v191
    v_and_b32 v179, 0xffff0000, v191
    v_pk_add_f32 v[164:165], v[164:165], v[172:173]
    v_pk_add_f32 v[166:167], v[166:167], v[174:175]
    v_pk_add_f32 v[168:169], v[168:169], v[176:177]
    v_pk_add_f32 v[170:171], v[170:171], v[178:179]
    v_cvt_pk_bf16_f32 v208, v164, v165
    v_cvt_pk_bf16_f32 v209, v166, v167
    v_cvt_pk_bf16_f32 v210, v168, v169
    v_cvt_pk_bf16_f32 v211, v170, v171
    buffer_store_dwordx4 v[208:211], v4, s[92:95], s49 offen offset:64 nt
f_end:
    s_endpgm
f_code_end:
.section .rodata,"a"
.p2align 6
.amdhsa_kernel recurrent_scan__mha_block_cached__mixer_gmlp__prompt_kernel
  .amdhsa_next_free_vgpr 512
  .amdhsa_next_free_sgpr 102
  .amdhsa_accum_offset 256
  .amdhsa_group_segment_fixed_size 0
  .amdhsa_kernarg_size 104
  .amdhsa_user_sgpr_count 2
  .amdhsa_user_sgpr_kernarg_segment_ptr 1
  .amdhsa_system_sgpr_workgroup_id_x 1
  .amdhsa_float_denorm_mode_32 3
  .amdhsa_float_denorm_mode_16_64 3
.end_amdhsa_kernel
```
